```python
import torch

def _softmax(x, axis=-1):
    return torch.softmax(x, dim=axis)

def _gelu(x):
    return torch.nn.functional.gelu(x, approximate='tanh')

def _silu(x):
    return torch.nn.functional.silu(x)

def _sigmoid(x):
    return torch.sigmoid(x)

def _layernorm(x, axis=-1, eps=1e-05):
    m = x.mean(dim=axis, keepdim=True)
    v = x.var(dim=axis, keepdim=True, unbiased=False)
    return (x - m) / torch.sqrt(v + eps)

def _scatter_add(tgt, idx, src, axis=0):
    return tgt.clone().index_add_(axis, idx, src)

def _segment_sum(src, seg, n):
    out = torch.zeros((n,) + src.shape[1:], dtype=src.dtype)
    return out.index_add_(0, seg, src)

def _pad(x, pw):
    flat = tuple((v for pair in reversed(pw) for v in pair))
    return torch.nn.functional.pad(x, flat)
kernel_name = 'parallel_sum__memory_aug_recurrent_mem_tr__mixer_token_mlp__prompt'

def setup_inputs():

    _w = lambda a: (lambda t: t.to(torch.bfloat16) if t.is_floating_point() else t)(torch.as_tensor(a))

    def _A_setup():
        B, S, Dm = (1, 2048, 512)
        H, Dh = (32, 128)
        M, seg = (8, 32)
        seg = min(seg, S)
        S = S // seg * seg
        return {'x': _w((lambda *s: torch.randn(*s, dtype=torch.bfloat16) * 0.05)(B, S, Dm)), 'mem0': _w((lambda *s: torch.randn(*s, dtype=torch.bfloat16) * 0.2)(B, M, Dm)), 'Wq': _w((lambda *s: torch.randn(*s, dtype=torch.bfloat16) * 1.6)(Dm, H, Dh) * Dm ** (-0.5)), 'Wk': _w((lambda *s: torch.randn(*s, dtype=torch.bfloat16) * 1.6)(Dm, H, Dh) * Dm ** (-0.5)), 'Wv': _w((lambda *s: torch.randn(*s, dtype=torch.bfloat16) * 0.2)(Dm, H, Dh) * Dm ** (-0.5)), 'Wo': _w((lambda *s: torch.randn(*s, dtype=torch.bfloat16) * 0.2)(H, Dh, Dm) * (H * Dh) ** (-0.5)), 'seg_len': seg}
    _A_in = _A_setup()

    def _B_setup():
        B, S, D, F = (1, 2048, 512, 1792)
        return {'x': _w((lambda *s: torch.randn(*s, dtype=torch.bfloat16) * 0.05)(B, S, D)), 'w1': _w((lambda *s: torch.randn(*s, dtype=torch.bfloat16) * 0.4)(S, F) * S ** (-0.5)), 'b1': _w((lambda *s: torch.randn(*s, dtype=torch.bfloat16) * 3.2)(F) * 0.02), 'w2': _w((lambda *s: torch.randn(*s, dtype=torch.bfloat16) * 0.2)(F, S) * F ** (-0.5)), 'b2': _w((lambda *s: torch.randn(*s, dtype=torch.bfloat16) * 0.4)(S) * 0.02)}
    _B_in = _B_setup()
    return {'A_x': _A_in['x'], 'A_mem0': _A_in['mem0'], 'A_Wq': _A_in['Wq'], 'A_Wk': _A_in['Wk'], 'A_Wv': _A_in['Wv'], 'A_Wo': _A_in['Wo'], 'A_seg_len': _A_in['seg_len'], 'B_x': _B_in['x'], 'B_w1': _B_in['w1'], 'B_b1': _B_in['b1'], 'B_w2': _B_in['w2'], 'B_b2': _B_in['b2']}

def reference(A_x, A_mem0, A_Wq, A_Wk, A_Wv, A_Wo, A_seg_len, B_x, B_w1, B_b1, B_w2, B_b2):

    def _A_ref(x, mem0, Wq, Wk, Wv, Wo, seg_len):
        B, S, Dm = x.shape
        H, Dh = (Wq.shape[1], Wq.shape[2])
        M = mem0.shape[1]
        scale = Dh ** (-0.5)
        n_seg = S // seg_len
        L = M + seg_len
        idx = torch.arange(L)
        mask = (idx[:, None] < M) | (idx[:, None] >= idx[None, :])
        mem = mem0
        outs = []
        for s in range(n_seg):
            xs = x[:, s * seg_len:(s + 1) * seg_len, :].clone()
            h = torch.concatenate([mem, xs], axis=1)
            q = torch.einsum('btd,dhe->bhte', h, Wq)
            k = torch.einsum('btd,dhe->bhte', h, Wk)
            v = torch.einsum('btd,dhe->bhte', h, Wv)
            scores = torch.einsum('bhqe,bhke->bhqk', q, k) * scale
            scores = torch.where(mask[None, None], scores, -1000000000.0)
            p = _softmax(scores, axis=-1)
            o = torch.einsum('bhqk,bhke->bhqe', p, v)
            o = torch.einsum('bhte,hed->btd', o, Wo)
            mem = o[:, :M, :].clone()
            outs.append(o[:, M:, :])
        return torch.concatenate(outs, axis=1)

    def _B_ref(x, w1, b1, w2, b2):
        B, S, D = x.shape
        h = _layernorm(x, axis=-1)
        u = torch.einsum('bsd,sf->bdf', h, w1) + b1
        u = _gelu(u)
        y = torch.einsum('bdf,fs->bds', u, w2) + b2
        return (lambda x, *d: x.permute(*d))(y, 0, 2, 1)
    x = A_x
    xn = _layernorm(x, axis=-1)
    return x + _A_ref(xn, A_mem0, A_Wq, A_Wk, A_Wv, A_Wo, A_seg_len) + _B_ref(xn, B_w1, B_b1, B_w2, B_b2)
```

```asm
; @launch grid=(256,1,1) block=(256,1,1) lds=163840
.amdgcn_target "amdgcn-amd-amdhsa--gfx950"
.text
.globl parallel_sum__memory_aug_recurrent_mem_tr__mixer_token_mlp__prompt_kernel
.p2align 8
.type parallel_sum__memory_aug_recurrent_mem_tr__mixer_token_mlp__prompt_kernel,@function
parallel_sum__memory_aug_recurrent_mem_tr__mixer_token_mlp__prompt_kernel:
    s_cmp_ge_u32 s2, 256
    s_cbranch_scc1 L_end
    s_load_dwordx16 s[56:71], s[0:1], 0
    s_load_dwordx8 s[72:79], s[0:1], 64
    s_load_dwordx4 s[80:83], s[0:1], 96
    s_load_dwordx2 s[84:85], s[0:1], 112
    s_waitcnt lgkmcnt(0)
    s_mov_b32 s28, s56
    s_mov_b32 s29, s57
    s_mov_b32 s30, 0x200000
    s_mov_b32 s31, 0x20000
    s_mov_b32 s32, s58
    s_mov_b32 s33, s59
    s_mov_b32 s34, 0x2000
    s_mov_b32 s35, 0x20000
    s_mov_b32 s12, s60
    s_mov_b32 s13, s61
    s_mov_b32 s14, 0x400000
    s_mov_b32 s15, 0x20000
    s_mov_b32 s16, s62
    s_mov_b32 s17, s63
    s_mov_b32 s18, 0x400000
    s_mov_b32 s19, 0x20000
    s_mov_b32 s20, s64
    s_mov_b32 s21, s65
    s_mov_b32 s22, 0x400000
    s_mov_b32 s23, 0x20000
    s_mov_b32 s24, s66
    s_mov_b32 s25, s67
    s_mov_b32 s26, 0x400000
    s_mov_b32 s27, 0x20000
    s_mov_b32 s36, s72
    s_mov_b32 s37, s73
    s_mov_b32 s38, 0x700000
    s_mov_b32 s39, 0x20000
    s_mov_b32 s48, s74
    s_mov_b32 s49, s75
    s_mov_b32 s50, 0xe00
    s_mov_b32 s51, 0x20000
    s_mov_b32 s40, s76
    s_mov_b32 s41, s77
    s_mov_b32 s42, 0x700000
    s_mov_b32 s43, 0x20000
    s_mov_b32 s52, s78
    s_mov_b32 s53, s79
    s_mov_b32 s54, 0x1000
    s_mov_b32 s55, 0x20000
    s_mov_b32 s44, s80
    s_mov_b32 s45, s81
    s_mov_b32 s46, 0x200000
    s_mov_b32 s47, 0x20000
    s_mov_b32 s4, s84
    s_mov_b32 s5, s85
    s_mov_b32 s6, 0x10000000
    s_mov_b32 s7, 0x20000
    s_mov_b32 s8, s82
    s_mov_b32 s9, s83
    s_mov_b32 s101, 0
    s_getreg_b32 s58, hwreg(HW_REG_XCC_ID, 0, 4)
    v_lshrrev_b32 v1, 6, v0
    v_and_b32 v2, 63, v0
    s_nop 0
    v_readfirstlane_b32 s56, v1
    s_add_u32 s58, s58, 1
    v_mov_b32 v16, 0
    s_cmp_lg_u32 s56, 0
    s_cbranch_scc1 L_role_wait
    s_cmp_ge_u32 s2, 8
    s_cbranch_scc1 L_role_wait
    v_lshlrev_b32 v8, 4, v2
    v_mov_b32 v17, 0
    v_mov_b32 v18, 0
    v_mov_b32 v19, 0
    s_lshl_b32 s61, s2, 13
    s_add_u32 s62, s61, 0x1000
    buffer_store_dwordx4 v[16:19], v8, s[4:7], s61 offen offset:0 sc1
    buffer_store_dwordx4 v[16:19], v8, s[4:7], s61 offen offset:1024 sc1
    buffer_store_dwordx4 v[16:19], v8, s[4:7], s61 offen offset:2048 sc1
    buffer_store_dwordx4 v[16:19], v8, s[4:7], s61 offen offset:3072 sc1
    buffer_store_dwordx4 v[16:19], v8, s[4:7], s62 offen offset:0 sc1
    buffer_store_dwordx4 v[16:19], v8, s[4:7], s62 offen offset:1024 sc1
    buffer_store_dwordx4 v[16:19], v8, s[4:7], s62 offen offset:2048 sc1
    buffer_store_dwordx4 v[16:19], v8, s[4:7], s62 offen offset:3072 sc1
    s_lshl_b32 s61, s2, 2
    v_mov_b32 v3, s61
    v_mov_b32 v4, 1
    s_waitcnt vmcnt(0)
    s_mov_b64 exec, 1
    global_store_dword v3, v4, s[8:9] sc1
    s_mov_b64 exec, -1
L_role_wait:
    s_lshr_b32 s60, s2, 3
    s_sub_u32 s61, s58, 1
    s_and_b32 s61, s61, 7
    s_lshl_b32 s61, s61, 5
    s_add_u32 s57, s60, s61
    s_mov_b32 s59, 0
L_dispatch:
    s_cmp_ge_u32 s57, 32
    s_cbranch_scc1 L_worker
    v_and_b32 v1, 63, v0
    v_and_b32 v2, 15, v1
    v_lshrrev_b32 v3, 4, v1
    v_lshrrev_b32 v4, 1, v3
    v_and_b32 v5, 1, v3
    v_lshrrev_b32 v6, 2, v2
    v_and_b32 v7, 3, v2
    v_lshrrev_b32 v9, 3, v2
    v_lshl_add_u32 v9, v9, 1, v4
    v_and_b32 v10, 7, v2
    v_lshl_add_u32 v8, v5, 3, v10
    v_lshlrev_b32 v8, 4, v8
    v_lshl_add_u32 v8, v9, 13, v8
    s_lshl_b32 s88, s56, 3
    s_xor_b32 s88, s88, s57
    s_xor_b32 s88, s88, 31
    v_xor_b32 v9, s88, v9
    v_lshl_add_u32 v8, v9, 8, v8
    s_lshr_b32 s88, s57, 1
    s_lshl_b32 s88, s88, 9
    s_and_b32 s89, s57, 1
    s_lshl_b32 s89, s89, 7
    s_add_u32 s88, s88, s89
    v_lshrrev_b32 v9, 3, v2
    v_lshl_add_u32 v10, v9, 1, v5
    v_lshlrev_b32 v10, 5, v10
    v_lshl_add_u32 v10, v7, 3, v10
    v_and_b32 v9, 1, v6
    v_lshl_add_u32 v10, v9, 8, v10
    v_add_u32 v10, s88, v10
    v_lshlrev_b32 v9, 1, v3
    v_xor_b32 v9, v2, v9
    v_lshlrev_b32 v9, 4, v9
    s_lshl_b32 s88, s56, 2
    v_add_u32 v13, s88, v3
    v_lshl_add_u32 v11, v13, 13, v9
    v_lshl_add_u32 v12, v13, 10, v9
    v_and_b32 v9, 1, v6
    v_lshrrev_b32 v13, 1, v6
    v_lshl_add_u32 v14, v13, 1, v5
    v_lshl_add_u32 v15, v9, 2, v14
    v_lshl_add_u32 v14, v4, 2, v14
    v_lshl_add_u32 v14, v9, 4, v14
    v_lshlrev_b32 v14, 8, v14
    v_lshl_add_u32 v14, v15, 5, v14
    s_lshl_b32 s88, s56, 6
    v_xor_b32 v14, s88, v14
    v_lshrrev_b32 v15, 1, v7
    v_lshlrev_b32 v15, 5, v15
    v_xor_b32 v1, v15, v14
    v_and_b32 v15, 1, v7
    v_lshl_add_u32 v2, v15, 3, v1
    v_lshl_add_u32 v14, v7, 3, v14
    v_lshlrev_b32 v15, 1, v5
    v_lshl_add_u32 v1, v13, 2, v15
    v_lshl_add_u32 v1, v4, 3, v1
    v_lshl_add_u32 v1, v9, 4, v1
    v_lshl_add_u32 v15, v9, 2, v15
    v_lshlrev_b32 v1, 8, v1
    v_lshl_add_u32 v1, v7, 3, v1
    v_lshl_add_u32 v13, v15, 5, v1
    v_xor_b32 v5, 128, v11
    v_xor_b32 v6, 128, v12
    s_lshl_b32 s90, s57, 8
    s_lshl_b32 s91, s57, 17
    s_lshl_b32 s92, s56, 10
    s_add_u32 m0, s92, 0x8000
    s_add_u32 s89, s91, 0x0
    buffer_load_dwordx4 v12, s[24:27], s89 offen lds
    s_add_u32 m0, s92, 0x9000
    s_add_u32 s89, s91, 0x4000
    buffer_load_dwordx4 v6, s[24:27], s89 offen lds
    s_add_u32 m0, s92, 0xa000
    s_add_u32 s89, s91, 0x8000
    buffer_load_dwordx4 v12, s[24:27], s89 offen lds
    s_add_u32 m0, s92, 0xb000
    s_add_u32 s89, s91, 0xc000
    buffer_load_dwordx4 v6, s[24:27], s89 offen lds
    s_add_u32 m0, s92, 0xc000
    s_add_u32 s89, s91, 0x100
    buffer_load_dwordx4 v12, s[24:27], s89 offen lds
    s_add_u32 m0, s92, 0xd000
    s_add_u32 s89, s91, 0x4100
    buffer_load_dwordx4 v6, s[24:27], s89 offen lds
    s_add_u32 m0, s92, 0xe000
    s_add_u32 s89, s91, 0x8100
    buffer_load_dwordx4 v12, s[24:27], s89 offen lds
    s_add_u32 m0, s92, 0xf000
    s_add_u32 s89, s91, 0xc100
    buffer_load_dwordx4 v6, s[24:27], s89 offen lds
    s_add_u32 m0, s92, 0x10000
    s_add_u32 s89, s91, 0x200
    buffer_load_dwordx4 v12, s[24:27], s89 offen lds
    s_add_u32 m0, s92, 0x11000
    s_add_u32 s89, s91, 0x4200
    buffer_load_dwordx4 v6, s[24:27], s89 offen lds
    s_add_u32 m0, s92, 0x12000
    s_add_u32 s89, s91, 0x8200
    buffer_load_dwordx4 v12, s[24:27], s89 offen lds
    s_add_u32 m0, s92, 0x13000
    s_add_u32 s89, s91, 0xc200
    buffer_load_dwordx4 v6, s[24:27], s89 offen lds
    s_add_u32 m0, s92, 0x14000
    s_add_u32 s89, s91, 0x300
    buffer_load_dwordx4 v12, s[24:27], s89 offen lds
    s_add_u32 m0, s92, 0x15000
    s_add_u32 s89, s91, 0x4300
    buffer_load_dwordx4 v6, s[24:27], s89 offen lds
    s_add_u32 m0, s92, 0x16000
    s_add_u32 s89, s91, 0x8300
    buffer_load_dwordx4 v12, s[24:27], s89 offen lds
    s_add_u32 m0, s92, 0x17000
    s_add_u32 s89, s91, 0xc300
    buffer_load_dwordx4 v6, s[24:27], s89 offen lds
    s_add_u32 m0, s92, 0x18000
    s_add_u32 s89, s91, 0x10000
    buffer_load_dwordx4 v12, s[24:27], s89 offen lds
    s_add_u32 m0, s92, 0x19000
    s_add_u32 s89, s91, 0x14000
    buffer_load_dwordx4 v6, s[24:27], s89 offen lds
    s_add_u32 m0, s92, 0x1a000
    s_add_u32 s89, s91, 0x18000
    buffer_load_dwordx4 v12, s[24:27], s89 offen lds
    s_add_u32 m0, s92, 0x1b000
    s_add_u32 s89, s91, 0x1c000
    buffer_load_dwordx4 v6, s[24:27], s89 offen lds
    s_add_u32 m0, s92, 0x1c000
    s_add_u32 s89, s91, 0x10100
    buffer_load_dwordx4 v12, s[24:27], s89 offen lds
    s_add_u32 m0, s92, 0x1d000
    s_add_u32 s89, s91, 0x14100
    buffer_load_dwordx4 v6, s[24:27], s89 offen lds
    s_add_u32 m0, s92, 0x1e000
    s_add_u32 s89, s91, 0x18100
    buffer_load_dwordx4 v12, s[24:27], s89 offen lds
    s_add_u32 m0, s92, 0x1f000
    s_add_u32 s89, s91, 0x1c100
    buffer_load_dwordx4 v6, s[24:27], s89 offen lds
    s_add_u32 m0, s92, 0x20000
    s_add_u32 s89, s91, 0x10200
    buffer_load_dwordx4 v12, s[24:27], s89 offen lds
    s_add_u32 m0, s92, 0x21000
    s_add_u32 s89, s91, 0x14200
    buffer_load_dwordx4 v6, s[24:27], s89 offen lds
    s_add_u32 m0, s92, 0x22000
    s_add_u32 s89, s91, 0x18200
    buffer_load_dwordx4 v12, s[24:27], s89 offen lds
    s_add_u32 m0, s92, 0x23000
    s_add_u32 s89, s91, 0x1c200
    buffer_load_dwordx4 v6, s[24:27], s89 offen lds
    s_add_u32 m0, s92, 0x24000
    s_add_u32 s89, s91, 0x10300
    buffer_load_dwordx4 v12, s[24:27], s89 offen lds
    s_add_u32 m0, s92, 0x25000
    s_add_u32 s89, s91, 0x14300
    buffer_load_dwordx4 v6, s[24:27], s89 offen lds
    s_add_u32 m0, s92, 0x26000
    s_add_u32 s89, s91, 0x18300
    buffer_load_dwordx4 v12, s[24:27], s89 offen lds
    s_add_u32 m0, s92, 0x27000
    s_add_u32 s89, s91, 0x1c300
    buffer_load_dwordx4 v6, s[24:27], s89 offen lds
    s_add_u32 m0, s92, 0x0
    s_add_u32 s89, s90, 0x0
    buffer_load_dwordx4 v11, s[12:15], s89 offen lds
    s_add_u32 m0, s92, 0x1000
    s_add_u32 s89, s90, 0x20000
    buffer_load_dwordx4 v5, s[12:15], s89 offen lds
    s_add_u32 m0, s92, 0x2000
    s_add_u32 s89, s90, 0x40000
    buffer_load_dwordx4 v11, s[12:15], s89 offen lds
    s_add_u32 m0, s92, 0x3000
    s_add_u32 s89, s90, 0x60000
    buffer_load_dwordx4 v5, s[12:15], s89 offen lds
    s_add_u32 m0, s92, 0x4000
    s_add_u32 s89, s90, 0x0
    buffer_load_dwordx4 v11, s[16:19], s89 offen lds
    s_add_u32 m0, s92, 0x5000
    s_add_u32 s89, s90, 0x20000
    buffer_load_dwordx4 v5, s[16:19], s89 offen lds
    s_add_u32 m0, s92, 0x6000
    s_add_u32 s89, s90, 0x40000
    buffer_load_dwordx4 v11, s[16:19], s89 offen lds
    s_add_u32 m0, s92, 0x7000
    s_add_u32 s89, s90, 0x60000
    buffer_load_dwordx4 v5, s[16:19], s89 offen lds
    v_and_b32 v9, 63, v0
    v_bfe_u32 v15, v9, 1, 3
    v_lshlrev_b32 v15, 10, v15
    v_lshrrev_b32 v1, 4, v9
    v_lshl_add_u32 v15, v1, 3, v15
    v_and_b32 v1, 1, v9
    v_lshl_add_u32 v15, v1, 2, v15
    s_lshl_b32 s88, s56, 8
    s_cmp_lg_u32 s56, 0
    s_cbranch_scc1 Lwn_2
    buffer_load_dword a96, v15, s[32:35], s88 offen offset:0
    buffer_load_dword a97, v15, s[32:35], s88 offen offset:32
    buffer_load_dword a98, v15, s[32:35], s88 offen offset:64
    buffer_load_dword a99, v15, s[32:35], s88 offen offset:96
    buffer_load_dword a100, v15, s[32:35], s88 offen offset:128
    buffer_load_dword a101, v15, s[32:35], s88 offen offset:160
    buffer_load_dword a102, v15, s[32:35], s88 offen offset:192
    buffer_load_dword a103, v15, s[32:35], s88 offen offset:224
    s_branch Lwe_1
Lwn_2:
    s_cmp_lg_u32 s56, 1
    s_cbranch_scc1 Lwn_3
    buffer_load_dword a112, v15, s[32:35], s88 offen offset:0
    buffer_load_dword a113, v15, s[32:35], s88 offen offset:32
    buffer_load_dword a114, v15, s[32:35], s88 offen offset:64
    buffer_load_dword a115, v15, s[32:35], s88 offen offset:96
    buffer_load_dword a116, v15, s[32:35], s88 offen offset:128
    buffer_load_dword a117, v15, s[32:35], s88 offen offset:160
    buffer_load_dword a118, v15, s[32:35], s88 offen offset:192
    buffer_load_dword a119, v15, s[32:35], s88 offen offset:224
    s_branch Lwe_1
Lwn_3:
    s_cmp_lg_u32 s56, 2
    s_cbranch_scc1 Lwn_4
    buffer_load_dword a128, v15, s[32:35], s88 offen offset:0
    buffer_load_dword a129, v15, s[32:35], s88 offen offset:32
    buffer_load_dword a130, v15, s[32:35], s88 offen offset:64
    buffer_load_dword a131, v15, s[32:35], s88 offen offset:96
    buffer_load_dword a132, v15, s[32:35], s88 offen offset:128
    buffer_load_dword a133, v15, s[32:35], s88 offen offset:160
    buffer_load_dword a134, v15, s[32:35], s88 offen offset:192
    buffer_load_dword a135, v15, s[32:35], s88 offen offset:224
    s_branch Lwe_1
Lwn_4:
    buffer_load_dword a144, v15, s[32:35], s88 offen offset:0
    buffer_load_dword a145, v15, s[32:35], s88 offen offset:32
    buffer_load_dword a146, v15, s[32:35], s88 offen offset:64
    buffer_load_dword a147, v15, s[32:35], s88 offen offset:96
    buffer_load_dword a148, v15, s[32:35], s88 offen offset:128
    buffer_load_dword a149, v15, s[32:35], s88 offen offset:160
    buffer_load_dword a150, v15, s[32:35], s88 offen offset:192
    buffer_load_dword a151, v15, s[32:35], s88 offen offset:224
Lwe_1:
    s_mov_b32 s93, 0
    s_waitcnt vmcnt(44)
    s_barrier
    s_cmp_lg_u32 s56, 0
    s_cbranch_scc1 Lskipo_6
    v_xor_b32 v9, 0, v13
    v_add_u32 v9, 0x8000, v9
    v_xor_b32 v15, 32, v9
    ds_read_b64_tr_b16 v[16:17], v9 offset:0
    ds_read_b64_tr_b16 v[18:19], v15 offset:256
    ds_read_b64_tr_b16 v[20:21], v9 offset:8192
    ds_read_b64_tr_b16 v[22:23], v15 offset:8448
    s_waitcnt lgkmcnt(0)
    v_xor_b32 v9, 32, v13
    v_add_u32 v9, 0x8000, v9
    v_xor_b32 v15, 32, v9
    ds_read_b64_tr_b16 v[192:193], v9 offset:0
    ds_read_b64_tr_b16 v[194:195], v15 offset:256
    ds_read_b64_tr_b16 v[196:197], v9 offset:8192
    ds_read_b64_tr_b16 v[198:199], v15 offset:8448
    s_waitcnt lgkmcnt(0)
    v_xor_b32 v9, 64, v13
    v_add_u32 v9, 0x8000, v9
    v_xor_b32 v15, 32, v9
    ds_read_b64_tr_b16 v[24:25], v9 offset:0
    ds_read_b64_tr_b16 v[26:27], v15 offset:256
    ds_read_b64_tr_b16 v[28:29], v9 offset:8192
    ds_read_b64_tr_b16 v[30:31], v15 offset:8448
    s_waitcnt lgkmcnt(0)
    v_xor_b32 v9, 96, v13
    v_add_u32 v9, 0x8000, v9
    v_xor_b32 v15, 32, v9
    ds_read_b64_tr_b16 v[208:209], v9 offset:0
    ds_read_b64_tr_b16 v[210:211], v15 offset:256
    ds_read_b64_tr_b16 v[212:213], v9 offset:8192
    ds_read_b64_tr_b16 v[214:215], v15 offset:8448
    s_waitcnt lgkmcnt(0)
    v_xor_b32 v9, 128, v13
    v_add_u32 v9, 0x8000, v9
    v_xor_b32 v15, 32, v9
    ds_read_b64_tr_b16 v[32:33], v9 offset:0
    ds_read_b64_tr_b16 v[34:35], v15 offset:256
    ds_read_b64_tr_b16 v[36:37], v9 offset:8192
    ds_read_b64_tr_b16 v[38:39], v15 offset:8448
    s_waitcnt lgkmcnt(0)
    v_xor_b32 v9, 160, v13
    v_add_u32 v9, 0x8000, v9
    v_xor_b32 v15, 32, v9
    ds_read_b64_tr_b16 v[224:225], v9 offset:0
    ds_read_b64_tr_b16 v[226:227], v15 offset:256
    ds_read_b64_tr_b16 v[228:229], v9 offset:8192
    ds_read_b64_tr_b16 v[230:231], v15 offset:8448
    s_waitcnt lgkmcnt(0)
    v_xor_b32 v9, 192, v13
    v_add_u32 v9, 0x8000, v9
    v_xor_b32 v15, 32, v9
    ds_read_b64_tr_b16 v[40:41], v9 offset:0
    ds_read_b64_tr_b16 v[42:43], v15 offset:256
    ds_read_b64_tr_b16 v[44:45], v9 offset:8192
    ds_read_b64_tr_b16 v[46:47], v15 offset:8448
    s_waitcnt lgkmcnt(0)
    v_xor_b32 v9, 224, v13
    v_add_u32 v9, 0x8000, v9
    v_xor_b32 v15, 32, v9
    ds_read_b64_tr_b16 v[240:241], v9 offset:0
    ds_read_b64_tr_b16 v[242:243], v15 offset:256
    ds_read_b64_tr_b16 v[244:245], v9 offset:8192
    ds_read_b64_tr_b16 v[246:247], v15 offset:8448
    s_waitcnt lgkmcnt(0)
Lskipo_6:
    s_barrier
    s_add_u32 m0, s92, 0x8000
    s_add_u32 s89, s90, 0x100000
    buffer_load_dwordx4 v11, s[12:15], s89 offen lds
    s_add_u32 m0, s92, 0x9000
    s_add_u32 s89, s90, 0x120000
    buffer_load_dwordx4 v5, s[12:15], s89 offen lds
    s_add_u32 m0, s92, 0xa000
    s_add_u32 s89, s90, 0x140000
    buffer_load_dwordx4 v11, s[12:15], s89 offen lds
    s_add_u32 m0, s92, 0xb000
    s_add_u32 s89, s90, 0x160000
    buffer_load_dwordx4 v5, s[12:15], s89 offen lds
    s_waitcnt vmcnt(44)
    s_barrier
    s_cmp_lg_u32 s56, 1
    s_cbranch_scc1 Lskipo_7
    v_xor_b32 v9, 0, v13
    v_add_u32 v9, 0x8000, v9
    v_xor_b32 v15, 32, v9
    ds_read_b64_tr_b16 v[16:17], v9 offset:16384
    ds_read_b64_tr_b16 v[18:19], v15 offset:16640
    ds_read_b64_tr_b16 v[20:21], v9 offset:24576
    ds_read_b64_tr_b16 v[22:23], v15 offset:24832
    s_waitcnt lgkmcnt(0)
    v_xor_b32 v9, 32, v13
    v_add_u32 v9, 0x8000, v9
    v_xor_b32 v15, 32, v9
    ds_read_b64_tr_b16 v[192:193], v9 offset:16384
    ds_read_b64_tr_b16 v[194:195], v15 offset:16640
    ds_read_b64_tr_b16 v[196:197], v9 offset:24576
    ds_read_b64_tr_b16 v[198:199], v15 offset:24832
    s_waitcnt lgkmcnt(0)
    v_xor_b32 v9, 64, v13
    v_add_u32 v9, 0x8000, v9
    v_xor_b32 v15, 32, v9
    ds_read_b64_tr_b16 v[24:25], v9 offset:16384
    ds_read_b64_tr_b16 v[26:27], v15 offset:16640
    ds_read_b64_tr_b16 v[28:29], v9 offset:24576
    ds_read_b64_tr_b16 v[30:31], v15 offset:24832
    s_waitcnt lgkmcnt(0)
    v_xor_b32 v9, 96, v13
    v_add_u32 v9, 0x8000, v9
    v_xor_b32 v15, 32, v9
    ds_read_b64_tr_b16 v[208:209], v9 offset:16384
    ds_read_b64_tr_b16 v[210:211], v15 offset:16640
    ds_read_b64_tr_b16 v[212:213], v9 offset:24576
    ds_read_b64_tr_b16 v[214:215], v15 offset:24832
    s_waitcnt lgkmcnt(0)
    v_xor_b32 v9, 128, v13
    v_add_u32 v9, 0x8000, v9
    v_xor_b32 v15, 32, v9
    ds_read_b64_tr_b16 v[32:33], v9 offset:16384
    ds_read_b64_tr_b16 v[34:35], v15 offset:16640
    ds_read_b64_tr_b16 v[36:37], v9 offset:24576
    ds_read_b64_tr_b16 v[38:39], v15 offset:24832
    s_waitcnt lgkmcnt(0)
    v_xor_b32 v9, 160, v13
    v_add_u32 v9, 0x8000, v9
    v_xor_b32 v15, 32, v9
    ds_read_b64_tr_b16 v[224:225], v9 offset:16384
    ds_read_b64_tr_b16 v[226:227], v15 offset:16640
    ds_read_b64_tr_b16 v[228:229], v9 offset:24576
    ds_read_b64_tr_b16 v[230:231], v15 offset:24832
    s_waitcnt lgkmcnt(0)
    v_xor_b32 v9, 192, v13
    v_add_u32 v9, 0x8000, v9
    v_xor_b32 v15, 32, v9
    ds_read_b64_tr_b16 v[40:41], v9 offset:16384
    ds_read_b64_tr_b16 v[42:43], v15 offset:16640
    ds_read_b64_tr_b16 v[44:45], v9 offset:24576
    ds_read_b64_tr_b16 v[46:47], v15 offset:24832
    s_waitcnt lgkmcnt(0)
    v_xor_b32 v9, 224, v13
    v_add_u32 v9, 0x8000, v9
    v_xor_b32 v15, 32, v9
    ds_read_b64_tr_b16 v[240:241], v9 offset:16384
    ds_read_b64_tr_b16 v[242:243], v15 offset:16640
    ds_read_b64_tr_b16 v[244:245], v9 offset:24576
    ds_read_b64_tr_b16 v[246:247], v15 offset:24832
    s_waitcnt lgkmcnt(0)
Lskipo_7:
    s_barrier
    s_add_u32 m0, s92, 0xc000
    s_add_u32 s89, s90, 0x200000
    buffer_load_dwordx4 v11, s[12:15], s89 offen lds
    s_add_u32 m0, s92, 0xd000
    s_add_u32 s89, s90, 0x220000
    buffer_load_dwordx4 v5, s[12:15], s89 offen lds
    s_add_u32 m0, s92, 0xe000
    s_add_u32 s89, s90, 0x240000
    buffer_load_dwordx4 v11, s[12:15], s89 offen lds
    s_add_u32 m0, s92, 0xf000
    s_add_u32 s89, s90, 0x260000
    buffer_load_dwordx4 v5, s[12:15], s89 offen lds
    s_waitcnt vmcnt(44)
    s_barrier
    s_cmp_lg_u32 s56, 2
    s_cbranch_scc1 Lskipo_8
    v_xor_b32 v9, 0, v13
    v_add_u32 v9, 0x10000, v9
    v_xor_b32 v15, 32, v9
    ds_read_b64_tr_b16 v[16:17], v9 offset:0
    ds_read_b64_tr_b16 v[18:19], v15 offset:256
    ds_read_b64_tr_b16 v[20:21], v9 offset:8192
    ds_read_b64_tr_b16 v[22:23], v15 offset:8448
    s_waitcnt lgkmcnt(0)
    v_xor_b32 v9, 32, v13
    v_add_u32 v9, 0x10000, v9
    v_xor_b32 v15, 32, v9
    ds_read_b64_tr_b16 v[192:193], v9 offset:0
    ds_read_b64_tr_b16 v[194:195], v15 offset:256
    ds_read_b64_tr_b16 v[196:197], v9 offset:8192
    ds_read_b64_tr_b16 v[198:199], v15 offset:8448
    s_waitcnt lgkmcnt(0)
    v_xor_b32 v9, 64, v13
    v_add_u32 v9, 0x10000, v9
    v_xor_b32 v15, 32, v9
    ds_read_b64_tr_b16 v[24:25], v9 offset:0
    ds_read_b64_tr_b16 v[26:27], v15 offset:256
    ds_read_b64_tr_b16 v[28:29], v9 offset:8192
    ds_read_b64_tr_b16 v[30:31], v15 offset:8448
    s_waitcnt lgkmcnt(0)
    v_xor_b32 v9, 96, v13
    v_add_u32 v9, 0x10000, v9
    v_xor_b32 v15, 32, v9
    ds_read_b64_tr_b16 v[208:209], v9 offset:0
    ds_read_b64_tr_b16 v[210:211], v15 offset:256
    ds_read_b64_tr_b16 v[212:213], v9 offset:8192
    ds_read_b64_tr_b16 v[214:215], v15 offset:8448
    s_waitcnt lgkmcnt(0)
    v_xor_b32 v9, 128, v13
    v_add_u32 v9, 0x10000, v9
    v_xor_b32 v15, 32, v9
    ds_read_b64_tr_b16 v[32:33], v9 offset:0
    ds_read_b64_tr_b16 v[34:35], v15 offset:256
    ds_read_b64_tr_b16 v[36:37], v9 offset:8192
    ds_read_b64_tr_b16 v[38:39], v15 offset:8448
    s_waitcnt lgkmcnt(0)
    v_xor_b32 v9, 160, v13
    v_add_u32 v9, 0x10000, v9
    v_xor_b32 v15, 32, v9
    ds_read_b64_tr_b16 v[224:225], v9 offset:0
    ds_read_b64_tr_b16 v[226:227], v15 offset:256
    ds_read_b64_tr_b16 v[228:229], v9 offset:8192
    ds_read_b64_tr_b16 v[230:231], v15 offset:8448
    s_waitcnt lgkmcnt(0)
    v_xor_b32 v9, 192, v13
    v_add_u32 v9, 0x10000, v9
    v_xor_b32 v15, 32, v9
    ds_read_b64_tr_b16 v[40:41], v9 offset:0
    ds_read_b64_tr_b16 v[42:43], v15 offset:256
    ds_read_b64_tr_b16 v[44:45], v9 offset:8192
    ds_read_b64_tr_b16 v[46:47], v15 offset:8448
    s_waitcnt lgkmcnt(0)
    v_xor_b32 v9, 224, v13
    v_add_u32 v9, 0x10000, v9
    v_xor_b32 v15, 32, v9
    ds_read_b64_tr_b16 v[240:241], v9 offset:0
    ds_read_b64_tr_b16 v[242:243], v15 offset:256
    ds_read_b64_tr_b16 v[244:245], v9 offset:8192
    ds_read_b64_tr_b16 v[246:247], v15 offset:8448
    s_waitcnt lgkmcnt(0)
Lskipo_8:
    s_barrier
    s_add_u32 m0, s92, 0x10000
    s_add_u32 s89, s90, 0x300000
    buffer_load_dwordx4 v11, s[12:15], s89 offen lds
    s_add_u32 m0, s92, 0x11000
    s_add_u32 s89, s90, 0x320000
    buffer_load_dwordx4 v5, s[12:15], s89 offen lds
    s_add_u32 m0, s92, 0x12000
    s_add_u32 s89, s90, 0x340000
    buffer_load_dwordx4 v11, s[12:15], s89 offen lds
    s_add_u32 m0, s92, 0x13000
    s_add_u32 s89, s90, 0x360000
    buffer_load_dwordx4 v5, s[12:15], s89 offen lds
    v_mbcnt_lo_u32_b32 v4, -1, 0
    v_and_b32 v4, 7, v4
    v_lshlrev_b32 v4, 2, v4
    global_load_dword v3, v4, s[8:9] sc1
    s_waitcnt vmcnt(45)
    s_barrier
    s_cmp_lg_u32 s56, 3
    s_cbranch_scc1 Lskipo_9
    v_xor_b32 v9, 0, v13
    v_add_u32 v9, 0x10000, v9
    v_xor_b32 v15, 32, v9
    ds_read_b64_tr_b16 v[16:17], v9 offset:16384
    ds_read_b64_tr_b16 v[18:19], v15 offset:16640
    ds_read_b64_tr_b16 v[20:21], v9 offset:24576
    ds_read_b64_tr_b16 v[22:23], v15 offset:24832
    s_waitcnt lgkmcnt(0)
    v_xor_b32 v9, 32, v13
    v_add_u32 v9, 0x10000, v9
    v_xor_b32 v15, 32, v9
    ds_read_b64_tr_b16 v[192:193], v9 offset:16384
    ds_read_b64_tr_b16 v[194:195], v15 offset:16640
    ds_read_b64_tr_b16 v[196:197], v9 offset:24576
    ds_read_b64_tr_b16 v[198:199], v15 offset:24832
    s_waitcnt lgkmcnt(0)
    v_xor_b32 v9, 64, v13
    v_add_u32 v9, 0x10000, v9
    v_xor_b32 v15, 32, v9
    ds_read_b64_tr_b16 v[24:25], v9 offset:16384
    ds_read_b64_tr_b16 v[26:27], v15 offset:16640
    ds_read_b64_tr_b16 v[28:29], v9 offset:24576
    ds_read_b64_tr_b16 v[30:31], v15 offset:24832
    s_waitcnt lgkmcnt(0)
    v_xor_b32 v9, 96, v13
    v_add_u32 v9, 0x10000, v9
    v_xor_b32 v15, 32, v9
    ds_read_b64_tr_b16 v[208:209], v9 offset:16384
    ds_read_b64_tr_b16 v[210:211], v15 offset:16640
    ds_read_b64_tr_b16 v[212:213], v9 offset:24576
    ds_read_b64_tr_b16 v[214:215], v15 offset:24832
    s_waitcnt lgkmcnt(0)
    v_xor_b32 v9, 128, v13
    v_add_u32 v9, 0x10000, v9
    v_xor_b32 v15, 32, v9
    ds_read_b64_tr_b16 v[32:33], v9 offset:16384
    ds_read_b64_tr_b16 v[34:35], v15 offset:16640
    ds_read_b64_tr_b16 v[36:37], v9 offset:24576
    ds_read_b64_tr_b16 v[38:39], v15 offset:24832
    s_waitcnt lgkmcnt(0)
    v_xor_b32 v9, 160, v13
    v_add_u32 v9, 0x10000, v9
    v_xor_b32 v15, 32, v9
    ds_read_b64_tr_b16 v[224:225], v9 offset:16384
    ds_read_b64_tr_b16 v[226:227], v15 offset:16640
    ds_read_b64_tr_b16 v[228:229], v9 offset:24576
    ds_read_b64_tr_b16 v[230:231], v15 offset:24832
    s_waitcnt lgkmcnt(0)
    v_xor_b32 v9, 192, v13
    v_add_u32 v9, 0x10000, v9
    v_xor_b32 v15, 32, v9
    ds_read_b64_tr_b16 v[40:41], v9 offset:16384
    ds_read_b64_tr_b16 v[42:43], v15 offset:16640
    ds_read_b64_tr_b16 v[44:45], v9 offset:24576
    ds_read_b64_tr_b16 v[46:47], v15 offset:24832
    s_waitcnt lgkmcnt(0)
    v_xor_b32 v9, 224, v13
    v_add_u32 v9, 0x10000, v9
    v_xor_b32 v15, 32, v9
    ds_read_b64_tr_b16 v[240:241], v9 offset:16384
    ds_read_b64_tr_b16 v[242:243], v15 offset:16640
    ds_read_b64_tr_b16 v[244:245], v9 offset:24576
    ds_read_b64_tr_b16 v[246:247], v15 offset:24832
    s_waitcnt lgkmcnt(0)
Lskipo_9:
    s_barrier
    s_add_u32 m0, s92, 0x14000
    s_add_u32 s89, s90, 0x100000
    buffer_load_dwordx4 v11, s[16:19], s89 offen lds
    s_add_u32 m0, s92, 0x15000
    s_add_u32 s89, s90, 0x120000
    buffer_load_dwordx4 v5, s[16:19], s89 offen lds
    s_add_u32 m0, s92, 0x16000
    s_add_u32 s89, s90, 0x140000
    buffer_load_dwordx4 v11, s[16:19], s89 offen lds
    s_add_u32 m0, s92, 0x17000
    s_add_u32 s89, s90, 0x160000
    buffer_load_dwordx4 v5, s[16:19], s89 offen lds
    s_waitcnt vmcnt(45)
    s_barrier
    s_cmp_lg_u32 s56, 0
    s_cbranch_scc1 Lskipo_10
    v_xor_b32 v9, 0, v13
    v_add_u32 v9, 0x18000, v9
    v_xor_b32 v15, 32, v9
    ds_read_b64_tr_b16 v[48:49], v9 offset:0
    ds_read_b64_tr_b16 v[50:51], v15 offset:256
    ds_read_b64_tr_b16 v[52:53], v9 offset:8192
    ds_read_b64_tr_b16 v[54:55], v15 offset:8448
    s_waitcnt lgkmcnt(0)
    v_xor_b32 v9, 32, v13
    v_add_u32 v9, 0x18000, v9
    v_xor_b32 v15, 32, v9
    ds_read_b64_tr_b16 v[200:201], v9 offset:0
    ds_read_b64_tr_b16 v[202:203], v15 offset:256
    ds_read_b64_tr_b16 v[204:205], v9 offset:8192
    ds_read_b64_tr_b16 v[206:207], v15 offset:8448
    s_waitcnt lgkmcnt(0)
    v_xor_b32 v9, 64, v13
    v_add_u32 v9, 0x18000, v9
    v_xor_b32 v15, 32, v9
    ds_read_b64_tr_b16 v[56:57], v9 offset:0
    ds_read_b64_tr_b16 v[58:59], v15 offset:256
    ds_read_b64_tr_b16 v[60:61], v9 offset:8192
    ds_read_b64_tr_b16 v[62:63], v15 offset:8448
    s_waitcnt lgkmcnt(0)
    v_xor_b32 v9, 96, v13
    v_add_u32 v9, 0x18000, v9
    v_xor_b32 v15, 32, v9
    ds_read_b64_tr_b16 v[216:217], v9 offset:0
    ds_read_b64_tr_b16 v[218:219], v15 offset:256
    ds_read_b64_tr_b16 v[220:221], v9 offset:8192
    ds_read_b64_tr_b16 v[222:223], v15 offset:8448
    s_waitcnt lgkmcnt(0)
    v_xor_b32 v9, 128, v13
    v_add_u32 v9, 0x18000, v9
    v_xor_b32 v15, 32, v9
    ds_read_b64_tr_b16 v[64:65], v9 offset:0
    ds_read_b64_tr_b16 v[66:67], v15 offset:256
    ds_read_b64_tr_b16 v[68:69], v9 offset:8192
    ds_read_b64_tr_b16 v[70:71], v15 offset:8448
    s_waitcnt lgkmcnt(0)
    v_xor_b32 v9, 160, v13
    v_add_u32 v9, 0x18000, v9
    v_xor_b32 v15, 32, v9
    ds_read_b64_tr_b16 v[232:233], v9 offset:0
    ds_read_b64_tr_b16 v[234:235], v15 offset:256
    ds_read_b64_tr_b16 v[236:237], v9 offset:8192
    ds_read_b64_tr_b16 v[238:239], v15 offset:8448
    s_waitcnt lgkmcnt(0)
    v_xor_b32 v9, 192, v13
    v_add_u32 v9, 0x18000, v9
    v_xor_b32 v15, 32, v9
    ds_read_b64_tr_b16 v[72:73], v9 offset:0
    ds_read_b64_tr_b16 v[74:75], v15 offset:256
    ds_read_b64_tr_b16 v[76:77], v9 offset:8192
    ds_read_b64_tr_b16 v[78:79], v15 offset:8448
    s_waitcnt lgkmcnt(0)
    v_xor_b32 v9, 224, v13
    v_add_u32 v9, 0x18000, v9
    v_xor_b32 v15, 32, v9
    ds_read_b64_tr_b16 v[248:249], v9 offset:0
    ds_read_b64_tr_b16 v[250:251], v15 offset:256
    ds_read_b64_tr_b16 v[252:253], v9 offset:8192
    ds_read_b64_tr_b16 v[254:255], v15 offset:8448
    s_waitcnt lgkmcnt(0)
Lskipo_10:
    s_barrier
    s_add_u32 m0, s92, 0x18000
    s_add_u32 s89, s90, 0x200000
    buffer_load_dwordx4 v11, s[16:19], s89 offen lds
    s_add_u32 m0, s92, 0x19000
    s_add_u32 s89, s90, 0x220000
    buffer_load_dwordx4 v5, s[16:19], s89 offen lds
    s_add_u32 m0, s92, 0x1a000
    s_add_u32 s89, s90, 0x240000
    buffer_load_dwordx4 v11, s[16:19], s89 offen lds
    s_add_u32 m0, s92, 0x1b000
    s_add_u32 s89, s90, 0x260000
    buffer_load_dwordx4 v5, s[16:19], s89 offen lds
    s_waitcnt vmcnt(45)
    s_barrier
    s_cmp_lg_u32 s56, 1
    s_cbranch_scc1 Lskipo_11
    v_xor_b32 v9, 0, v13
    v_add_u32 v9, 0x18000, v9
    v_xor_b32 v15, 32, v9
    ds_read_b64_tr_b16 v[48:49], v9 offset:16384
    ds_read_b64_tr_b16 v[50:51], v15 offset:16640
    ds_read_b64_tr_b16 v[52:53], v9 offset:24576
    ds_read_b64_tr_b16 v[54:55], v15 offset:24832
    s_waitcnt lgkmcnt(0)
    v_xor_b32 v9, 32, v13
    v_add_u32 v9, 0x18000, v9
    v_xor_b32 v15, 32, v9
    ds_read_b64_tr_b16 v[200:201], v9 offset:16384
    ds_read_b64_tr_b16 v[202:203], v15 offset:16640
    ds_read_b64_tr_b16 v[204:205], v9 offset:24576
    ds_read_b64_tr_b16 v[206:207], v15 offset:24832
    s_waitcnt lgkmcnt(0)
    v_xor_b32 v9, 64, v13
    v_add_u32 v9, 0x18000, v9
    v_xor_b32 v15, 32, v9
    ds_read_b64_tr_b16 v[56:57], v9 offset:16384
    ds_read_b64_tr_b16 v[58:59], v15 offset:16640
    ds_read_b64_tr_b16 v[60:61], v9 offset:24576
    ds_read_b64_tr_b16 v[62:63], v15 offset:24832
    s_waitcnt lgkmcnt(0)
    v_xor_b32 v9, 96, v13
    v_add_u32 v9, 0x18000, v9
    v_xor_b32 v15, 32, v9
    ds_read_b64_tr_b16 v[216:217], v9 offset:16384
    ds_read_b64_tr_b16 v[218:219], v15 offset:16640
    ds_read_b64_tr_b16 v[220:221], v9 offset:24576
    ds_read_b64_tr_b16 v[222:223], v15 offset:24832
    s_waitcnt lgkmcnt(0)
    v_xor_b32 v9, 128, v13
    v_add_u32 v9, 0x18000, v9
    v_xor_b32 v15, 32, v9
    ds_read_b64_tr_b16 v[64:65], v9 offset:16384
    ds_read_b64_tr_b16 v[66:67], v15 offset:16640
    ds_read_b64_tr_b16 v[68:69], v9 offset:24576
    ds_read_b64_tr_b16 v[70:71], v15 offset:24832
    s_waitcnt lgkmcnt(0)
    v_xor_b32 v9, 160, v13
    v_add_u32 v9, 0x18000, v9
    v_xor_b32 v15, 32, v9
    ds_read_b64_tr_b16 v[232:233], v9 offset:16384
    ds_read_b64_tr_b16 v[234:235], v15 offset:16640
    ds_read_b64_tr_b16 v[236:237], v9 offset:24576
    ds_read_b64_tr_b16 v[238:239], v15 offset:24832
    s_waitcnt lgkmcnt(0)
    v_xor_b32 v9, 192, v13
    v_add_u32 v9, 0x18000, v9
    v_xor_b32 v15, 32, v9
    ds_read_b64_tr_b16 v[72:73], v9 offset:16384
    ds_read_b64_tr_b16 v[74:75], v15 offset:16640
    ds_read_b64_tr_b16 v[76:77], v9 offset:24576
    ds_read_b64_tr_b16 v[78:79], v15 offset:24832
    s_waitcnt lgkmcnt(0)
    v_xor_b32 v9, 224, v13
    v_add_u32 v9, 0x18000, v9
    v_xor_b32 v15, 32, v9
    ds_read_b64_tr_b16 v[248:249], v9 offset:16384
    ds_read_b64_tr_b16 v[250:251], v15 offset:16640
    ds_read_b64_tr_b16 v[252:253], v9 offset:24576
    ds_read_b64_tr_b16 v[254:255], v15 offset:24832
    s_waitcnt lgkmcnt(0)
Lskipo_11:
    s_barrier
    s_add_u32 m0, s92, 0x1c000
    s_add_u32 s89, s90, 0x300000
    buffer_load_dwordx4 v11, s[16:19], s89 offen lds
    s_add_u32 m0, s92, 0x1d000
    s_add_u32 s89, s90, 0x320000
    buffer_load_dwordx4 v5, s[16:19], s89 offen lds
    s_add_u32 m0, s92, 0x1e000
    s_add_u32 s89, s90, 0x340000
    buffer_load_dwordx4 v11, s[16:19], s89 offen lds
    s_add_u32 m0, s92, 0x1f000
    s_add_u32 s89, s90, 0x360000
    buffer_load_dwordx4 v5, s[16:19], s89 offen lds
    s_waitcnt vmcnt(45)
    s_barrier
    s_cmp_lg_u32 s56, 2
    s_cbranch_scc1 Lskipo_12
    v_xor_b32 v9, 0, v13
    v_add_u32 v9, 0x20000, v9
    v_xor_b32 v15, 32, v9
    ds_read_b64_tr_b16 v[48:49], v9 offset:0
    ds_read_b64_tr_b16 v[50:51], v15 offset:256
    ds_read_b64_tr_b16 v[52:53], v9 offset:8192
    ds_read_b64_tr_b16 v[54:55], v15 offset:8448
    s_waitcnt lgkmcnt(0)
    v_xor_b32 v9, 32, v13
    v_add_u32 v9, 0x20000, v9
    v_xor_b32 v15, 32, v9
    ds_read_b64_tr_b16 v[200:201], v9 offset:0
    ds_read_b64_tr_b16 v[202:203], v15 offset:256
    ds_read_b64_tr_b16 v[204:205], v9 offset:8192
    ds_read_b64_tr_b16 v[206:207], v15 offset:8448
    s_waitcnt lgkmcnt(0)
    v_xor_b32 v9, 64, v13
    v_add_u32 v9, 0x20000, v9
    v_xor_b32 v15, 32, v9
    ds_read_b64_tr_b16 v[56:57], v9 offset:0
    ds_read_b64_tr_b16 v[58:59], v15 offset:256
    ds_read_b64_tr_b16 v[60:61], v9 offset:8192
    ds_read_b64_tr_b16 v[62:63], v15 offset:8448
    s_waitcnt lgkmcnt(0)
    v_xor_b32 v9, 96, v13
    v_add_u32 v9, 0x20000, v9
    v_xor_b32 v15, 32, v9
    ds_read_b64_tr_b16 v[216:217], v9 offset:0
    ds_read_b64_tr_b16 v[218:219], v15 offset:256
    ds_read_b64_tr_b16 v[220:221], v9 offset:8192
    ds_read_b64_tr_b16 v[222:223], v15 offset:8448
    s_waitcnt lgkmcnt(0)
    v_xor_b32 v9, 128, v13
    v_add_u32 v9, 0x20000, v9
    v_xor_b32 v15, 32, v9
    ds_read_b64_tr_b16 v[64:65], v9 offset:0
    ds_read_b64_tr_b16 v[66:67], v15 offset:256
    ds_read_b64_tr_b16 v[68:69], v9 offset:8192
    ds_read_b64_tr_b16 v[70:71], v15 offset:8448
    s_waitcnt lgkmcnt(0)
    v_xor_b32 v9, 160, v13
    v_add_u32 v9, 0x20000, v9
    v_xor_b32 v15, 32, v9
    ds_read_b64_tr_b16 v[232:233], v9 offset:0
    ds_read_b64_tr_b16 v[234:235], v15 offset:256
    ds_read_b64_tr_b16 v[236:237], v9 offset:8192
    ds_read_b64_tr_b16 v[238:239], v15 offset:8448
    s_waitcnt lgkmcnt(0)
    v_xor_b32 v9, 192, v13
    v_add_u32 v9, 0x20000, v9
    v_xor_b32 v15, 32, v9
    ds_read_b64_tr_b16 v[72:73], v9 offset:0
    ds_read_b64_tr_b16 v[74:75], v15 offset:256
    ds_read_b64_tr_b16 v[76:77], v9 offset:8192
    ds_read_b64_tr_b16 v[78:79], v15 offset:8448
    s_waitcnt lgkmcnt(0)
    v_xor_b32 v9, 224, v13
    v_add_u32 v9, 0x20000, v9
    v_xor_b32 v15, 32, v9
    ds_read_b64_tr_b16 v[248:249], v9 offset:0
    ds_read_b64_tr_b16 v[250:251], v15 offset:256
    ds_read_b64_tr_b16 v[252:253], v9 offset:8192
    ds_read_b64_tr_b16 v[254:255], v15 offset:8448
    s_waitcnt lgkmcnt(0)
Lskipo_12:
    s_barrier
    s_add_u32 m0, s92, 0x20000
    s_add_u32 s89, s90, 0x0
    buffer_load_dwordx4 v11, s[20:23], s89 offen lds
    s_add_u32 m0, s92, 0x21000
    s_add_u32 s89, s90, 0x20000
    buffer_load_dwordx4 v5, s[20:23], s89 offen lds
    s_add_u32 m0, s92, 0x22000
    s_add_u32 s89, s90, 0x40000
    buffer_load_dwordx4 v11, s[20:23], s89 offen lds
    s_add_u32 m0, s92, 0x23000
    s_add_u32 s89, s90, 0x60000
    buffer_load_dwordx4 v5, s[20:23], s89 offen lds
    s_waitcnt vmcnt(45)
    s_barrier
    s_cmp_lg_u32 s56, 3
    s_cbranch_scc1 Lskipo_13
    v_xor_b32 v9, 0, v13
    v_add_u32 v9, 0x20000, v9
    v_xor_b32 v15, 32, v9
    ds_read_b64_tr_b16 v[48:49], v9 offset:16384
    ds_read_b64_tr_b16 v[50:51], v15 offset:16640
    ds_read_b64_tr_b16 v[52:53], v9 offset:24576
    ds_read_b64_tr_b16 v[54:55], v15 offset:24832
    s_waitcnt lgkmcnt(0)
    v_xor_b32 v9, 32, v13
    v_add_u32 v9, 0x20000, v9
    v_xor_b32 v15, 32, v9
    ds_read_b64_tr_b16 v[200:201], v9 offset:16384
    ds_read_b64_tr_b16 v[202:203], v15 offset:16640
    ds_read_b64_tr_b16 v[204:205], v9 offset:24576
    ds_read_b64_tr_b16 v[206:207], v15 offset:24832
    s_waitcnt lgkmcnt(0)
    v_xor_b32 v9, 64, v13
    v_add_u32 v9, 0x20000, v9
    v_xor_b32 v15, 32, v9
    ds_read_b64_tr_b16 v[56:57], v9 offset:16384
    ds_read_b64_tr_b16 v[58:59], v15 offset:16640
    ds_read_b64_tr_b16 v[60:61], v9 offset:24576
    ds_read_b64_tr_b16 v[62:63], v15 offset:24832
    s_waitcnt lgkmcnt(0)
    v_xor_b32 v9, 96, v13
    v_add_u32 v9, 0x20000, v9
    v_xor_b32 v15, 32, v9
    ds_read_b64_tr_b16 v[216:217], v9 offset:16384
    ds_read_b64_tr_b16 v[218:219], v15 offset:16640
    ds_read_b64_tr_b16 v[220:221], v9 offset:24576
    ds_read_b64_tr_b16 v[222:223], v15 offset:24832
    s_waitcnt lgkmcnt(0)
    v_xor_b32 v9, 128, v13
    v_add_u32 v9, 0x20000, v9
    v_xor_b32 v15, 32, v9
    ds_read_b64_tr_b16 v[64:65], v9 offset:16384
    ds_read_b64_tr_b16 v[66:67], v15 offset:16640
    ds_read_b64_tr_b16 v[68:69], v9 offset:24576
    ds_read_b64_tr_b16 v[70:71], v15 offset:24832
    s_waitcnt lgkmcnt(0)
    v_xor_b32 v9, 160, v13
    v_add_u32 v9, 0x20000, v9
    v_xor_b32 v15, 32, v9
    ds_read_b64_tr_b16 v[232:233], v9 offset:16384
    ds_read_b64_tr_b16 v[234:235], v15 offset:16640
    ds_read_b64_tr_b16 v[236:237], v9 offset:24576
    ds_read_b64_tr_b16 v[238:239], v15 offset:24832
    s_waitcnt lgkmcnt(0)
    v_xor_b32 v9, 192, v13
    v_add_u32 v9, 0x20000, v9
    v_xor_b32 v15, 32, v9
    ds_read_b64_tr_b16 v[72:73], v9 offset:16384
    ds_read_b64_tr_b16 v[74:75], v15 offset:16640
    ds_read_b64_tr_b16 v[76:77], v9 offset:24576
    ds_read_b64_tr_b16 v[78:79], v15 offset:24832
    s_waitcnt lgkmcnt(0)
    v_xor_b32 v9, 224, v13
    v_add_u32 v9, 0x20000, v9
    v_xor_b32 v15, 32, v9
    ds_read_b64_tr_b16 v[248:249], v9 offset:16384
    ds_read_b64_tr_b16 v[250:251], v15 offset:16640
    ds_read_b64_tr_b16 v[252:253], v9 offset:24576
    ds_read_b64_tr_b16 v[254:255], v15 offset:24832
    s_waitcnt lgkmcnt(0)
Lskipo_13:
    s_barrier
    s_add_u32 m0, s92, 0x24000
    s_add_u32 s89, s90, 0x80000
    buffer_load_dwordx4 v11, s[20:23], s89 offen lds
    s_add_u32 m0, s92, 0x25000
    s_add_u32 s89, s90, 0xa0000
    buffer_load_dwordx4 v5, s[20:23], s89 offen lds
    s_add_u32 m0, s92, 0x26000
    s_add_u32 s89, s90, 0xc0000
    buffer_load_dwordx4 v11, s[20:23], s89 offen lds
    s_add_u32 m0, s92, 0x27000
    s_add_u32 s89, s90, 0xe0000
    buffer_load_dwordx4 v5, s[20:23], s89 offen lds
    s_waitcnt vmcnt(29)
    s_barrier
    v_add_u32 v9, 0x8000, v2
    v_add_u32 v15, 0x8010, v2
    s_cmp_lg_u32 s56, 0
    s_cbranch_scc1 Lwn_15
    ds_read_b64_tr_b16 a[16:17], v9 offset:0
    ds_read_b64_tr_b16 a[18:19], v9 offset:8192
    ds_read_b64_tr_b16 a[20:21], v9 offset:2048
    ds_read_b64_tr_b16 a[22:23], v9 offset:10240
    ds_read_b64_tr_b16 v[80:81], v15 offset:0
    ds_read_b64_tr_b16 v[82:83], v15 offset:8192
    ds_read_b64_tr_b16 v[84:85], v15 offset:2048
    ds_read_b64_tr_b16 v[86:87], v15 offset:10240
    s_waitcnt lgkmcnt(0)
    s_branch Lwe_14
Lwn_15:
    s_cmp_lg_u32 s56, 1
    s_cbranch_scc1 Lwn_16
    ds_read_b64_tr_b16 a[0:1], v9 offset:0
    ds_read_b64_tr_b16 a[2:3], v9 offset:8192
    ds_read_b64_tr_b16 a[4:5], v9 offset:2048
    ds_read_b64_tr_b16 a[6:7], v9 offset:10240
    ds_read_b64_tr_b16 v[80:81], v15 offset:0
    ds_read_b64_tr_b16 v[82:83], v15 offset:8192
    ds_read_b64_tr_b16 v[84:85], v15 offset:2048
    ds_read_b64_tr_b16 v[86:87], v15 offset:10240
    s_waitcnt lgkmcnt(0)
    s_branch Lwe_14
Lwn_16:
    s_cmp_lg_u32 s56, 2
    s_cbranch_scc1 Lwn_17
    ds_read_b64_tr_b16 a[48:49], v9 offset:0
    ds_read_b64_tr_b16 a[50:51], v9 offset:8192
    ds_read_b64_tr_b16 a[52:53], v9 offset:2048
    ds_read_b64_tr_b16 a[54:55], v9 offset:10240
    ds_read_b64_tr_b16 v[80:81], v15 offset:0
    ds_read_b64_tr_b16 v[82:83], v15 offset:8192
    ds_read_b64_tr_b16 v[84:85], v15 offset:2048
    ds_read_b64_tr_b16 v[86:87], v15 offset:10240
    s_waitcnt lgkmcnt(0)
    s_branch Lwe_14
Lwn_17:
    ds_read_b64_tr_b16 a[32:33], v9 offset:0
    ds_read_b64_tr_b16 a[34:35], v9 offset:8192
    ds_read_b64_tr_b16 a[36:37], v9 offset:2048
    ds_read_b64_tr_b16 a[38:39], v9 offset:10240
    ds_read_b64_tr_b16 v[80:81], v15 offset:0
    ds_read_b64_tr_b16 v[82:83], v15 offset:8192
    ds_read_b64_tr_b16 v[84:85], v15 offset:2048
    ds_read_b64_tr_b16 v[86:87], v15 offset:10240
    s_waitcnt lgkmcnt(0)
Lwe_14:
    s_barrier
    s_add_u32 m0, s92, 0x8000
    s_add_u32 s89, s90, 0x100000
    buffer_load_dwordx4 v11, s[20:23], s89 offen lds
    s_add_u32 m0, s92, 0x9000
    s_add_u32 s89, s90, 0x120000
    buffer_load_dwordx4 v5, s[20:23], s89 offen lds
    s_add_u32 m0, s92, 0xa000
    s_add_u32 s89, s90, 0x140000
    buffer_load_dwordx4 v11, s[20:23], s89 offen lds
    s_add_u32 m0, s92, 0xb000
    s_add_u32 s89, s90, 0x160000
    buffer_load_dwordx4 v5, s[20:23], s89 offen lds
    s_waitcnt vmcnt(29)
    s_barrier
    v_add_u32 v9, 0x8000, v2
    v_add_u32 v15, 0x8010, v2
    s_cmp_lg_u32 s56, 0
    s_cbranch_scc1 Lwn_20
    ds_read_b64_tr_b16 a[32:33], v9 offset:16384
    ds_read_b64_tr_b16 a[34:35], v9 offset:24576
    ds_read_b64_tr_b16 a[36:37], v9 offset:18432
    ds_read_b64_tr_b16 a[38:39], v9 offset:26624
    ds_read_b64_tr_b16 v[88:89], v15 offset:16384
    ds_read_b64_tr_b16 v[90:91], v15 offset:24576
    ds_read_b64_tr_b16 v[92:93], v15 offset:18432
    ds_read_b64_tr_b16 v[94:95], v15 offset:26624
    s_waitcnt lgkmcnt(0)
    s_branch Lwe_19
Lwn_20:
    s_cmp_lg_u32 s56, 1
    s_cbranch_scc1 Lwn_21
    ds_read_b64_tr_b16 a[48:49], v9 offset:16384
    ds_read_b64_tr_b16 a[50:51], v9 offset:24576
    ds_read_b64_tr_b16 a[52:53], v9 offset:18432
    ds_read_b64_tr_b16 a[54:55], v9 offset:26624
    ds_read_b64_tr_b16 v[88:89], v15 offset:16384
    ds_read_b64_tr_b16 v[90:91], v15 offset:24576
    ds_read_b64_tr_b16 v[92:93], v15 offset:18432
    ds_read_b64_tr_b16 v[94:95], v15 offset:26624
    s_waitcnt lgkmcnt(0)
    s_branch Lwe_19
Lwn_21:
    s_cmp_lg_u32 s56, 2
    s_cbranch_scc1 Lwn_22
    ds_read_b64_tr_b16 a[0:1], v9 offset:16384
    ds_read_b64_tr_b16 a[2:3], v9 offset:24576
    ds_read_b64_tr_b16 a[4:5], v9 offset:18432
    ds_read_b64_tr_b16 a[6:7], v9 offset:26624
    ds_read_b64_tr_b16 v[88:89], v15 offset:16384
    ds_read_b64_tr_b16 v[90:91], v15 offset:24576
    ds_read_b64_tr_b16 v[92:93], v15 offset:18432
    ds_read_b64_tr_b16 v[94:95], v15 offset:26624
    s_waitcnt lgkmcnt(0)
    s_branch Lwe_19
Lwn_22:
    ds_read_b64_tr_b16 a[16:17], v9 offset:16384
    ds_read_b64_tr_b16 a[18:19], v9 offset:24576
    ds_read_b64_tr_b16 a[20:21], v9 offset:18432
    ds_read_b64_tr_b16 a[22:23], v9 offset:26624
    ds_read_b64_tr_b16 v[88:89], v15 offset:16384
    ds_read_b64_tr_b16 v[90:91], v15 offset:24576
    ds_read_b64_tr_b16 v[92:93], v15 offset:18432
    ds_read_b64_tr_b16 v[94:95], v15 offset:26624
    s_waitcnt lgkmcnt(0)
Lwe_19:
    s_barrier
    s_add_u32 m0, s92, 0xc000
    s_add_u32 s89, s90, 0x180000
    buffer_load_dwordx4 v11, s[20:23], s89 offen lds
    s_add_u32 m0, s92, 0xd000
    s_add_u32 s89, s90, 0x1a0000
    buffer_load_dwordx4 v5, s[20:23], s89 offen lds
    s_add_u32 m0, s92, 0xe000
    s_add_u32 s89, s90, 0x1c0000
    buffer_load_dwordx4 v11, s[20:23], s89 offen lds
    s_add_u32 m0, s92, 0xf000
    s_add_u32 s89, s90, 0x1e0000
    buffer_load_dwordx4 v5, s[20:23], s89 offen lds
    s_waitcnt vmcnt(29)
    s_barrier
    v_add_u32 v9, 0x10000, v2
    v_add_u32 v15, 0x10010, v2
    s_cmp_lg_u32 s56, 0
    s_cbranch_scc1 Lwn_25
    ds_read_b64_tr_b16 a[48:49], v9 offset:0
    ds_read_b64_tr_b16 a[50:51], v9 offset:8192
    ds_read_b64_tr_b16 a[52:53], v9 offset:2048
    ds_read_b64_tr_b16 a[54:55], v9 offset:10240
    ds_read_b64_tr_b16 v[96:97], v15 offset:0
    ds_read_b64_tr_b16 v[98:99], v15 offset:8192
    ds_read_b64_tr_b16 v[100:101], v15 offset:2048
    ds_read_b64_tr_b16 v[102:103], v15 offset:10240
    s_waitcnt lgkmcnt(0)
    s_branch Lwe_24
Lwn_25:
    s_cmp_lg_u32 s56, 1
    s_cbranch_scc1 Lwn_26
    ds_read_b64_tr_b16 a[32:33], v9 offset:0
    ds_read_b64_tr_b16 a[34:35], v9 offset:8192
    ds_read_b64_tr_b16 a[36:37], v9 offset:2048
    ds_read_b64_tr_b16 a[38:39], v9 offset:10240
    ds_read_b64_tr_b16 v[96:97], v15 offset:0
    ds_read_b64_tr_b16 v[98:99], v15 offset:8192
    ds_read_b64_tr_b16 v[100:101], v15 offset:2048
    ds_read_b64_tr_b16 v[102:103], v15 offset:10240
    s_waitcnt lgkmcnt(0)
    s_branch Lwe_24
Lwn_26:
    s_cmp_lg_u32 s56, 2
    s_cbranch_scc1 Lwn_27
    ds_read_b64_tr_b16 a[16:17], v9 offset:0
    ds_read_b64_tr_b16 a[18:19], v9 offset:8192
    ds_read_b64_tr_b16 a[20:21], v9 offset:2048
    ds_read_b64_tr_b16 a[22:23], v9 offset:10240
    ds_read_b64_tr_b16 v[96:97], v15 offset:0
    ds_read_b64_tr_b16 v[98:99], v15 offset:8192
    ds_read_b64_tr_b16 v[100:101], v15 offset:2048
    ds_read_b64_tr_b16 v[102:103], v15 offset:10240
    s_waitcnt lgkmcnt(0)
    s_branch Lwe_24
Lwn_27:
    ds_read_b64_tr_b16 a[0:1], v9 offset:0
    ds_read_b64_tr_b16 a[2:3], v9 offset:8192
    ds_read_b64_tr_b16 a[4:5], v9 offset:2048
    ds_read_b64_tr_b16 a[6:7], v9 offset:10240
    ds_read_b64_tr_b16 v[96:97], v15 offset:0
    ds_read_b64_tr_b16 v[98:99], v15 offset:8192
    ds_read_b64_tr_b16 v[100:101], v15 offset:2048
    ds_read_b64_tr_b16 v[102:103], v15 offset:10240
    s_waitcnt lgkmcnt(0)
Lwe_24:
    s_barrier
    s_add_u32 m0, s92, 0x10000
    s_add_u32 s89, s90, 0x200000
    buffer_load_dwordx4 v11, s[20:23], s89 offen lds
    s_add_u32 m0, s92, 0x11000
    s_add_u32 s89, s90, 0x220000
    buffer_load_dwordx4 v5, s[20:23], s89 offen lds
    s_add_u32 m0, s92, 0x12000
    s_add_u32 s89, s90, 0x240000
    buffer_load_dwordx4 v11, s[20:23], s89 offen lds
    s_add_u32 m0, s92, 0x13000
    s_add_u32 s89, s90, 0x260000
    buffer_load_dwordx4 v5, s[20:23], s89 offen lds
    s_waitcnt vmcnt(32)
    v_cmp_ne_u32 vcc, 1, v3
    s_cbranch_vccnz Lz_29
    s_mov_b32 s93, 1
    s_cmp_lg_u32 s56, 0
    s_cbranch_scc1 Lann_30
    s_lshr_b32 s3, s2, 3
    s_lshl_b32 s3, s3, 7
    s_and_b32 vcc_lo, s2, 7
    s_add_u32 s3, s3, vcc_lo
    s_add_u32 s3, s3, 0x2000
    v_mov_b32 v3, s3
    v_mov_b32 v4, s58
    s_mov_b64 exec, 1
    buffer_store_byte v4, v3, s[4:7], 0 offen sc1
    s_mov_b64 exec, -1
Lann_30:
Lz_29:
    s_waitcnt vmcnt(28)
    s_barrier
    v_add_u32 v9, 0x10000, v2
    v_add_u32 v15, 0x10010, v2
    s_cmp_lg_u32 s56, 0
    s_cbranch_scc1 Lwn_32
    ds_read_b64_tr_b16 a[112:113], v9 offset:16384
    ds_read_b64_tr_b16 a[114:115], v9 offset:24576
    ds_read_b64_tr_b16 a[116:117], v9 offset:18432
    ds_read_b64_tr_b16 a[118:119], v9 offset:26624
    ds_read_b64_tr_b16 v[104:105], v15 offset:16384
    ds_read_b64_tr_b16 v[106:107], v15 offset:24576
    ds_read_b64_tr_b16 v[108:109], v15 offset:18432
    ds_read_b64_tr_b16 v[110:111], v15 offset:26624
    s_waitcnt lgkmcnt(0)
    s_branch Lwe_31
Lwn_32:
    s_cmp_lg_u32 s56, 1
    s_cbranch_scc1 Lwn_33
    ds_read_b64_tr_b16 a[96:97], v9 offset:16384
    ds_read_b64_tr_b16 a[98:99], v9 offset:24576
    ds_read_b64_tr_b16 a[100:101], v9 offset:18432
    ds_read_b64_tr_b16 a[102:103], v9 offset:26624
    ds_read_b64_tr_b16 v[104:105], v15 offset:16384
    ds_read_b64_tr_b16 v[106:107], v15 offset:24576
    ds_read_b64_tr_b16 v[108:109], v15 offset:18432
    ds_read_b64_tr_b16 v[110:111], v15 offset:26624
    s_waitcnt lgkmcnt(0)
    s_branch Lwe_31
Lwn_33:
    s_cmp_lg_u32 s56, 2
    s_cbranch_scc1 Lwn_34
    ds_read_b64_tr_b16 a[144:145], v9 offset:16384
    ds_read_b64_tr_b16 a[146:147], v9 offset:24576
    ds_read_b64_tr_b16 a[148:149], v9 offset:18432
    ds_read_b64_tr_b16 a[150:151], v9 offset:26624
    ds_read_b64_tr_b16 v[104:105], v15 offset:16384
    ds_read_b64_tr_b16 v[106:107], v15 offset:24576
    ds_read_b64_tr_b16 v[108:109], v15 offset:18432
    ds_read_b64_tr_b16 v[110:111], v15 offset:26624
    s_waitcnt lgkmcnt(0)
    s_branch Lwe_31
Lwn_34:
    ds_read_b64_tr_b16 a[128:129], v9 offset:16384
    ds_read_b64_tr_b16 a[130:131], v9 offset:24576
    ds_read_b64_tr_b16 a[132:133], v9 offset:18432
    ds_read_b64_tr_b16 a[134:135], v9 offset:26624
    ds_read_b64_tr_b16 v[104:105], v15 offset:16384
    ds_read_b64_tr_b16 v[106:107], v15 offset:24576
    ds_read_b64_tr_b16 v[108:109], v15 offset:18432
    ds_read_b64_tr_b16 v[110:111], v15 offset:26624
    s_waitcnt lgkmcnt(0)
Lwe_31:
    s_barrier
    s_add_u32 m0, s92, 0x14000
    s_add_u32 s89, s90, 0x280000
    buffer_load_dwordx4 v11, s[20:23], s89 offen lds
    s_add_u32 m0, s92, 0x15000
    s_add_u32 s89, s90, 0x2a0000
    buffer_load_dwordx4 v5, s[20:23], s89 offen lds
    s_add_u32 m0, s92, 0x16000
    s_add_u32 s89, s90, 0x2c0000
    buffer_load_dwordx4 v11, s[20:23], s89 offen lds
    s_add_u32 m0, s92, 0x17000
    s_add_u32 s89, s90, 0x2e0000
    buffer_load_dwordx4 v5, s[20:23], s89 offen lds
    s_waitcnt vmcnt(28)
    s_barrier
    v_add_u32 v9, 0x18000, v2
    v_add_u32 v15, 0x18010, v2
    s_cmp_lg_u32 s56, 0
    s_cbranch_scc1 Lwn_37
    ds_read_b64_tr_b16 a[128:129], v9 offset:0
    ds_read_b64_tr_b16 a[130:131], v9 offset:8192
    ds_read_b64_tr_b16 a[132:133], v9 offset:2048
    ds_read_b64_tr_b16 a[134:135], v9 offset:10240
    ds_read_b64_tr_b16 v[112:113], v15 offset:0
    ds_read_b64_tr_b16 v[114:115], v15 offset:8192
    ds_read_b64_tr_b16 v[116:117], v15 offset:2048
    ds_read_b64_tr_b16 v[118:119], v15 offset:10240
    s_waitcnt lgkmcnt(0)
    s_branch Lwe_36
Lwn_37:
    s_cmp_lg_u32 s56, 1
    s_cbranch_scc1 Lwn_38
    ds_read_b64_tr_b16 a[144:145], v9 offset:0
    ds_read_b64_tr_b16 a[146:147], v9 offset:8192
    ds_read_b64_tr_b16 a[148:149], v9 offset:2048
    ds_read_b64_tr_b16 a[150:151], v9 offset:10240
    ds_read_b64_tr_b16 v[112:113], v15 offset:0
    ds_read_b64_tr_b16 v[114:115], v15 offset:8192
    ds_read_b64_tr_b16 v[116:117], v15 offset:2048
    ds_read_b64_tr_b16 v[118:119], v15 offset:10240
    s_waitcnt lgkmcnt(0)
    s_branch Lwe_36
Lwn_38:
    s_cmp_lg_u32 s56, 2
    s_cbranch_scc1 Lwn_39
    ds_read_b64_tr_b16 a[96:97], v9 offset:0
    ds_read_b64_tr_b16 a[98:99], v9 offset:8192
    ds_read_b64_tr_b16 a[100:101], v9 offset:2048
    ds_read_b64_tr_b16 a[102:103], v9 offset:10240
    ds_read_b64_tr_b16 v[112:113], v15 offset:0
    ds_read_b64_tr_b16 v[114:115], v15 offset:8192
    ds_read_b64_tr_b16 v[116:117], v15 offset:2048
    ds_read_b64_tr_b16 v[118:119], v15 offset:10240
    s_waitcnt lgkmcnt(0)
    s_branch Lwe_36
Lwn_39:
    ds_read_b64_tr_b16 a[112:113], v9 offset:0
    ds_read_b64_tr_b16 a[114:115], v9 offset:8192
    ds_read_b64_tr_b16 a[116:117], v9 offset:2048
    ds_read_b64_tr_b16 a[118:119], v9 offset:10240
    ds_read_b64_tr_b16 v[112:113], v15 offset:0
    ds_read_b64_tr_b16 v[114:115], v15 offset:8192
    ds_read_b64_tr_b16 v[116:117], v15 offset:2048
    ds_read_b64_tr_b16 v[118:119], v15 offset:10240
    s_waitcnt lgkmcnt(0)
Lwe_36:
    s_barrier
    s_add_u32 m0, s92, 0x18000
    s_add_u32 s89, s90, 0x300000
    buffer_load_dwordx4 v11, s[20:23], s89 offen lds
    s_add_u32 m0, s92, 0x19000
    s_add_u32 s89, s90, 0x320000
    buffer_load_dwordx4 v5, s[20:23], s89 offen lds
    s_add_u32 m0, s92, 0x1a000
    s_add_u32 s89, s90, 0x340000
    buffer_load_dwordx4 v11, s[20:23], s89 offen lds
    s_add_u32 m0, s92, 0x1b000
    s_add_u32 s89, s90, 0x360000
    buffer_load_dwordx4 v5, s[20:23], s89 offen lds
    s_waitcnt vmcnt(28)
    s_barrier
    v_add_u32 v9, 0x18000, v2
    v_add_u32 v15, 0x18010, v2
    s_cmp_lg_u32 s56, 0
    s_cbranch_scc1 Lwn_42
    ds_read_b64_tr_b16 a[144:145], v9 offset:16384
    ds_read_b64_tr_b16 a[146:147], v9 offset:24576
    ds_read_b64_tr_b16 a[148:149], v9 offset:18432
    ds_read_b64_tr_b16 a[150:151], v9 offset:26624
    ds_read_b64_tr_b16 v[120:121], v15 offset:16384
    ds_read_b64_tr_b16 v[122:123], v15 offset:24576
    ds_read_b64_tr_b16 v[124:125], v15 offset:18432
    ds_read_b64_tr_b16 v[126:127], v15 offset:26624
    s_waitcnt lgkmcnt(0)
    s_branch Lwe_41
Lwn_42:
    s_cmp_lg_u32 s56, 1
    s_cbranch_scc1 Lwn_43
    ds_read_b64_tr_b16 a[128:129], v9 offset:16384
    ds_read_b64_tr_b16 a[130:131], v9 offset:24576
    ds_read_b64_tr_b16 a[132:133], v9 offset:18432
    ds_read_b64_tr_b16 a[134:135], v9 offset:26624
    ds_read_b64_tr_b16 v[120:121], v15 offset:16384
    ds_read_b64_tr_b16 v[122:123], v15 offset:24576
    ds_read_b64_tr_b16 v[124:125], v15 offset:18432
    ds_read_b64_tr_b16 v[126:127], v15 offset:26624
    s_waitcnt lgkmcnt(0)
    s_branch Lwe_41
Lwn_43:
    s_cmp_lg_u32 s56, 2
    s_cbranch_scc1 Lwn_44
    ds_read_b64_tr_b16 a[112:113], v9 offset:16384
    ds_read_b64_tr_b16 a[114:115], v9 offset:24576
    ds_read_b64_tr_b16 a[116:117], v9 offset:18432
    ds_read_b64_tr_b16 a[118:119], v9 offset:26624
    ds_read_b64_tr_b16 v[120:121], v15 offset:16384
    ds_read_b64_tr_b16 v[122:123], v15 offset:24576
    ds_read_b64_tr_b16 v[124:125], v15 offset:18432
    ds_read_b64_tr_b16 v[126:127], v15 offset:26624
    s_waitcnt lgkmcnt(0)
    s_branch Lwe_41
Lwn_44:
    ds_read_b64_tr_b16 a[96:97], v9 offset:16384
    ds_read_b64_tr_b16 a[98:99], v9 offset:24576
    ds_read_b64_tr_b16 a[100:101], v9 offset:18432
    ds_read_b64_tr_b16 a[102:103], v9 offset:26624
    ds_read_b64_tr_b16 v[120:121], v15 offset:16384
    ds_read_b64_tr_b16 v[122:123], v15 offset:24576
    ds_read_b64_tr_b16 v[124:125], v15 offset:18432
    ds_read_b64_tr_b16 v[126:127], v15 offset:26624
    s_waitcnt lgkmcnt(0)
Lwe_41:
    s_barrier
    s_add_u32 m0, s92, 0x1c000
    s_add_u32 s89, s90, 0x380000
    buffer_load_dwordx4 v11, s[20:23], s89 offen lds
    s_add_u32 m0, s92, 0x1d000
    s_add_u32 s89, s90, 0x3a0000
    buffer_load_dwordx4 v5, s[20:23], s89 offen lds
    s_add_u32 m0, s92, 0x1e000
    s_add_u32 s89, s90, 0x3c0000
    buffer_load_dwordx4 v11, s[20:23], s89 offen lds
    s_add_u32 m0, s92, 0x1f000
    s_add_u32 s89, s90, 0x3e0000
    buffer_load_dwordx4 v5, s[20:23], s89 offen lds
    v_and_b32 v4, 7, v0
    v_lshlrev_b32 v4, 2, v4
    buffer_load_dword v3, v4, s[4:7], 0 offen offset:256 sc1
    s_waitcnt vmcnt(29)
    s_barrier
    v_xor_b32 v9, 0, v14
    v_add_u32 v9, 0x20000, v9
    v_xor_b32 v15, 32, v14
    v_add_u32 v15, 0x20000, v15
    s_cmp_lg_u32 s56, 0
    s_cbranch_scc1 Lwn_47
    ds_read_b64_tr_b16 a[192:193], v9 offset:0
    ds_read_b64_tr_b16 a[194:195], v9 offset:8192
    ds_read_b64_tr_b16 a[196:197], v9 offset:2048
    ds_read_b64_tr_b16 a[198:199], v9 offset:10240
    ds_read_b64_tr_b16 v[128:129], v15 offset:0
    ds_read_b64_tr_b16 v[130:131], v15 offset:8192
    ds_read_b64_tr_b16 v[132:133], v15 offset:2048
    ds_read_b64_tr_b16 v[134:135], v15 offset:10240
    s_waitcnt lgkmcnt(0)
    s_branch Lwe_46
Lwn_47:
    s_cmp_lg_u32 s56, 1
    s_cbranch_scc1 Lwn_48
    ds_read_b64_tr_b16 a[208:209], v9 offset:0
    ds_read_b64_tr_b16 a[210:211], v9 offset:8192
    ds_read_b64_tr_b16 a[212:213], v9 offset:2048
    ds_read_b64_tr_b16 a[214:215], v9 offset:10240
    ds_read_b64_tr_b16 v[144:145], v15 offset:0
    ds_read_b64_tr_b16 v[146:147], v15 offset:8192
    ds_read_b64_tr_b16 v[148:149], v15 offset:2048
    ds_read_b64_tr_b16 v[150:151], v15 offset:10240
    s_waitcnt lgkmcnt(0)
    s_branch Lwe_46
Lwn_48:
    s_cmp_lg_u32 s56, 2
    s_cbranch_scc1 Lwn_49
    ds_read_b64_tr_b16 a[224:225], v9 offset:0
    ds_read_b64_tr_b16 a[226:227], v9 offset:8192
    ds_read_b64_tr_b16 a[228:229], v9 offset:2048
    ds_read_b64_tr_b16 a[230:231], v9 offset:10240
    ds_read_b64_tr_b16 v[160:161], v15 offset:0
    ds_read_b64_tr_b16 v[162:163], v15 offset:8192
    ds_read_b64_tr_b16 v[164:165], v15 offset:2048
    ds_read_b64_tr_b16 v[166:167], v15 offset:10240
    s_waitcnt lgkmcnt(0)
    s_branch Lwe_46
Lwn_49:
    ds_read_b64_tr_b16 a[240:241], v9 offset:0
    ds_read_b64_tr_b16 a[242:243], v9 offset:8192
    ds_read_b64_tr_b16 a[244:245], v9 offset:2048
    ds_read_b64_tr_b16 a[246:247], v9 offset:10240
    ds_read_b64_tr_b16 v[176:177], v15 offset:0
    ds_read_b64_tr_b16 v[178:179], v15 offset:8192
    ds_read_b64_tr_b16 v[180:181], v15 offset:2048
    ds_read_b64_tr_b16 v[182:183], v15 offset:10240
    s_waitcnt lgkmcnt(0)
Lwe_46:
    s_barrier
    s_add_u32 m0, s92, 0x20000
    s_add_u32 s89, s90, 0x80000
    buffer_load_dwordx4 v11, s[12:15], s89 offen lds
    s_add_u32 m0, s92, 0x21000
    s_add_u32 s89, s90, 0xa0000
    buffer_load_dwordx4 v5, s[12:15], s89 offen lds
    s_add_u32 m0, s92, 0x22000
    s_add_u32 s89, s90, 0xc0000
    buffer_load_dwordx4 v11, s[12:15], s89 offen lds
    s_add_u32 m0, s92, 0x23000
    s_add_u32 s89, s90, 0xe0000
    buffer_load_dwordx4 v5, s[12:15], s89 offen lds
    s_waitcnt vmcnt(29)
    s_barrier
    v_xor_b32 v9, 0, v14
    v_add_u32 v9, 0x20000, v9
    v_xor_b32 v15, 32, v14
    v_add_u32 v15, 0x20000, v15
    s_cmp_lg_u32 s56, 0
    s_cbranch_scc1 Lwn_52
    ds_read_b64_tr_b16 a[200:201], v9 offset:16384
    ds_read_b64_tr_b16 a[202:203], v9 offset:24576
    ds_read_b64_tr_b16 a[204:205], v9 offset:18432
    ds_read_b64_tr_b16 a[206:207], v9 offset:26624
    ds_read_b64_tr_b16 v[136:137], v15 offset:16384
    ds_read_b64_tr_b16 v[138:139], v15 offset:24576
    ds_read_b64_tr_b16 v[140:141], v15 offset:18432
    ds_read_b64_tr_b16 v[142:143], v15 offset:26624
    s_waitcnt lgkmcnt(0)
    s_branch Lwe_51
Lwn_52:
    s_cmp_lg_u32 s56, 1
    s_cbranch_scc1 Lwn_53
    ds_read_b64_tr_b16 a[216:217], v9 offset:16384
    ds_read_b64_tr_b16 a[218:219], v9 offset:24576
    ds_read_b64_tr_b16 a[220:221], v9 offset:18432
    ds_read_b64_tr_b16 a[222:223], v9 offset:26624
    ds_read_b64_tr_b16 v[152:153], v15 offset:16384
    ds_read_b64_tr_b16 v[154:155], v15 offset:24576
    ds_read_b64_tr_b16 v[156:157], v15 offset:18432
    ds_read_b64_tr_b16 v[158:159], v15 offset:26624
    s_waitcnt lgkmcnt(0)
    s_branch Lwe_51
Lwn_53:
    s_cmp_lg_u32 s56, 2
    s_cbranch_scc1 Lwn_54
    ds_read_b64_tr_b16 a[232:233], v9 offset:16384
    ds_read_b64_tr_b16 a[234:235], v9 offset:24576
    ds_read_b64_tr_b16 a[236:237], v9 offset:18432
    ds_read_b64_tr_b16 a[238:239], v9 offset:26624
    ds_read_b64_tr_b16 v[168:169], v15 offset:16384
    ds_read_b64_tr_b16 v[170:171], v15 offset:24576
    ds_read_b64_tr_b16 v[172:173], v15 offset:18432
    ds_read_b64_tr_b16 v[174:175], v15 offset:26624
    s_waitcnt lgkmcnt(0)
    s_branch Lwe_51
Lwn_54:
    ds_read_b64_tr_b16 a[248:249], v9 offset:16384
    ds_read_b64_tr_b16 a[250:251], v9 offset:24576
    ds_read_b64_tr_b16 a[252:253], v9 offset:18432
    ds_read_b64_tr_b16 a[254:255], v9 offset:26624
    ds_read_b64_tr_b16 v[184:185], v15 offset:16384
    ds_read_b64_tr_b16 v[186:187], v15 offset:24576
    ds_read_b64_tr_b16 v[188:189], v15 offset:18432
    ds_read_b64_tr_b16 v[190:191], v15 offset:26624
    s_waitcnt lgkmcnt(0)
Lwe_51:
    s_barrier
    s_add_u32 m0, s92, 0x24000
    s_add_u32 s89, s90, 0x180000
    buffer_load_dwordx4 v11, s[12:15], s89 offen lds
    s_add_u32 m0, s92, 0x25000
    s_add_u32 s89, s90, 0x1a0000
    buffer_load_dwordx4 v5, s[12:15], s89 offen lds
    s_add_u32 m0, s92, 0x26000
    s_add_u32 s89, s90, 0x1c0000
    buffer_load_dwordx4 v11, s[12:15], s89 offen lds
    s_add_u32 m0, s92, 0x27000
    s_add_u32 s89, s90, 0x1e0000
    buffer_load_dwordx4 v5, s[12:15], s89 offen lds
    s_waitcnt vmcnt(29)
    s_barrier
    v_xor_b32 v9, 0, v14
    v_add_u32 v9, 0x8000, v9
    v_xor_b32 v15, 32, v14
    v_add_u32 v15, 0x8000, v15
    s_cmp_lg_u32 s56, 0
    s_cbranch_scc1 Lwn_57
    ds_read_b64_tr_b16 a[208:209], v9 offset:0
    ds_read_b64_tr_b16 a[210:211], v9 offset:8192
    ds_read_b64_tr_b16 a[212:213], v9 offset:2048
    ds_read_b64_tr_b16 a[214:215], v9 offset:10240
    ds_read_b64_tr_b16 v[144:145], v15 offset:0
    ds_read_b64_tr_b16 v[146:147], v15 offset:8192
    ds_read_b64_tr_b16 v[148:149], v15 offset:2048
    ds_read_b64_tr_b16 v[150:151], v15 offset:10240
    s_waitcnt lgkmcnt(0)
    s_branch Lwe_56
Lwn_57:
    s_cmp_lg_u32 s56, 1
    s_cbranch_scc1 Lwn_58
    ds_read_b64_tr_b16 a[192:193], v9 offset:0
    ds_read_b64_tr_b16 a[194:195], v9 offset:8192
    ds_read_b64_tr_b16 a[196:197], v9 offset:2048
    ds_read_b64_tr_b16 a[198:199], v9 offset:10240
    ds_read_b64_tr_b16 v[128:129], v15 offset:0
    ds_read_b64_tr_b16 v[130:131], v15 offset:8192
    ds_read_b64_tr_b16 v[132:133], v15 offset:2048
    ds_read_b64_tr_b16 v[134:135], v15 offset:10240
    s_waitcnt lgkmcnt(0)
    s_branch Lwe_56
Lwn_58:
    s_cmp_lg_u32 s56, 2
    s_cbranch_scc1 Lwn_59
    ds_read_b64_tr_b16 a[240:241], v9 offset:0
    ds_read_b64_tr_b16 a[242:243], v9 offset:8192
    ds_read_b64_tr_b16 a[244:245], v9 offset:2048
    ds_read_b64_tr_b16 a[246:247], v9 offset:10240
    ds_read_b64_tr_b16 v[176:177], v15 offset:0
    ds_read_b64_tr_b16 v[178:179], v15 offset:8192
    ds_read_b64_tr_b16 v[180:181], v15 offset:2048
    ds_read_b64_tr_b16 v[182:183], v15 offset:10240
    s_waitcnt lgkmcnt(0)
    s_branch Lwe_56
Lwn_59:
    ds_read_b64_tr_b16 a[224:225], v9 offset:0
    ds_read_b64_tr_b16 a[226:227], v9 offset:8192
    ds_read_b64_tr_b16 a[228:229], v9 offset:2048
    ds_read_b64_tr_b16 a[230:231], v9 offset:10240
    ds_read_b64_tr_b16 v[160:161], v15 offset:0
    ds_read_b64_tr_b16 v[162:163], v15 offset:8192
    ds_read_b64_tr_b16 v[164:165], v15 offset:2048
    ds_read_b64_tr_b16 v[166:167], v15 offset:10240
    s_waitcnt lgkmcnt(0)
Lwe_56:
    s_barrier
    s_add_u32 m0, s92, 0x8000
    s_add_u32 s89, s90, 0x280000
    buffer_load_dwordx4 v11, s[12:15], s89 offen lds
    s_add_u32 m0, s92, 0x9000
    s_add_u32 s89, s90, 0x2a0000
    buffer_load_dwordx4 v5, s[12:15], s89 offen lds
    s_add_u32 m0, s92, 0xa000
    s_add_u32 s89, s90, 0x2c0000
    buffer_load_dwordx4 v11, s[12:15], s89 offen lds
    s_add_u32 m0, s92, 0xb000
    s_add_u32 s89, s90, 0x2e0000
    buffer_load_dwordx4 v5, s[12:15], s89 offen lds
    s_waitcnt vmcnt(29)
    s_barrier
    v_xor_b32 v9, 0, v14
    v_add_u32 v9, 0x8000, v9
    v_xor_b32 v15, 32, v14
    v_add_u32 v15, 0x8000, v15
    s_cmp_lg_u32 s56, 0
    s_cbranch_scc1 Lwn_62
    ds_read_b64_tr_b16 a[216:217], v9 offset:16384
    ds_read_b64_tr_b16 a[218:219], v9 offset:24576
    ds_read_b64_tr_b16 a[220:221], v9 offset:18432
    ds_read_b64_tr_b16 a[222:223], v9 offset:26624
    ds_read_b64_tr_b16 v[152:153], v15 offset:16384
    ds_read_b64_tr_b16 v[154:155], v15 offset:24576
    ds_read_b64_tr_b16 v[156:157], v15 offset:18432
    ds_read_b64_tr_b16 v[158:159], v15 offset:26624
    s_waitcnt lgkmcnt(0)
    s_branch Lwe_61
Lwn_62:
    s_cmp_lg_u32 s56, 1
    s_cbranch_scc1 Lwn_63
    ds_read_b64_tr_b16 a[200:201], v9 offset:16384
    ds_read_b64_tr_b16 a[202:203], v9 offset:24576
    ds_read_b64_tr_b16 a[204:205], v9 offset:18432
    ds_read_b64_tr_b16 a[206:207], v9 offset:26624
    ds_read_b64_tr_b16 v[136:137], v15 offset:16384
    ds_read_b64_tr_b16 v[138:139], v15 offset:24576
    ds_read_b64_tr_b16 v[140:141], v15 offset:18432
    ds_read_b64_tr_b16 v[142:143], v15 offset:26624
    s_waitcnt lgkmcnt(0)
    s_branch Lwe_61
Lwn_63:
    s_cmp_lg_u32 s56, 2
    s_cbranch_scc1 Lwn_64
    ds_read_b64_tr_b16 a[248:249], v9 offset:16384
    ds_read_b64_tr_b16 a[250:251], v9 offset:24576
    ds_read_b64_tr_b16 a[252:253], v9 offset:18432
    ds_read_b64_tr_b16 a[254:255], v9 offset:26624
    ds_read_b64_tr_b16 v[184:185], v15 offset:16384
    ds_read_b64_tr_b16 v[186:187], v15 offset:24576
    ds_read_b64_tr_b16 v[188:189], v15 offset:18432
    ds_read_b64_tr_b16 v[190:191], v15 offset:26624
    s_waitcnt lgkmcnt(0)
    s_branch Lwe_61
Lwn_64:
    ds_read_b64_tr_b16 a[232:233], v9 offset:16384
    ds_read_b64_tr_b16 a[234:235], v9 offset:24576
    ds_read_b64_tr_b16 a[236:237], v9 offset:18432
    ds_read_b64_tr_b16 a[238:239], v9 offset:26624
    ds_read_b64_tr_b16 v[168:169], v15 offset:16384
    ds_read_b64_tr_b16 v[170:171], v15 offset:24576
    ds_read_b64_tr_b16 v[172:173], v15 offset:18432
    ds_read_b64_tr_b16 v[174:175], v15 offset:26624
    s_waitcnt lgkmcnt(0)
Lwe_61:
    s_barrier
    s_add_u32 m0, s92, 0xc000
    s_add_u32 s89, s90, 0x380000
    buffer_load_dwordx4 v11, s[12:15], s89 offen lds
    s_add_u32 m0, s92, 0xd000
    s_add_u32 s89, s90, 0x3a0000
    buffer_load_dwordx4 v5, s[12:15], s89 offen lds
    s_add_u32 m0, s92, 0xe000
    s_add_u32 s89, s90, 0x3c0000
    buffer_load_dwordx4 v11, s[12:15], s89 offen lds
    s_add_u32 m0, s92, 0xf000
    s_add_u32 s89, s90, 0x3e0000
    buffer_load_dwordx4 v5, s[12:15], s89 offen lds
    s_waitcnt vmcnt(29)
    s_barrier
    v_xor_b32 v9, 0, v14
    v_add_u32 v9, 0x10000, v9
    v_xor_b32 v15, 32, v14
    v_add_u32 v15, 0x10000, v15
    s_cmp_lg_u32 s56, 0
    s_cbranch_scc1 Lwn_67
    ds_read_b64_tr_b16 a[224:225], v9 offset:0
    ds_read_b64_tr_b16 a[226:227], v9 offset:8192
    ds_read_b64_tr_b16 a[228:229], v9 offset:2048
    ds_read_b64_tr_b16 a[230:231], v9 offset:10240
    ds_read_b64_tr_b16 v[160:161], v15 offset:0
    ds_read_b64_tr_b16 v[162:163], v15 offset:8192
    ds_read_b64_tr_b16 v[164:165], v15 offset:2048
    ds_read_b64_tr_b16 v[166:167], v15 offset:10240
    s_waitcnt lgkmcnt(0)
    s_branch Lwe_66
Lwn_67:
    s_cmp_lg_u32 s56, 1
    s_cbranch_scc1 Lwn_68
    ds_read_b64_tr_b16 a[240:241], v9 offset:0
    ds_read_b64_tr_b16 a[242:243], v9 offset:8192
    ds_read_b64_tr_b16 a[244:245], v9 offset:2048
    ds_read_b64_tr_b16 a[246:247], v9 offset:10240
    ds_read_b64_tr_b16 v[176:177], v15 offset:0
    ds_read_b64_tr_b16 v[178:179], v15 offset:8192
    ds_read_b64_tr_b16 v[180:181], v15 offset:2048
    ds_read_b64_tr_b16 v[182:183], v15 offset:10240
    s_waitcnt lgkmcnt(0)
    s_branch Lwe_66
Lwn_68:
    s_cmp_lg_u32 s56, 2
    s_cbranch_scc1 Lwn_69
    ds_read_b64_tr_b16 a[192:193], v9 offset:0
    ds_read_b64_tr_b16 a[194:195], v9 offset:8192
    ds_read_b64_tr_b16 a[196:197], v9 offset:2048
    ds_read_b64_tr_b16 a[198:199], v9 offset:10240
    ds_read_b64_tr_b16 v[128:129], v15 offset:0
    ds_read_b64_tr_b16 v[130:131], v15 offset:8192
    ds_read_b64_tr_b16 v[132:133], v15 offset:2048
    ds_read_b64_tr_b16 v[134:135], v15 offset:10240
    s_waitcnt lgkmcnt(0)
    s_branch Lwe_66
Lwn_69:
    ds_read_b64_tr_b16 a[208:209], v9 offset:0
    ds_read_b64_tr_b16 a[210:211], v9 offset:8192
    ds_read_b64_tr_b16 a[212:213], v9 offset:2048
    ds_read_b64_tr_b16 a[214:215], v9 offset:10240
    ds_read_b64_tr_b16 v[144:145], v15 offset:0
    ds_read_b64_tr_b16 v[146:147], v15 offset:8192
    ds_read_b64_tr_b16 v[148:149], v15 offset:2048
    ds_read_b64_tr_b16 v[150:151], v15 offset:10240
    s_waitcnt lgkmcnt(0)
Lwe_66:
    s_barrier
    s_add_u32 m0, s92, 0x10000
    s_add_u32 s89, s90, 0x80000
    buffer_load_dwordx4 v11, s[16:19], s89 offen lds
    s_add_u32 m0, s92, 0x11000
    s_add_u32 s89, s90, 0xa0000
    buffer_load_dwordx4 v5, s[16:19], s89 offen lds
    s_add_u32 m0, s92, 0x12000
    s_add_u32 s89, s90, 0xc0000
    buffer_load_dwordx4 v11, s[16:19], s89 offen lds
    s_add_u32 m0, s92, 0x13000
    s_add_u32 s89, s90, 0xe0000
    buffer_load_dwordx4 v5, s[16:19], s89 offen lds
    s_waitcnt vmcnt(29)
    s_barrier
    v_xor_b32 v9, 0, v14
    v_add_u32 v9, 0x10000, v9
    v_xor_b32 v15, 32, v14
    v_add_u32 v15, 0x10000, v15
    s_cmp_lg_u32 s56, 0
    s_cbranch_scc1 Lwn_72
    ds_read_b64_tr_b16 a[232:233], v9 offset:16384
    ds_read_b64_tr_b16 a[234:235], v9 offset:24576
    ds_read_b64_tr_b16 a[236:237], v9 offset:18432
    ds_read_b64_tr_b16 a[238:239], v9 offset:26624
    ds_read_b64_tr_b16 v[168:169], v15 offset:16384
    ds_read_b64_tr_b16 v[170:171], v15 offset:24576
    ds_read_b64_tr_b16 v[172:173], v15 offset:18432
    ds_read_b64_tr_b16 v[174:175], v15 offset:26624
    s_waitcnt lgkmcnt(0)
    s_branch Lwe_71
Lwn_72:
    s_cmp_lg_u32 s56, 1
    s_cbranch_scc1 Lwn_73
    ds_read_b64_tr_b16 a[248:249], v9 offset:16384
    ds_read_b64_tr_b16 a[250:251], v9 offset:24576
    ds_read_b64_tr_b16 a[252:253], v9 offset:18432
    ds_read_b64_tr_b16 a[254:255], v9 offset:26624
    ds_read_b64_tr_b16 v[184:185], v15 offset:16384
    ds_read_b64_tr_b16 v[186:187], v15 offset:24576
    ds_read_b64_tr_b16 v[188:189], v15 offset:18432
    ds_read_b64_tr_b16 v[190:191], v15 offset:26624
    s_waitcnt lgkmcnt(0)
    s_branch Lwe_71
Lwn_73:
    s_cmp_lg_u32 s56, 2
    s_cbranch_scc1 Lwn_74
    ds_read_b64_tr_b16 a[200:201], v9 offset:16384
    ds_read_b64_tr_b16 a[202:203], v9 offset:24576
    ds_read_b64_tr_b16 a[204:205], v9 offset:18432
    ds_read_b64_tr_b16 a[206:207], v9 offset:26624
    ds_read_b64_tr_b16 v[136:137], v15 offset:16384
    ds_read_b64_tr_b16 v[138:139], v15 offset:24576
    ds_read_b64_tr_b16 v[140:141], v15 offset:18432
    ds_read_b64_tr_b16 v[142:143], v15 offset:26624
    s_waitcnt lgkmcnt(0)
    s_branch Lwe_71
Lwn_74:
    ds_read_b64_tr_b16 a[216:217], v9 offset:16384
    ds_read_b64_tr_b16 a[218:219], v9 offset:24576
    ds_read_b64_tr_b16 a[220:221], v9 offset:18432
    ds_read_b64_tr_b16 a[222:223], v9 offset:26624
    ds_read_b64_tr_b16 v[152:153], v15 offset:16384
    ds_read_b64_tr_b16 v[154:155], v15 offset:24576
    ds_read_b64_tr_b16 v[156:157], v15 offset:18432
    ds_read_b64_tr_b16 v[158:159], v15 offset:26624
    s_waitcnt lgkmcnt(0)
Lwe_71:
    s_barrier
    s_add_u32 m0, s92, 0x14000
    s_add_u32 s89, s90, 0x180000
    buffer_load_dwordx4 v11, s[16:19], s89 offen lds
    s_add_u32 m0, s92, 0x15000
    s_add_u32 s89, s90, 0x1a0000
    buffer_load_dwordx4 v5, s[16:19], s89 offen lds
    s_add_u32 m0, s92, 0x16000
    s_add_u32 s89, s90, 0x1c0000
    buffer_load_dwordx4 v11, s[16:19], s89 offen lds
    s_add_u32 m0, s92, 0x17000
    s_add_u32 s89, s90, 0x1e0000
    buffer_load_dwordx4 v5, s[16:19], s89 offen lds
    s_waitcnt vmcnt(29)
    s_barrier
    v_xor_b32 v9, 0, v14
    v_add_u32 v9, 0x18000, v9
    v_xor_b32 v15, 32, v14
    v_add_u32 v15, 0x18000, v15
    s_cmp_lg_u32 s56, 0
    s_cbranch_scc1 Lwn_77
    ds_read_b64_tr_b16 a[240:241], v9 offset:0
    ds_read_b64_tr_b16 a[242:243], v9 offset:8192
    ds_read_b64_tr_b16 a[244:245], v9 offset:2048
    ds_read_b64_tr_b16 a[246:247], v9 offset:10240
    ds_read_b64_tr_b16 v[176:177], v15 offset:0
    ds_read_b64_tr_b16 v[178:179], v15 offset:8192
    ds_read_b64_tr_b16 v[180:181], v15 offset:2048
    ds_read_b64_tr_b16 v[182:183], v15 offset:10240
    s_waitcnt lgkmcnt(0)
    s_branch Lwe_76
Lwn_77:
    s_cmp_lg_u32 s56, 1
    s_cbranch_scc1 Lwn_78
    ds_read_b64_tr_b16 a[224:225], v9 offset:0
    ds_read_b64_tr_b16 a[226:227], v9 offset:8192
    ds_read_b64_tr_b16 a[228:229], v9 offset:2048
    ds_read_b64_tr_b16 a[230:231], v9 offset:10240
    ds_read_b64_tr_b16 v[160:161], v15 offset:0
    ds_read_b64_tr_b16 v[162:163], v15 offset:8192
    ds_read_b64_tr_b16 v[164:165], v15 offset:2048
    ds_read_b64_tr_b16 v[166:167], v15 offset:10240
    s_waitcnt lgkmcnt(0)
    s_branch Lwe_76
Lwn_78:
    s_cmp_lg_u32 s56, 2
    s_cbranch_scc1 Lwn_79
    ds_read_b64_tr_b16 a[208:209], v9 offset:0
    ds_read_b64_tr_b16 a[210:211], v9 offset:8192
    ds_read_b64_tr_b16 a[212:213], v9 offset:2048
    ds_read_b64_tr_b16 a[214:215], v9 offset:10240
    ds_read_b64_tr_b16 v[144:145], v15 offset:0
    ds_read_b64_tr_b16 v[146:147], v15 offset:8192
    ds_read_b64_tr_b16 v[148:149], v15 offset:2048
    ds_read_b64_tr_b16 v[150:151], v15 offset:10240
    s_waitcnt lgkmcnt(0)
    s_branch Lwe_76
Lwn_79:
    ds_read_b64_tr_b16 a[192:193], v9 offset:0
    ds_read_b64_tr_b16 a[194:195], v9 offset:8192
    ds_read_b64_tr_b16 a[196:197], v9 offset:2048
    ds_read_b64_tr_b16 a[198:199], v9 offset:10240
    ds_read_b64_tr_b16 v[128:129], v15 offset:0
    ds_read_b64_tr_b16 v[130:131], v15 offset:8192
    ds_read_b64_tr_b16 v[132:133], v15 offset:2048
    ds_read_b64_tr_b16 v[134:135], v15 offset:10240
    s_waitcnt lgkmcnt(0)
Lwe_76:
    s_barrier
    s_add_u32 m0, s92, 0x18000
    s_add_u32 s89, s90, 0x280000
    buffer_load_dwordx4 v11, s[16:19], s89 offen lds
    s_add_u32 m0, s92, 0x19000
    s_add_u32 s89, s90, 0x2a0000
    buffer_load_dwordx4 v5, s[16:19], s89 offen lds
    s_add_u32 m0, s92, 0x1a000
    s_add_u32 s89, s90, 0x2c0000
    buffer_load_dwordx4 v11, s[16:19], s89 offen lds
    s_add_u32 m0, s92, 0x1b000
    s_add_u32 s89, s90, 0x2e0000
    buffer_load_dwordx4 v5, s[16:19], s89 offen lds
    s_waitcnt vmcnt(29)
    s_barrier
    v_xor_b32 v9, 0, v14
    v_add_u32 v9, 0x18000, v9
    v_xor_b32 v15, 32, v14
    v_add_u32 v15, 0x18000, v15
    s_cmp_lg_u32 s56, 0
    s_cbranch_scc1 Lwn_82
    ds_read_b64_tr_b16 a[248:249], v9 offset:16384
    ds_read_b64_tr_b16 a[250:251], v9 offset:24576
    ds_read_b64_tr_b16 a[252:253], v9 offset:18432
    ds_read_b64_tr_b16 a[254:255], v9 offset:26624
    ds_read_b64_tr_b16 v[184:185], v15 offset:16384
    ds_read_b64_tr_b16 v[186:187], v15 offset:24576
    ds_read_b64_tr_b16 v[188:189], v15 offset:18432
    ds_read_b64_tr_b16 v[190:191], v15 offset:26624
    s_waitcnt lgkmcnt(0)
    s_branch Lwe_81
Lwn_82:
    s_cmp_lg_u32 s56, 1
    s_cbranch_scc1 Lwn_83
    ds_read_b64_tr_b16 a[232:233], v9 offset:16384
    ds_read_b64_tr_b16 a[234:235], v9 offset:24576
    ds_read_b64_tr_b16 a[236:237], v9 offset:18432
    ds_read_b64_tr_b16 a[238:239], v9 offset:26624
    ds_read_b64_tr_b16 v[168:169], v15 offset:16384
    ds_read_b64_tr_b16 v[170:171], v15 offset:24576
    ds_read_b64_tr_b16 v[172:173], v15 offset:18432
    ds_read_b64_tr_b16 v[174:175], v15 offset:26624
    s_waitcnt lgkmcnt(0)
    s_branch Lwe_81
Lwn_83:
    s_cmp_lg_u32 s56, 2
    s_cbranch_scc1 Lwn_84
    ds_read_b64_tr_b16 a[216:217], v9 offset:16384
    ds_read_b64_tr_b16 a[218:219], v9 offset:24576
    ds_read_b64_tr_b16 a[220:221], v9 offset:18432
    ds_read_b64_tr_b16 a[222:223], v9 offset:26624
    ds_read_b64_tr_b16 v[152:153], v15 offset:16384
    ds_read_b64_tr_b16 v[154:155], v15 offset:24576
    ds_read_b64_tr_b16 v[156:157], v15 offset:18432
    ds_read_b64_tr_b16 v[158:159], v15 offset:26624
    s_waitcnt lgkmcnt(0)
    s_branch Lwe_81
Lwn_84:
    ds_read_b64_tr_b16 a[200:201], v9 offset:16384
    ds_read_b64_tr_b16 a[202:203], v9 offset:24576
    ds_read_b64_tr_b16 a[204:205], v9 offset:18432
    ds_read_b64_tr_b16 a[206:207], v9 offset:26624
    ds_read_b64_tr_b16 v[136:137], v15 offset:16384
    ds_read_b64_tr_b16 v[138:139], v15 offset:24576
    ds_read_b64_tr_b16 v[140:141], v15 offset:18432
    ds_read_b64_tr_b16 v[142:143], v15 offset:26624
    s_waitcnt lgkmcnt(0)
Lwe_81:
    s_barrier
    s_add_u32 m0, s92, 0x1c000
    s_add_u32 s89, s90, 0x380000
    buffer_load_dwordx4 v11, s[16:19], s89 offen lds
    s_add_u32 m0, s92, 0x1d000
    s_add_u32 s89, s90, 0x3a0000
    buffer_load_dwordx4 v5, s[16:19], s89 offen lds
    s_add_u32 m0, s92, 0x1e000
    s_add_u32 s89, s90, 0x3c0000
    buffer_load_dwordx4 v11, s[16:19], s89 offen lds
    s_add_u32 m0, s92, 0x1f000
    s_add_u32 s89, s90, 0x3e0000
    buffer_load_dwordx4 v5, s[16:19], s89 offen lds
    v_and_b32 v9, 63, v0
    v_lshlrev_b32 v9, 4, v9
    s_lshl_b32 s89, s56, 15
    s_add_u32 s89, s89, 0x8000
    v_add_u32 v7, s89, v9
    s_waitcnt vmcnt(28)
    s_barrier
    v_add_u32 v9, 0x20000, v2
    v_add_u32 v15, 0x20010, v2
    s_cmp_lg_u32 s56, 0
    s_cbranch_scc1 Lwn_87
    ds_read_b64_tr_b16 a[8:9], v9 offset:0
    ds_read_b64_tr_b16 a[10:11], v9 offset:8192
    ds_read_b64_tr_b16 a[12:13], v9 offset:2048
    ds_read_b64_tr_b16 a[14:15], v9 offset:10240
    ds_read_b64_tr_b16 a[64:65], v15 offset:0
    ds_read_b64_tr_b16 a[66:67], v15 offset:8192
    ds_read_b64_tr_b16 a[68:69], v15 offset:2048
    ds_read_b64_tr_b16 a[70:71], v15 offset:10240
    s_waitcnt lgkmcnt(0)
    s_branch Lwe_86
Lwn_87:
    s_cmp_lg_u32 s56, 1
    s_cbranch_scc1 Lwn_88
    ds_read_b64_tr_b16 a[24:25], v9 offset:0
    ds_read_b64_tr_b16 a[26:27], v9 offset:8192
    ds_read_b64_tr_b16 a[28:29], v9 offset:2048
    ds_read_b64_tr_b16 a[30:31], v9 offset:10240
    ds_read_b64_tr_b16 a[72:73], v15 offset:0
    ds_read_b64_tr_b16 a[74:75], v15 offset:8192
    ds_read_b64_tr_b16 a[76:77], v15 offset:2048
    ds_read_b64_tr_b16 a[78:79], v15 offset:10240
    s_waitcnt lgkmcnt(0)
    s_branch Lwe_86
Lwn_88:
    s_cmp_lg_u32 s56, 2
    s_cbranch_scc1 Lwn_89
    ds_read_b64_tr_b16 a[40:41], v9 offset:0
    ds_read_b64_tr_b16 a[42:43], v9 offset:8192
    ds_read_b64_tr_b16 a[44:45], v9 offset:2048
    ds_read_b64_tr_b16 a[46:47], v9 offset:10240
    ds_read_b64_tr_b16 a[80:81], v15 offset:0
    ds_read_b64_tr_b16 a[82:83], v15 offset:8192
    ds_read_b64_tr_b16 a[84:85], v15 offset:2048
    ds_read_b64_tr_b16 a[86:87], v15 offset:10240
    s_waitcnt lgkmcnt(0)
    s_branch Lwe_86
Lwn_89:
    ds_read_b64_tr_b16 a[56:57], v9 offset:0
    ds_read_b64_tr_b16 a[58:59], v9 offset:8192
    ds_read_b64_tr_b16 a[60:61], v9 offset:2048
    ds_read_b64_tr_b16 a[62:63], v9 offset:10240
    ds_read_b64_tr_b16 a[88:89], v15 offset:0
    ds_read_b64_tr_b16 a[90:91], v15 offset:8192
    ds_read_b64_tr_b16 a[92:93], v15 offset:2048
    ds_read_b64_tr_b16 a[94:95], v15 offset:10240
    s_waitcnt lgkmcnt(0)
Lwe_86:
    s_barrier
    s_waitcnt vmcnt(24)
    s_barrier
    v_add_u32 v9, 0x20000, v2
    v_add_u32 v15, 0x20010, v2
    s_cmp_lg_u32 s56, 0
    s_cbranch_scc1 Lwn_92
    ds_read_b64_tr_b16 a[24:25], v9 offset:16384
    ds_read_b64_tr_b16 a[26:27], v9 offset:24576
    ds_read_b64_tr_b16 a[28:29], v9 offset:18432
    ds_read_b64_tr_b16 a[30:31], v9 offset:26624
    ds_read_b64_tr_b16 a[72:73], v15 offset:16384
    ds_read_b64_tr_b16 a[74:75], v15 offset:24576
    ds_read_b64_tr_b16 a[76:77], v15 offset:18432
    ds_read_b64_tr_b16 a[78:79], v15 offset:26624
    s_waitcnt lgkmcnt(0)
    s_branch Lwe_91
Lwn_92:
    s_cmp_lg_u32 s56, 1
    s_cbranch_scc1 Lwn_93
    ds_read_b64_tr_b16 a[8:9], v9 offset:16384
    ds_read_b64_tr_b16 a[10:11], v9 offset:24576
    ds_read_b64_tr_b16 a[12:13], v9 offset:18432
    ds_read_b64_tr_b16 a[14:15], v9 offset:26624
    ds_read_b64_tr_b16 a[64:65], v15 offset:16384
    ds_read_b64_tr_b16 a[66:67], v15 offset:24576
    ds_read_b64_tr_b16 a[68:69], v15 offset:18432
    ds_read_b64_tr_b16 a[70:71], v15 offset:26624
    s_waitcnt lgkmcnt(0)
    s_branch Lwe_91
Lwn_93:
    s_cmp_lg_u32 s56, 2
    s_cbranch_scc1 Lwn_94
    ds_read_b64_tr_b16 a[56:57], v9 offset:16384
    ds_read_b64_tr_b16 a[58:59], v9 offset:24576
    ds_read_b64_tr_b16 a[60:61], v9 offset:18432
    ds_read_b64_tr_b16 a[62:63], v9 offset:26624
    ds_read_b64_tr_b16 a[88:89], v15 offset:16384
    ds_read_b64_tr_b16 a[90:91], v15 offset:24576
    ds_read_b64_tr_b16 a[92:93], v15 offset:18432
    ds_read_b64_tr_b16 a[94:95], v15 offset:26624
    s_waitcnt lgkmcnt(0)
    s_branch Lwe_91
Lwn_94:
    ds_read_b64_tr_b16 a[40:41], v9 offset:16384
    ds_read_b64_tr_b16 a[42:43], v9 offset:24576
    ds_read_b64_tr_b16 a[44:45], v9 offset:18432
    ds_read_b64_tr_b16 a[46:47], v9 offset:26624
    ds_read_b64_tr_b16 a[80:81], v15 offset:16384
    ds_read_b64_tr_b16 a[82:83], v15 offset:24576
    ds_read_b64_tr_b16 a[84:85], v15 offset:18432
    ds_read_b64_tr_b16 a[86:87], v15 offset:26624
    s_waitcnt lgkmcnt(0)
Lwe_91:
    s_barrier
    s_cmp_lg_u32 s56, 0
    s_cbranch_scc1 Lwn_97
    v_mbcnt_lo_u32_b32 v9, -1, 0
    v_lshlrev_b32 v9, 7, v9
    v_and_b32 v9, 0xf80, v9
    v_add_u32 v9, 0x2000, v9
    buffer_load_dwordx2 a[0:1], v9, s[4:7], 0 offen sc1
    s_branch Lwe_96
Lwn_97:
    s_cmp_lg_u32 s56, 1
    s_cbranch_scc1 Lwn_98
    v_mbcnt_lo_u32_b32 v9, -1, 0
    v_lshlrev_b32 v9, 7, v9
    v_and_b32 v9, 0xf80, v9
    v_add_u32 v9, 0x2000, v9
    buffer_load_dwordx2 a[16:17], v9, s[4:7], 0 offen sc1
    s_branch Lwe_96
Lwn_98:
    s_cmp_lg_u32 s56, 2
    s_cbranch_scc1 Lwn_99
    v_mbcnt_lo_u32_b32 v9, -1, 0
    v_lshlrev_b32 v9, 7, v9
    v_and_b32 v9, 0xf80, v9
    v_add_u32 v9, 0x2000, v9
    buffer_load_dwordx2 a[32:33], v9, s[4:7], 0 offen sc1
    s_branch Lwe_96
Lwn_99:
    v_mbcnt_lo_u32_b32 v9, -1, 0
    v_lshlrev_b32 v9, 7, v9
    v_and_b32 v9, 0xf80, v9
    v_add_u32 v9, 0x2000, v9
    buffer_load_dwordx2 a[48:49], v9, s[4:7], 0 offen sc1
Lwe_96:
    s_cmp_lg_u32 s56, 3
    s_cbranch_scc1 Lhw_101
    ds_write_b128 v7, v[16:19] offset:16384
    ds_write_b128 v7, v[20:23] offset:17408
    ds_write_b128 v7, v[24:27] offset:20480
    ds_write_b128 v7, v[28:31] offset:21504
    ds_write_b128 v7, v[32:35] offset:24576
    ds_write_b128 v7, v[36:39] offset:25600
    ds_write_b128 v7, v[40:43] offset:28672
    ds_write_b128 v7, v[44:47] offset:29696
    ds_write_b128 v7, v[48:51] offset:18432
    ds_write_b128 v7, v[52:55] offset:19456
    ds_write_b128 v7, v[56:59] offset:22528
    ds_write_b128 v7, v[60:63] offset:23552
    ds_write_b128 v7, v[64:67] offset:26624
    ds_write_b128 v7, v[68:71] offset:27648
    ds_write_b128 v7, v[72:75] offset:30720
    ds_write_b128 v7, v[76:79] offset:31744
    ds_write_b128 v7, v[80:83] offset:4096
    ds_write_b128 v7, v[84:87] offset:5120
    ds_write_b128 v7, v[88:91] offset:2048
    ds_write_b128 v7, v[92:95] offset:3072
    ds_write_b128 v7, v[96:99] offset:0
    ds_write_b128 v7, v[100:103] offset:1024
    ds_write_b128 v7, v[104:107] offset:12288
    ds_write_b128 v7, v[108:111] offset:13312
    ds_write_b128 v7, v[112:115] offset:10240
    ds_write_b128 v7, v[116:119] offset:11264
    ds_write_b128 v7, v[120:123] offset:8192
    ds_write_b128 v7, v[124:127] offset:9216
    s_waitcnt lgkmcnt(0)
Lhw_101:
    s_waitcnt vmcnt(21)
    s_barrier
    v_add_u32 v9, 0x8000, v2
    v_add_u32 v15, 0x8010, v2
    s_cmp_lg_u32 s56, 0
    s_cbranch_scc1 Lwn_103
    ds_read_b64_tr_b16 a[40:41], v9 offset:0
    ds_read_b64_tr_b16 a[42:43], v9 offset:8192
    ds_read_b64_tr_b16 a[44:45], v9 offset:2048
    ds_read_b64_tr_b16 a[46:47], v9 offset:10240
    ds_read_b64_tr_b16 a[80:81], v15 offset:0
    ds_read_b64_tr_b16 a[82:83], v15 offset:8192
    ds_read_b64_tr_b16 a[84:85], v15 offset:2048
    ds_read_b64_tr_b16 a[86:87], v15 offset:10240
    s_waitcnt lgkmcnt(0)
    s_branch Lwe_102
Lwn_103:
    s_cmp_lg_u32 s56, 1
    s_cbranch_scc1 Lwn_104
    ds_read_b64_tr_b16 a[56:57], v9 offset:0
    ds_read_b64_tr_b16 a[58:59], v9 offset:8192
    ds_read_b64_tr_b16 a[60:61], v9 offset:2048
    ds_read_b64_tr_b16 a[62:63], v9 offset:10240
    ds_read_b64_tr_b16 a[88:89], v15 offset:0
    ds_read_b64_tr_b16 a[90:91], v15 offset:8192
    ds_read_b64_tr_b16 a[92:93], v15 offset:2048
    ds_read_b64_tr_b16 a[94:95], v15 offset:10240
    s_waitcnt lgkmcnt(0)
    s_branch Lwe_102
Lwn_104:
    s_cmp_lg_u32 s56, 2
    s_cbranch_scc1 Lwn_105
    ds_read_b64_tr_b16 a[8:9], v9 offset:0
    ds_read_b64_tr_b16 a[10:11], v9 offset:8192
    ds_read_b64_tr_b16 a[12:13], v9 offset:2048
    ds_read_b64_tr_b16 a[14:15], v9 offset:10240
    ds_read_b64_tr_b16 a[64:65], v15 offset:0
    ds_read_b64_tr_b16 a[66:67], v15 offset:8192
    ds_read_b64_tr_b16 a[68:69], v15 offset:2048
    ds_read_b64_tr_b16 a[70:71], v15 offset:10240
    s_waitcnt lgkmcnt(0)
    s_branch Lwe_102
Lwn_105:
    ds_read_b64_tr_b16 a[24:25], v9 offset:0
    ds_read_b64_tr_b16 a[26:27], v9 offset:8192
    ds_read_b64_tr_b16 a[28:29], v9 offset:2048
    ds_read_b64_tr_b16 a[30:31], v9 offset:10240
    ds_read_b64_tr_b16 a[72:73], v15 offset:0
    ds_read_b64_tr_b16 a[74:75], v15 offset:8192
    ds_read_b64_tr_b16 a[76:77], v15 offset:2048
    ds_read_b64_tr_b16 a[78:79], v15 offset:10240
    s_waitcnt lgkmcnt(0)
Lwe_102:
    s_barrier
    s_waitcnt vmcnt(17)
    s_barrier
    v_add_u32 v9, 0x8000, v2
    v_add_u32 v15, 0x8010, v2
    s_cmp_lg_u32 s56, 0
    s_cbranch_scc1 Lwn_108
    ds_read_b64_tr_b16 a[56:57], v9 offset:16384
    ds_read_b64_tr_b16 a[58:59], v9 offset:24576
    ds_read_b64_tr_b16 a[60:61], v9 offset:18432
    ds_read_b64_tr_b16 a[62:63], v9 offset:26624
    ds_read_b64_tr_b16 a[88:89], v15 offset:16384
    ds_read_b64_tr_b16 a[90:91], v15 offset:24576
    ds_read_b64_tr_b16 a[92:93], v15 offset:18432
    ds_read_b64_tr_b16 a[94:95], v15 offset:26624
    s_waitcnt lgkmcnt(0)
    s_branch Lwe_107
Lwn_108:
    s_cmp_lg_u32 s56, 1
    s_cbranch_scc1 Lwn_109
    ds_read_b64_tr_b16 a[40:41], v9 offset:16384
    ds_read_b64_tr_b16 a[42:43], v9 offset:24576
    ds_read_b64_tr_b16 a[44:45], v9 offset:18432
    ds_read_b64_tr_b16 a[46:47], v9 offset:26624
    ds_read_b64_tr_b16 a[80:81], v15 offset:16384
    ds_read_b64_tr_b16 a[82:83], v15 offset:24576
    ds_read_b64_tr_b16 a[84:85], v15 offset:18432
    ds_read_b64_tr_b16 a[86:87], v15 offset:26624
    s_waitcnt lgkmcnt(0)
    s_branch Lwe_107
Lwn_109:
    s_cmp_lg_u32 s56, 2
    s_cbranch_scc1 Lwn_110
    ds_read_b64_tr_b16 a[24:25], v9 offset:16384
    ds_read_b64_tr_b16 a[26:27], v9 offset:24576
    ds_read_b64_tr_b16 a[28:29], v9 offset:18432
    ds_read_b64_tr_b16 a[30:31], v9 offset:26624
    ds_read_b64_tr_b16 a[72:73], v15 offset:16384
    ds_read_b64_tr_b16 a[74:75], v15 offset:24576
    ds_read_b64_tr_b16 a[76:77], v15 offset:18432
    ds_read_b64_tr_b16 a[78:79], v15 offset:26624
    s_waitcnt lgkmcnt(0)
    s_branch Lwe_107
Lwn_110:
    ds_read_b64_tr_b16 a[8:9], v9 offset:16384
    ds_read_b64_tr_b16 a[10:11], v9 offset:24576
    ds_read_b64_tr_b16 a[12:13], v9 offset:18432
    ds_read_b64_tr_b16 a[14:15], v9 offset:26624
    ds_read_b64_tr_b16 a[64:65], v15 offset:16384
    ds_read_b64_tr_b16 a[66:67], v15 offset:24576
    ds_read_b64_tr_b16 a[68:69], v15 offset:18432
    ds_read_b64_tr_b16 a[70:71], v15 offset:26624
    s_waitcnt lgkmcnt(0)
Lwe_107:
    s_barrier
    s_lshl_b32 s70, s57, 9
    s_add_u32 s70, s70, 0x8000
    v_and_b32 v1, 1, v0
    v_lshlrev_b32 v1, 7, v1
    buffer_load_dword v1, v1, s[4:7], s70 offen sc1
    s_cmp_lg_u32 s56, 0
    s_cbranch_scc1 Lhw_112
    ds_write_b128 v7, v[16:19] offset:16384
    ds_write_b128 v7, v[20:23] offset:17408
    ds_write_b128 v7, v[24:27] offset:20480
    ds_write_b128 v7, v[28:31] offset:21504
    ds_write_b128 v7, v[32:35] offset:24576
    ds_write_b128 v7, v[36:39] offset:25600
    ds_write_b128 v7, v[40:43] offset:28672
    ds_write_b128 v7, v[44:47] offset:29696
    ds_write_b128 v7, v[48:51] offset:18432
    ds_write_b128 v7, v[52:55] offset:19456
    ds_write_b128 v7, v[56:59] offset:22528
    ds_write_b128 v7, v[60:63] offset:23552
    ds_write_b128 v7, v[64:67] offset:26624
    ds_write_b128 v7, v[68:71] offset:27648
    ds_write_b128 v7, v[72:75] offset:30720
    ds_write_b128 v7, v[76:79] offset:31744
    ds_write_b128 v7, v[80:83] offset:2048
    ds_write_b128 v7, v[84:87] offset:3072
    ds_write_b128 v7, v[88:91] offset:4096
    ds_write_b128 v7, v[92:95] offset:5120
    ds_write_b128 v7, v[96:99] offset:6144
    ds_write_b128 v7, v[100:103] offset:7168
    ds_write_b128 v7, v[104:107] offset:10240
    ds_write_b128 v7, v[108:111] offset:11264
    ds_write_b128 v7, v[112:115] offset:12288
    ds_write_b128 v7, v[116:119] offset:13312
    ds_write_b128 v7, v[120:123] offset:14336
    ds_write_b128 v7, v[124:127] offset:15360
    s_waitcnt lgkmcnt(0)
Lhw_112:
    s_waitcnt vmcnt(14)
    s_barrier
    v_add_u32 v9, 0x10000, v2
    v_add_u32 v15, 0x10010, v2
    s_cmp_lg_u32 s56, 0
    s_cbranch_scc1 Lwn_114
    ds_read_b64_tr_b16 a[104:105], v9 offset:0
    ds_read_b64_tr_b16 a[106:107], v9 offset:8192
    ds_read_b64_tr_b16 a[108:109], v9 offset:2048
    ds_read_b64_tr_b16 a[110:111], v9 offset:10240
    ds_read_b64_tr_b16 a[160:161], v15 offset:0
    ds_read_b64_tr_b16 a[162:163], v15 offset:8192
    ds_read_b64_tr_b16 a[164:165], v15 offset:2048
    ds_read_b64_tr_b16 a[166:167], v15 offset:10240
    s_waitcnt lgkmcnt(0)
    s_branch Lwe_113
Lwn_114:
    s_cmp_lg_u32 s56, 1
    s_cbranch_scc1 Lwn_115
    ds_read_b64_tr_b16 a[120:121], v9 offset:0
    ds_read_b64_tr_b16 a[122:123], v9 offset:8192
    ds_read_b64_tr_b16 a[124:125], v9 offset:2048
    ds_read_b64_tr_b16 a[126:127], v9 offset:10240
    ds_read_b64_tr_b16 a[168:169], v15 offset:0
    ds_read_b64_tr_b16 a[170:171], v15 offset:8192
    ds_read_b64_tr_b16 a[172:173], v15 offset:2048
    ds_read_b64_tr_b16 a[174:175], v15 offset:10240
    s_waitcnt lgkmcnt(0)
    s_branch Lwe_113
Lwn_115:
    s_cmp_lg_u32 s56, 2
    s_cbranch_scc1 Lwn_116
    ds_read_b64_tr_b16 a[136:137], v9 offset:0
    ds_read_b64_tr_b16 a[138:139], v9 offset:8192
    ds_read_b64_tr_b16 a[140:141], v9 offset:2048
    ds_read_b64_tr_b16 a[142:143], v9 offset:10240
    ds_read_b64_tr_b16 a[176:177], v15 offset:0
    ds_read_b64_tr_b16 a[178:179], v15 offset:8192
    ds_read_b64_tr_b16 a[180:181], v15 offset:2048
    ds_read_b64_tr_b16 a[182:183], v15 offset:10240
    s_waitcnt lgkmcnt(0)
    s_branch Lwe_113
Lwn_116:
    ds_read_b64_tr_b16 a[152:153], v9 offset:0
    ds_read_b64_tr_b16 a[154:155], v9 offset:8192
    ds_read_b64_tr_b16 a[156:157], v9 offset:2048
    ds_read_b64_tr_b16 a[158:159], v9 offset:10240
    ds_read_b64_tr_b16 a[184:185], v15 offset:0
    ds_read_b64_tr_b16 a[186:187], v15 offset:8192
    ds_read_b64_tr_b16 a[188:189], v15 offset:2048
    ds_read_b64_tr_b16 a[190:191], v15 offset:10240
    s_waitcnt lgkmcnt(0)
Lwe_113:
    s_barrier
    v_cmp_ne_u32 vcc, 0x01010101, v3
    s_cbranch_vccnz Lpr_118
    s_cmp_eq_u32 s93, 0
    s_cbranch_scc1 Lpr_118
    s_cmp_lg_u32 s59, 0
    s_cbranch_scc1 Lpr_118
    v_and_b32 v4, 63, v0
    v_lshlrev_b32 v4, 7, v4
    s_lshl_b32 s88, s57, 13
    s_lshl_b32 s89, s56, 18
    s_add_u32 s89, s89, s88
    s_add_u32 s89, s89, 0x200000
    buffer_load_dword v3, v4, s[4:7], s89 offen sc1
    s_lshl_b32 s89, s56, 13
    s_add_u32 s89, s89, 0x100000
    buffer_load_dword v3, v4, s[4:7], s89 offen sc1
Lpr_118:
    s_waitcnt vmcnt(10)
    s_barrier
    v_add_u32 v9, 0x10000, v2
    v_add_u32 v15, 0x10010, v2
    s_cmp_lg_u32 s56, 0
    s_cbranch_scc1 Lwn_120
    ds_read_b64_tr_b16 a[120:121], v9 offset:16384
    ds_read_b64_tr_b16 a[122:123], v9 offset:24576
    ds_read_b64_tr_b16 a[124:125], v9 offset:18432
    ds_read_b64_tr_b16 a[126:127], v9 offset:26624
    ds_read_b64_tr_b16 a[168:169], v15 offset:16384
    ds_read_b64_tr_b16 a[170:171], v15 offset:24576
    ds_read_b64_tr_b16 a[172:173], v15 offset:18432
    ds_read_b64_tr_b16 a[174:175], v15 offset:26624
    s_waitcnt lgkmcnt(0)
    s_branch Lwe_119
Lwn_120:
    s_cmp_lg_u32 s56, 1
    s_cbranch_scc1 Lwn_121
    ds_read_b64_tr_b16 a[104:105], v9 offset:16384
    ds_read_b64_tr_b16 a[106:107], v9 offset:24576
    ds_read_b64_tr_b16 a[108:109], v9 offset:18432
    ds_read_b64_tr_b16 a[110:111], v9 offset:26624
    ds_read_b64_tr_b16 a[160:161], v15 offset:16384
    ds_read_b64_tr_b16 a[162:163], v15 offset:24576
    ds_read_b64_tr_b16 a[164:165], v15 offset:18432
    ds_read_b64_tr_b16 a[166:167], v15 offset:26624
    s_waitcnt lgkmcnt(0)
    s_branch Lwe_119
Lwn_121:
    s_cmp_lg_u32 s56, 2
    s_cbranch_scc1 Lwn_122
    ds_read_b64_tr_b16 a[152:153], v9 offset:16384
    ds_read_b64_tr_b16 a[154:155], v9 offset:24576
    ds_read_b64_tr_b16 a[156:157], v9 offset:18432
    ds_read_b64_tr_b16 a[158:159], v9 offset:26624
    ds_read_b64_tr_b16 a[184:185], v15 offset:16384
    ds_read_b64_tr_b16 a[186:187], v15 offset:24576
    ds_read_b64_tr_b16 a[188:189], v15 offset:18432
    ds_read_b64_tr_b16 a[190:191], v15 offset:26624
    s_waitcnt lgkmcnt(0)
    s_branch Lwe_119
Lwn_122:
    ds_read_b64_tr_b16 a[136:137], v9 offset:16384
    ds_read_b64_tr_b16 a[138:139], v9 offset:24576
    ds_read_b64_tr_b16 a[140:141], v9 offset:18432
    ds_read_b64_tr_b16 a[142:143], v9 offset:26624
    ds_read_b64_tr_b16 a[176:177], v15 offset:16384
    ds_read_b64_tr_b16 a[178:179], v15 offset:24576
    ds_read_b64_tr_b16 a[180:181], v15 offset:18432
    ds_read_b64_tr_b16 a[182:183], v15 offset:26624
    s_waitcnt lgkmcnt(0)
Lwe_119:
    s_barrier
    s_cmp_lg_u32 s56, 1
    s_cbranch_scc1 Lhw_124
    ds_write_b128 v7, v[16:19] offset:16384
    ds_write_b128 v7, v[20:23] offset:17408
    ds_write_b128 v7, v[24:27] offset:20480
    ds_write_b128 v7, v[28:31] offset:21504
    ds_write_b128 v7, v[32:35] offset:24576
    ds_write_b128 v7, v[36:39] offset:25600
    ds_write_b128 v7, v[40:43] offset:28672
    ds_write_b128 v7, v[44:47] offset:29696
    ds_write_b128 v7, v[48:51] offset:18432
    ds_write_b128 v7, v[52:55] offset:19456
    ds_write_b128 v7, v[56:59] offset:22528
    ds_write_b128 v7, v[60:63] offset:23552
    ds_write_b128 v7, v[64:67] offset:26624
    ds_write_b128 v7, v[68:71] offset:27648
    ds_write_b128 v7, v[72:75] offset:30720
    ds_write_b128 v7, v[76:79] offset:31744
    ds_write_b128 v7, v[80:83] offset:0
    ds_write_b128 v7, v[84:87] offset:1024
    ds_write_b128 v7, v[88:91] offset:6144
    ds_write_b128 v7, v[92:95] offset:7168
    ds_write_b128 v7, v[96:99] offset:4096
    ds_write_b128 v7, v[100:103] offset:5120
    ds_write_b128 v7, v[104:107] offset:8192
    ds_write_b128 v7, v[108:111] offset:9216
    ds_write_b128 v7, v[112:115] offset:14336
    ds_write_b128 v7, v[116:119] offset:15360
    ds_write_b128 v7, v[120:123] offset:12288
    ds_write_b128 v7, v[124:127] offset:13312
    s_waitcnt lgkmcnt(0)
Lhw_124:
    s_waitcnt vmcnt(6)
    s_barrier
    v_add_u32 v9, 0x18000, v2
    v_add_u32 v15, 0x18010, v2
    s_cmp_lg_u32 s56, 0
    s_cbranch_scc1 Lwn_126
    ds_read_b64_tr_b16 a[136:137], v9 offset:0
    ds_read_b64_tr_b16 a[138:139], v9 offset:8192
    ds_read_b64_tr_b16 a[140:141], v9 offset:2048
    ds_read_b64_tr_b16 a[142:143], v9 offset:10240
    ds_read_b64_tr_b16 a[176:177], v15 offset:0
    ds_read_b64_tr_b16 a[178:179], v15 offset:8192
    ds_read_b64_tr_b16 a[180:181], v15 offset:2048
    ds_read_b64_tr_b16 a[182:183], v15 offset:10240
    s_waitcnt lgkmcnt(0)
    s_branch Lwe_125
Lwn_126:
    s_cmp_lg_u32 s56, 1
    s_cbranch_scc1 Lwn_127
    ds_read_b64_tr_b16 a[152:153], v9 offset:0
    ds_read_b64_tr_b16 a[154:155], v9 offset:8192
    ds_read_b64_tr_b16 a[156:157], v9 offset:2048
    ds_read_b64_tr_b16 a[158:159], v9 offset:10240
    ds_read_b64_tr_b16 a[184:185], v15 offset:0
    ds_read_b64_tr_b16 a[186:187], v15 offset:8192
    ds_read_b64_tr_b16 a[188:189], v15 offset:2048
    ds_read_b64_tr_b16 a[190:191], v15 offset:10240
    s_waitcnt lgkmcnt(0)
    s_branch Lwe_125
Lwn_127:
    s_cmp_lg_u32 s56, 2
    s_cbranch_scc1 Lwn_128
    ds_read_b64_tr_b16 a[104:105], v9 offset:0
    ds_read_b64_tr_b16 a[106:107], v9 offset:8192
    ds_read_b64_tr_b16 a[108:109], v9 offset:2048
    ds_read_b64_tr_b16 a[110:111], v9 offset:10240
    ds_read_b64_tr_b16 a[160:161], v15 offset:0
    ds_read_b64_tr_b16 a[162:163], v15 offset:8192
    ds_read_b64_tr_b16 a[164:165], v15 offset:2048
    ds_read_b64_tr_b16 a[166:167], v15 offset:10240
    s_waitcnt lgkmcnt(0)
    s_branch Lwe_125
Lwn_128:
    ds_read_b64_tr_b16 a[120:121], v9 offset:0
    ds_read_b64_tr_b16 a[122:123], v9 offset:8192
    ds_read_b64_tr_b16 a[124:125], v9 offset:2048
    ds_read_b64_tr_b16 a[126:127], v9 offset:10240
    ds_read_b64_tr_b16 a[168:169], v15 offset:0
    ds_read_b64_tr_b16 a[170:171], v15 offset:8192
    ds_read_b64_tr_b16 a[172:173], v15 offset:2048
    ds_read_b64_tr_b16 a[174:175], v15 offset:10240
    s_waitcnt lgkmcnt(0)
Lwe_125:
    s_barrier
    s_waitcnt vmcnt(2)
    s_barrier
    v_add_u32 v9, 0x18000, v2
    v_add_u32 v15, 0x18010, v2
    s_cmp_lg_u32 s56, 0
    s_cbranch_scc1 Lwn_131
    ds_read_b64_tr_b16 a[152:153], v9 offset:16384
    ds_read_b64_tr_b16 a[154:155], v9 offset:24576
    ds_read_b64_tr_b16 a[156:157], v9 offset:18432
    ds_read_b64_tr_b16 a[158:159], v9 offset:26624
    ds_read_b64_tr_b16 a[184:185], v15 offset:16384
    ds_read_b64_tr_b16 a[186:187], v15 offset:24576
    ds_read_b64_tr_b16 a[188:189], v15 offset:18432
    ds_read_b64_tr_b16 a[190:191], v15 offset:26624
    s_waitcnt lgkmcnt(0)
    s_branch Lwe_130
Lwn_131:
    s_cmp_lg_u32 s56, 1
    s_cbranch_scc1 Lwn_132
    ds_read_b64_tr_b16 a[136:137], v9 offset:16384
    ds_read_b64_tr_b16 a[138:139], v9 offset:24576
    ds_read_b64_tr_b16 a[140:141], v9 offset:18432
    ds_read_b64_tr_b16 a[142:143], v9 offset:26624
    ds_read_b64_tr_b16 a[176:177], v15 offset:16384
    ds_read_b64_tr_b16 a[178:179], v15 offset:24576
    ds_read_b64_tr_b16 a[180:181], v15 offset:18432
    ds_read_b64_tr_b16 a[182:183], v15 offset:26624
    s_waitcnt lgkmcnt(0)
    s_branch Lwe_130
Lwn_132:
    s_cmp_lg_u32 s56, 2
    s_cbranch_scc1 Lwn_133
    ds_read_b64_tr_b16 a[120:121], v9 offset:16384
    ds_read_b64_tr_b16 a[122:123], v9 offset:24576
    ds_read_b64_tr_b16 a[124:125], v9 offset:18432
    ds_read_b64_tr_b16 a[126:127], v9 offset:26624
    ds_read_b64_tr_b16 a[168:169], v15 offset:16384
    ds_read_b64_tr_b16 a[170:171], v15 offset:24576
    ds_read_b64_tr_b16 a[172:173], v15 offset:18432
    ds_read_b64_tr_b16 a[174:175], v15 offset:26624
    s_waitcnt lgkmcnt(0)
    s_branch Lwe_130
Lwn_133:
    ds_read_b64_tr_b16 a[104:105], v9 offset:16384
    ds_read_b64_tr_b16 a[106:107], v9 offset:24576
    ds_read_b64_tr_b16 a[108:109], v9 offset:18432
    ds_read_b64_tr_b16 a[110:111], v9 offset:26624
    ds_read_b64_tr_b16 a[160:161], v15 offset:16384
    ds_read_b64_tr_b16 a[162:163], v15 offset:24576
    ds_read_b64_tr_b16 a[164:165], v15 offset:18432
    ds_read_b64_tr_b16 a[166:167], v15 offset:26624
    s_waitcnt lgkmcnt(0)
Lwe_130:
    s_barrier
    s_cmp_lg_u32 s56, 2
    s_cbranch_scc1 Lhw_135
    ds_write_b128 v7, v[16:19] offset:16384
    ds_write_b128 v7, v[20:23] offset:17408
    ds_write_b128 v7, v[24:27] offset:20480
    ds_write_b128 v7, v[28:31] offset:21504
    ds_write_b128 v7, v[32:35] offset:24576
    ds_write_b128 v7, v[36:39] offset:25600
    ds_write_b128 v7, v[40:43] offset:28672
    ds_write_b128 v7, v[44:47] offset:29696
    ds_write_b128 v7, v[48:51] offset:18432
    ds_write_b128 v7, v[52:55] offset:19456
    ds_write_b128 v7, v[56:59] offset:22528
    ds_write_b128 v7, v[60:63] offset:23552
    ds_write_b128 v7, v[64:67] offset:26624
    ds_write_b128 v7, v[68:71] offset:27648
    ds_write_b128 v7, v[72:75] offset:30720
    ds_write_b128 v7, v[76:79] offset:31744
    ds_write_b128 v7, v[80:83] offset:6144
    ds_write_b128 v7, v[84:87] offset:7168
    ds_write_b128 v7, v[88:91] offset:0
    ds_write_b128 v7, v[92:95] offset:1024
    ds_write_b128 v7, v[96:99] offset:2048
    ds_write_b128 v7, v[100:103] offset:3072
    ds_write_b128 v7, v[104:107] offset:14336
    ds_write_b128 v7, v[108:111] offset:15360
    ds_write_b128 v7, v[112:115] offset:8192
    ds_write_b128 v7, v[116:119] offset:9216
    ds_write_b128 v7, v[120:123] offset:10240
    ds_write_b128 v7, v[124:127] offset:11264
    s_waitcnt lgkmcnt(0)
Lhw_135:
    s_waitcnt vmcnt(1)
    s_cmp_lg_u32 s56, 0
    s_cbranch_scc1 Lwn_137
    v_accvgpr_read_b32 v40, a96
    v_accvgpr_read_b32 v41, a97
    v_accvgpr_read_b32 v42, a98
    v_accvgpr_read_b32 v43, a99
    v_accvgpr_read_b32 v44, a100
    v_accvgpr_read_b32 v45, a101
    v_accvgpr_read_b32 v46, a102
    v_accvgpr_read_b32 v47, a103
    v_accvgpr_read_b32 v48, a0
    v_accvgpr_read_b32 v49, a1
    s_branch Lwe_136
Lwn_137:
    s_cmp_lg_u32 s56, 1
    s_cbranch_scc1 Lwn_138
    v_accvgpr_read_b32 v40, a112
    v_accvgpr_read_b32 v41, a113
    v_accvgpr_read_b32 v42, a114
    v_accvgpr_read_b32 v43, a115
    v_accvgpr_read_b32 v44, a116
    v_accvgpr_read_b32 v45, a117
    v_accvgpr_read_b32 v46, a118
    v_accvgpr_read_b32 v47, a119
    v_accvgpr_read_b32 v48, a16
    v_accvgpr_read_b32 v49, a17
    s_branch Lwe_136
Lwn_138:
    s_cmp_lg_u32 s56, 2
    s_cbranch_scc1 Lwn_139
    v_accvgpr_read_b32 v40, a128
    v_accvgpr_read_b32 v41, a129
    v_accvgpr_read_b32 v42, a130
    v_accvgpr_read_b32 v43, a131
    v_accvgpr_read_b32 v44, a132
    v_accvgpr_read_b32 v45, a133
    v_accvgpr_read_b32 v46, a134
    v_accvgpr_read_b32 v47, a135
    v_accvgpr_read_b32 v48, a32
    v_accvgpr_read_b32 v49, a33
    s_branch Lwe_136
Lwn_139:
    v_accvgpr_read_b32 v40, a144
    v_accvgpr_read_b32 v41, a145
    v_accvgpr_read_b32 v42, a146
    v_accvgpr_read_b32 v43, a147
    v_accvgpr_read_b32 v44, a148
    v_accvgpr_read_b32 v45, a149
    v_accvgpr_read_b32 v46, a150
    v_accvgpr_read_b32 v47, a151
    v_accvgpr_read_b32 v48, a48
    v_accvgpr_read_b32 v49, a49
Lwe_136:
    s_barrier
    v_add_u32 v9, 0x0, v2
    v_add_u32 v15, 0x10, v2
    s_cmp_lg_u32 s56, 0
    s_cbranch_scc1 Lwn_142
    ds_read_b64_tr_b16 a[0:1], v9 offset:0
    ds_read_b64_tr_b16 a[2:3], v9 offset:8192
    ds_read_b64_tr_b16 a[4:5], v9 offset:2048
    ds_read_b64_tr_b16 a[6:7], v9 offset:10240
    ds_read_b64_tr_b16 v[16:17], v15 offset:0
    ds_read_b64_tr_b16 v[18:19], v15 offset:8192
    ds_read_b64_tr_b16 v[20:21], v15 offset:2048
    ds_read_b64_tr_b16 v[22:23], v15 offset:10240
    s_waitcnt lgkmcnt(0)
    ds_write_b128 v7, v[16:19] offset:0
    ds_write_b128 v7, v[20:23] offset:1024
    s_waitcnt lgkmcnt(0)
    s_branch Lwe_141
Lwn_142:
    s_cmp_lg_u32 s56, 1
    s_cbranch_scc1 Lwn_143
    ds_read_b64_tr_b16 a[16:17], v9 offset:0
    ds_read_b64_tr_b16 a[18:19], v9 offset:8192
    ds_read_b64_tr_b16 a[20:21], v9 offset:2048
    ds_read_b64_tr_b16 a[22:23], v9 offset:10240
    ds_read_b64_tr_b16 v[16:17], v15 offset:0
    ds_read_b64_tr_b16 v[18:19], v15 offset:8192
    ds_read_b64_tr_b16 v[20:21], v15 offset:2048
    ds_read_b64_tr_b16 v[22:23], v15 offset:10240
    s_waitcnt lgkmcnt(0)
    ds_write_b128 v7, v[16:19] offset:2048
    ds_write_b128 v7, v[20:23] offset:3072
    s_waitcnt lgkmcnt(0)
    s_branch Lwe_141
Lwn_143:
    s_cmp_lg_u32 s56, 2
    s_cbranch_scc1 Lwn_144
    ds_read_b64_tr_b16 a[32:33], v9 offset:0
    ds_read_b64_tr_b16 a[34:35], v9 offset:8192
    ds_read_b64_tr_b16 a[36:37], v9 offset:2048
    ds_read_b64_tr_b16 a[38:39], v9 offset:10240
    ds_read_b64_tr_b16 v[16:17], v15 offset:0
    ds_read_b64_tr_b16 v[18:19], v15 offset:8192
    ds_read_b64_tr_b16 v[20:21], v15 offset:2048
    ds_read_b64_tr_b16 v[22:23], v15 offset:10240
    s_waitcnt lgkmcnt(0)
    ds_write_b128 v7, v[16:19] offset:4096
    ds_write_b128 v7, v[20:23] offset:5120
    s_waitcnt lgkmcnt(0)
    s_branch Lwe_141
Lwn_144:
    ds_read_b64_tr_b16 a[48:49], v9 offset:0
    ds_read_b64_tr_b16 a[50:51], v9 offset:8192
    ds_read_b64_tr_b16 a[52:53], v9 offset:2048
    ds_read_b64_tr_b16 a[54:55], v9 offset:10240
    ds_read_b64_tr_b16 v[16:17], v15 offset:0
    ds_read_b64_tr_b16 v[18:19], v15 offset:8192
    ds_read_b64_tr_b16 v[20:21], v15 offset:2048
    ds_read_b64_tr_b16 v[22:23], v15 offset:10240
    s_waitcnt lgkmcnt(0)
    ds_write_b128 v7, v[16:19] offset:6144
    ds_write_b128 v7, v[20:23] offset:7168
    s_waitcnt lgkmcnt(0)
Lwe_141:
    s_barrier
    s_waitcnt vmcnt(0)
    v_cmp_eq_u32 vcc, 0, v1
    s_cbranch_vccnz Lpf_146
    s_cmp_eq_u32 s93, 0
    s_cbranch_scc1 Lpf_146
    s_mov_b32 s93, 2
    v_and_b32 v1, 63, v0
    v_lshlrev_b32 v1, 7, v1
    s_mul_i32 s88, s57, 0x2000
    s_and_b32 s89, s56, 1
    s_lshl_b32 s89, s89, 18
    s_add_u32 s88, s88, s89
    s_lshr_b32 s89, s56, 1
    s_lshl_b32 s89, s89, 25
    s_add_u32 s88, s88, s89
    s_add_u32 s88, s88, 0x2000000
    buffer_load_dword v116, v1, s[4:7], s88 offen
Lpf_146:
    s_barrier
    v_add_u32 v9, 0x0, v2
    v_add_u32 v15, 0x10, v2
    s_cmp_lg_u32 s56, 0
    s_cbranch_scc1 Lwn_148
    ds_read_b64_tr_b16 a[96:97], v9 offset:16384
    ds_read_b64_tr_b16 a[98:99], v9 offset:24576
    ds_read_b64_tr_b16 a[100:101], v9 offset:18432
    ds_read_b64_tr_b16 a[102:103], v9 offset:26624
    ds_read_b64_tr_b16 v[16:17], v15 offset:16384
    ds_read_b64_tr_b16 v[18:19], v15 offset:24576
    ds_read_b64_tr_b16 v[20:21], v15 offset:18432
    ds_read_b64_tr_b16 v[22:23], v15 offset:26624
    s_waitcnt lgkmcnt(0)
    ds_write_b128 v7, v[16:19] offset:8192
    ds_write_b128 v7, v[20:23] offset:9216
    s_waitcnt lgkmcnt(0)
    s_branch Lwe_147
Lwn_148:
    s_cmp_lg_u32 s56, 1
    s_cbranch_scc1 Lwn_149
    ds_read_b64_tr_b16 a[112:113], v9 offset:16384
    ds_read_b64_tr_b16 a[114:115], v9 offset:24576
    ds_read_b64_tr_b16 a[116:117], v9 offset:18432
    ds_read_b64_tr_b16 a[118:119], v9 offset:26624
    ds_read_b64_tr_b16 v[16:17], v15 offset:16384
    ds_read_b64_tr_b16 v[18:19], v15 offset:24576
    ds_read_b64_tr_b16 v[20:21], v15 offset:18432
    ds_read_b64_tr_b16 v[22:23], v15 offset:26624
    s_waitcnt lgkmcnt(0)
    ds_write_b128 v7, v[16:19] offset:10240
    ds_write_b128 v7, v[20:23] offset:11264
    s_waitcnt lgkmcnt(0)
    s_branch Lwe_147
Lwn_149:
    s_cmp_lg_u32 s56, 2
    s_cbranch_scc1 Lwn_150
    ds_read_b64_tr_b16 a[128:129], v9 offset:16384
    ds_read_b64_tr_b16 a[130:131], v9 offset:24576
    ds_read_b64_tr_b16 a[132:133], v9 offset:18432
    ds_read_b64_tr_b16 a[134:135], v9 offset:26624
    ds_read_b64_tr_b16 v[16:17], v15 offset:16384
    ds_read_b64_tr_b16 v[18:19], v15 offset:24576
    ds_read_b64_tr_b16 v[20:21], v15 offset:18432
    ds_read_b64_tr_b16 v[22:23], v15 offset:26624
    s_waitcnt lgkmcnt(0)
    ds_write_b128 v7, v[16:19] offset:12288
    ds_write_b128 v7, v[20:23] offset:13312
    s_waitcnt lgkmcnt(0)
    s_branch Lwe_147
Lwn_150:
    ds_read_b64_tr_b16 a[144:145], v9 offset:16384
    ds_read_b64_tr_b16 a[146:147], v9 offset:24576
    ds_read_b64_tr_b16 a[148:149], v9 offset:18432
    ds_read_b64_tr_b16 a[150:151], v9 offset:26624
    ds_read_b64_tr_b16 v[16:17], v15 offset:16384
    ds_read_b64_tr_b16 v[18:19], v15 offset:24576
    ds_read_b64_tr_b16 v[20:21], v15 offset:18432
    ds_read_b64_tr_b16 v[22:23], v15 offset:26624
    s_waitcnt lgkmcnt(0)
    ds_write_b128 v7, v[16:19] offset:14336
    ds_write_b128 v7, v[20:23] offset:15360
    s_waitcnt lgkmcnt(0)
Lwe_147:
    s_barrier
    v_and_b32 v20, 63, v0
    v_and_b32 v21, 15, v20
    v_lshrrev_b32 v22, 4, v20
    v_lshrrev_b32 v23, 1, v22
    v_and_b32 v24, 1, v22
    v_lshrrev_b32 v25, 2, v21
    v_and_b32 v26, 3, v21
    v_lshlrev_b32 v0, 4, v20
    v_mov_b32 v1, 0x4444
    v_mov_b32 v27, 0xeeee
    s_mov_b32 s80, 0xaaaaaaaa
    s_mov_b32 s81, 0xaaaaaaaa
    s_mov_b32 s82, 0x55555555
    s_mov_b32 s83, 0
    s_mov_b32 s10, 0xaaaaaaaa
    s_mov_b32 s11, 0
    s_mov_b32 s84, 0x3e0293ee
    s_mov_b32 s99, 0x6000
    s_mov_b32 s98, 0x7200
    v_cndmask_b32 v1, v1, v27, s[80:81]
    s_lshl_b32 s88, s56, 6
    v_lshlrev_b32 v27, 2, v21
    v_add_u32 v27, s88, v27
    v_mul_u32_u24 v28, 1088, v22
    v_add3_u32 v2, v27, v28, s99
    v_mul_u32_u24 v28, 640, v22
    v_add3_u32 v9, v27, v28, s98
    v_lshrrev_b32 v27, 1, v21
    v_mul_u32_u24 v28, 544, v27
    v_lshl_add_u32 v28, v22, 4, v28
    v_add_u32 v3, 0x6000, v28
    v_mul_u32_u24 v28, 320, v27
    v_lshl_add_u32 v28, v22, 5, v28
    v_and_b32 v29, 1, v21
    v_lshl_add_u32 v28, v29, 4, v28
    v_add_u32 v5, 0x7200, v28
    v_and_b32 v27, 7, v21
    v_mul_u32_u24 v28, 544, v27
    v_lshl_add_u32 v28, v22, 4, v28
    v_add_u32 v4, 0x6100, v28
    v_lshlrev_b32 v27, 9, v22
    v_lshl_add_u32 v6, v21, 4, v27
    v_and_b32 v29, 1, v25
    v_mov_b32 v30, 0x3f80
    v_mov_b32 v31, 0x3f800000
    v_cmp_eq_u32 vcc, 1, v29
    s_nop 1
    v_cndmask_b32 v30, v30, v31, vcc
    v_cmp_eq_u32 vcc, 0, v26
    s_nop 1
    v_cndmask_b32 v16, 0, v30, vcc
    v_cmp_eq_u32 vcc, 1, v26
    s_nop 1
    v_cndmask_b32 v17, 0, v30, vcc
    v_cmp_eq_u32 vcc, 2, v26
    s_nop 1
    v_cndmask_b32 v18, 0, v30, vcc
    v_cmp_eq_u32 vcc, 3, v26
    s_nop 1
    v_cndmask_b32 v19, 0, v30, vcc
    v_mov_b32 v114, 0
    v_mov_b32 v115, 0
    v_mov_b32 v122, 0
    v_mov_b32 v123, 0
    v_bfrev_b32 v30, 1
    v_cmp_lt_u32 vcc, 31, v20
    s_nop 1
    v_cndmask_b32 v10, v10, v30, vcc
    v_bfrev_b32 v30, 1
    v_cmp_ne_u32 vcc, 0, v20
    s_nop 1
    v_cndmask_b32 v114, v114, v30, vcc
    v_mov_b32 v12, 0x3f803f80
    v_mov_b32 v13, 0x3f803f80
    v_mov_b32 v14, 0x3f803f80
    v_mov_b32 v15, 0x3f803f80
    s_cmp_lg_u32 s93, 0
    s_cbranch_scc1 Lci_152_z
Lwz_153:
    s_add_u32 s101, s101, 1
    s_cmp_gt_u32 s101, 0x400000
    s_cbranch_scc1 L_end
    v_mbcnt_lo_u32_b32 v49, -1, 0
    v_and_b32 v49, 7, v49
    v_lshlrev_b32 v49, 2, v49
    global_load_dword v48, v49, s[8:9] sc1
    s_waitcnt vmcnt(0)
    v_cmp_ne_u32 vcc, 1, v48
    s_cbranch_vccnz Lwz_153
    s_cmp_lg_u32 s56, 0
    s_cbranch_scc1 Lann_154
    s_lshr_b32 s3, s2, 3
    s_lshl_b32 s3, s3, 7
    s_and_b32 vcc_lo, s2, 7
    s_add_u32 s3, s3, vcc_lo
    s_add_u32 s3, s3, 0x2000
    v_mov_b32 v48, s3
    v_mov_b32 v49, s58
    s_mov_b64 exec, 1
    buffer_store_byte v49, v48, s[4:7], 0 offen sc1
    s_mov_b64 exec, -1
Lann_154:
    v_mov_b32 v48, 0
Lci_152_z:
    s_branch Lval_155_chk
Lval_155:
    s_add_u32 s101, s101, 1
    s_cmp_gt_u32 s101, 0x400000
    s_cbranch_scc1 L_end
    v_mbcnt_lo_u32_b32 v50, -1, 0
    v_lshlrev_b32 v50, 7, v50
    v_and_b32 v50, 0xf80, v50
    v_add_u32 v50, 0x2000, v50
    buffer_load_dwordx2 v[48:49], v50, s[4:7], 0 offen sc1
    s_waitcnt vmcnt(0)
Lval_155_chk:
    v_bfe_u32 v50, v48, 0, 5
    v_bfe_u32 v51, v48, 8, 5
    v_bfe_u32 v52, v48, 16, 5
    v_bfe_u32 v53, v48, 24, 5
    v_bfe_u32 v54, v49, 0, 5
    v_bfe_u32 v55, v49, 8, 5
    v_bfe_u32 v56, v49, 16, 5
    v_bfe_u32 v57, v49, 24, 5
    v_min3_u32 v58, v50, v51, v52
    v_min3_u32 v58, v58, v53, v54
    v_min3_u32 v58, v58, v55, v56
    v_min_u32 v58, v58, v57
    v_cmp_eq_u32 vcc, 0, v58
    s_cbranch_vccnz Lval_155
    s_mov_b32 s3, s59
    s_cmp_lg_u32 s59, 0
    s_cbranch_scc1 Lval_155_ok
    v_lshlrev_b32 v58, v50, 1
    v_lshlrev_b32 v59, v51, 1
    v_or_b32 v58, v58, v59
    v_lshlrev_b32 v59, v52, 1
    v_or_b32 v58, v58, v59
    v_lshlrev_b32 v59, v53, 1
    v_or_b32 v58, v58, v59
    v_lshlrev_b32 v59, v54, 1
    v_or_b32 v58, v58, v59
    v_lshlrev_b32 v59, v55, 1
    v_or_b32 v58, v58, v59
    v_lshlrev_b32 v59, v56, 1
    v_or_b32 v58, v58, v59
    v_lshlrev_b32 v59, v57, 1
    v_or_b32 v58, v58, v59
    v_cmp_ne_u32 vcc, 0x1fe, v58
    s_mov_b32 s3, 32
    s_cbranch_vccz Lval_155_ok
    s_lshr_b32 s60, s2, 3
    s_lshl_b32 s62, 1, s60
    s_sub_u32 s64, s62, 1
    s_or_b32 s66, s62, s64
    s_and_b32 s61, s2, 7
    s_mov_b32 s68, 0
    s_mov_b32 s69, 0
    s_mov_b32 s70, 0
    v_cmp_eq_u32 vcc, s58, v50
    s_cmp_gt_u32 s61, 0
    s_cselect_b32 s74, s66, s64
    s_and_b32 s74, s74, vcc_lo
    s_bcnt1_i32_b32 s71, s74
    s_add_u32 s68, s68, s71
    v_cmp_eq_u32 vcc, 1, v50
    s_bcnt1_i32_b32 s71, vcc_lo
    s_add_u32 s69, s69, s71
    v_cmp_gt_u32 vcc, s58, v50
    s_bcnt1_i32_b32 s71, vcc_lo
    s_add_u32 s70, s70, s71
    v_cmp_eq_u32 vcc, s58, v51
    s_cmp_gt_u32 s61, 1
    s_cselect_b32 s74, s66, s64
    s_and_b32 s74, s74, vcc_lo
    s_bcnt1_i32_b32 s71, s74
    s_add_u32 s68, s68, s71
    v_cmp_eq_u32 vcc, 1, v51
    s_bcnt1_i32_b32 s71, vcc_lo
    s_add_u32 s69, s69, s71
    v_cmp_gt_u32 vcc, s58, v51
    s_bcnt1_i32_b32 s71, vcc_lo
    s_add_u32 s70, s70, s71
    v_cmp_eq_u32 vcc, s58, v52
    s_cmp_gt_u32 s61, 2
    s_cselect_b32 s74, s66, s64
    s_and_b32 s74, s74, vcc_lo
    s_bcnt1_i32_b32 s71, s74
    s_add_u32 s68, s68, s71
    v_cmp_eq_u32 vcc, 1, v52
    s_bcnt1_i32_b32 s71, vcc_lo
    s_add_u32 s69, s69, s71
    v_cmp_gt_u32 vcc, s58, v52
    s_bcnt1_i32_b32 s71, vcc_lo
    s_add_u32 s70, s70, s71
    v_cmp_eq_u32 vcc, s58, v53
    s_cmp_gt_u32 s61, 3
    s_cselect_b32 s74, s66, s64
    s_and_b32 s74, s74, vcc_lo
    s_bcnt1_i32_b32 s71, s74
    s_add_u32 s68, s68, s71
    v_cmp_eq_u32 vcc, 1, v53
    s_bcnt1_i32_b32 s71, vcc_lo
    s_add_u32 s69, s69, s71
    v_cmp_gt_u32 vcc, s58, v53
    s_bcnt1_i32_b32 s71, vcc_lo
    s_add_u32 s70, s70, s71
    v_cmp_eq_u32 vcc, s58, v54
    s_cmp_gt_u32 s61, 4
    s_cselect_b32 s74, s66, s64
    s_and_b32 s74, s74, vcc_lo
    s_bcnt1_i32_b32 s71, s74
    s_add_u32 s68, s68, s71
    v_cmp_eq_u32 vcc, 1, v54
    s_bcnt1_i32_b32 s71, vcc_lo
    s_add_u32 s69, s69, s71
    v_cmp_gt_u32 vcc, s58, v54
    s_bcnt1_i32_b32 s71, vcc_lo
    s_add_u32 s70, s70, s71
    v_cmp_eq_u32 vcc, s58, v55
    s_cmp_gt_u32 s61, 5
    s_cselect_b32 s74, s66, s64
    s_and_b32 s74, s74, vcc_lo
    s_bcnt1_i32_b32 s71, s74
    s_add_u32 s68, s68, s71
    v_cmp_eq_u32 vcc, 1, v55
    s_bcnt1_i32_b32 s71, vcc_lo
    s_add_u32 s69, s69, s71
    v_cmp_gt_u32 vcc, s58, v55
    s_bcnt1_i32_b32 s71, vcc_lo
    s_add_u32 s70, s70, s71
    v_cmp_eq_u32 vcc, s58, v56
    s_cmp_gt_u32 s61, 6
    s_cselect_b32 s74, s66, s64
    s_and_b32 s74, s74, vcc_lo
    s_bcnt1_i32_b32 s71, s74
    s_add_u32 s68, s68, s71
    v_cmp_eq_u32 vcc, 1, v56
    s_bcnt1_i32_b32 s71, vcc_lo
    s_add_u32 s69, s69, s71
    v_cmp_gt_u32 vcc, s58, v56
    s_bcnt1_i32_b32 s71, vcc_lo
    s_add_u32 s70, s70, s71
    v_cmp_eq_u32 vcc, s58, v57
    s_cmp_gt_u32 s61, 7
    s_cselect_b32 s74, s66, s64
    s_and_b32 s74, s74, vcc_lo
    s_bcnt1_i32_b32 s71, s74
    s_add_u32 s68, s68, s71
    v_cmp_eq_u32 vcc, 1, v57
    s_bcnt1_i32_b32 s71, vcc_lo
    s_add_u32 s69, s69, s71
    v_cmp_gt_u32 vcc, s58, v57
    s_bcnt1_i32_b32 s71, vcc_lo
    s_add_u32 s70, s70, s71
    s_min_u32 s71, s69, 32
    s_sub_u32 s70, s70, s69
    s_add_u32 s70, s70, s71
    s_add_u32 s70, s70, s68
    s_sub_u32 s71, 256, s69
    s_add_u32 s71, s71, s68
    s_cmp_lt_u32 s68, 32
    s_cselect_b32 s71, s68, s71
    s_cmp_eq_u32 s58, 1
    s_cselect_b32 s57, s71, s70
    s_or_b32 s59, s69, 0x1000
    v_mbcnt_lo_u32_b32 v0, -1, 0
    v_mbcnt_hi_u32_b32 v0, -1, v0
    v_mov_b32 v48, s2
    v_mov_b32 v49, 1
    s_waitcnt vmcnt(0) lgkmcnt(0)
    s_barrier
    buffer_store_byte v49, v48, s[4:7], 0 offen sc1
    s_branch L_dispatch
Lval_155_ok:
    s_and_b32 s3, s3, 0xfff
    s_mov_b32 s95, s3
    v_mov_b32 v32, 0
    s_cmp_eq_u32 s59, 0
    s_cbranch_scc1 Lci_152_r
    v_lshrrev_b32 v33, 2, v0
    s_mov_b32 s93, 0
Lci_152_p2:
    s_add_u32 s101, s101, 1
    s_cmp_gt_u32 s101, 0x400000
    s_cbranch_scc1 L_end
    buffer_load_dword v34, v33, s[4:7], 0 offen sc1
    s_waitcnt vmcnt(0)
    v_cmp_ne_u32 vcc, 0x01010101, v34
    s_cbranch_vccnz Lci_152_p2
    v_and_b32 v33, 28, v33
Lci_152_p3:
    s_add_u32 s101, s101, 1
    s_cmp_gt_u32 s101, 0x400000
    s_cbranch_scc1 L_end
    buffer_load_dword v34, v33, s[4:7], 0 offen offset:288 sc1
    s_waitcnt vmcnt(0)
    v_cmp_ne_u32 vcc, 0x01010101, v34
    s_cbranch_vccnz Lci_152_p3
Lci_152_r:
    v_mov_b32 v11, 1
    s_cmp_eq_u32 s93, 2
    s_cbranch_scc1 Lf0_156_ok
Lf0_156:
    s_add_u32 s101, s101, 1
    s_cmp_gt_u32 s101, 0x400000
    s_cbranch_scc1 L_end
    buffer_load_dword v11, v32, s[4:7], s70 offen sc1
    buffer_load_dword v34, v32, s[4:7], s70 offen offset:128 sc1
    s_waitcnt vmcnt(0)
    v_min_u32 v11, v11, v34
    s_nop 0
    v_readfirstlane_b32 s85, v11
    s_cmp_eq_u32 s85, 0
    s_cbranch_scc1 Lf0_156
Lf0_156_ok:
    s_mul_i32 s88, s57, 0x2000
    s_lshl_b32 s89, s56, 11
    s_add_u32 s64, s88, s89
    s_add_u32 s64, s64, 0x4000000
    s_mov_b32 s75, s64
    s_add_u32 s74, s88, s89
    s_add_u32 s74, s74, 0x2000000
    s_mov_b32 s78, s89
    s_lshl_b32 s90, s56, 9
    s_add_u32 s76, s88, s90
    s_add_u32 s76, s76, 0x7fc0000
    s_mov_b32 m0, s78
    s_nop 0
    buffer_load_dwordx4 v0, s[4:7], s74 offen lds
    buffer_load_dwordx4 v0, s[4:7], s74 offen offset:1024 lds
    s_mul_i32 s89, s56, 0xc00
    s_sub_u32 s89, s89, 0xc00
    s_min_u32 s89, s89, 0x1400
    s_add_u32 s74, s88, s89
    s_add_u32 s74, s74, 0x2000000
    s_mul_i32 s90, s56, 2752
    s_add_u32 s63, s88, s90
    s_add_u32 s63, s63, 0x3fff540
    s_mov_b32 s48, s4
    s_mov_b32 s49, s5
    s_mov_b32 s51, 0x20000
    s_cmp_eq_u32 s56, 0
    s_cselect_b32 s50, 0, s6
    s_cselect_b32 s78, 0x30000, s89
    s_cselect_b32 s67, -1, 0
    s_mov_b32 s88, 0x05040100
    s_mov_b32 s89, 0x07060302
    v_perm_b32 v20, v41, v40, s88
    v_perm_b32 v21, v43, v42, s88
    v_perm_b32 v22, v41, v40, s89
    v_perm_b32 v23, v43, v42, s89
    v_perm_b32 v24, v45, v44, s88
    v_perm_b32 v25, v47, v46, s88
    v_perm_b32 v26, v45, v44, s89
    v_perm_b32 v27, v47, v46, s89
    s_mov_b32 s60, 0
    s_lshl_b32 s79, s57, 7
    s_add_u32 s79, s79, 0x1000
    v_bfrev_b32 v124, 1
    s_cmp_eq_u32 s56, 1
    s_cselect_b64 vcc, -1, 0
    s_nop 1
    v_cndmask_b32 v115, v124, v114, vcc
    s_and_b32 s88, s60, 3
    s_lshl_b32 s89, s88, 18
    s_add_u32 s89, s89, 0x200000
    s_lshl_b32 s90, s56, 16
    s_add_u32 s61, s89, s90
    s_bitcmp1_b32 s57, 2
    s_movk_i32 s68, 0x7c00
    s_cselect_b32 s68, 0x8400, s68
    s_add_u32 s62, s61, s68
    s_lshl_b32 s90, s57, 13
    s_add_u32 s69, s89, s90
    s_add_u32 s89, s60, 3
    s_and_b32 s89, s89, 3
    s_lshl_b32 s89, s89, 18
    s_lshl_b32 s90, s56, 16
    s_add_u32 s89, s89, s90
    s_add_u32 s65, s89, 0x200000
    s_add_u32 s66, s65, s68
    s_lshl_b32 s72, s88, 13
    s_add_u32 s72, s72, 0x100000
    s_add_u32 s89, s60, 1
    s_and_b32 s89, s89, 3
    s_lshl_b32 s89, s89, 13
    s_add_u32 s71, s89, 0x100000
    s_lshl_b32 s89, s56, 11
    s_add_u32 s73, s71, s89
    s_add_u32 s74, s74, 0x40000
    s_add_u32 s63, s63, 0x40000
    s_add_u32 s76, s76, 0x40000
    s_xor_b32 s78, s78, 0x2000
    s_add_u32 s77, s70, 0
    s_mov_b32 s87, 0
    s_lshl_b32 s86, s56, 11
    ds_read_b128 v[76:79], v7 offset:0
    ds_read_b128 v[80:83], v7 offset:1024
    ds_read_b128 v[84:87], v7 offset:2048
    ds_read_b128 v[88:91], v7 offset:3072
    ds_read_b128 v[92:95], v7 offset:4096
    ds_read_b128 v[96:99], v7 offset:5120
    ds_read_b128 v[100:103], v7 offset:6144
    ds_read_b128 v[104:107], v7 offset:7168
    v_mov_b64 v[52:53], 0
    v_mov_b64 v[54:55], 0
    v_mov_b64 v[56:57], 0
    v_mov_b64 v[58:59], 0
    v_mov_b64 v[60:61], 0
    v_mov_b64 v[62:63], 0
    v_mov_b64 v[64:65], 0
    v_mov_b64 v[66:67], 0
    v_mov_b64 v[68:69], 0
    v_mov_b64 v[70:71], 0
    v_mov_b64 v[72:73], 0
    v_mov_b64 v[74:75], 0
    v_add_u32 v111, s86, v0
    v_xor_b32 v108, 0x800, v111
    v_xor_b32 v109, 0x1000, v111
    v_xor_b32 v112, 0x1800, v111
    v_lshrrev_b32 v126, 2, v0
    ds_write_b128 v111, v[20:23] offset:16384
    ds_write_b128 v111, v[24:27] offset:17408
    s_waitcnt vmcnt(0) lgkmcnt(0)
    s_mov_b32 s96, s76
    s_mov_b32 s99, 0
    s_mov_b32 s93, 0x100000
    s_cmp_lt_u32 s95, 32
    s_cbranch_scc1 Lchain_slow
Lchain_fast:
    s_branch Lhop_157_compute
.p2align 6
Lhop_157:
    v_mov_b32 v126, -1
    v_mov_b32 v127, -1
    buffer_store_dwordx2 v[126:127], v10, s[4:7], s93 offen
    s_mov_b32 s94, s69
    s_add_u32 s95, s69, 0x1000
    s_mov_b32 s92, s71
    s_mov_b32 s93, s72
    s_mov_b32 s91, s73
    s_mov_b32 s97, 0
    s_mov_b32 s98, 0
    s_mov_b32 s96, s76
    s_mov_b32 s99, s60
    ds_read_b128 v[76:79], v7 offset:0
    ds_read_b128 v[80:83], v7 offset:1024
    ds_read_b128 v[84:87], v7 offset:2048
    ds_read_b128 v[88:91], v7 offset:3072
    ds_read_b128 v[92:95], v7 offset:4096
    ds_read_b128 v[96:99], v7 offset:5120
    ds_read_b128 v[100:103], v7 offset:6144
    ds_read_b128 v[104:107], v7 offset:7168
    v_mov_b64 v[52:53], 0
    v_mov_b64 v[54:55], 0
    v_mov_b64 v[56:57], 0
    v_mov_b64 v[58:59], 0
    v_mov_b64 v[60:61], 0
    v_mov_b64 v[62:63], 0
    v_mov_b64 v[64:65], 0
    v_mov_b64 v[66:67], 0
    v_mov_b64 v[68:69], 0
    v_mov_b64 v[70:71], 0
    v_mov_b64 v[72:73], 0
    v_mov_b64 v[74:75], 0
    v_add_u32 v111, s86, v0
    v_xor_b32 v108, 0x800, v111
    v_xor_b32 v109, 0x1000, v111
    v_xor_b32 v112, 0x1800, v111
    buffer_load_dwordx4 v[20:23], v0, s[4:7], s94 offen offset:0 sc1
    buffer_load_dwordx4 v[24:27], v0, s[4:7], s94 offen offset:1024 sc1
    buffer_load_dwordx4 v[28:31], v0, s[4:7], s94 offen offset:2048 sc1
    buffer_load_dwordx4 v[32:35], v0, s[4:7], s94 offen offset:3072 sc1
    buffer_load_dwordx4 v[36:39], v0, s[4:7], s95 offen offset:0 sc1
    buffer_load_dwordx4 v[40:43], v0, s[4:7], s95 offen offset:1024 sc1
    buffer_load_dwordx4 v[44:47], v0, s[4:7], s95 offen offset:2048 sc1
    buffer_load_dwordx4 v[48:51], v0, s[4:7], s95 offen offset:3072 sc1
Lhop_157_red:
    buffer_load_dwordx4 v[20:23], v0, s[4:7], s94 offen offset:0 sc1
    buffer_load_dwordx4 v[24:27], v0, s[4:7], s94 offen offset:1024 sc1
    buffer_load_dwordx4 v[28:31], v0, s[4:7], s94 offen offset:2048 sc1
    buffer_load_dwordx4 v[32:35], v0, s[4:7], s94 offen offset:3072 sc1
    s_waitcnt vmcnt(11)
    v_mfma_f32_16x16x32_bf16 v[124:127], v[16:19], v[20:23], 0
    buffer_load_dwordx4 v[36:39], v0, s[4:7], s95 offen offset:0 sc1
    s_waitcnt vmcnt(11)
    v_mfma_f32_16x16x32_bf16 v[124:127], v[16:19], v[24:27], v[124:127]
    buffer_load_dwordx4 v[40:43], v0, s[4:7], s95 offen offset:1024 sc1
    s_waitcnt vmcnt(11)
    v_mfma_f32_16x16x32_bf16 v[124:127], v[16:19], v[28:31], v[124:127]
    buffer_load_dwordx4 v[44:47], v0, s[4:7], s95 offen offset:2048 sc1
    s_waitcnt vmcnt(11)
    v_mfma_f32_16x16x32_bf16 v[124:127], v[16:19], v[32:35], v[124:127]
    buffer_load_dwordx4 v[48:51], v0, s[4:7], s95 offen offset:3072 sc1
    s_waitcnt vmcnt(11)
    v_mfma_f32_16x16x32_bf16 v[124:127], v[16:19], v[36:39], v[124:127]
    s_waitcnt vmcnt(10)
    v_mfma_f32_16x16x32_bf16 v[124:127], v[16:19], v[40:43], v[124:127]
    s_waitcnt vmcnt(9)
    v_mfma_f32_16x16x32_bf16 v[124:127], v[16:19], v[44:47], v[124:127]
    s_waitcnt vmcnt(8)
    v_mfma_f32_16x16x32_bf16 v[124:127], v[16:19], v[48:51], v[124:127]
    s_add_u32 s97, s97, 1
    s_cmp_gt_u32 s97, 64
    s_cbranch_scc1 Lhop_157_nan
    s_nop 4
    v_cmp_u_f32 vcc, v124, v124
    v_cvt_pk_bf16_f32 v124, v124, v125
    v_cvt_pk_bf16_f32 v125, v126, v127
    s_cbranch_vccnz Lhop_157_red
Lhop_157_ok:
    buffer_store_dwordx2 v[124:125], v10, s[4:7], s92 offen
Lhop_157_bar:
    s_waitcnt lgkmcnt(0)
    s_barrier
    s_add_u32 s60, s60, 1
    s_mov_b32 s65, s61
    s_mov_b32 s66, s62
    s_mov_b32 s72, s71
    s_add_u32 s61, s61, 0x40000
    s_bitset0_b32 s61, 20
    s_add_u32 s62, s61, s68
    s_add_u32 s69, s69, 0x40000
    s_bitset0_b32 s69, 20
    s_add_u32 s71, s71, 0x2000
    s_bitset0_b32 s71, 15
    s_add_u32 s73, s73, 0x2000
    s_bitset0_b32 s73, 15
    s_add_u32 s74, s74, 0x40000
    s_add_u32 s64, s64, 0x40000
    s_and_b32 s88, s78, 0x2000
    s_sub_u32 s75, s64, s88
    s_add_u32 s63, s63, 0x40000
    s_add_u32 s76, s76, 0x40000
    s_xor_b32 s78, s78, 0x2000
    s_add_u32 s88, s60, 1
    s_lshr_b32 s87, s88, 1
    s_add_u32 s88, s60, 2
    s_and_b32 s88, s88, 1
    s_lshl_b32 s88, s88, 7
    s_add_u32 s77, s70, s88
    buffer_load_dwordx4 v[20:23], v0, s[4:7], s91 offen sc1
    buffer_load_dwordx4 v[24:27], v0, s[4:7], s91 offen offset:1024 sc1
    s_mov_b64 s[54:55], -1
    s_mov_b64 s[52:53], -1
    v_lshrrev_b32 v126, 2, v0
    buffer_load_dwordx4 v[20:23], v0, s[4:7], s91 offen sc1
    buffer_load_dwordx4 v[24:27], v0, s[4:7], s91 offen offset:1024 sc1
Lhop_157_poll:
    s_mov_b64 exec, s[54:55]
    buffer_load_dwordx4 v[20:23], v0, s[4:7], s91 offen sc1
    s_mov_b64 exec, s[52:53]
    buffer_load_dwordx4 v[24:27], v0, s[4:7], s91 offen offset:1024 sc1
    s_mov_b64 exec, -1
    s_add_u32 s98, s98, 1
    s_cmp_gt_u32 s98, 0x400000
    s_cbranch_scc1 L_end
Lhop_157_chk:
    s_waitcnt vmcnt(5)
    v_max3_u32 v124, v20, v21, v22
    v_max_u32 v124, v124, v23
    s_waitcnt vmcnt(4)
    v_max3_u32 v125, v24, v25, v26
    v_max_u32 v125, v125, v27
    v_cmp_eq_u32 s[54:55], -1, v124
    v_cmp_eq_u32 s[52:53], -1, v125
    s_or_b64 vcc, s[54:55], s[52:53]
    s_cbranch_scc1 Lhop_157_poll
    ds_write_b128 v111, v[20:23] offset:16384
    s_cmp_eq_u32 s60, 63
    ds_write_b128 v111, v[24:27] offset:17408
    s_cbranch_scc1 Lhop_157_last
Lhop_157_compute:
    v_smfmac_f32_16x16x64_bf16 v[56:59], v[20:23], v[76:83], v1
    ds_read2_b32 v[124:125], v2 offset0:64 offset1:200
    buffer_store_dword v110, v126, s[4:7], s96 offen offset:2048 sc1
    v_smfmac_f32_16x16x64_bf16 v[52:55], v[20:23], a[0:7], v1
    ds_read_b128 v[76:79], v7 offset:8192
    buffer_store_dword v118, v126, s[4:7], s96 offen offset:2304 sc1
    v_smfmac_f32_16x16x64_bf16 v[52:55], v[24:27], a[8:15], v1
    ds_read_b128 v[80:83], v7 offset:9216
    v_readfirstlane_b32 s85, v11
    v_smfmac_f32_16x16x64_bf16 v[56:59], v[24:27], a[64:71], v1
    s_or_b32 s85, s85, s67
    s_cmp_le_u32 s85, s87
    s_cbranch_scc1 Lflagslow_158
Lflagslow_158_ret:
    v_smfmac_f32_16x16x64_bf16 v[60:63], v[24:27], a[104:111], v1
    s_waitcnt lgkmcnt(2)
    buffer_store_dword v124, v126, s[4:7], s96 offen sc1
    s_mov_b32 m0, s78
    v_smfmac_f32_16x16x64_bf16 v[64:67], v[24:27], a[160:167], v1
    buffer_store_dword v125, v126, s[4:7], s96 offen offset:256 sc1
    v_smfmac_f32_16x16x64_bf16 v[68:71], v[20:23], a[192:199], v1
    v_mov_b32 v127, s99
    s_barrier
    ds_read_b128 v[28:31], v108 offset:16384
    v_smfmac_f32_16x16x64_bf16 v[72:75], v[20:23], v[128:135], v1
    ds_read_b128 v[32:35], v108 offset:17408
    v_mul_u32_u24 v113, 11, v126
    v_smfmac_f32_16x16x64_bf16 v[68:71], v[24:27], a[200:207], v1
    ds_read_b128 v[36:39], v109 offset:16384
    buffer_store_dword v127, v115, s[4:7], s79 offen sc1
    v_smfmac_f32_16x16x64_bf16 v[72:75], v[24:27], v[136:143], v1
    ds_read_b128 v[40:43], v109 offset:17408
    v_smfmac_f32_16x16x64_bf16 v[60:63], v[20:23], a[96:103], v1
    ds_read_b128 v[44:47], v112 offset:16384
    s_waitcnt lgkmcnt(5)
    v_smfmac_f32_16x16x64_bf16 v[64:67], v[20:23], v[76:83], v1
    ds_read_b128 v[48:51], v112 offset:17408
    s_waitcnt lgkmcnt(5)
    v_smfmac_f32_16x16x64_bf16 v[56:59], v[28:31], v[84:91], v1
    v_mov_b32 v124, 0x7f817f81
    v_smfmac_f32_16x16x64_bf16 v[52:55], v[28:31], a[16:23], v1
    s_waitcnt lgkmcnt(3)
    v_mov_b32 v125, 0x7f817f81
    v_smfmac_f32_16x16x64_bf16 v[52:55], v[32:35], a[24:31], v1
    ds_read_b128 v[84:87], v7 offset:10240
    v_mov_b32 v126, 0x7f817f81
    v_smfmac_f32_16x16x64_bf16 v[56:59], v[32:35], a[72:79], v1
    ds_read_b128 v[88:91], v7 offset:11264
    buffer_load_dwordx4 v[108:111], v6, s[4:7], s75 offen
    v_smfmac_f32_16x16x64_bf16 v[56:59], v[36:39], v[92:99], v1
    ds_read_b128 v[76:79], v6 offset:0
    v_mov_b32 v127, 0x7f817f81
    v_smfmac_f32_16x16x64_bf16 v[52:55], v[36:39], a[32:39], v1
    ds_read_b128 v[80:83], v6 offset:256
    s_waitcnt lgkmcnt(4)
    v_smfmac_f32_16x16x64_bf16 v[52:55], v[40:43], a[40:47], v1
    ds_read_b128 v[92:95], v7 offset:12288
    buffer_load_dwordx4 v[116:119], v6, s[4:7], s75 offen offset:256
    v_smfmac_f32_16x16x64_bf16 v[56:59], v[40:43], a[80:87], v1
    ds_read_b128 v[96:99], v7 offset:13312
    v_smfmac_f32_16x16x64_bf16 v[56:59], v[44:47], v[100:107], v1
    v_smfmac_f32_16x16x64_bf16 v[52:55], v[44:47], a[48:55], v1
    buffer_store_dwordx4 v[124:127], v8, s[4:7], s65 offen
    v_smfmac_f32_16x16x64_bf16 v[52:55], v[48:51], a[56:63], v1
    ds_read_b128 v[100:103], v7 offset:14336
    v_smfmac_f32_16x16x64_bf16 v[56:59], v[48:51], a[88:95], v1
    ds_read_b128 v[104:107], v7 offset:15360
    s_waitcnt lgkmcnt(6)
    v_smfmac_f32_16x16x64_bf16 v[64:67], v[28:31], v[84:91], v1
    buffer_load_dword v11, v113, s[48:51], s63 offen
    v_smfmac_f32_16x16x64_bf16 v[60:63], v[28:31], a[112:119], v1
    ds_read_b128 v[84:87], v6 offset:2048
    v_add_f32 v52, v52, v53
    v_smfmac_f32_16x16x64_bf16 v[60:63], v[32:35], a[120:127], v1
    ds_read_b128 v[88:91], v6 offset:2304
    v_add_f32 v54, v54, v55
    v_smfmac_f32_16x16x64_bf16 v[64:67], v[32:35], a[168:175], v1
    s_waitcnt lgkmcnt(2)
    v_add_f32 v56, v56, v57
    v_smfmac_f32_16x16x64_bf16 v[64:67], v[36:39], v[92:99], v1
    buffer_store_dwordx4 v[124:127], v8, s[4:7], s66 offen
    v_add_f32 v58, v58, v59
    v_smfmac_f32_16x16x64_bf16 v[60:63], v[36:39], a[128:135], v1
    ds_read_b128 v[92:95], v6 offset:4096
    v_cvt_pk_bf16_f32 v52, v52, v56
    v_smfmac_f32_16x16x64_bf16 v[60:63], v[40:43], a[136:143], v1
    ds_read_b128 v[96:99], v6 offset:4352
    v_cvt_pk_bf16_f32 v53, v54, v58
    v_smfmac_f32_16x16x64_bf16 v[64:67], v[40:43], a[176:183], v1
    ds_write2_b32 v2, v52, v53 offset0:0 offset1:136
    v_smfmac_f32_16x16x64_bf16 v[64:67], v[44:47], v[100:107], v1
    buffer_load_dwordx4 v0, s[48:51], s74 offen lds
    v_smfmac_f32_16x16x64_bf16 v[60:63], v[44:47], a[144:151], v1
    ds_read_b128 v[100:103], v6 offset:6144
    v_smfmac_f32_16x16x64_bf16 v[60:63], v[48:51], a[152:159], v1
    ds_read_b128 v[104:107], v6 offset:6400
    v_smfmac_f32_16x16x64_bf16 v[64:67], v[48:51], a[184:191], v1
    buffer_load_dword v11, v114, s[48:51], s77 offen sc1
    v_smfmac_f32_16x16x64_bf16 v[68:71], v[28:31], a[208:215], v1
    v_add_f32 v60, v60, v61
    v_smfmac_f32_16x16x64_bf16 v[72:75], v[28:31], v[144:151], v1
    v_add_f32 v62, v62, v63
    v_add_f32 v64, v64, v65
    v_add_f32 v66, v66, v67
    v_cvt_pk_bf16_f32 v60, v60, v64
    v_cvt_pk_bf16_f32 v61, v62, v66
    ds_write2_b32 v2, v60, v61 offset0:64 offset1:200
    v_smfmac_f32_16x16x64_bf16 v[68:71], v[32:35], a[216:223], v1
    buffer_load_dwordx4 v0, s[48:51], s74 offen offset:1024 lds
    s_waitcnt vmcnt(13)
    v_smfmac_f32_16x16x64_bf16 v[72:75], v[32:35], v[152:159], v1
    v_smfmac_f32_16x16x64_bf16 v[68:71], v[36:39], a[224:231], v1
    v_smfmac_f32_16x16x64_bf16 v[72:75], v[36:39], v[160:167], v1
    buffer_load_dwordx4 v0, s[48:51], s74 offen offset:2048 lds
    v_smfmac_f32_16x16x64_bf16 v[68:71], v[40:43], a[232:239], v1
    s_waitcnt lgkmcnt(0)
    s_barrier
    ds_read_b128 v[52:55], v3 offset:0
    ds_read_b128 v[56:59], v3 offset:64
    v_smfmac_f32_16x16x64_bf16 v[72:75], v[40:43], v[168:175], v1
    ds_read_b128 v[60:63], v3 offset:128
    v_smfmac_f32_16x16x64_bf16 v[68:71], v[44:47], a[240:247], v1
    ds_read_b128 v[64:67], v3 offset:192
    v_mov_b64 v[32:33], 0
    v_smfmac_f32_16x16x64_bf16 v[72:75], v[44:47], v[176:183], v1
    v_mov_b64 v[34:35], 0
    v_smfmac_f32_16x16x64_bf16 v[68:71], v[48:51], a[248:255], v1
    v_mov_b64 v[36:37], 0
    v_smfmac_f32_16x16x64_bf16 v[72:75], v[48:51], v[184:191], v1
    s_waitcnt lgkmcnt(2)
    v_mov_b64 v[38:39], 0
    v_mfma_f32_16x16x32_bf16 v[20:23], v[76:79], v[52:55], 0
    ds_read_b128 v[76:79], v4 offset:0
    v_mfma_f32_16x16x32_bf16 v[24:27], v[80:83], v[52:55], 0
    ds_read_b128 v[80:83], v4 offset:64
    v_xor_b32 v6, 0x2000, v6
    v_mfma_f32_16x16x32_bf16 v[20:23], v[84:87], v[56:59], v[20:23]
    ds_read_b128 v[84:87], v4 offset:128
    v_add_f32 v68, v68, v69
    v_mfma_f32_16x16x32_bf16 v[24:27], v[88:91], v[56:59], v[24:27]
    ds_read_b128 v[88:91], v4 offset:192
    s_waitcnt lgkmcnt(4)
    v_mfma_f32_16x16x32_bf16 v[20:23], v[92:95], v[60:63], v[20:23]
    v_add_f32 v70, v70, v71
    v_cvt_pk_bf16_f32 v69, v68, v70
    v_mfma_f32_16x16x32_bf16 v[24:27], v[96:99], v[60:63], v[24:27]
    v_cvt_pk_bf16_f32 v68, v68, v70
    v_add_f32 v72, v72, v73
    v_mfma_f32_16x16x32_bf16 v[20:23], v[100:103], v[64:67], v[20:23]
    v_add_f32 v74, v74, v75
    v_cvt_pk_bf16_f32 v73, v72, v74
    v_mfma_f32_16x16x32_bf16 v[24:27], v[104:107], v[64:67], v[24:27]
    s_waitcnt lgkmcnt(0)
    v_cvt_pk_bf16_f32 v72, v72, v74
    v_mfma_f32_16x16x32_bf16 v[28:31], v[76:79], v[52:55], 0
    ds_read_b128 v[92:95], v7 offset:16384
    v_mfma_f32_16x16x32_bf16 v[28:31], v[80:83], v[56:59], v[28:31]
    ds_read_b128 v[96:99], v7 offset:17408
    v_max3_f32 v124, v20, v21, v22
    v_mfma_f32_16x16x32_bf16 v[28:31], v[84:87], v[60:63], v[28:31]
    ds_read_b128 v[100:103], v7 offset:18432
    v_max3_f32 v125, v23, v24, v25
    v_mfma_f32_16x16x32_bf16 v[28:31], v[88:91], v[64:67], v[28:31]
    ds_read_b128 v[104:107], v7 offset:19456
    v_max3_f32 v124, v124, v26, v27
    v_max_f32 v124, v124, v125
    v_cndmask_b32 v20, v20, v22, s[80:81]
    v_cndmask_b32 v21, v21, v23, s[80:81]
    v_cndmask_b32 v24, v24, v26, s[80:81]
    v_cndmask_b32 v25, v25, v27, s[80:81]
    s_nop 0
    v_max3_f32 v124, v124, v28, v29
    v_max3_f32 v124, v124, v30, v31
    v_mov_b32 v125, v124
    v_cndmask_b32 v28, v28, v30, s[80:81]
    v_cndmask_b32 v29, v29, v31, s[80:81]
    v_permlane32_swap_b32 v124, v125
    v_max_f32 v124, v124, v125
    v_mov_b32 v125, v124
    s_nop 0
    s_waitcnt vmcnt(7)
    v_permlane16_swap_b32 v124, v125
    v_max_f32 v124, v124, v125
    v_mul_f32 v124, s84, v124
    v_fma_f32 v20, v20, s84, -v124
    v_fma_f32 v21, v21, s84, -v124
    v_fma_f32 v24, v24, s84, -v124
    v_fma_f32 v25, v25, s84, -v124
    v_fma_f32 v28, v28, s84, -v124
    v_fma_f32 v29, v29, s84, -v124
    v_exp_f32 v28, v28
    v_exp_f32 v29, v29
    v_exp_f32 v20, v20
    v_exp_f32 v21, v21
    v_exp_f32 v24, v24
    v_exp_f32 v25, v25
    v_cvt_pk_bf16_f32 v22, v28, v29
    v_cvt_pk_bf16_f32 v124, v20, v21
    v_cvt_pk_bf16_f32 v126, v24, v25
    v_cndmask_b32 v125, 0, v22, s[82:83]
    v_cndmask_b32 v127, 0, v22, s[10:11]
    v_mov_b64 v[112:113], v[110:111]
    v_mov_b64 v[110:111], v[68:69]
    v_mfma_f32_16x16x32_bf16 v[40:43], v[124:127], v[12:15], 0
    v_mov_b64 v[120:121], v[118:119]
    v_mov_b64 v[118:119], v[72:73]
    v_smfmac_f32_16x16x64_bf16 v[32:35], v[124:127], v[108:115], v1
    ds_read_b128 v[76:79], v7 offset:20480
    v_mov_b64 v[20:21], 0
    v_smfmac_f32_16x16x64_bf16 v[36:39], v[124:127], v[116:123], v1
    ds_read_b128 v[80:83], v7 offset:21504
    v_add_f32 v40, v40, v41
    v_add_f32 v42, v42, v43
    v_rcp_f32 v40, v40
    v_rcp_f32 v42, v42
    v_add_f32 v32, v32, v33
    v_add_f32 v34, v34, v35
    v_mul_f32 v32, v32, v40
    v_mul_f32 v34, v34, v42
    v_add_f32 v36, v36, v37
    v_add_f32 v38, v38, v39
    v_mul_f32 v36, v36, v40
    v_mul_f32 v38, v38, v42
    v_cvt_pk_bf16_f32 v124, v32, v36
    v_cvt_pk_bf16_f32 v125, v34, v38
    ds_write2_b32 v9, v124, v125 offset0:0 offset1:80
    v_mov_b64 v[22:23], 0
    v_mov_b64 v[24:25], 0
    v_mov_b64 v[26:27], 0
    v_mov_b64 v[28:29], 0
    v_mov_b64 v[30:31], 0
    v_mov_b64 v[32:33], 0
    v_mov_b64 v[34:35], 0
    v_mov_b64 v[36:37], 0
    v_mov_b64 v[38:39], 0
    v_mov_b64 v[40:41], 0
    v_mov_b64 v[42:43], 0
    v_mov_b64 v[44:45], 0
    s_waitcnt lgkmcnt(0)
    s_barrier
    ds_read_b128 v[52:55], v5 offset:0
    ds_read_b128 v[56:59], v5 offset:128
    ds_read_b128 v[84:87], v7 offset:22528
    ds_read_b128 v[88:91], v7 offset:23552
    v_mov_b64 v[46:47], 0
    v_mov_b64 v[48:49], 0
    v_mov_b64 v[50:51], 0
    s_waitcnt lgkmcnt(2)
    v_smfmac_f32_16x16x64_bf16 v[20:23], v[52:55], v[92:99], v1
    ds_read_b128 v[60:63], v7 offset:24576
    v_smfmac_f32_16x16x64_bf16 v[20:23], v[56:59], v[100:107], v1
    ds_read_b128 v[64:67], v7 offset:25600
    v_smfmac_f32_16x16x64_bf16 v[24:27], v[52:55], v[192:199], v1
    ds_read_b128 v[68:71], v7 offset:26624
    v_smfmac_f32_16x16x64_bf16 v[24:27], v[56:59], v[200:207], v1
    ds_read_b128 v[72:75], v7 offset:27648
    s_waitcnt lgkmcnt(4)
    v_add_f32 v20, v20, v21
    v_smfmac_f32_16x16x64_bf16 v[28:31], v[52:55], v[76:83], v1
    ds_read_b128 v[92:95], v7 offset:28672
    v_add_f32 v22, v22, v23
    v_cvt_pk_bf16_f32 v20, v20, v22
    v_smfmac_f32_16x16x64_bf16 v[28:31], v[56:59], v[84:91], v1
    ds_read_b128 v[96:99], v7 offset:29696
    v_add_f32 v24, v24, v25
    v_smfmac_f32_16x16x64_bf16 v[32:35], v[52:55], v[208:215], v1
    ds_read_b128 v[100:103], v7 offset:30720
    v_add_f32 v26, v26, v27
    v_cvt_pk_bf16_f32 v21, v24, v26
    v_smfmac_f32_16x16x64_bf16 v[32:35], v[56:59], v[216:223], v1
    ds_read_b128 v[104:107], v7 offset:31744
    s_waitcnt lgkmcnt(4)
    v_add_f32 v28, v28, v29
    v_smfmac_f32_16x16x64_bf16 v[36:39], v[52:55], v[60:67], v1
    v_add_f32 v30, v30, v31
    v_cvt_pk_bf16_f32 v22, v28, v30
    v_smfmac_f32_16x16x64_bf16 v[36:39], v[56:59], v[68:75], v1
    v_add_f32 v32, v32, v33
    v_smfmac_f32_16x16x64_bf16 v[40:43], v[52:55], v[224:231], v1
    v_add_f32 v34, v34, v35
    v_cvt_pk_bf16_f32 v23, v32, v34
    buffer_store_dwordx4 v[20:23], v8, s[4:7], s61 offen
    v_smfmac_f32_16x16x64_bf16 v[40:43], v[56:59], v[232:239], v1
    s_waitcnt lgkmcnt(0)
    v_add_f32 v36, v36, v37
    v_smfmac_f32_16x16x64_bf16 v[44:47], v[52:55], v[92:99], v1
    v_add_f32 v38, v38, v39
    v_cvt_pk_bf16_f32 v36, v36, v38
    v_smfmac_f32_16x16x64_bf16 v[44:47], v[56:59], v[100:107], v1
    v_add_f32 v40, v40, v41
    v_smfmac_f32_16x16x64_bf16 v[48:51], v[52:55], v[240:247], v1
    v_add_f32 v42, v42, v43
    v_cvt_pk_bf16_f32 v37, v40, v42
    v_smfmac_f32_16x16x64_bf16 v[48:51], v[56:59], v[248:255], v1
    v_add_f32 v44, v44, v45
    v_add_f32 v46, v46, v47
    v_cvt_pk_bf16_f32 v38, v44, v46
    s_nop 4
    v_add_f32 v48, v48, v49
    v_add_f32 v50, v50, v51
    v_cvt_pk_bf16_f32 v39, v48, v50
    buffer_store_dwordx4 v[36:39], v8, s[4:7], s62 offen
    s_cmp_lg_u32 s56, 0
    s_cbranch_scc1 Lhop_157_other
    s_branch Lhop_157
Lhop_157_last:
    s_nop 0
    ds_read2_b32 v[124:125], v2 offset0:64 offset1:200
    buffer_store_dword v110, v126, s[4:7], s96 offen offset:2048 sc1
    s_nop 0
    ds_read_b128 v[76:79], v7 offset:8192
    buffer_store_dword v118, v126, s[4:7], s96 offen offset:2304 sc1
    s_nop 0
    ds_read_b128 v[80:83], v7 offset:9216
    s_nop 0
    v_smfmac_f32_16x16x64_bf16 v[60:63], v[24:27], a[104:111], v1
    s_waitcnt lgkmcnt(2)
    buffer_store_dword v124, v126, s[4:7], s96 offen sc1
    s_mov_b32 m0, s78
    v_smfmac_f32_16x16x64_bf16 v[64:67], v[24:27], a[160:167], v1
    buffer_store_dword v125, v126, s[4:7], s96 offen offset:256 sc1
    v_smfmac_f32_16x16x64_bf16 v[68:71], v[20:23], a[192:199], v1
    v_mov_b32 v127, s99
    s_barrier
    ds_read_b128 v[28:31], v108 offset:16384
    v_smfmac_f32_16x16x64_bf16 v[72:75], v[20:23], v[128:135], v1
    ds_read_b128 v[32:35], v108 offset:17408
    v_smfmac_f32_16x16x64_bf16 v[68:71], v[24:27], a[200:207], v1
    ds_read_b128 v[36:39], v109 offset:16384
    buffer_store_dword v127, v115, s[4:7], s79 offen sc1
    v_smfmac_f32_16x16x64_bf16 v[72:75], v[24:27], v[136:143], v1
    ds_read_b128 v[40:43], v109 offset:17408
    v_smfmac_f32_16x16x64_bf16 v[60:63], v[20:23], a[96:103], v1
    ds_read_b128 v[44:47], v112 offset:16384
    s_waitcnt lgkmcnt(5)
    v_smfmac_f32_16x16x64_bf16 v[64:67], v[20:23], v[76:83], v1
    ds_read_b128 v[48:51], v112 offset:17408
    s_waitcnt lgkmcnt(5)
    s_nop 0
    s_nop 0
    s_waitcnt lgkmcnt(3)
    s_nop 0
    ds_read_b128 v[84:87], v7 offset:10240
    s_nop 0
    ds_read_b128 v[88:91], v7 offset:11264
    s_nop 0
    s_nop 0
    s_waitcnt lgkmcnt(2)
    s_nop 0
    ds_read_b128 v[92:95], v7 offset:12288
    s_nop 0
    ds_read_b128 v[96:99], v7 offset:13312
    s_nop 0
    s_nop 0
    s_nop 0
    ds_read_b128 v[100:103], v7 offset:14336
    s_nop 0
    ds_read_b128 v[104:107], v7 offset:15360
    s_waitcnt lgkmcnt(4)
    v_smfmac_f32_16x16x64_bf16 v[64:67], v[28:31], v[84:91], v1
    v_smfmac_f32_16x16x64_bf16 v[60:63], v[28:31], a[112:119], v1
    v_smfmac_f32_16x16x64_bf16 v[60:63], v[32:35], a[120:127], v1
    v_smfmac_f32_16x16x64_bf16 v[64:67], v[32:35], a[168:175], v1
    s_waitcnt lgkmcnt(0)
    v_smfmac_f32_16x16x64_bf16 v[64:67], v[36:39], v[92:99], v1
    v_smfmac_f32_16x16x64_bf16 v[60:63], v[36:39], a[128:135], v1
    v_smfmac_f32_16x16x64_bf16 v[60:63], v[40:43], a[136:143], v1
    v_smfmac_f32_16x16x64_bf16 v[64:67], v[40:43], a[176:183], v1
    v_smfmac_f32_16x16x64_bf16 v[64:67], v[44:47], v[100:107], v1
    v_smfmac_f32_16x16x64_bf16 v[60:63], v[44:47], a[144:151], v1
    v_smfmac_f32_16x16x64_bf16 v[60:63], v[48:51], a[152:159], v1
    v_smfmac_f32_16x16x64_bf16 v[64:67], v[48:51], a[184:191], v1
    v_lshrrev_b32 v126, 2, v0
    v_smfmac_f32_16x16x64_bf16 v[68:71], v[28:31], a[208:215], v1
    v_smfmac_f32_16x16x64_bf16 v[72:75], v[28:31], v[144:151], v1
    v_smfmac_f32_16x16x64_bf16 v[68:71], v[32:35], a[216:223], v1
    v_add_f32 v60, v60, v61
    v_smfmac_f32_16x16x64_bf16 v[72:75], v[32:35], v[152:159], v1
    v_add_f32 v62, v62, v63
    v_smfmac_f32_16x16x64_bf16 v[68:71], v[36:39], a[224:231], v1
    v_add_f32 v64, v64, v65
    v_smfmac_f32_16x16x64_bf16 v[72:75], v[36:39], v[160:167], v1
    v_add_f32 v66, v66, v67
    v_smfmac_f32_16x16x64_bf16 v[68:71], v[40:43], a[232:239], v1
    v_cvt_pk_bf16_f32 v60, v60, v64
    v_smfmac_f32_16x16x64_bf16 v[72:75], v[40:43], v[168:175], v1
    v_cvt_pk_bf16_f32 v61, v62, v66
    v_smfmac_f32_16x16x64_bf16 v[68:71], v[44:47], a[240:247], v1
    buffer_store_dword v60, v126, s[4:7], s76 offen sc1
    v_smfmac_f32_16x16x64_bf16 v[72:75], v[44:47], v[176:183], v1
    buffer_store_dword v61, v126, s[4:7], s76 offen offset:256 sc1
    v_smfmac_f32_16x16x64_bf16 v[68:71], v[48:51], a[248:255], v1
    v_smfmac_f32_16x16x64_bf16 v[72:75], v[48:51], v[184:191], v1
    s_nop 7
    v_add_f32 v68, v68, v69
    v_add_f32 v70, v70, v71
    v_cvt_pk_bf16_f32 v110, v68, v70
    v_cvt_pk_bf16_f32 v111, v68, v70
    v_add_f32 v72, v72, v73
    v_add_f32 v74, v74, v75
    v_cvt_pk_bf16_f32 v118, v72, v74
    v_cvt_pk_bf16_f32 v119, v72, v74
    buffer_store_dword v110, v126, s[4:7], s76 offen offset:2048 sc1
    buffer_store_dword v118, v126, s[4:7], s76 offen offset:2304 sc1
    v_mov_b32 v124, 64
    s_waitcnt vmcnt(0)
    s_barrier
    buffer_store_dword v124, v115, s[4:7], s79 offen sc1
    s_waitcnt vmcnt(0)
    s_branch L_end
Lhop_157_other:
    s_mov_b32 s94, s69
    s_add_u32 s95, s69, 0x1000
    s_mov_b32 s92, s71
    s_mov_b32 s93, s72
    s_mov_b32 s91, s73
    s_mov_b32 s97, 0
    s_mov_b32 s98, 0
    s_mov_b32 s96, s76
    s_mov_b32 s99, s60
    ds_read_b128 v[76:79], v7 offset:0
    ds_read_b128 v[80:83], v7 offset:1024
    ds_read_b128 v[84:87], v7 offset:2048
    ds_read_b128 v[88:91], v7 offset:3072
    ds_read_b128 v[92:95], v7 offset:4096
    ds_read_b128 v[96:99], v7 offset:5120
    ds_read_b128 v[100:103], v7 offset:6144
    ds_read_b128 v[104:107], v7 offset:7168
    v_mov_b64 v[52:53], 0
    v_mov_b64 v[54:55], 0
    v_mov_b64 v[56:57], 0
    v_mov_b64 v[58:59], 0
    v_mov_b64 v[60:61], 0
    v_mov_b64 v[62:63], 0
    v_mov_b64 v[64:65], 0
    v_mov_b64 v[66:67], 0
    v_mov_b64 v[68:69], 0
    v_mov_b64 v[70:71], 0
    v_mov_b64 v[72:73], 0
    v_mov_b64 v[74:75], 0
    v_add_u32 v111, s86, v0
    v_xor_b32 v108, 0x800, v111
    v_xor_b32 v109, 0x1000, v111
    v_xor_b32 v112, 0x1800, v111
    s_branch Lhop_157_bar
Lflagslow_158:
    s_add_u32 s88, s60, 1
    s_and_b32 s88, s88, 1
    s_lshl_b32 s88, s88, 7
    s_add_u32 s88, s88, s70
Lflagslow_158_l:
    s_add_u32 s101, s101, 1
    s_cmp_gt_u32 s101, 0x400000
    s_cbranch_scc1 L_end
    buffer_load_dword v11, v114, s[4:7], s88 offen sc1
    s_waitcnt vmcnt(0)
    v_readfirstlane_b32 s85, v11
    s_cmp_le_u32 s85, s87
    s_cbranch_scc1 Lflagslow_158_l
    s_branch Lflagslow_158_ret
Lhop_157_nan:
    s_add_u32 s101, s101, 1
    s_cmp_gt_u32 s101, 0x400000
    s_cbranch_scc1 L_end
    s_mov_b32 s90, 0x7f817f81
    s_mov_b64 s[88:89], 0
    s_waitcnt vmcnt(0)
    v_cmp_eq_u32 vcc, s90, v20
    s_or_b64 s[88:89], s[88:89], vcc
    v_cmp_eq_u32 vcc, s90, v21
    s_or_b64 s[88:89], s[88:89], vcc
    v_cmp_eq_u32 vcc, s90, v22
    s_or_b64 s[88:89], s[88:89], vcc
    v_cmp_eq_u32 vcc, s90, v23
    s_or_b64 s[88:89], s[88:89], vcc
    v_cmp_eq_u32 vcc, s90, v24
    s_or_b64 s[88:89], s[88:89], vcc
    v_cmp_eq_u32 vcc, s90, v25
    s_or_b64 s[88:89], s[88:89], vcc
    v_cmp_eq_u32 vcc, s90, v26
    s_or_b64 s[88:89], s[88:89], vcc
    v_cmp_eq_u32 vcc, s90, v27
    s_or_b64 s[88:89], s[88:89], vcc
    v_cmp_eq_u32 vcc, s90, v28
    s_or_b64 s[88:89], s[88:89], vcc
    v_cmp_eq_u32 vcc, s90, v29
    s_or_b64 s[88:89], s[88:89], vcc
    v_cmp_eq_u32 vcc, s90, v30
    s_or_b64 s[88:89], s[88:89], vcc
    v_cmp_eq_u32 vcc, s90, v31
    s_or_b64 s[88:89], s[88:89], vcc
    v_cmp_eq_u32 vcc, s90, v32
    s_or_b64 s[88:89], s[88:89], vcc
    v_cmp_eq_u32 vcc, s90, v33
    s_or_b64 s[88:89], s[88:89], vcc
    v_cmp_eq_u32 vcc, s90, v34
    s_or_b64 s[88:89], s[88:89], vcc
    v_cmp_eq_u32 vcc, s90, v35
    s_or_b64 s[88:89], s[88:89], vcc
    v_cmp_eq_u32 vcc, s90, v36
    s_or_b64 s[88:89], s[88:89], vcc
    v_cmp_eq_u32 vcc, s90, v37
    s_or_b64 s[88:89], s[88:89], vcc
    v_cmp_eq_u32 vcc, s90, v38
    s_or_b64 s[88:89], s[88:89], vcc
    v_cmp_eq_u32 vcc, s90, v39
    s_or_b64 s[88:89], s[88:89], vcc
    v_cmp_eq_u32 vcc, s90, v40
    s_or_b64 s[88:89], s[88:89], vcc
    v_cmp_eq_u32 vcc, s90, v41
    s_or_b64 s[88:89], s[88:89], vcc
    v_cmp_eq_u32 vcc, s90, v42
    s_or_b64 s[88:89], s[88:89], vcc
    v_cmp_eq_u32 vcc, s90, v43
    s_or_b64 s[88:89], s[88:89], vcc
    v_cmp_eq_u32 vcc, s90, v44
    s_or_b64 s[88:89], s[88:89], vcc
    v_cmp_eq_u32 vcc, s90, v45
    s_or_b64 s[88:89], s[88:89], vcc
    v_cmp_eq_u32 vcc, s90, v46
    s_or_b64 s[88:89], s[88:89], vcc
    v_cmp_eq_u32 vcc, s90, v47
    s_or_b64 s[88:89], s[88:89], vcc
    v_cmp_eq_u32 vcc, s90, v48
    s_or_b64 s[88:89], s[88:89], vcc
    v_cmp_eq_u32 vcc, s90, v49
    s_or_b64 s[88:89], s[88:89], vcc
    v_cmp_eq_u32 vcc, s90, v50
    s_or_b64 s[88:89], s[88:89], vcc
    v_cmp_eq_u32 vcc, s90, v51
    s_or_b64 s[88:89], s[88:89], vcc
    s_cmp_eq_u64 s[88:89], 0
    s_cbranch_scc1 Lhop_157_acc
    buffer_load_dwordx4 v[20:23], v0, s[4:7], s94 offen offset:0 sc1
    buffer_load_dwordx4 v[24:27], v0, s[4:7], s94 offen offset:1024 sc1
    buffer_load_dwordx4 v[28:31], v0, s[4:7], s94 offen offset:2048 sc1
    buffer_load_dwordx4 v[32:35], v0, s[4:7], s94 offen offset:3072 sc1
    buffer_load_dwordx4 v[36:39], v0, s[4:7], s95 offen offset:0 sc1
    buffer_load_dwordx4 v[40:43], v0, s[4:7], s95 offen offset:1024 sc1
    buffer_load_dwordx4 v[44:47], v0, s[4:7], s95 offen offset:2048 sc1
    buffer_load_dwordx4 v[48:51], v0, s[4:7], s95 offen offset:3072 sc1
    s_branch Lhop_157_red
Lhop_157_acc:
    v_mfma_f32_16x16x32_bf16 v[124:127], v[16:19], v[20:23], 0
    v_mfma_f32_16x16x32_bf16 v[124:127], v[16:19], v[24:27], v[124:127]
    v_mfma_f32_16x16x32_bf16 v[124:127], v[16:19], v[28:31], v[124:127]
    v_mfma_f32_16x16x32_bf16 v[124:127], v[16:19], v[32:35], v[124:127]
    v_mfma_f32_16x16x32_bf16 v[124:127], v[16:19], v[36:39], v[124:127]
    v_mfma_f32_16x16x32_bf16 v[124:127], v[16:19], v[40:43], v[124:127]
    v_mfma_f32_16x16x32_bf16 v[124:127], v[16:19], v[44:47], v[124:127]
    v_mfma_f32_16x16x32_bf16 v[124:127], v[16:19], v[48:51], v[124:127]
    s_nop 7
    v_cvt_pk_bf16_f32 v124, v124, v125
    v_cvt_pk_bf16_f32 v125, v126, v127
    v_min_u32 v124, -2, v124
    v_min_u32 v125, -2, v125
    s_branch Lhop_157_ok
Lchain_slow:
    s_branch Lhop_160_compute
.p2align 6
Lhop_160:
    v_mov_b32 v126, -1
    v_mov_b32 v127, -1
    buffer_store_dwordx2 v[126:127], v10, s[4:7], s93 offen sc1
    s_mov_b32 s94, s69
    s_add_u32 s95, s69, 0x1000
    s_mov_b32 s92, s71
    s_mov_b32 s93, s72
    s_mov_b32 s91, s73
    s_mov_b32 s97, 0
    s_mov_b32 s98, 0
    s_mov_b32 s96, s76
    s_mov_b32 s99, s60
    ds_read_b128 v[76:79], v7 offset:0
    ds_read_b128 v[80:83], v7 offset:1024
    ds_read_b128 v[84:87], v7 offset:2048
    ds_read_b128 v[88:91], v7 offset:3072
    ds_read_b128 v[92:95], v7 offset:4096
    ds_read_b128 v[96:99], v7 offset:5120
    ds_read_b128 v[100:103], v7 offset:6144
    ds_read_b128 v[104:107], v7 offset:7168
    v_mov_b64 v[52:53], 0
    v_mov_b64 v[54:55], 0
    v_mov_b64 v[56:57], 0
    v_mov_b64 v[58:59], 0
    v_mov_b64 v[60:61], 0
    v_mov_b64 v[62:63], 0
    v_mov_b64 v[64:65], 0
    v_mov_b64 v[66:67], 0
    v_mov_b64 v[68:69], 0
    v_mov_b64 v[70:71], 0
    v_mov_b64 v[72:73], 0
    v_mov_b64 v[74:75], 0
    v_add_u32 v111, s86, v0
    v_xor_b32 v108, 0x800, v111
    v_xor_b32 v109, 0x1000, v111
    v_xor_b32 v112, 0x1800, v111
    buffer_load_dwordx4 v[20:23], v0, s[4:7], s94 offen offset:0 sc1
    buffer_load_dwordx4 v[24:27], v0, s[4:7], s94 offen offset:1024 sc1
    buffer_load_dwordx4 v[28:31], v0, s[4:7], s94 offen offset:2048 sc1
    buffer_load_dwordx4 v[32:35], v0, s[4:7], s94 offen offset:3072 sc1
    buffer_load_dwordx4 v[36:39], v0, s[4:7], s95 offen offset:0 sc1
    buffer_load_dwordx4 v[40:43], v0, s[4:7], s95 offen offset:1024 sc1
    buffer_load_dwordx4 v[44:47], v0, s[4:7], s95 offen offset:2048 sc1
    buffer_load_dwordx4 v[48:51], v0, s[4:7], s95 offen offset:3072 sc1
Lhop_160_red:
    buffer_load_dwordx4 v[20:23], v0, s[4:7], s94 offen offset:0 sc1
    buffer_load_dwordx4 v[24:27], v0, s[4:7], s94 offen offset:1024 sc1
    buffer_load_dwordx4 v[28:31], v0, s[4:7], s94 offen offset:2048 sc1
    buffer_load_dwordx4 v[32:35], v0, s[4:7], s94 offen offset:3072 sc1
    s_waitcnt vmcnt(11)
    v_mfma_f32_16x16x32_bf16 v[124:127], v[16:19], v[20:23], 0
    buffer_load_dwordx4 v[36:39], v0, s[4:7], s95 offen offset:0 sc1
    s_waitcnt vmcnt(11)
    v_mfma_f32_16x16x32_bf16 v[124:127], v[16:19], v[24:27], v[124:127]
    buffer_load_dwordx4 v[40:43], v0, s[4:7], s95 offen offset:1024 sc1
    s_waitcnt vmcnt(11)
    v_mfma_f32_16x16x32_bf16 v[124:127], v[16:19], v[28:31], v[124:127]
    buffer_load_dwordx4 v[44:47], v0, s[4:7], s95 offen offset:2048 sc1
    s_waitcnt vmcnt(11)
    v_mfma_f32_16x16x32_bf16 v[124:127], v[16:19], v[32:35], v[124:127]
    buffer_load_dwordx4 v[48:51], v0, s[4:7], s95 offen offset:3072 sc1
    s_waitcnt vmcnt(11)
    v_mfma_f32_16x16x32_bf16 v[124:127], v[16:19], v[36:39], v[124:127]
    s_waitcnt vmcnt(10)
    v_mfma_f32_16x16x32_bf16 v[124:127], v[16:19], v[40:43], v[124:127]
    s_waitcnt vmcnt(9)
    v_mfma_f32_16x16x32_bf16 v[124:127], v[16:19], v[44:47], v[124:127]
    s_waitcnt vmcnt(8)
    v_mfma_f32_16x16x32_bf16 v[124:127], v[16:19], v[48:51], v[124:127]
    s_add_u32 s97, s97, 1
    s_cmp_gt_u32 s97, 64
    s_cbranch_scc1 Lhop_160_nan
    s_nop 4
    v_cmp_u_f32 vcc, v124, v124
    v_cvt_pk_bf16_f32 v124, v124, v125
    v_cvt_pk_bf16_f32 v125, v126, v127
    s_cbranch_vccnz Lhop_160_red
Lhop_160_ok:
    buffer_store_dwordx2 v[124:125], v10, s[4:7], s92 offen sc1
Lhop_160_bar:
    s_waitcnt lgkmcnt(0)
    s_barrier
    s_add_u32 s60, s60, 1
    s_mov_b32 s65, s61
    s_mov_b32 s66, s62
    s_mov_b32 s72, s71
    s_add_u32 s61, s61, 0x40000
    s_bitset0_b32 s61, 20
    s_add_u32 s62, s61, s68
    s_add_u32 s69, s69, 0x40000
    s_bitset0_b32 s69, 20
    s_add_u32 s71, s71, 0x2000
    s_bitset0_b32 s71, 15
    s_add_u32 s73, s73, 0x2000
    s_bitset0_b32 s73, 15
    s_add_u32 s74, s74, 0x40000
    s_add_u32 s64, s64, 0x40000
    s_and_b32 s88, s78, 0x2000
    s_sub_u32 s75, s64, s88
    s_add_u32 s63, s63, 0x40000
    s_add_u32 s76, s76, 0x40000
    s_xor_b32 s78, s78, 0x2000
    s_add_u32 s88, s60, 1
    s_lshr_b32 s87, s88, 1
    s_add_u32 s88, s60, 2
    s_and_b32 s88, s88, 1
    s_lshl_b32 s88, s88, 7
    s_add_u32 s77, s70, s88
    buffer_load_dwordx4 v[20:23], v0, s[4:7], s91 offen sc1
    buffer_load_dwordx4 v[24:27], v0, s[4:7], s91 offen offset:1024 sc1
    s_mov_b64 s[54:55], -1
    s_mov_b64 s[52:53], -1
    v_lshrrev_b32 v126, 2, v0
    buffer_load_dwordx4 v[20:23], v0, s[4:7], s91 offen sc1
    buffer_load_dwordx4 v[24:27], v0, s[4:7], s91 offen offset:1024 sc1
Lhop_160_poll:
    s_mov_b64 exec, s[54:55]
    buffer_load_dwordx4 v[20:23], v0, s[4:7], s91 offen sc1
    s_mov_b64 exec, s[52:53]
    buffer_load_dwordx4 v[24:27], v0, s[4:7], s91 offen offset:1024 sc1
    s_mov_b64 exec, -1
    s_add_u32 s98, s98, 1
    s_cmp_gt_u32 s98, 0x400000
    s_cbranch_scc1 L_end
Lhop_160_chk:
    s_waitcnt vmcnt(5)
    v_max3_u32 v124, v20, v21, v22
    v_max_u32 v124, v124, v23
    s_waitcnt vmcnt(4)
    v_max3_u32 v125, v24, v25, v26
    v_max_u32 v125, v125, v27
    v_cmp_eq_u32 s[54:55], -1, v124
    v_cmp_eq_u32 s[52:53], -1, v125
    s_or_b64 vcc, s[54:55], s[52:53]
    s_cbranch_scc1 Lhop_160_poll
    ds_write_b128 v111, v[20:23] offset:16384
    s_cmp_eq_u32 s60, 63
    ds_write_b128 v111, v[24:27] offset:17408
    s_cbranch_scc1 Lhop_160_last
Lhop_160_compute:
    v_smfmac_f32_16x16x64_bf16 v[56:59], v[20:23], v[76:83], v1
    ds_read2_b32 v[124:125], v2 offset0:64 offset1:200
    buffer_store_dword v110, v126, s[4:7], s96 offen offset:2048 sc1
    v_smfmac_f32_16x16x64_bf16 v[52:55], v[20:23], a[0:7], v1
    ds_read_b128 v[76:79], v7 offset:8192
    buffer_store_dword v118, v126, s[4:7], s96 offen offset:2304 sc1
    v_smfmac_f32_16x16x64_bf16 v[52:55], v[24:27], a[8:15], v1
    ds_read_b128 v[80:83], v7 offset:9216
    v_readfirstlane_b32 s85, v11
    v_smfmac_f32_16x16x64_bf16 v[56:59], v[24:27], a[64:71], v1
    s_or_b32 s85, s85, s67
    s_cmp_le_u32 s85, s87
    s_cbranch_scc1 Lflagslow_161
Lflagslow_161_ret:
    v_smfmac_f32_16x16x64_bf16 v[60:63], v[24:27], a[104:111], v1
    s_waitcnt lgkmcnt(2)
    buffer_store_dword v124, v126, s[4:7], s96 offen sc1
    s_mov_b32 m0, s78
    v_smfmac_f32_16x16x64_bf16 v[64:67], v[24:27], a[160:167], v1
    buffer_store_dword v125, v126, s[4:7], s96 offen offset:256 sc1
    v_smfmac_f32_16x16x64_bf16 v[68:71], v[20:23], a[192:199], v1
    v_mov_b32 v127, s99
    s_barrier
    ds_read_b128 v[28:31], v108 offset:16384
    v_smfmac_f32_16x16x64_bf16 v[72:75], v[20:23], v[128:135], v1
    ds_read_b128 v[32:35], v108 offset:17408
    v_mul_u32_u24 v113, 11, v126
    v_smfmac_f32_16x16x64_bf16 v[68:71], v[24:27], a[200:207], v1
    ds_read_b128 v[36:39], v109 offset:16384
    buffer_store_dword v127, v115, s[4:7], s79 offen sc1
    v_smfmac_f32_16x16x64_bf16 v[72:75], v[24:27], v[136:143], v1
    ds_read_b128 v[40:43], v109 offset:17408
    v_smfmac_f32_16x16x64_bf16 v[60:63], v[20:23], a[96:103], v1
    ds_read_b128 v[44:47], v112 offset:16384
    s_waitcnt lgkmcnt(5)
    v_smfmac_f32_16x16x64_bf16 v[64:67], v[20:23], v[76:83], v1
    ds_read_b128 v[48:51], v112 offset:17408
    s_waitcnt lgkmcnt(5)
    v_smfmac_f32_16x16x64_bf16 v[56:59], v[28:31], v[84:91], v1
    v_mov_b32 v124, 0x7f817f81
    v_smfmac_f32_16x16x64_bf16 v[52:55], v[28:31], a[16:23], v1
    s_waitcnt lgkmcnt(3)
    v_mov_b32 v125, 0x7f817f81
    v_smfmac_f32_16x16x64_bf16 v[52:55], v[32:35], a[24:31], v1
    ds_read_b128 v[84:87], v7 offset:10240
    v_mov_b32 v126, 0x7f817f81
    v_smfmac_f32_16x16x64_bf16 v[56:59], v[32:35], a[72:79], v1
    ds_read_b128 v[88:91], v7 offset:11264
    buffer_load_dwordx4 v[108:111], v6, s[4:7], s75 offen
    v_smfmac_f32_16x16x64_bf16 v[56:59], v[36:39], v[92:99], v1
    ds_read_b128 v[76:79], v6 offset:0
    v_mov_b32 v127, 0x7f817f81
    v_smfmac_f32_16x16x64_bf16 v[52:55], v[36:39], a[32:39], v1
    ds_read_b128 v[80:83], v6 offset:256
    s_waitcnt lgkmcnt(4)
    v_smfmac_f32_16x16x64_bf16 v[52:55], v[40:43], a[40:47], v1
    ds_read_b128 v[92:95], v7 offset:12288
    buffer_load_dwordx4 v[116:119], v6, s[4:7], s75 offen offset:256
    v_smfmac_f32_16x16x64_bf16 v[56:59], v[40:43], a[80:87], v1
    ds_read_b128 v[96:99], v7 offset:13312
    v_smfmac_f32_16x16x64_bf16 v[56:59], v[44:47], v[100:107], v1
    v_smfmac_f32_16x16x64_bf16 v[52:55], v[44:47], a[48:55], v1
    buffer_store_dwordx4 v[124:127], v8, s[4:7], s65 offen sc1
    v_smfmac_f32_16x16x64_bf16 v[52:55], v[48:51], a[56:63], v1
    ds_read_b128 v[100:103], v7 offset:14336
    v_smfmac_f32_16x16x64_bf16 v[56:59], v[48:51], a[88:95], v1
    ds_read_b128 v[104:107], v7 offset:15360
    s_waitcnt lgkmcnt(6)
    v_smfmac_f32_16x16x64_bf16 v[64:67], v[28:31], v[84:91], v1
    buffer_load_dword v11, v113, s[48:51], s63 offen
    v_smfmac_f32_16x16x64_bf16 v[60:63], v[28:31], a[112:119], v1
    ds_read_b128 v[84:87], v6 offset:2048
    v_add_f32 v52, v52, v53
    v_smfmac_f32_16x16x64_bf16 v[60:63], v[32:35], a[120:127], v1
    ds_read_b128 v[88:91], v6 offset:2304
    v_add_f32 v54, v54, v55
    v_smfmac_f32_16x16x64_bf16 v[64:67], v[32:35], a[168:175], v1
    s_waitcnt lgkmcnt(2)
    v_add_f32 v56, v56, v57
    v_smfmac_f32_16x16x64_bf16 v[64:67], v[36:39], v[92:99], v1
    buffer_store_dwordx4 v[124:127], v8, s[4:7], s66 offen sc1
    v_add_f32 v58, v58, v59
    v_smfmac_f32_16x16x64_bf16 v[60:63], v[36:39], a[128:135], v1
    ds_read_b128 v[92:95], v6 offset:4096
    v_cvt_pk_bf16_f32 v52, v52, v56
    v_smfmac_f32_16x16x64_bf16 v[60:63], v[40:43], a[136:143], v1
    ds_read_b128 v[96:99], v6 offset:4352
    v_cvt_pk_bf16_f32 v53, v54, v58
    v_smfmac_f32_16x16x64_bf16 v[64:67], v[40:43], a[176:183], v1
    ds_write2_b32 v2, v52, v53 offset0:0 offset1:136
    v_smfmac_f32_16x16x64_bf16 v[64:67], v[44:47], v[100:107], v1
    buffer_load_dwordx4 v0, s[48:51], s74 offen lds
    v_smfmac_f32_16x16x64_bf16 v[60:63], v[44:47], a[144:151], v1
    ds_read_b128 v[100:103], v6 offset:6144
    v_smfmac_f32_16x16x64_bf16 v[60:63], v[48:51], a[152:159], v1
    ds_read_b128 v[104:107], v6 offset:6400
    v_smfmac_f32_16x16x64_bf16 v[64:67], v[48:51], a[184:191], v1
    buffer_load_dword v11, v114, s[48:51], s77 offen sc1
    v_smfmac_f32_16x16x64_bf16 v[68:71], v[28:31], a[208:215], v1
    v_add_f32 v60, v60, v61
    v_smfmac_f32_16x16x64_bf16 v[72:75], v[28:31], v[144:151], v1
    v_add_f32 v62, v62, v63
    v_add_f32 v64, v64, v65
    v_add_f32 v66, v66, v67
    v_cvt_pk_bf16_f32 v60, v60, v64
    v_cvt_pk_bf16_f32 v61, v62, v66
    ds_write2_b32 v2, v60, v61 offset0:64 offset1:200
    v_smfmac_f32_16x16x64_bf16 v[68:71], v[32:35], a[216:223], v1
    buffer_load_dwordx4 v0, s[48:51], s74 offen offset:1024 lds
    s_waitcnt vmcnt(13)
    v_smfmac_f32_16x16x64_bf16 v[72:75], v[32:35], v[152:159], v1
    v_smfmac_f32_16x16x64_bf16 v[68:71], v[36:39], a[224:231], v1
    v_smfmac_f32_16x16x64_bf16 v[72:75], v[36:39], v[160:167], v1
    buffer_load_dwordx4 v0, s[48:51], s74 offen offset:2048 lds
    v_smfmac_f32_16x16x64_bf16 v[68:71], v[40:43], a[232:239], v1
    s_waitcnt lgkmcnt(0)
    s_barrier
    ds_read_b128 v[52:55], v3 offset:0
    ds_read_b128 v[56:59], v3 offset:64
    v_smfmac_f32_16x16x64_bf16 v[72:75], v[40:43], v[168:175], v1
    ds_read_b128 v[60:63], v3 offset:128
    v_smfmac_f32_16x16x64_bf16 v[68:71], v[44:47], a[240:247], v1
    ds_read_b128 v[64:67], v3 offset:192
    v_mov_b64 v[32:33], 0
    v_smfmac_f32_16x16x64_bf16 v[72:75], v[44:47], v[176:183], v1
    v_mov_b64 v[34:35], 0
    v_smfmac_f32_16x16x64_bf16 v[68:71], v[48:51], a[248:255], v1
    v_mov_b64 v[36:37], 0
    v_smfmac_f32_16x16x64_bf16 v[72:75], v[48:51], v[184:191], v1
    s_waitcnt lgkmcnt(2)
    v_mov_b64 v[38:39], 0
    v_mfma_f32_16x16x32_bf16 v[20:23], v[76:79], v[52:55], 0
    ds_read_b128 v[76:79], v4 offset:0
    v_mfma_f32_16x16x32_bf16 v[24:27], v[80:83], v[52:55], 0
    ds_read_b128 v[80:83], v4 offset:64
    v_xor_b32 v6, 0x2000, v6
    v_mfma_f32_16x16x32_bf16 v[20:23], v[84:87], v[56:59], v[20:23]
    ds_read_b128 v[84:87], v4 offset:128
    v_add_f32 v68, v68, v69
    v_mfma_f32_16x16x32_bf16 v[24:27], v[88:91], v[56:59], v[24:27]
    ds_read_b128 v[88:91], v4 offset:192
    s_waitcnt lgkmcnt(4)
    v_mfma_f32_16x16x32_bf16 v[20:23], v[92:95], v[60:63], v[20:23]
    v_add_f32 v70, v70, v71
    v_cvt_pk_bf16_f32 v69, v68, v70
    v_mfma_f32_16x16x32_bf16 v[24:27], v[96:99], v[60:63], v[24:27]
    v_cvt_pk_bf16_f32 v68, v68, v70
    v_add_f32 v72, v72, v73
    v_mfma_f32_16x16x32_bf16 v[20:23], v[100:103], v[64:67], v[20:23]
    v_add_f32 v74, v74, v75
    v_cvt_pk_bf16_f32 v73, v72, v74
    v_mfma_f32_16x16x32_bf16 v[24:27], v[104:107], v[64:67], v[24:27]
    s_waitcnt lgkmcnt(0)
    v_cvt_pk_bf16_f32 v72, v72, v74
    v_mfma_f32_16x16x32_bf16 v[28:31], v[76:79], v[52:55], 0
    ds_read_b128 v[92:95], v7 offset:16384
    v_mfma_f32_16x16x32_bf16 v[28:31], v[80:83], v[56:59], v[28:31]
    ds_read_b128 v[96:99], v7 offset:17408
    v_max3_f32 v124, v20, v21, v22
    v_mfma_f32_16x16x32_bf16 v[28:31], v[84:87], v[60:63], v[28:31]
    ds_read_b128 v[100:103], v7 offset:18432
    v_max3_f32 v125, v23, v24, v25
    v_mfma_f32_16x16x32_bf16 v[28:31], v[88:91], v[64:67], v[28:31]
    ds_read_b128 v[104:107], v7 offset:19456
    v_max3_f32 v124, v124, v26, v27
    v_max_f32 v124, v124, v125
    v_cndmask_b32 v20, v20, v22, s[80:81]
    v_cndmask_b32 v21, v21, v23, s[80:81]
    v_cndmask_b32 v24, v24, v26, s[80:81]
    v_cndmask_b32 v25, v25, v27, s[80:81]
    s_nop 0
    v_max3_f32 v124, v124, v28, v29
    v_max3_f32 v124, v124, v30, v31
    v_mov_b32 v125, v124
    v_cndmask_b32 v28, v28, v30, s[80:81]
    v_cndmask_b32 v29, v29, v31, s[80:81]
    v_permlane32_swap_b32 v124, v125
    v_max_f32 v124, v124, v125
    v_mov_b32 v125, v124
    s_nop 0
    s_waitcnt vmcnt(7)
    v_permlane16_swap_b32 v124, v125
    v_max_f32 v124, v124, v125
    v_mul_f32 v124, s84, v124
    v_fma_f32 v20, v20, s84, -v124
    v_fma_f32 v21, v21, s84, -v124
    v_fma_f32 v24, v24, s84, -v124
    v_fma_f32 v25, v25, s84, -v124
    v_fma_f32 v28, v28, s84, -v124
    v_fma_f32 v29, v29, s84, -v124
    v_exp_f32 v28, v28
    v_exp_f32 v29, v29
    v_exp_f32 v20, v20
    v_exp_f32 v21, v21
    v_exp_f32 v24, v24
    v_exp_f32 v25, v25
    v_cvt_pk_bf16_f32 v22, v28, v29
    v_cvt_pk_bf16_f32 v124, v20, v21
    v_cvt_pk_bf16_f32 v126, v24, v25
    v_cndmask_b32 v125, 0, v22, s[82:83]
    v_cndmask_b32 v127, 0, v22, s[10:11]
    v_mov_b64 v[112:113], v[110:111]
    v_mov_b64 v[110:111], v[68:69]
    v_mfma_f32_16x16x32_bf16 v[40:43], v[124:127], v[12:15], 0
    v_mov_b64 v[120:121], v[118:119]
    v_mov_b64 v[118:119], v[72:73]
    v_smfmac_f32_16x16x64_bf16 v[32:35], v[124:127], v[108:115], v1
    ds_read_b128 v[76:79], v7 offset:20480
    v_mov_b64 v[20:21], 0
    v_smfmac_f32_16x16x64_bf16 v[36:39], v[124:127], v[116:123], v1
    ds_read_b128 v[80:83], v7 offset:21504
    v_add_f32 v40, v40, v41
    v_add_f32 v42, v42, v43
    v_rcp_f32 v40, v40
    v_rcp_f32 v42, v42
    v_add_f32 v32, v32, v33
    v_add_f32 v34, v34, v35
    v_mul_f32 v32, v32, v40
    v_mul_f32 v34, v34, v42
    v_add_f32 v36, v36, v37
    v_add_f32 v38, v38, v39
    v_mul_f32 v36, v36, v40
    v_mul_f32 v38, v38, v42
    v_cvt_pk_bf16_f32 v124, v32, v36
    v_cvt_pk_bf16_f32 v125, v34, v38
    ds_write2_b32 v9, v124, v125 offset0:0 offset1:80
    v_mov_b64 v[22:23], 0
    v_mov_b64 v[24:25], 0
    v_mov_b64 v[26:27], 0
    v_mov_b64 v[28:29], 0
    v_mov_b64 v[30:31], 0
    v_mov_b64 v[32:33], 0
    v_mov_b64 v[34:35], 0
    v_mov_b64 v[36:37], 0
    v_mov_b64 v[38:39], 0
    v_mov_b64 v[40:41], 0
    v_mov_b64 v[42:43], 0
    v_mov_b64 v[44:45], 0
    s_waitcnt lgkmcnt(0)
    s_barrier
    ds_read_b128 v[52:55], v5 offset:0
    ds_read_b128 v[56:59], v5 offset:128
    ds_read_b128 v[84:87], v7 offset:22528
    ds_read_b128 v[88:91], v7 offset:23552
    v_mov_b64 v[46:47], 0
    v_mov_b64 v[48:49], 0
    v_mov_b64 v[50:51], 0
    s_waitcnt lgkmcnt(2)
    v_smfmac_f32_16x16x64_bf16 v[20:23], v[52:55], v[92:99], v1
    ds_read_b128 v[60:63], v7 offset:24576
    v_smfmac_f32_16x16x64_bf16 v[20:23], v[56:59], v[100:107], v1
    ds_read_b128 v[64:67], v7 offset:25600
    v_smfmac_f32_16x16x64_bf16 v[24:27], v[52:55], v[192:199], v1
    ds_read_b128 v[68:71], v7 offset:26624
    v_smfmac_f32_16x16x64_bf16 v[24:27], v[56:59], v[200:207], v1
    ds_read_b128 v[72:75], v7 offset:27648
    s_waitcnt lgkmcnt(4)
    v_add_f32 v20, v20, v21
    v_smfmac_f32_16x16x64_bf16 v[28:31], v[52:55], v[76:83], v1
    ds_read_b128 v[92:95], v7 offset:28672
    v_add_f32 v22, v22, v23
    v_cvt_pk_bf16_f32 v20, v20, v22
    v_smfmac_f32_16x16x64_bf16 v[28:31], v[56:59], v[84:91], v1
    ds_read_b128 v[96:99], v7 offset:29696
    v_add_f32 v24, v24, v25
    v_smfmac_f32_16x16x64_bf16 v[32:35], v[52:55], v[208:215], v1
    ds_read_b128 v[100:103], v7 offset:30720
    v_add_f32 v26, v26, v27
    v_cvt_pk_bf16_f32 v21, v24, v26
    v_smfmac_f32_16x16x64_bf16 v[32:35], v[56:59], v[216:223], v1
    ds_read_b128 v[104:107], v7 offset:31744
    s_waitcnt lgkmcnt(4)
    v_add_f32 v28, v28, v29
    v_smfmac_f32_16x16x64_bf16 v[36:39], v[52:55], v[60:67], v1
    v_add_f32 v30, v30, v31
    v_cvt_pk_bf16_f32 v22, v28, v30
    v_smfmac_f32_16x16x64_bf16 v[36:39], v[56:59], v[68:75], v1
    v_add_f32 v32, v32, v33
    v_smfmac_f32_16x16x64_bf16 v[40:43], v[52:55], v[224:231], v1
    v_add_f32 v34, v34, v35
    v_cvt_pk_bf16_f32 v23, v32, v34
    buffer_store_dwordx4 v[20:23], v8, s[4:7], s61 offen sc1
    v_smfmac_f32_16x16x64_bf16 v[40:43], v[56:59], v[232:239], v1
    s_waitcnt lgkmcnt(0)
    v_add_f32 v36, v36, v37
    v_smfmac_f32_16x16x64_bf16 v[44:47], v[52:55], v[92:99], v1
    v_add_f32 v38, v38, v39
    v_cvt_pk_bf16_f32 v36, v36, v38
    v_smfmac_f32_16x16x64_bf16 v[44:47], v[56:59], v[100:107], v1
    v_add_f32 v40, v40, v41
    v_smfmac_f32_16x16x64_bf16 v[48:51], v[52:55], v[240:247], v1
    v_add_f32 v42, v42, v43
    v_cvt_pk_bf16_f32 v37, v40, v42
    v_smfmac_f32_16x16x64_bf16 v[48:51], v[56:59], v[248:255], v1
    v_add_f32 v44, v44, v45
    v_add_f32 v46, v46, v47
    v_cvt_pk_bf16_f32 v38, v44, v46
    s_nop 4
    v_add_f32 v48, v48, v49
    v_add_f32 v50, v50, v51
    v_cvt_pk_bf16_f32 v39, v48, v50
    buffer_store_dwordx4 v[36:39], v8, s[4:7], s62 offen sc1
    s_cmp_lg_u32 s56, 0
    s_cbranch_scc1 Lhop_160_other
    s_branch Lhop_160
Lhop_160_last:
    s_nop 0
    ds_read2_b32 v[124:125], v2 offset0:64 offset1:200
    buffer_store_dword v110, v126, s[4:7], s96 offen offset:2048 sc1
    s_nop 0
    ds_read_b128 v[76:79], v7 offset:8192
    buffer_store_dword v118, v126, s[4:7], s96 offen offset:2304 sc1
    s_nop 0
    ds_read_b128 v[80:83], v7 offset:9216
    s_nop 0
    v_smfmac_f32_16x16x64_bf16 v[60:63], v[24:27], a[104:111], v1
    s_waitcnt lgkmcnt(2)
    buffer_store_dword v124, v126, s[4:7], s96 offen sc1
    s_mov_b32 m0, s78
    v_smfmac_f32_16x16x64_bf16 v[64:67], v[24:27], a[160:167], v1
    buffer_store_dword v125, v126, s[4:7], s96 offen offset:256 sc1
    v_smfmac_f32_16x16x64_bf16 v[68:71], v[20:23], a[192:199], v1
    v_mov_b32 v127, s99
    s_barrier
    ds_read_b128 v[28:31], v108 offset:16384
    v_smfmac_f32_16x16x64_bf16 v[72:75], v[20:23], v[128:135], v1
    ds_read_b128 v[32:35], v108 offset:17408
    v_smfmac_f32_16x16x64_bf16 v[68:71], v[24:27], a[200:207], v1
    ds_read_b128 v[36:39], v109 offset:16384
    buffer_store_dword v127, v115, s[4:7], s79 offen sc1
    v_smfmac_f32_16x16x64_bf16 v[72:75], v[24:27], v[136:143], v1
    ds_read_b128 v[40:43], v109 offset:17408
    v_smfmac_f32_16x16x64_bf16 v[60:63], v[20:23], a[96:103], v1
    ds_read_b128 v[44:47], v112 offset:16384
    s_waitcnt lgkmcnt(5)
    v_smfmac_f32_16x16x64_bf16 v[64:67], v[20:23], v[76:83], v1
    ds_read_b128 v[48:51], v112 offset:17408
    s_waitcnt lgkmcnt(5)
    s_nop 0
    s_nop 0
    s_waitcnt lgkmcnt(3)
    s_nop 0
    ds_read_b128 v[84:87], v7 offset:10240
    s_nop 0
    ds_read_b128 v[88:91], v7 offset:11264
    s_nop 0
    s_nop 0
    s_waitcnt lgkmcnt(2)
    s_nop 0
    ds_read_b128 v[92:95], v7 offset:12288
    s_nop 0
    ds_read_b128 v[96:99], v7 offset:13312
    s_nop 0
    s_nop 0
    s_nop 0
    ds_read_b128 v[100:103], v7 offset:14336
    s_nop 0
    ds_read_b128 v[104:107], v7 offset:15360
    s_waitcnt lgkmcnt(4)
    v_smfmac_f32_16x16x64_bf16 v[64:67], v[28:31], v[84:91], v1
    v_smfmac_f32_16x16x64_bf16 v[60:63], v[28:31], a[112:119], v1
    v_smfmac_f32_16x16x64_bf16 v[60:63], v[32:35], a[120:127], v1
    v_smfmac_f32_16x16x64_bf16 v[64:67], v[32:35], a[168:175], v1
    s_waitcnt lgkmcnt(0)
    v_smfmac_f32_16x16x64_bf16 v[64:67], v[36:39], v[92:99], v1
    v_smfmac_f32_16x16x64_bf16 v[60:63], v[36:39], a[128:135], v1
    v_smfmac_f32_16x16x64_bf16 v[60:63], v[40:43], a[136:143], v1
    v_smfmac_f32_16x16x64_bf16 v[64:67], v[40:43], a[176:183], v1
    v_smfmac_f32_16x16x64_bf16 v[64:67], v[44:47], v[100:107], v1
    v_smfmac_f32_16x16x64_bf16 v[60:63], v[44:47], a[144:151], v1
    v_smfmac_f32_16x16x64_bf16 v[60:63], v[48:51], a[152:159], v1
    v_smfmac_f32_16x16x64_bf16 v[64:67], v[48:51], a[184:191], v1
    v_lshrrev_b32 v126, 2, v0
    v_smfmac_f32_16x16x64_bf16 v[68:71], v[28:31], a[208:215], v1
    v_smfmac_f32_16x16x64_bf16 v[72:75], v[28:31], v[144:151], v1
    v_smfmac_f32_16x16x64_bf16 v[68:71], v[32:35], a[216:223], v1
    v_add_f32 v60, v60, v61
    v_smfmac_f32_16x16x64_bf16 v[72:75], v[32:35], v[152:159], v1
    v_add_f32 v62, v62, v63
    v_smfmac_f32_16x16x64_bf16 v[68:71], v[36:39], a[224:231], v1
    v_add_f32 v64, v64, v65
    v_smfmac_f32_16x16x64_bf16 v[72:75], v[36:39], v[160:167], v1
    v_add_f32 v66, v66, v67
    v_smfmac_f32_16x16x64_bf16 v[68:71], v[40:43], a[232:239], v1
    v_cvt_pk_bf16_f32 v60, v60, v64
    v_smfmac_f32_16x16x64_bf16 v[72:75], v[40:43], v[168:175], v1
    v_cvt_pk_bf16_f32 v61, v62, v66
    v_smfmac_f32_16x16x64_bf16 v[68:71], v[44:47], a[240:247], v1
    buffer_store_dword v60, v126, s[4:7], s76 offen sc1
    v_smfmac_f32_16x16x64_bf16 v[72:75], v[44:47], v[176:183], v1
    buffer_store_dword v61, v126, s[4:7], s76 offen offset:256 sc1
    v_smfmac_f32_16x16x64_bf16 v[68:71], v[48:51], a[248:255], v1
    v_smfmac_f32_16x16x64_bf16 v[72:75], v[48:51], v[184:191], v1
    s_nop 7
    v_add_f32 v68, v68, v69
    v_add_f32 v70, v70, v71
    v_cvt_pk_bf16_f32 v110, v68, v70
    v_cvt_pk_bf16_f32 v111, v68, v70
    v_add_f32 v72, v72, v73
    v_add_f32 v74, v74, v75
    v_cvt_pk_bf16_f32 v118, v72, v74
    v_cvt_pk_bf16_f32 v119, v72, v74
    buffer_store_dword v110, v126, s[4:7], s76 offen offset:2048 sc1
    buffer_store_dword v118, v126, s[4:7], s76 offen offset:2304 sc1
    v_mov_b32 v124, 64
    s_waitcnt vmcnt(0)
    s_barrier
    buffer_store_dword v124, v115, s[4:7], s79 offen sc1
    s_waitcnt vmcnt(0)
    s_branch L_end
Lhop_160_other:
    s_mov_b32 s94, s69
    s_add_u32 s95, s69, 0x1000
    s_mov_b32 s92, s71
    s_mov_b32 s93, s72
    s_mov_b32 s91, s73
    s_mov_b32 s97, 0
    s_mov_b32 s98, 0
    s_mov_b32 s96, s76
    s_mov_b32 s99, s60
    ds_read_b128 v[76:79], v7 offset:0
    ds_read_b128 v[80:83], v7 offset:1024
    ds_read_b128 v[84:87], v7 offset:2048
    ds_read_b128 v[88:91], v7 offset:3072
    ds_read_b128 v[92:95], v7 offset:4096
    ds_read_b128 v[96:99], v7 offset:5120
    ds_read_b128 v[100:103], v7 offset:6144
    ds_read_b128 v[104:107], v7 offset:7168
    v_mov_b64 v[52:53], 0
    v_mov_b64 v[54:55], 0
    v_mov_b64 v[56:57], 0
    v_mov_b64 v[58:59], 0
    v_mov_b64 v[60:61], 0
    v_mov_b64 v[62:63], 0
    v_mov_b64 v[64:65], 0
    v_mov_b64 v[66:67], 0
    v_mov_b64 v[68:69], 0
    v_mov_b64 v[70:71], 0
    v_mov_b64 v[72:73], 0
    v_mov_b64 v[74:75], 0
    v_add_u32 v111, s86, v0
    v_xor_b32 v108, 0x800, v111
    v_xor_b32 v109, 0x1000, v111
    v_xor_b32 v112, 0x1800, v111
    s_branch Lhop_160_bar
Lflagslow_161:
    s_add_u32 s88, s60, 1
    s_and_b32 s88, s88, 1
    s_lshl_b32 s88, s88, 7
    s_add_u32 s88, s88, s70
Lflagslow_161_l:
    s_add_u32 s101, s101, 1
    s_cmp_gt_u32 s101, 0x400000
    s_cbranch_scc1 L_end
    buffer_load_dword v11, v114, s[4:7], s88 offen sc1
    s_waitcnt vmcnt(0)
    v_readfirstlane_b32 s85, v11
    s_cmp_le_u32 s85, s87
    s_cbranch_scc1 Lflagslow_161_l
    s_branch Lflagslow_161_ret
Lhop_160_nan:
    s_add_u32 s101, s101, 1
    s_cmp_gt_u32 s101, 0x400000
    s_cbranch_scc1 L_end
    s_mov_b32 s90, 0x7f817f81
    s_mov_b64 s[88:89], 0
    s_waitcnt vmcnt(0)
    v_cmp_eq_u32 vcc, s90, v20
    s_or_b64 s[88:89], s[88:89], vcc
    v_cmp_eq_u32 vcc, s90, v21
    s_or_b64 s[88:89], s[88:89], vcc
    v_cmp_eq_u32 vcc, s90, v22
    s_or_b64 s[88:89], s[88:89], vcc
    v_cmp_eq_u32 vcc, s90, v23
    s_or_b64 s[88:89], s[88:89], vcc
    v_cmp_eq_u32 vcc, s90, v24
    s_or_b64 s[88:89], s[88:89], vcc
    v_cmp_eq_u32 vcc, s90, v25
    s_or_b64 s[88:89], s[88:89], vcc
    v_cmp_eq_u32 vcc, s90, v26
    s_or_b64 s[88:89], s[88:89], vcc
    v_cmp_eq_u32 vcc, s90, v27
    s_or_b64 s[88:89], s[88:89], vcc
    v_cmp_eq_u32 vcc, s90, v28
    s_or_b64 s[88:89], s[88:89], vcc
    v_cmp_eq_u32 vcc, s90, v29
    s_or_b64 s[88:89], s[88:89], vcc
    v_cmp_eq_u32 vcc, s90, v30
    s_or_b64 s[88:89], s[88:89], vcc
    v_cmp_eq_u32 vcc, s90, v31
    s_or_b64 s[88:89], s[88:89], vcc
    v_cmp_eq_u32 vcc, s90, v32
    s_or_b64 s[88:89], s[88:89], vcc
    v_cmp_eq_u32 vcc, s90, v33
    s_or_b64 s[88:89], s[88:89], vcc
    v_cmp_eq_u32 vcc, s90, v34
    s_or_b64 s[88:89], s[88:89], vcc
    v_cmp_eq_u32 vcc, s90, v35
    s_or_b64 s[88:89], s[88:89], vcc
    v_cmp_eq_u32 vcc, s90, v36
    s_or_b64 s[88:89], s[88:89], vcc
    v_cmp_eq_u32 vcc, s90, v37
    s_or_b64 s[88:89], s[88:89], vcc
    v_cmp_eq_u32 vcc, s90, v38
    s_or_b64 s[88:89], s[88:89], vcc
    v_cmp_eq_u32 vcc, s90, v39
    s_or_b64 s[88:89], s[88:89], vcc
    v_cmp_eq_u32 vcc, s90, v40
    s_or_b64 s[88:89], s[88:89], vcc
    v_cmp_eq_u32 vcc, s90, v41
    s_or_b64 s[88:89], s[88:89], vcc
    v_cmp_eq_u32 vcc, s90, v42
    s_or_b64 s[88:89], s[88:89], vcc
    v_cmp_eq_u32 vcc, s90, v43
    s_or_b64 s[88:89], s[88:89], vcc
    v_cmp_eq_u32 vcc, s90, v44
    s_or_b64 s[88:89], s[88:89], vcc
    v_cmp_eq_u32 vcc, s90, v45
    s_or_b64 s[88:89], s[88:89], vcc
    v_cmp_eq_u32 vcc, s90, v46
    s_or_b64 s[88:89], s[88:89], vcc
    v_cmp_eq_u32 vcc, s90, v47
    s_or_b64 s[88:89], s[88:89], vcc
    v_cmp_eq_u32 vcc, s90, v48
    s_or_b64 s[88:89], s[88:89], vcc
    v_cmp_eq_u32 vcc, s90, v49
    s_or_b64 s[88:89], s[88:89], vcc
    v_cmp_eq_u32 vcc, s90, v50
    s_or_b64 s[88:89], s[88:89], vcc
    v_cmp_eq_u32 vcc, s90, v51
    s_or_b64 s[88:89], s[88:89], vcc
    s_cmp_eq_u64 s[88:89], 0
    s_cbranch_scc1 Lhop_160_acc
    buffer_load_dwordx4 v[20:23], v0, s[4:7], s94 offen offset:0 sc1
    buffer_load_dwordx4 v[24:27], v0, s[4:7], s94 offen offset:1024 sc1
    buffer_load_dwordx4 v[28:31], v0, s[4:7], s94 offen offset:2048 sc1
    buffer_load_dwordx4 v[32:35], v0, s[4:7], s94 offen offset:3072 sc1
    buffer_load_dwordx4 v[36:39], v0, s[4:7], s95 offen offset:0 sc1
    buffer_load_dwordx4 v[40:43], v0, s[4:7], s95 offen offset:1024 sc1
    buffer_load_dwordx4 v[44:47], v0, s[4:7], s95 offen offset:2048 sc1
    buffer_load_dwordx4 v[48:51], v0, s[4:7], s95 offen offset:3072 sc1
    s_branch Lhop_160_red
Lhop_160_acc:
    v_mfma_f32_16x16x32_bf16 v[124:127], v[16:19], v[20:23], 0
    v_mfma_f32_16x16x32_bf16 v[124:127], v[16:19], v[24:27], v[124:127]
    v_mfma_f32_16x16x32_bf16 v[124:127], v[16:19], v[28:31], v[124:127]
    v_mfma_f32_16x16x32_bf16 v[124:127], v[16:19], v[32:35], v[124:127]
    v_mfma_f32_16x16x32_bf16 v[124:127], v[16:19], v[36:39], v[124:127]
    v_mfma_f32_16x16x32_bf16 v[124:127], v[16:19], v[40:43], v[124:127]
    v_mfma_f32_16x16x32_bf16 v[124:127], v[16:19], v[44:47], v[124:127]
    v_mfma_f32_16x16x32_bf16 v[124:127], v[16:19], v[48:51], v[124:127]
    s_nop 7
    v_cvt_pk_bf16_f32 v124, v124, v125
    v_cvt_pk_bf16_f32 v125, v126, v127
    v_min_u32 v124, -2, v124
    v_min_u32 v125, -2, v125
    s_branch Lhop_160_ok
L_worker:
    s_sub_u32 s57, s57, 32
    v_and_b32 v1, 63, v0
    v_lshlrev_b32 v11, 4, v1
    v_mov_b32 v8, 0
    v_mov_b32 v9, 1
    s_lshl_b32 s76, s56, 6
    v_or_b32 v2, s76, v1
    v_bfrev_b32 v3, 1
    v_cmp_eq_u32 vcc, 0, v2
    s_nop 1
    v_cndmask_b32 v3, v3, v8, vcc
    s_mul_i32 s76, s57, 9363
    s_lshr_b32 s76, s76, 16
    s_mul_i32 s77, s76, 7
    s_sub_u32 s77, s57, s77
    s_mov_b32 s99, s76
    s_cmp_eq_u32 s77, 6
    s_cbranch_scc1 L_p2_idle
    s_mul_i32 s76, s76, 6
    s_add_u32 s76, s76, s77
    s_mov_b32 s87, s76
    s_lshr_b32 s78, s76, 2
    s_and_b32 s79, s76, 3
    s_lshl1_add_u32 s99, s78, s79
    s_add_u32 s99, s99, 30
    s_cmp_ge_u32 s79, 2
    s_cbranch_scc1 L_p2_skip
    s_mov_b32 s99, -1
    s_mov_b32 s62, 0x400000
    s_mov_b32 s63, 0x20000
    s_mov_b32 s66, 0x400000
    s_mov_b32 s67, 0x20000
    s_sub_u32 s80, s78, 32
    s_lshl_b32 s80, s80, 1
    s_add_u32 s81, s80, 1
    s_cmp_lt_u32 s78, 32
    s_cselect_b64 s[60:61], s[16:17], s[12:13]
    s_cselect_b64 s[64:65], s[20:21], s[12:13]
    s_cselect_b32 s80, s78, s80
    s_cselect_b32 s81, s78, s81
    s_cselect_b32 s83, 1, 3
    s_cselect_b32 s85, 2, 3
    s_lshl_b32 s68, s80, 8
    s_lshl_b32 s69, s81, 8
    s_cmp_lt_u32 s56, 2
    s_cselect_b32 s80, s80, s81
    s_cselect_b32 s83, s83, s85
    s_lshl_b32 s71, s83, 25
    s_lshl_b32 s85, s79, 18
    s_add_u32 s71, s71, s85
    s_mul_i32 s85, s80, 0x2000
    s_add_u32 s71, s71, s85
    s_and_b32 s85, s56, 1
    s_lshl_b32 s85, s85, 12
    s_add_u32 s71, s71, s85
    s_sub_u32 s71, s71, 0x80000
    s_lshl_b32 s72, s87, 7
    s_add_u32 s72, s72, 0x8000
    s_lshl_b32 s70, s56, 10
    s_lshl_b32 s73, s79, 15
    s_add_u32 s73, s73, s70
    s_add_u32 s73, s73, 0xc00000
    s_mov_b32 s74, 0
    s_mov_b32 s86, s83
    v_and_b32 v80, 15, v1
    v_lshrrev_b32 v81, 4, v1
    v_lshlrev_b32 v82, 2, v81
    v_xor_b32 v82, v80, v82
    v_lshlrev_b32 v82, 4, v82
    s_lshl_b32 s76, s56, 2
    v_add_u32 v83, s76, v81
    v_lshl_add_u32 v12, v83, 13, v82
    v_add_u32 v13, 0x20000, v12
    v_add_u32 v14, 0x40000, v12
    v_add_u32 v15, 0x60000, v12
    s_lshl2_add_u32 s76, s79, 0
    s_and_b32 s76, s76, 7
    s_lshl_b32 s88, s76, 12
    s_lshl2_add_u32 s76, s79, 1
    s_and_b32 s76, s76, 7
    s_lshl_b32 s89, s76, 12
    s_lshl2_add_u32 s76, s79, 2
    s_and_b32 s76, s76, 7
    s_lshl_b32 s90, s76, 12
    s_lshl2_add_u32 s76, s79, 3
    s_and_b32 s76, s76, 7
    s_lshl_b32 s91, s76, 12
    s_lshl2_add_u32 s76, s79, 4
    s_and_b32 s76, s76, 7
    s_lshl_b32 s92, s76, 12
    s_lshl2_add_u32 s76, s79, 5
    s_and_b32 s76, s76, 7
    s_lshl_b32 s93, s76, 12
    s_lshl2_add_u32 s76, s79, 6
    s_and_b32 s76, s76, 7
    s_lshl_b32 s10, s76, 12
    s_lshl2_add_u32 s76, s79, 7
    s_and_b32 s76, s76, 7
    s_lshl_b32 s11, s76, 12
Lwz_163:
    s_add_u32 s101, s101, 1
    s_cmp_gt_u32 s101, 0x400000
    s_cbranch_scc1 L_end
    v_mbcnt_lo_u32_b32 v117, -1, 0
    v_and_b32 v117, 7, v117
    v_lshlrev_b32 v117, 2, v117
    global_load_dword v116, v117, s[8:9] sc1
    s_waitcnt vmcnt(0)
    v_cmp_ne_u32 vcc, 1, v116
    s_cbranch_vccnz Lwz_163
    s_cmp_lg_u32 s56, 0
    s_cbranch_scc1 Lann_164
    s_lshr_b32 s3, s2, 3
    s_lshl_b32 s3, s3, 7
    s_and_b32 vcc_lo, s2, 7
    s_add_u32 s3, s3, vcc_lo
    s_add_u32 s3, s3, 0x2000
    v_mov_b32 v116, s3
    v_mov_b32 v117, s58
    s_mov_b64 exec, 1
    buffer_store_byte v117, v116, s[4:7], 0 offen sc1
    s_mov_b64 exec, -1
Lann_164:
    s_lshl_b32 s84, s88, 7
    s_add_u32 s84, s84, s68
    s_add_u32 m0, s70, 0x8000
    s_nop 0
    buffer_load_dwordx4 v12, s[60:63], s84 offen lds
    s_add_u32 m0, s70, 0x9000
    s_nop 0
    buffer_load_dwordx4 v13, s[60:63], s84 offen lds
    s_add_u32 m0, s70, 0xa000
    s_nop 0
    buffer_load_dwordx4 v14, s[60:63], s84 offen lds
    s_add_u32 m0, s70, 0xb000
    s_nop 0
    buffer_load_dwordx4 v15, s[60:63], s84 offen lds
    s_lshl_b32 s84, s88, 7
    s_add_u32 s84, s84, s69
    s_add_u32 m0, s70, 0xc000
    s_nop 0
    buffer_load_dwordx4 v12, s[64:67], s84 offen lds
    s_add_u32 m0, s70, 0xd000
    s_nop 0
    buffer_load_dwordx4 v13, s[64:67], s84 offen lds
    s_add_u32 m0, s70, 0xe000
    s_nop 0
    buffer_load_dwordx4 v14, s[64:67], s84 offen lds
    s_add_u32 m0, s70, 0xf000
    s_nop 0
    buffer_load_dwordx4 v15, s[64:67], s84 offen lds
    s_lshl_b32 s84, s89, 7
    s_add_u32 s84, s84, s68
    s_add_u32 m0, s70, 0x10000
    s_nop 0
    buffer_load_dwordx4 v12, s[60:63], s84 offen lds
    s_add_u32 m0, s70, 0x11000
    s_nop 0
    buffer_load_dwordx4 v13, s[60:63], s84 offen lds
    s_add_u32 m0, s70, 0x12000
    s_nop 0
    buffer_load_dwordx4 v14, s[60:63], s84 offen lds
    s_add_u32 m0, s70, 0x13000
    s_nop 0
    buffer_load_dwordx4 v15, s[60:63], s84 offen lds
    s_lshl_b32 s84, s89, 7
    s_add_u32 s84, s84, s69
    s_add_u32 m0, s70, 0x14000
    s_nop 0
    buffer_load_dwordx4 v12, s[64:67], s84 offen lds
    s_add_u32 m0, s70, 0x15000
    s_nop 0
    buffer_load_dwordx4 v13, s[64:67], s84 offen lds
    s_add_u32 m0, s70, 0x16000
    s_nop 0
    buffer_load_dwordx4 v14, s[64:67], s84 offen lds
    s_add_u32 m0, s70, 0x17000
    s_nop 0
    buffer_load_dwordx4 v15, s[64:67], s84 offen lds
    s_lshl_b32 s84, s90, 7
    s_add_u32 s84, s84, s68
    s_add_u32 m0, s70, 0x18000
    s_nop 0
    buffer_load_dwordx4 v12, s[60:63], s84 offen lds
    s_add_u32 m0, s70, 0x19000
    s_nop 0
    buffer_load_dwordx4 v13, s[60:63], s84 offen lds
    s_add_u32 m0, s70, 0x1a000
    s_nop 0
    buffer_load_dwordx4 v14, s[60:63], s84 offen lds
    s_add_u32 m0, s70, 0x1b000
    s_nop 0
    buffer_load_dwordx4 v15, s[60:63], s84 offen lds
    s_lshl_b32 s84, s90, 7
    s_add_u32 s84, s84, s69
    s_add_u32 m0, s70, 0x1c000
    s_nop 0
    buffer_load_dwordx4 v12, s[64:67], s84 offen lds
    s_add_u32 m0, s70, 0x1d000
    s_nop 0
    buffer_load_dwordx4 v13, s[64:67], s84 offen lds
    s_add_u32 m0, s70, 0x1e000
    s_nop 0
    buffer_load_dwordx4 v14, s[64:67], s84 offen lds
    s_add_u32 m0, s70, 0x1f000
    s_nop 0
    buffer_load_dwordx4 v15, s[64:67], s84 offen lds
    s_lshl_b32 s84, s91, 7
    s_add_u32 s84, s84, s68
    s_add_u32 m0, s70, 0x20000
    s_nop 0
    buffer_load_dwordx4 v12, s[60:63], s84 offen lds
    s_add_u32 m0, s70, 0x21000
    s_nop 0
    buffer_load_dwordx4 v13, s[60:63], s84 offen lds
    s_add_u32 m0, s70, 0x22000
    s_nop 0
    buffer_load_dwordx4 v14, s[60:63], s84 offen lds
    s_add_u32 m0, s70, 0x23000
    s_nop 0
    buffer_load_dwordx4 v15, s[60:63], s84 offen lds
    s_lshl_b32 s84, s91, 7
    s_add_u32 s84, s84, s69
    s_add_u32 m0, s70, 0x24000
    s_nop 0
    buffer_load_dwordx4 v12, s[64:67], s84 offen lds
    s_add_u32 m0, s70, 0x25000
    s_nop 0
    buffer_load_dwordx4 v13, s[64:67], s84 offen lds
    s_add_u32 m0, s70, 0x26000
    s_nop 0
    buffer_load_dwordx4 v14, s[64:67], s84 offen lds
    s_add_u32 m0, s70, 0x27000
    s_nop 0
    buffer_load_dwordx4 v15, s[64:67], s84 offen lds
    v_lshrrev_b32 v87, 5, v1
    v_lshrrev_b32 v82, 2, v80
    v_and_b32 v83, 3, v80
    v_lshl_add_u32 v84, v87, 3, v82
    v_lshlrev_b32 v84, 8, v84
    v_lshl_add_u32 v84, v82, 6, v84
    v_and_b32 v85, 1, v81
    v_lshl_add_u32 v84, v85, 5, v84
    v_lshl_add_u32 v84, v83, 3, v84
    s_and_b32 s76, s56, 1
    s_lshl_b32 s76, s76, 7
    v_xor_b32 v4, s76, v84
    v_xor_b32 v5, 64, v4
    v_and_b32 v88, 31, v1
    v_lshlrev_b32 v84, 10, v87
    v_lshl_add_u32 v84, v88, 4, v84
    s_cmp_eq_u32 s86, 2
    s_cselect_b64 vcc, -1, 0
    s_movk_i32 s77, 0x400
    s_cselect_b32 s76, 512, s77
    v_cndmask_b32 v112, v11, v84, vcc
    v_add_u32 v113, s76, v112
    v_bfrev_b32 v6, 1
    v_bfrev_b32 v7, 1
    v_mov_b32 v10, v11
    v_mov_b32 v110, v112
    v_mov_b32 v111, v113
    s_lshr_b32 s76, s59, 7
    s_and_b32 s76, s76, 32
    s_add_u32 s76, s76, 0x100
    s_lshr_b32 s77, s73, 16
    s_and_b32 s77, s77, 1
    s_add_u32 s76, s76, s77
L_p2_t0_o:
    s_cmp_lg_u32 s56, 0
    s_cbranch_scc1 L_p2_t0_x
    s_mov_b32 s77, 0
L_p2_t0:
    s_add_u32 s101, s101, 1
    s_cmp_gt_u32 s101, 0x400000
    s_cbranch_scc1 L_end
    buffer_load_ubyte v112, v8, s[4:7], s76 offen sc1
    s_waitcnt vmcnt(0)
    v_cmp_ne_u32 vcc, 1, v112
    s_cbranch_vccz L_p2_t0_y
    s_sleep 4
    s_add_u32 s77, s77, 1
    s_cmp_lt_u32 s77, 32
    s_cbranch_scc1 L_p2_t0
L_p2_t0_y:
    v_mov_b32 v112, s77
    v_mov_b32 v114, 0x0
    ds_write_b32 v114, v112
L_p2_t0_x:
    v_mov_b32 v114, 0x0
    s_waitcnt vmcnt(0) lgkmcnt(0)
    s_barrier
    ds_read_b32 v112, v114
    s_waitcnt lgkmcnt(0)
    v_readfirstlane_b32 s77, v112
    s_cmp_lt_u32 s77, 32
    s_cbranch_scc1 L_p2_t0_d
Lval_165:
    s_add_u32 s101, s101, 1
    s_cmp_gt_u32 s101, 0x400000
    s_cbranch_scc1 L_end
    v_mbcnt_lo_u32_b32 v118, -1, 0
    v_lshlrev_b32 v118, 7, v118
    v_and_b32 v118, 0xf80, v118
    v_add_u32 v118, 0x2000, v118
    buffer_load_dwordx2 v[116:117], v118, s[4:7], 0 offen sc1
    s_waitcnt vmcnt(0)
Lval_165_chk:
    v_bfe_u32 v118, v116, 0, 5
    v_bfe_u32 v119, v116, 8, 5
    v_bfe_u32 v120, v116, 16, 5
    v_bfe_u32 v121, v116, 24, 5
    v_bfe_u32 v122, v117, 0, 5
    v_bfe_u32 v123, v117, 8, 5
    v_bfe_u32 v124, v117, 16, 5
    v_bfe_u32 v125, v117, 24, 5
    v_min3_u32 v126, v118, v119, v120
    v_min3_u32 v126, v126, v121, v122
    v_min3_u32 v126, v126, v123, v124
    v_min_u32 v126, v126, v125
    v_cmp_eq_u32 vcc, 0, v126
    s_cbranch_vccnz Lval_165
    s_mov_b32 s3, s59
    s_cmp_lg_u32 s59, 0
    s_cbranch_scc1 Lval_165_ok
    v_lshlrev_b32 v126, v118, 1
    v_lshlrev_b32 v127, v119, 1
    v_or_b32 v126, v126, v127
    v_lshlrev_b32 v127, v120, 1
    v_or_b32 v126, v126, v127
    v_lshlrev_b32 v127, v121, 1
    v_or_b32 v126, v126, v127
    v_lshlrev_b32 v127, v122, 1
    v_or_b32 v126, v126, v127
    v_lshlrev_b32 v127, v123, 1
    v_or_b32 v126, v126, v127
    v_lshlrev_b32 v127, v124, 1
    v_or_b32 v126, v126, v127
    v_lshlrev_b32 v127, v125, 1
    v_or_b32 v126, v126, v127
    v_cmp_ne_u32 vcc, 0x1fe, v126
    s_mov_b32 s3, 32
    s_cbranch_vccz Lval_165_ok
    s_lshr_b32 s60, s2, 3
    s_lshl_b32 s62, 1, s60
    s_sub_u32 s64, s62, 1
    s_or_b32 s66, s62, s64
    s_and_b32 s61, s2, 7
    s_mov_b32 s68, 0
    s_mov_b32 s69, 0
    s_mov_b32 s70, 0
    v_cmp_eq_u32 vcc, s58, v118
    s_cmp_gt_u32 s61, 0
    s_cselect_b32 s74, s66, s64
    s_and_b32 s74, s74, vcc_lo
    s_bcnt1_i32_b32 s71, s74
    s_add_u32 s68, s68, s71
    v_cmp_eq_u32 vcc, 1, v118
    s_bcnt1_i32_b32 s71, vcc_lo
    s_add_u32 s69, s69, s71
    v_cmp_gt_u32 vcc, s58, v118
    s_bcnt1_i32_b32 s71, vcc_lo
    s_add_u32 s70, s70, s71
    v_cmp_eq_u32 vcc, s58, v119
    s_cmp_gt_u32 s61, 1
    s_cselect_b32 s74, s66, s64
    s_and_b32 s74, s74, vcc_lo
    s_bcnt1_i32_b32 s71, s74
    s_add_u32 s68, s68, s71
    v_cmp_eq_u32 vcc, 1, v119
    s_bcnt1_i32_b32 s71, vcc_lo
    s_add_u32 s69, s69, s71
    v_cmp_gt_u32 vcc, s58, v119
    s_bcnt1_i32_b32 s71, vcc_lo
    s_add_u32 s70, s70, s71
    v_cmp_eq_u32 vcc, s58, v120
    s_cmp_gt_u32 s61, 2
    s_cselect_b32 s74, s66, s64
    s_and_b32 s74, s74, vcc_lo
    s_bcnt1_i32_b32 s71, s74
    s_add_u32 s68, s68, s71
    v_cmp_eq_u32 vcc, 1, v120
    s_bcnt1_i32_b32 s71, vcc_lo
    s_add_u32 s69, s69, s71
    v_cmp_gt_u32 vcc, s58, v120
    s_bcnt1_i32_b32 s71, vcc_lo
    s_add_u32 s70, s70, s71
    v_cmp_eq_u32 vcc, s58, v121
    s_cmp_gt_u32 s61, 3
    s_cselect_b32 s74, s66, s64
    s_and_b32 s74, s74, vcc_lo
    s_bcnt1_i32_b32 s71, s74
    s_add_u32 s68, s68, s71
    v_cmp_eq_u32 vcc, 1, v121
    s_bcnt1_i32_b32 s71, vcc_lo
    s_add_u32 s69, s69, s71
    v_cmp_gt_u32 vcc, s58, v121
    s_bcnt1_i32_b32 s71, vcc_lo
    s_add_u32 s70, s70, s71
    v_cmp_eq_u32 vcc, s58, v122
    s_cmp_gt_u32 s61, 4
    s_cselect_b32 s74, s66, s64
    s_and_b32 s74, s74, vcc_lo
    s_bcnt1_i32_b32 s71, s74
    s_add_u32 s68, s68, s71
    v_cmp_eq_u32 vcc, 1, v122
    s_bcnt1_i32_b32 s71, vcc_lo
    s_add_u32 s69, s69, s71
    v_cmp_gt_u32 vcc, s58, v122
    s_bcnt1_i32_b32 s71, vcc_lo
    s_add_u32 s70, s70, s71
    v_cmp_eq_u32 vcc, s58, v123
    s_cmp_gt_u32 s61, 5
    s_cselect_b32 s74, s66, s64
    s_and_b32 s74, s74, vcc_lo
    s_bcnt1_i32_b32 s71, s74
    s_add_u32 s68, s68, s71
    v_cmp_eq_u32 vcc, 1, v123
    s_bcnt1_i32_b32 s71, vcc_lo
    s_add_u32 s69, s69, s71
    v_cmp_gt_u32 vcc, s58, v123
    s_bcnt1_i32_b32 s71, vcc_lo
    s_add_u32 s70, s70, s71
    v_cmp_eq_u32 vcc, s58, v124
    s_cmp_gt_u32 s61, 6
    s_cselect_b32 s74, s66, s64
    s_and_b32 s74, s74, vcc_lo
    s_bcnt1_i32_b32 s71, s74
    s_add_u32 s68, s68, s71
    v_cmp_eq_u32 vcc, 1, v124
    s_bcnt1_i32_b32 s71, vcc_lo
    s_add_u32 s69, s69, s71
    v_cmp_gt_u32 vcc, s58, v124
    s_bcnt1_i32_b32 s71, vcc_lo
    s_add_u32 s70, s70, s71
    v_cmp_eq_u32 vcc, s58, v125
    s_cmp_gt_u32 s61, 7
    s_cselect_b32 s74, s66, s64
    s_and_b32 s74, s74, vcc_lo
    s_bcnt1_i32_b32 s71, s74
    s_add_u32 s68, s68, s71
    v_cmp_eq_u32 vcc, 1, v125
    s_bcnt1_i32_b32 s71, vcc_lo
    s_add_u32 s69, s69, s71
    v_cmp_gt_u32 vcc, s58, v125
    s_bcnt1_i32_b32 s71, vcc_lo
    s_add_u32 s70, s70, s71
    s_min_u32 s71, s69, 32
    s_sub_u32 s70, s70, s69
    s_add_u32 s70, s70, s71
    s_add_u32 s70, s70, s68
    s_sub_u32 s71, 256, s69
    s_add_u32 s71, s71, s68
    s_cmp_lt_u32 s68, 32
    s_cselect_b32 s71, s68, s71
    s_cmp_eq_u32 s58, 1
    s_cselect_b32 s57, s71, s70
    s_or_b32 s59, s69, 0x1000
    v_mbcnt_lo_u32_b32 v0, -1, 0
    v_mbcnt_hi_u32_b32 v0, -1, v0
    v_mov_b32 v116, s2
    v_mov_b32 v117, 1
    s_waitcnt vmcnt(0) lgkmcnt(0)
    s_barrier
    buffer_store_byte v117, v116, s[4:7], 0 offen sc1
    s_branch L_dispatch
Lval_165_ok:
    s_and_b32 s3, s3, 0xfff
    s_barrier
    s_branch L_p2_t0_o
L_p2_t0_d:
    s_barrier
    s_add_u32 m0, s70, 0x0
    s_add_u32 s84, s73, s88
    buffer_load_dwordx4 v11, s[4:7], s84 offen lds
    s_add_u32 m0, s70, 0x1000
    s_add_u32 s84, s73, s89
    buffer_load_dwordx4 v11, s[4:7], s84 offen lds
    s_add_u32 m0, s70, 0x2000
    s_add_u32 s84, s73, s90
    buffer_load_dwordx4 v11, s[4:7], s84 offen lds
    s_add_u32 m0, s70, 0x3000
    s_add_u32 s84, s73, s91
    buffer_load_dwordx4 v11, s[4:7], s84 offen lds
    s_add_u32 m0, s70, 0x4000
    s_add_u32 s84, s73, s92
    buffer_load_dwordx4 v11, s[4:7], s84 offen lds
    s_add_u32 m0, s70, 0x5000
    s_add_u32 s84, s73, s93
    buffer_load_dwordx4 v11, s[4:7], s84 offen lds
    s_add_u32 m0, s70, 0x6000
    s_add_u32 s84, s73, s10
    buffer_load_dwordx4 v11, s[4:7], s84 offen lds
    s_add_u32 m0, s70, 0x7000
    s_add_u32 s84, s73, s11
    buffer_load_dwordx4 v11, s[4:7], s84 offen lds
    s_add_u32 s73, s73, 0x10000
    s_barrier
    s_cmp_ge_u32 s56, 2
    s_cbranch_scc1 Lskw_166
    v_add_u32 v86, 0x0, v4
    ds_read_b64_tr_b16 a[0:1], v86 offset:32768
    ds_read_b64_tr_b16 a[2:3], v86 offset:33792
    ds_read_b64_tr_b16 a[4:5], v86 offset:36864
    ds_read_b64_tr_b16 a[6:7], v86 offset:37888
    ds_read_b64_tr_b16 a[8:9], v86 offset:40960
    ds_read_b64_tr_b16 a[10:11], v86 offset:41984
    ds_read_b64_tr_b16 a[12:13], v86 offset:45056
    ds_read_b64_tr_b16 a[14:15], v86 offset:46080
    v_add_u32 v86, 0x0, v5
    ds_read_b64_tr_b16 a[128:129], v86 offset:32768
    ds_read_b64_tr_b16 a[130:131], v86 offset:33792
    ds_read_b64_tr_b16 a[132:133], v86 offset:36864
    ds_read_b64_tr_b16 a[134:135], v86 offset:37888
    ds_read_b64_tr_b16 a[136:137], v86 offset:40960
    ds_read_b64_tr_b16 a[138:139], v86 offset:41984
    ds_read_b64_tr_b16 a[140:141], v86 offset:45056
    ds_read_b64_tr_b16 a[142:143], v86 offset:46080
    s_waitcnt lgkmcnt(0)
Lskw_166:
    s_barrier
    s_lshl_b32 s84, s92, 7
    s_add_u32 s84, s84, s68
    s_add_u32 m0, s70, 0x8000
    s_nop 0
    buffer_load_dwordx4 v12, s[60:63], s84 offen lds
    s_add_u32 m0, s70, 0x9000
    s_nop 0
    buffer_load_dwordx4 v13, s[60:63], s84 offen lds
    s_add_u32 m0, s70, 0xa000
    s_nop 0
    buffer_load_dwordx4 v14, s[60:63], s84 offen lds
    s_add_u32 m0, s70, 0xb000
    s_nop 0
    buffer_load_dwordx4 v15, s[60:63], s84 offen lds
    s_barrier
    s_cmp_lt_u32 s56, 2
    s_cbranch_scc1 Lskw_167
    v_add_u32 v86, 0x0, v4
    ds_read_b64_tr_b16 a[0:1], v86 offset:49152
    ds_read_b64_tr_b16 a[2:3], v86 offset:50176
    ds_read_b64_tr_b16 a[4:5], v86 offset:53248
    ds_read_b64_tr_b16 a[6:7], v86 offset:54272
    ds_read_b64_tr_b16 a[8:9], v86 offset:57344
    ds_read_b64_tr_b16 a[10:11], v86 offset:58368
    ds_read_b64_tr_b16 a[12:13], v86 offset:61440
    ds_read_b64_tr_b16 a[14:15], v86 offset:62464
    v_add_u32 v86, 0x0, v5
    ds_read_b64_tr_b16 a[128:129], v86 offset:49152
    ds_read_b64_tr_b16 a[130:131], v86 offset:50176
    ds_read_b64_tr_b16 a[132:133], v86 offset:53248
    ds_read_b64_tr_b16 a[134:135], v86 offset:54272
    ds_read_b64_tr_b16 a[136:137], v86 offset:57344
    ds_read_b64_tr_b16 a[138:139], v86 offset:58368
    ds_read_b64_tr_b16 a[140:141], v86 offset:61440
    ds_read_b64_tr_b16 a[142:143], v86 offset:62464
    s_waitcnt lgkmcnt(0)
Lskw_167:
    s_barrier
    s_lshl_b32 s84, s92, 7
    s_add_u32 s84, s84, s69
    s_add_u32 m0, s70, 0xc000
    s_nop 0
    buffer_load_dwordx4 v12, s[64:67], s84 offen lds
    s_add_u32 m0, s70, 0xd000
    s_nop 0
    buffer_load_dwordx4 v13, s[64:67], s84 offen lds
    s_add_u32 m0, s70, 0xe000
    s_nop 0
    buffer_load_dwordx4 v14, s[64:67], s84 offen lds
    s_add_u32 m0, s70, 0xf000
    s_nop 0
    buffer_load_dwordx4 v15, s[64:67], s84 offen lds
    s_barrier
    s_cmp_ge_u32 s56, 2
    s_cbranch_scc1 Lskw_168
    v_add_u32 v86, 0x10000, v4
    ds_read_b64_tr_b16 a[16:17], v86 offset:0
    ds_read_b64_tr_b16 a[18:19], v86 offset:1024
    ds_read_b64_tr_b16 a[20:21], v86 offset:4096
    ds_read_b64_tr_b16 a[22:23], v86 offset:5120
    ds_read_b64_tr_b16 a[24:25], v86 offset:8192
    ds_read_b64_tr_b16 a[26:27], v86 offset:9216
    ds_read_b64_tr_b16 a[28:29], v86 offset:12288
    ds_read_b64_tr_b16 a[30:31], v86 offset:13312
    v_add_u32 v86, 0x10000, v5
    ds_read_b64_tr_b16 a[144:145], v86 offset:0
    ds_read_b64_tr_b16 a[146:147], v86 offset:1024
    ds_read_b64_tr_b16 a[148:149], v86 offset:4096
    ds_read_b64_tr_b16 a[150:151], v86 offset:5120
    ds_read_b64_tr_b16 a[152:153], v86 offset:8192
    ds_read_b64_tr_b16 a[154:155], v86 offset:9216
    ds_read_b64_tr_b16 a[156:157], v86 offset:12288
    ds_read_b64_tr_b16 a[158:159], v86 offset:13312
    s_waitcnt lgkmcnt(0)
Lskw_168:
    s_barrier
    s_lshl_b32 s84, s93, 7
    s_add_u32 s84, s84, s68
    s_add_u32 m0, s70, 0x10000
    s_nop 0
    buffer_load_dwordx4 v12, s[60:63], s84 offen lds
    s_add_u32 m0, s70, 0x11000
    s_nop 0
    buffer_load_dwordx4 v13, s[60:63], s84 offen lds
    s_add_u32 m0, s70, 0x12000
    s_nop 0
    buffer_load_dwordx4 v14, s[60:63], s84 offen lds
    s_add_u32 m0, s70, 0x13000
    s_nop 0
    buffer_load_dwordx4 v15, s[60:63], s84 offen lds
    s_barrier
    s_cmp_lt_u32 s56, 2
    s_cbranch_scc1 Lskw_169
    v_add_u32 v86, 0x10000, v4
    ds_read_b64_tr_b16 a[16:17], v86 offset:16384
    ds_read_b64_tr_b16 a[18:19], v86 offset:17408
    ds_read_b64_tr_b16 a[20:21], v86 offset:20480
    ds_read_b64_tr_b16 a[22:23], v86 offset:21504
    ds_read_b64_tr_b16 a[24:25], v86 offset:24576
    ds_read_b64_tr_b16 a[26:27], v86 offset:25600
    ds_read_b64_tr_b16 a[28:29], v86 offset:28672
    ds_read_b64_tr_b16 a[30:31], v86 offset:29696
    v_add_u32 v86, 0x10000, v5
    ds_read_b64_tr_b16 a[144:145], v86 offset:16384
    ds_read_b64_tr_b16 a[146:147], v86 offset:17408
    ds_read_b64_tr_b16 a[148:149], v86 offset:20480
    ds_read_b64_tr_b16 a[150:151], v86 offset:21504
    ds_read_b64_tr_b16 a[152:153], v86 offset:24576
    ds_read_b64_tr_b16 a[154:155], v86 offset:25600
    ds_read_b64_tr_b16 a[156:157], v86 offset:28672
    ds_read_b64_tr_b16 a[158:159], v86 offset:29696
    s_waitcnt lgkmcnt(0)
Lskw_169:
    s_barrier
    s_lshl_b32 s84, s93, 7
    s_add_u32 s84, s84, s69
    s_add_u32 m0, s70, 0x14000
    s_nop 0
    buffer_load_dwordx4 v12, s[64:67], s84 offen lds
    s_add_u32 m0, s70, 0x15000
    s_nop 0
    buffer_load_dwordx4 v13, s[64:67], s84 offen lds
    s_add_u32 m0, s70, 0x16000
    s_nop 0
    buffer_load_dwordx4 v14, s[64:67], s84 offen lds
    s_add_u32 m0, s70, 0x17000
    s_nop 0
    buffer_load_dwordx4 v15, s[64:67], s84 offen lds
    s_barrier
    s_cmp_ge_u32 s56, 2
    s_cbranch_scc1 Lskw_170
    v_add_u32 v86, 0x10000, v4
    ds_read_b64_tr_b16 a[32:33], v86 offset:32768
    ds_read_b64_tr_b16 a[34:35], v86 offset:33792
    ds_read_b64_tr_b16 a[36:37], v86 offset:36864
    ds_read_b64_tr_b16 a[38:39], v86 offset:37888
    ds_read_b64_tr_b16 a[40:41], v86 offset:40960
    ds_read_b64_tr_b16 a[42:43], v86 offset:41984
    ds_read_b64_tr_b16 a[44:45], v86 offset:45056
    ds_read_b64_tr_b16 a[46:47], v86 offset:46080
    v_add_u32 v86, 0x10000, v5
    ds_read_b64_tr_b16 a[160:161], v86 offset:32768
    ds_read_b64_tr_b16 a[162:163], v86 offset:33792
    ds_read_b64_tr_b16 a[164:165], v86 offset:36864
    ds_read_b64_tr_b16 a[166:167], v86 offset:37888
    ds_read_b64_tr_b16 a[168:169], v86 offset:40960
    ds_read_b64_tr_b16 a[170:171], v86 offset:41984
    ds_read_b64_tr_b16 a[172:173], v86 offset:45056
    ds_read_b64_tr_b16 a[174:175], v86 offset:46080
    s_waitcnt lgkmcnt(0)
Lskw_170:
    s_barrier
    s_lshl_b32 s84, s10, 7
    s_add_u32 s84, s84, s68
    s_add_u32 m0, s70, 0x18000
    s_nop 0
    buffer_load_dwordx4 v12, s[60:63], s84 offen lds
    s_add_u32 m0, s70, 0x19000
    s_nop 0
    buffer_load_dwordx4 v13, s[60:63], s84 offen lds
    s_add_u32 m0, s70, 0x1a000
    s_nop 0
    buffer_load_dwordx4 v14, s[60:63], s84 offen lds
    s_add_u32 m0, s70, 0x1b000
    s_nop 0
    buffer_load_dwordx4 v15, s[60:63], s84 offen lds
    s_barrier
    s_cmp_lt_u32 s56, 2
    s_cbranch_scc1 Lskw_171
    v_add_u32 v86, 0x10000, v4
    ds_read_b64_tr_b16 a[32:33], v86 offset:49152
    ds_read_b64_tr_b16 a[34:35], v86 offset:50176
    ds_read_b64_tr_b16 a[36:37], v86 offset:53248
    ds_read_b64_tr_b16 a[38:39], v86 offset:54272
    ds_read_b64_tr_b16 a[40:41], v86 offset:57344
    ds_read_b64_tr_b16 a[42:43], v86 offset:58368
    ds_read_b64_tr_b16 a[44:45], v86 offset:61440
    ds_read_b64_tr_b16 a[46:47], v86 offset:62464
    v_add_u32 v86, 0x10000, v5
    ds_read_b64_tr_b16 a[160:161], v86 offset:49152
    ds_read_b64_tr_b16 a[162:163], v86 offset:50176
    ds_read_b64_tr_b16 a[164:165], v86 offset:53248
    ds_read_b64_tr_b16 a[166:167], v86 offset:54272
    ds_read_b64_tr_b16 a[168:169], v86 offset:57344
    ds_read_b64_tr_b16 a[170:171], v86 offset:58368
    ds_read_b64_tr_b16 a[172:173], v86 offset:61440
    ds_read_b64_tr_b16 a[174:175], v86 offset:62464
    s_waitcnt lgkmcnt(0)
Lskw_171:
    s_barrier
    s_lshl_b32 s84, s10, 7
    s_add_u32 s84, s84, s69
    s_add_u32 m0, s70, 0x1c000
    s_nop 0
    buffer_load_dwordx4 v12, s[64:67], s84 offen lds
    s_add_u32 m0, s70, 0x1d000
    s_nop 0
    buffer_load_dwordx4 v13, s[64:67], s84 offen lds
    s_add_u32 m0, s70, 0x1e000
    s_nop 0
    buffer_load_dwordx4 v14, s[64:67], s84 offen lds
    s_add_u32 m0, s70, 0x1f000
    s_nop 0
    buffer_load_dwordx4 v15, s[64:67], s84 offen lds
    s_barrier
    s_cmp_ge_u32 s56, 2
    s_cbranch_scc1 Lskw_172
    v_add_u32 v86, 0x20000, v4
    ds_read_b64_tr_b16 a[48:49], v86 offset:0
    ds_read_b64_tr_b16 a[50:51], v86 offset:1024
    ds_read_b64_tr_b16 a[52:53], v86 offset:4096
    ds_read_b64_tr_b16 a[54:55], v86 offset:5120
    ds_read_b64_tr_b16 a[56:57], v86 offset:8192
    ds_read_b64_tr_b16 a[58:59], v86 offset:9216
    ds_read_b64_tr_b16 a[60:61], v86 offset:12288
    ds_read_b64_tr_b16 a[62:63], v86 offset:13312
    v_add_u32 v86, 0x20000, v5
    ds_read_b64_tr_b16 a[176:177], v86 offset:0
    ds_read_b64_tr_b16 a[178:179], v86 offset:1024
    ds_read_b64_tr_b16 a[180:181], v86 offset:4096
    ds_read_b64_tr_b16 a[182:183], v86 offset:5120
    ds_read_b64_tr_b16 a[184:185], v86 offset:8192
    ds_read_b64_tr_b16 a[186:187], v86 offset:9216
    ds_read_b64_tr_b16 a[188:189], v86 offset:12288
    ds_read_b64_tr_b16 a[190:191], v86 offset:13312
    s_waitcnt lgkmcnt(0)
Lskw_172:
    s_barrier
    s_lshl_b32 s84, s11, 7
    s_add_u32 s84, s84, s68
    s_add_u32 m0, s70, 0x20000
    s_nop 0
    buffer_load_dwordx4 v12, s[60:63], s84 offen lds
    s_add_u32 m0, s70, 0x21000
    s_nop 0
    buffer_load_dwordx4 v13, s[60:63], s84 offen lds
    s_add_u32 m0, s70, 0x22000
    s_nop 0
    buffer_load_dwordx4 v14, s[60:63], s84 offen lds
    s_add_u32 m0, s70, 0x23000
    s_nop 0
    buffer_load_dwordx4 v15, s[60:63], s84 offen lds
    s_barrier
    s_cmp_lt_u32 s56, 2
    s_cbranch_scc1 Lskw_173
    v_add_u32 v86, 0x20000, v4
    ds_read_b64_tr_b16 a[48:49], v86 offset:16384
    ds_read_b64_tr_b16 a[50:51], v86 offset:17408
    ds_read_b64_tr_b16 a[52:53], v86 offset:20480
    ds_read_b64_tr_b16 a[54:55], v86 offset:21504
    ds_read_b64_tr_b16 a[56:57], v86 offset:24576
    ds_read_b64_tr_b16 a[58:59], v86 offset:25600
    ds_read_b64_tr_b16 a[60:61], v86 offset:28672
    ds_read_b64_tr_b16 a[62:63], v86 offset:29696
    v_add_u32 v86, 0x20000, v5
    ds_read_b64_tr_b16 a[176:177], v86 offset:16384
    ds_read_b64_tr_b16 a[178:179], v86 offset:17408
    ds_read_b64_tr_b16 a[180:181], v86 offset:20480
    ds_read_b64_tr_b16 a[182:183], v86 offset:21504
    ds_read_b64_tr_b16 a[184:185], v86 offset:24576
    ds_read_b64_tr_b16 a[186:187], v86 offset:25600
    ds_read_b64_tr_b16 a[188:189], v86 offset:28672
    ds_read_b64_tr_b16 a[190:191], v86 offset:29696
    s_waitcnt lgkmcnt(0)
Lskw_173:
    s_barrier
    s_lshl_b32 s84, s11, 7
    s_add_u32 s84, s84, s69
    s_add_u32 m0, s70, 0x24000
    s_nop 0
    buffer_load_dwordx4 v12, s[64:67], s84 offen lds
    s_add_u32 m0, s70, 0x25000
    s_nop 0
    buffer_load_dwordx4 v13, s[64:67], s84 offen lds
    s_add_u32 m0, s70, 0x26000
    s_nop 0
    buffer_load_dwordx4 v14, s[64:67], s84 offen lds
    s_add_u32 m0, s70, 0x27000
    s_nop 0
    buffer_load_dwordx4 v15, s[64:67], s84 offen lds
    s_waitcnt vmcnt(28)
    s_barrier
    s_cmp_ge_u32 s56, 2
    s_cbranch_scc1 Lskw_174
    v_add_u32 v86, 0x0, v4
    ds_read_b64_tr_b16 a[64:65], v86 offset:32768
    ds_read_b64_tr_b16 a[66:67], v86 offset:33792
    ds_read_b64_tr_b16 a[68:69], v86 offset:36864
    ds_read_b64_tr_b16 a[70:71], v86 offset:37888
    ds_read_b64_tr_b16 a[72:73], v86 offset:40960
    ds_read_b64_tr_b16 a[74:75], v86 offset:41984
    ds_read_b64_tr_b16 a[76:77], v86 offset:45056
    ds_read_b64_tr_b16 a[78:79], v86 offset:46080
    v_add_u32 v86, 0x0, v5
    ds_read_b64_tr_b16 a[192:193], v86 offset:32768
    ds_read_b64_tr_b16 a[194:195], v86 offset:33792
    ds_read_b64_tr_b16 a[196:197], v86 offset:36864
    ds_read_b64_tr_b16 a[198:199], v86 offset:37888
    ds_read_b64_tr_b16 a[200:201], v86 offset:40960
    ds_read_b64_tr_b16 a[202:203], v86 offset:41984
    ds_read_b64_tr_b16 a[204:205], v86 offset:45056
    ds_read_b64_tr_b16 a[206:207], v86 offset:46080
    s_waitcnt lgkmcnt(0)
Lskw_174:
    s_waitcnt vmcnt(24)
    s_barrier
    s_cmp_lt_u32 s56, 2
    s_cbranch_scc1 Lskw_175
    v_add_u32 v86, 0x0, v4
    ds_read_b64_tr_b16 a[64:65], v86 offset:49152
    ds_read_b64_tr_b16 a[66:67], v86 offset:50176
    ds_read_b64_tr_b16 a[68:69], v86 offset:53248
    ds_read_b64_tr_b16 a[70:71], v86 offset:54272
    ds_read_b64_tr_b16 a[72:73], v86 offset:57344
    ds_read_b64_tr_b16 a[74:75], v86 offset:58368
    ds_read_b64_tr_b16 a[76:77], v86 offset:61440
    ds_read_b64_tr_b16 a[78:79], v86 offset:62464
    v_add_u32 v86, 0x0, v5
    ds_read_b64_tr_b16 a[192:193], v86 offset:49152
    ds_read_b64_tr_b16 a[194:195], v86 offset:50176
    ds_read_b64_tr_b16 a[196:197], v86 offset:53248
    ds_read_b64_tr_b16 a[198:199], v86 offset:54272
    ds_read_b64_tr_b16 a[200:201], v86 offset:57344
    ds_read_b64_tr_b16 a[202:203], v86 offset:58368
    ds_read_b64_tr_b16 a[204:205], v86 offset:61440
    ds_read_b64_tr_b16 a[206:207], v86 offset:62464
    s_waitcnt lgkmcnt(0)
Lskw_175:
    s_waitcnt vmcnt(20)
    s_barrier
    s_cmp_ge_u32 s56, 2
    s_cbranch_scc1 Lskw_176
    v_add_u32 v86, 0x10000, v4
    ds_read_b64_tr_b16 a[80:81], v86 offset:0
    ds_read_b64_tr_b16 a[82:83], v86 offset:1024
    ds_read_b64_tr_b16 a[84:85], v86 offset:4096
    ds_read_b64_tr_b16 a[86:87], v86 offset:5120
    ds_read_b64_tr_b16 a[88:89], v86 offset:8192
    ds_read_b64_tr_b16 a[90:91], v86 offset:9216
    ds_read_b64_tr_b16 a[92:93], v86 offset:12288
    ds_read_b64_tr_b16 a[94:95], v86 offset:13312
    v_add_u32 v86, 0x10000, v5
    ds_read_b64_tr_b16 a[208:209], v86 offset:0
    ds_read_b64_tr_b16 a[210:211], v86 offset:1024
    ds_read_b64_tr_b16 a[212:213], v86 offset:4096
    ds_read_b64_tr_b16 a[214:215], v86 offset:5120
    ds_read_b64_tr_b16 a[216:217], v86 offset:8192
    ds_read_b64_tr_b16 a[218:219], v86 offset:9216
    ds_read_b64_tr_b16 a[220:221], v86 offset:12288
    ds_read_b64_tr_b16 a[222:223], v86 offset:13312
    s_waitcnt lgkmcnt(0)
Lskw_176:
    s_waitcnt vmcnt(16)
    s_barrier
    s_cmp_lt_u32 s56, 2
    s_cbranch_scc1 Lskw_177
    v_add_u32 v86, 0x10000, v4
    ds_read_b64_tr_b16 a[80:81], v86 offset:16384
    ds_read_b64_tr_b16 a[82:83], v86 offset:17408
    ds_read_b64_tr_b16 a[84:85], v86 offset:20480
    ds_read_b64_tr_b16 a[86:87], v86 offset:21504
    ds_read_b64_tr_b16 a[88:89], v86 offset:24576
    ds_read_b64_tr_b16 a[90:91], v86 offset:25600
    ds_read_b64_tr_b16 a[92:93], v86 offset:28672
    ds_read_b64_tr_b16 a[94:95], v86 offset:29696
    v_add_u32 v86, 0x10000, v5
    ds_read_b64_tr_b16 a[208:209], v86 offset:16384
    ds_read_b64_tr_b16 a[210:211], v86 offset:17408
    ds_read_b64_tr_b16 a[212:213], v86 offset:20480
    ds_read_b64_tr_b16 a[214:215], v86 offset:21504
    ds_read_b64_tr_b16 a[216:217], v86 offset:24576
    ds_read_b64_tr_b16 a[218:219], v86 offset:25600
    ds_read_b64_tr_b16 a[220:221], v86 offset:28672
    ds_read_b64_tr_b16 a[222:223], v86 offset:29696
    s_waitcnt lgkmcnt(0)
Lskw_177:
    s_waitcnt vmcnt(12)
    s_barrier
    s_cmp_ge_u32 s56, 2
    s_cbranch_scc1 Lskw_178
    v_add_u32 v86, 0x10000, v4
    ds_read_b64_tr_b16 a[96:97], v86 offset:32768
    ds_read_b64_tr_b16 a[98:99], v86 offset:33792
    ds_read_b64_tr_b16 a[100:101], v86 offset:36864
    ds_read_b64_tr_b16 a[102:103], v86 offset:37888
    ds_read_b64_tr_b16 a[104:105], v86 offset:40960
    ds_read_b64_tr_b16 a[106:107], v86 offset:41984
    ds_read_b64_tr_b16 a[108:109], v86 offset:45056
    ds_read_b64_tr_b16 a[110:111], v86 offset:46080
    v_add_u32 v86, 0x10000, v5
    ds_read_b64_tr_b16 a[224:225], v86 offset:32768
    ds_read_b64_tr_b16 a[226:227], v86 offset:33792
    ds_read_b64_tr_b16 a[228:229], v86 offset:36864
    ds_read_b64_tr_b16 a[230:231], v86 offset:37888
    ds_read_b64_tr_b16 a[232:233], v86 offset:40960
    ds_read_b64_tr_b16 a[234:235], v86 offset:41984
    ds_read_b64_tr_b16 a[236:237], v86 offset:45056
    ds_read_b64_tr_b16 a[238:239], v86 offset:46080
    s_waitcnt lgkmcnt(0)
Lskw_178:
    s_waitcnt vmcnt(8)
    s_barrier
    s_cmp_lt_u32 s56, 2
    s_cbranch_scc1 Lskw_179
    v_add_u32 v86, 0x10000, v4
    ds_read_b64_tr_b16 a[96:97], v86 offset:49152
    ds_read_b64_tr_b16 a[98:99], v86 offset:50176
    ds_read_b64_tr_b16 a[100:101], v86 offset:53248
    ds_read_b64_tr_b16 a[102:103], v86 offset:54272
    ds_read_b64_tr_b16 a[104:105], v86 offset:57344
    ds_read_b64_tr_b16 a[106:107], v86 offset:58368
    ds_read_b64_tr_b16 a[108:109], v86 offset:61440
    ds_read_b64_tr_b16 a[110:111], v86 offset:62464
    v_add_u32 v86, 0x10000, v5
    ds_read_b64_tr_b16 a[224:225], v86 offset:49152
    ds_read_b64_tr_b16 a[226:227], v86 offset:50176
    ds_read_b64_tr_b16 a[228:229], v86 offset:53248
    ds_read_b64_tr_b16 a[230:231], v86 offset:54272
    ds_read_b64_tr_b16 a[232:233], v86 offset:57344
    ds_read_b64_tr_b16 a[234:235], v86 offset:58368
    ds_read_b64_tr_b16 a[236:237], v86 offset:61440
    ds_read_b64_tr_b16 a[238:239], v86 offset:62464
    s_waitcnt lgkmcnt(0)
Lskw_179:
    s_waitcnt vmcnt(4)
    s_barrier
    s_cmp_ge_u32 s56, 2
    s_cbranch_scc1 Lskw_180
    v_add_u32 v86, 0x20000, v4
    ds_read_b64_tr_b16 a[112:113], v86 offset:0
    ds_read_b64_tr_b16 a[114:115], v86 offset:1024
    ds_read_b64_tr_b16 a[116:117], v86 offset:4096
    ds_read_b64_tr_b16 a[118:119], v86 offset:5120
    ds_read_b64_tr_b16 a[120:121], v86 offset:8192
    ds_read_b64_tr_b16 a[122:123], v86 offset:9216
    ds_read_b64_tr_b16 a[124:125], v86 offset:12288
    ds_read_b64_tr_b16 a[126:127], v86 offset:13312
    v_add_u32 v86, 0x20000, v5
    ds_read_b64_tr_b16 a[240:241], v86 offset:0
    ds_read_b64_tr_b16 a[242:243], v86 offset:1024
    ds_read_b64_tr_b16 a[244:245], v86 offset:4096
    ds_read_b64_tr_b16 a[246:247], v86 offset:5120
    ds_read_b64_tr_b16 a[248:249], v86 offset:8192
    ds_read_b64_tr_b16 a[250:251], v86 offset:9216
    ds_read_b64_tr_b16 a[252:253], v86 offset:12288
    ds_read_b64_tr_b16 a[254:255], v86 offset:13312
    s_waitcnt lgkmcnt(0)
Lskw_180:
    s_waitcnt vmcnt(0)
    s_barrier
    s_cmp_lt_u32 s56, 2
    s_cbranch_scc1 Lskw_181
    v_add_u32 v86, 0x20000, v4
    ds_read_b64_tr_b16 a[112:113], v86 offset:16384
    ds_read_b64_tr_b16 a[114:115], v86 offset:17408
    ds_read_b64_tr_b16 a[116:117], v86 offset:20480
    ds_read_b64_tr_b16 a[118:119], v86 offset:21504
    ds_read_b64_tr_b16 a[120:121], v86 offset:24576
    ds_read_b64_tr_b16 a[122:123], v86 offset:25600
    ds_read_b64_tr_b16 a[124:125], v86 offset:28672
    ds_read_b64_tr_b16 a[126:127], v86 offset:29696
    v_add_u32 v86, 0x20000, v5
    ds_read_b64_tr_b16 a[240:241], v86 offset:16384
    ds_read_b64_tr_b16 a[242:243], v86 offset:17408
    ds_read_b64_tr_b16 a[244:245], v86 offset:20480
    ds_read_b64_tr_b16 a[246:247], v86 offset:21504
    ds_read_b64_tr_b16 a[248:249], v86 offset:24576
    ds_read_b64_tr_b16 a[250:251], v86 offset:25600
    ds_read_b64_tr_b16 a[252:253], v86 offset:28672
    ds_read_b64_tr_b16 a[254:255], v86 offset:29696
    s_waitcnt lgkmcnt(0)
Lskw_181:
    v_and_b32 v113, 7, v0
    v_lshlrev_b32 v113, 2, v113
    s_lshr_b32 s76, s59, 7
    s_and_b32 s76, s76, 32
    s_add_u32 s76, s76, 0x100
L_p2_lnall_o:
    s_cmp_lg_u32 s56, 0
    s_cbranch_scc1 L_p2_lnall_x
    s_mov_b32 s77, 0
L_p2_lnall:
    s_add_u32 s101, s101, 1
    s_cmp_gt_u32 s101, 0x400000
    s_cbranch_scc1 L_end
    buffer_load_dword v112, v113, s[4:7], s76 offen sc1
    s_waitcnt vmcnt(0)
    v_cmp_ne_u32 vcc, 0x01010101, v112
    s_cbranch_vccz L_p2_lnall_y
    s_sleep 4
    s_add_u32 s77, s77, 1
    s_cmp_lt_u32 s77, 32
    s_cbranch_scc1 L_p2_lnall
L_p2_lnall_y:
    v_mov_b32 v112, s77
    v_mov_b32 v114, 0x20000
    ds_write_b32 v114, v112
L_p2_lnall_x:
    v_mov_b32 v114, 0x20000
    s_waitcnt vmcnt(0) lgkmcnt(0)
    s_barrier
    ds_read_b32 v112, v114
    s_waitcnt lgkmcnt(0)
    v_readfirstlane_b32 s77, v112
    s_cmp_lt_u32 s77, 32
    s_cbranch_scc1 L_p2_lnall_d
Lval_182:
    s_add_u32 s101, s101, 1
    s_cmp_gt_u32 s101, 0x400000
    s_cbranch_scc1 L_end
    v_mbcnt_lo_u32_b32 v118, -1, 0
    v_lshlrev_b32 v118, 7, v118
    v_and_b32 v118, 0xf80, v118
    v_add_u32 v118, 0x2000, v118
    buffer_load_dwordx2 v[116:117], v118, s[4:7], 0 offen sc1
    s_waitcnt vmcnt(0)
Lval_182_chk:
    v_bfe_u32 v118, v116, 0, 5
    v_bfe_u32 v119, v116, 8, 5
    v_bfe_u32 v120, v116, 16, 5
    v_bfe_u32 v121, v116, 24, 5
    v_bfe_u32 v122, v117, 0, 5
    v_bfe_u32 v123, v117, 8, 5
    v_bfe_u32 v124, v117, 16, 5
    v_bfe_u32 v125, v117, 24, 5
    v_min3_u32 v126, v118, v119, v120
    v_min3_u32 v126, v126, v121, v122
    v_min3_u32 v126, v126, v123, v124
    v_min_u32 v126, v126, v125
    v_cmp_eq_u32 vcc, 0, v126
    s_cbranch_vccnz Lval_182
    s_mov_b32 s3, s59
    s_cmp_lg_u32 s59, 0
    s_cbranch_scc1 Lval_182_ok
    v_lshlrev_b32 v126, v118, 1
    v_lshlrev_b32 v127, v119, 1
    v_or_b32 v126, v126, v127
    v_lshlrev_b32 v127, v120, 1
    v_or_b32 v126, v126, v127
    v_lshlrev_b32 v127, v121, 1
    v_or_b32 v126, v126, v127
    v_lshlrev_b32 v127, v122, 1
    v_or_b32 v126, v126, v127
    v_lshlrev_b32 v127, v123, 1
    v_or_b32 v126, v126, v127
    v_lshlrev_b32 v127, v124, 1
    v_or_b32 v126, v126, v127
    v_lshlrev_b32 v127, v125, 1
    v_or_b32 v126, v126, v127
    v_cmp_ne_u32 vcc, 0x1fe, v126
    s_mov_b32 s3, 32
    s_cbranch_vccz Lval_182_ok
    s_lshr_b32 s60, s2, 3
    s_lshl_b32 s62, 1, s60
    s_sub_u32 s64, s62, 1
    s_or_b32 s66, s62, s64
    s_and_b32 s61, s2, 7
    s_mov_b32 s68, 0
    s_mov_b32 s69, 0
    s_mov_b32 s70, 0
    v_cmp_eq_u32 vcc, s58, v118
    s_cmp_gt_u32 s61, 0
    s_cselect_b32 s74, s66, s64
    s_and_b32 s74, s74, vcc_lo
    s_bcnt1_i32_b32 s71, s74
    s_add_u32 s68, s68, s71
    v_cmp_eq_u32 vcc, 1, v118
    s_bcnt1_i32_b32 s71, vcc_lo
    s_add_u32 s69, s69, s71
    v_cmp_gt_u32 vcc, s58, v118
    s_bcnt1_i32_b32 s71, vcc_lo
    s_add_u32 s70, s70, s71
    v_cmp_eq_u32 vcc, s58, v119
    s_cmp_gt_u32 s61, 1
    s_cselect_b32 s74, s66, s64
    s_and_b32 s74, s74, vcc_lo
    s_bcnt1_i32_b32 s71, s74
    s_add_u32 s68, s68, s71
    v_cmp_eq_u32 vcc, 1, v119
    s_bcnt1_i32_b32 s71, vcc_lo
    s_add_u32 s69, s69, s71
    v_cmp_gt_u32 vcc, s58, v119
    s_bcnt1_i32_b32 s71, vcc_lo
    s_add_u32 s70, s70, s71
    v_cmp_eq_u32 vcc, s58, v120
    s_cmp_gt_u32 s61, 2
    s_cselect_b32 s74, s66, s64
    s_and_b32 s74, s74, vcc_lo
    s_bcnt1_i32_b32 s71, s74
    s_add_u32 s68, s68, s71
    v_cmp_eq_u32 vcc, 1, v120
    s_bcnt1_i32_b32 s71, vcc_lo
    s_add_u32 s69, s69, s71
    v_cmp_gt_u32 vcc, s58, v120
    s_bcnt1_i32_b32 s71, vcc_lo
    s_add_u32 s70, s70, s71
    v_cmp_eq_u32 vcc, s58, v121
    s_cmp_gt_u32 s61, 3
    s_cselect_b32 s74, s66, s64
    s_and_b32 s74, s74, vcc_lo
    s_bcnt1_i32_b32 s71, s74
    s_add_u32 s68, s68, s71
    v_cmp_eq_u32 vcc, 1, v121
    s_bcnt1_i32_b32 s71, vcc_lo
    s_add_u32 s69, s69, s71
    v_cmp_gt_u32 vcc, s58, v121
    s_bcnt1_i32_b32 s71, vcc_lo
    s_add_u32 s70, s70, s71
    v_cmp_eq_u32 vcc, s58, v122
    s_cmp_gt_u32 s61, 4
    s_cselect_b32 s74, s66, s64
    s_and_b32 s74, s74, vcc_lo
    s_bcnt1_i32_b32 s71, s74
    s_add_u32 s68, s68, s71
    v_cmp_eq_u32 vcc, 1, v122
    s_bcnt1_i32_b32 s71, vcc_lo
    s_add_u32 s69, s69, s71
    v_cmp_gt_u32 vcc, s58, v122
    s_bcnt1_i32_b32 s71, vcc_lo
    s_add_u32 s70, s70, s71
    v_cmp_eq_u32 vcc, s58, v123
    s_cmp_gt_u32 s61, 5
    s_cselect_b32 s74, s66, s64
    s_and_b32 s74, s74, vcc_lo
    s_bcnt1_i32_b32 s71, s74
    s_add_u32 s68, s68, s71
    v_cmp_eq_u32 vcc, 1, v123
    s_bcnt1_i32_b32 s71, vcc_lo
    s_add_u32 s69, s69, s71
    v_cmp_gt_u32 vcc, s58, v123
    s_bcnt1_i32_b32 s71, vcc_lo
    s_add_u32 s70, s70, s71
    v_cmp_eq_u32 vcc, s58, v124
    s_cmp_gt_u32 s61, 6
    s_cselect_b32 s74, s66, s64
    s_and_b32 s74, s74, vcc_lo
    s_bcnt1_i32_b32 s71, s74
    s_add_u32 s68, s68, s71
    v_cmp_eq_u32 vcc, 1, v124
    s_bcnt1_i32_b32 s71, vcc_lo
    s_add_u32 s69, s69, s71
    v_cmp_gt_u32 vcc, s58, v124
    s_bcnt1_i32_b32 s71, vcc_lo
    s_add_u32 s70, s70, s71
    v_cmp_eq_u32 vcc, s58, v125
    s_cmp_gt_u32 s61, 7
    s_cselect_b32 s74, s66, s64
    s_and_b32 s74, s74, vcc_lo
    s_bcnt1_i32_b32 s71, s74
    s_add_u32 s68, s68, s71
    v_cmp_eq_u32 vcc, 1, v125
    s_bcnt1_i32_b32 s71, vcc_lo
    s_add_u32 s69, s69, s71
    v_cmp_gt_u32 vcc, s58, v125
    s_bcnt1_i32_b32 s71, vcc_lo
    s_add_u32 s70, s70, s71
    s_min_u32 s71, s69, 32
    s_sub_u32 s70, s70, s69
    s_add_u32 s70, s70, s71
    s_add_u32 s70, s70, s68
    s_sub_u32 s71, 256, s69
    s_add_u32 s71, s71, s68
    s_cmp_lt_u32 s68, 32
    s_cselect_b32 s71, s68, s71
    s_cmp_eq_u32 s58, 1
    s_cselect_b32 s57, s71, s70
    s_or_b32 s59, s69, 0x1000
    v_mbcnt_lo_u32_b32 v0, -1, 0
    v_mbcnt_hi_u32_b32 v0, -1, v0
    v_mov_b32 v116, s2
    v_mov_b32 v117, 1
    s_waitcnt vmcnt(0) lgkmcnt(0)
    s_barrier
    buffer_store_byte v117, v116, s[4:7], 0 offen sc1
    s_branch L_dispatch
Lval_182_ok:
    s_and_b32 s3, s3, 0xfff
    s_barrier
    s_branch L_p2_lnall_o
L_p2_lnall_d:
    s_add_u32 m0, s70, 0x8000
    s_add_u32 s84, s73, s88
    buffer_load_dwordx4 v11, s[4:7], s84 offen lds
    s_add_u32 m0, s70, 0x9000
    s_add_u32 s84, s73, s89
    buffer_load_dwordx4 v11, s[4:7], s84 offen lds
    s_add_u32 m0, s70, 0xa000
    s_add_u32 s84, s73, s90
    buffer_load_dwordx4 v11, s[4:7], s84 offen lds
    s_add_u32 m0, s70, 0xb000
    s_add_u32 s84, s73, s91
    buffer_load_dwordx4 v11, s[4:7], s84 offen lds
    s_add_u32 m0, s70, 0xc000
    s_add_u32 s84, s73, s92
    buffer_load_dwordx4 v11, s[4:7], s84 offen lds
    s_add_u32 m0, s70, 0xd000
    s_add_u32 s84, s73, s93
    buffer_load_dwordx4 v11, s[4:7], s84 offen lds
    s_add_u32 m0, s70, 0xe000
    s_add_u32 s84, s73, s10
    buffer_load_dwordx4 v11, s[4:7], s84 offen lds
    s_add_u32 m0, s70, 0xf000
    s_add_u32 s84, s73, s11
    buffer_load_dwordx4 v11, s[4:7], s84 offen lds
    s_add_u32 s73, s73, 0x10000
    buffer_load_dword v119, v8, s[4:7], 0 offen
    s_add_u32 m0, s70, 0x10000
    s_add_u32 s84, s73, s88
    buffer_load_dwordx4 v11, s[4:7], s84 offen lds
    s_add_u32 m0, s70, 0x11000
    s_add_u32 s84, s73, s89
    buffer_load_dwordx4 v11, s[4:7], s84 offen lds
    s_add_u32 m0, s70, 0x12000
    s_add_u32 s84, s73, s90
    buffer_load_dwordx4 v11, s[4:7], s84 offen lds
    s_add_u32 m0, s70, 0x13000
    s_add_u32 s84, s73, s91
    buffer_load_dwordx4 v11, s[4:7], s84 offen lds
    s_add_u32 m0, s70, 0x14000
    s_add_u32 s84, s73, s92
    buffer_load_dwordx4 v11, s[4:7], s84 offen lds
    s_add_u32 m0, s70, 0x15000
    s_add_u32 s84, s73, s93
    buffer_load_dwordx4 v11, s[4:7], s84 offen lds
    s_add_u32 m0, s70, 0x16000
    s_add_u32 s84, s73, s10
    buffer_load_dwordx4 v11, s[4:7], s84 offen lds
    s_add_u32 m0, s70, 0x17000
    s_add_u32 s84, s73, s11
    buffer_load_dwordx4 v11, s[4:7], s84 offen lds
    s_add_u32 s73, s73, 0x10000
    v_mov_b32 v112, v110
    v_mov_b32 v113, v111
    v_bfrev_b32 v116, 1
    v_mov_b32 v117, -1
    v_mov_b32 v118, v3
    s_xor_b32 s70, s70, 0x10000
    ds_read_b128 v[16:19], v10 offset:0
    ds_read_b128 v[20:23], v10 offset:1024
    ds_read_b128 v[24:27], v10 offset:2048
    s_mov_b32 s94, 0
    s_mov_b32 s95, 0
    s_cmp_eq_u32 s86, 2
    s_cbranch_scc1 L_p2v
L_p2k:
    s_waitcnt lgkmcnt(2)
    v_mfma_f32_32x32x16_bf16 v[48:63], a[0:3], v[16:19], 0
    ds_read_b128 v[28:31], v10 offset:3072
    v_mfma_f32_32x32x16_bf16 v[64:79], a[128:131], v[16:19], 0
    s_waitcnt lgkmcnt(2)
    v_mfma_f32_32x32x16_bf16 v[48:63], a[4:7], v[20:23], v[48:63]
    ds_read_b128 v[16:19], v10 offset:4096
    v_cvt_pk_bf16_f32 v32, v80, v84
    v_cvt_pk_bf16_f32 v33, v81, v85
    v_mfma_f32_32x32x16_bf16 v[64:79], a[132:135], v[20:23], v[64:79]
    v_cvt_pk_bf16_f32 v34, v82, v86
    v_cvt_pk_bf16_f32 v35, v83, v87
    s_waitcnt lgkmcnt(2)
    v_mfma_f32_32x32x16_bf16 v[48:63], a[8:11], v[24:27], v[48:63]
    ds_read_b128 v[20:23], v10 offset:5120
    buffer_store_dwordx4 v[32:35], v6, s[4:7], s71 offen offset:0 sc1
    v_cvt_pk_bf16_f32 v36, v88, v92
    v_mfma_f32_32x32x16_bf16 v[64:79], a[136:139], v[24:27], v[64:79]
    v_cvt_pk_bf16_f32 v37, v89, v93
    v_cvt_pk_bf16_f32 v38, v90, v94
    s_waitcnt lgkmcnt(2)
    v_mfma_f32_32x32x16_bf16 v[48:63], a[12:15], v[28:31], v[48:63]
    ds_read_b128 v[24:27], v10 offset:6144
    v_cvt_pk_bf16_f32 v39, v91, v95
    buffer_store_dwordx4 v[36:39], v7, s[4:7], s71 offen offset:0 sc1
    v_mfma_f32_32x32x16_bf16 v[64:79], a[140:143], v[28:31], v[64:79]
    v_cvt_pk_bf16_f32 v40, v96, v100
    v_cvt_pk_bf16_f32 v41, v97, v101
    s_waitcnt lgkmcnt(2)
    v_mfma_f32_32x32x16_bf16 v[48:63], a[16:19], v[16:19], v[48:63]
    ds_read_b128 v[28:31], v10 offset:7168
    v_cvt_pk_bf16_f32 v42, v98, v102
    v_cvt_pk_bf16_f32 v43, v99, v103
    v_mfma_f32_32x32x16_bf16 v[64:79], a[144:147], v[16:19], v[64:79]
    buffer_store_dwordx4 v[40:43], v6, s[4:7], s71 offen offset:2048 sc1
    v_cvt_pk_bf16_f32 v44, v104, v108
    s_waitcnt lgkmcnt(2)
    v_mfma_f32_32x32x16_bf16 v[48:63], a[20:23], v[20:23], v[48:63]
    ds_read_b128 v[16:19], v10 offset:8192
    v_cvt_pk_bf16_f32 v45, v105, v109
    v_cvt_pk_bf16_f32 v46, v106, v110
    v_mfma_f32_32x32x16_bf16 v[64:79], a[148:151], v[20:23], v[64:79]
    v_cvt_pk_bf16_f32 v47, v107, v111
    buffer_store_dwordx4 v[44:47], v7, s[4:7], s71 offen offset:2048 sc1
    s_waitcnt lgkmcnt(2)
    v_mfma_f32_32x32x16_bf16 v[48:63], a[24:27], v[24:27], v[48:63]
    ds_read_b128 v[20:23], v10 offset:9216
    v_mfma_f32_32x32x16_bf16 v[64:79], a[152:155], v[24:27], v[64:79]
    s_waitcnt lgkmcnt(2)
    v_mfma_f32_32x32x16_bf16 v[48:63], a[28:31], v[28:31], v[48:63]
    ds_read_b128 v[24:27], v10 offset:10240
    v_mfma_f32_32x32x16_bf16 v[64:79], a[156:159], v[28:31], v[64:79]
    s_waitcnt lgkmcnt(2)
    v_mfma_f32_32x32x16_bf16 v[48:63], a[32:35], v[16:19], v[48:63]
    ds_read_b128 v[28:31], v10 offset:11264
    v_mfma_f32_32x32x16_bf16 v[64:79], a[160:163], v[16:19], v[64:79]
    s_waitcnt lgkmcnt(2)
    v_mfma_f32_32x32x16_bf16 v[48:63], a[36:39], v[20:23], v[48:63]
    ds_read_b128 v[16:19], v10 offset:12288
    v_mfma_f32_32x32x16_bf16 v[64:79], a[164:167], v[20:23], v[64:79]
    s_waitcnt lgkmcnt(2)
    v_mfma_f32_32x32x16_bf16 v[48:63], a[40:43], v[24:27], v[48:63]
    ds_read_b128 v[20:23], v10 offset:13312
    v_mfma_f32_32x32x16_bf16 v[64:79], a[168:171], v[24:27], v[64:79]
    s_waitcnt lgkmcnt(2)
    v_mfma_f32_32x32x16_bf16 v[48:63], a[44:47], v[28:31], v[48:63]
    ds_read_b128 v[24:27], v10 offset:14336
    v_mfma_f32_32x32x16_bf16 v[64:79], a[172:175], v[28:31], v[64:79]
    s_waitcnt lgkmcnt(2)
    v_mfma_f32_32x32x16_bf16 v[48:63], a[48:51], v[16:19], v[48:63]
    ds_read_b128 v[28:31], v10 offset:15360
    v_mfma_f32_32x32x16_bf16 v[64:79], a[176:179], v[16:19], v[64:79]
    s_waitcnt lgkmcnt(2)
    v_mfma_f32_32x32x16_bf16 v[48:63], a[52:55], v[20:23], v[48:63]
    ds_read_b128 v[16:19], v10 offset:16384
    v_mfma_f32_32x32x16_bf16 v[64:79], a[180:183], v[20:23], v[64:79]
    s_waitcnt lgkmcnt(2)
    v_mfma_f32_32x32x16_bf16 v[48:63], a[56:59], v[24:27], v[48:63]
    ds_read_b128 v[20:23], v10 offset:17408
    v_mfma_f32_32x32x16_bf16 v[64:79], a[184:187], v[24:27], v[64:79]
    s_waitcnt lgkmcnt(2)
    v_mfma_f32_32x32x16_bf16 v[48:63], a[60:63], v[28:31], v[48:63]
    ds_read_b128 v[24:27], v10 offset:18432
    v_mfma_f32_32x32x16_bf16 v[64:79], a[188:191], v[28:31], v[64:79]
    s_waitcnt lgkmcnt(2)
    v_mfma_f32_32x32x16_bf16 v[48:63], a[64:67], v[16:19], v[48:63]
    ds_read_b128 v[28:31], v10 offset:19456
    v_mfma_f32_32x32x16_bf16 v[64:79], a[192:195], v[16:19], v[64:79]
    s_waitcnt lgkmcnt(2)
    v_mfma_f32_32x32x16_bf16 v[48:63], a[68:71], v[20:23], v[48:63]
    ds_read_b128 v[16:19], v10 offset:20480
    v_mfma_f32_32x32x16_bf16 v[64:79], a[196:199], v[20:23], v[64:79]
    s_waitcnt lgkmcnt(2)
    v_mfma_f32_32x32x16_bf16 v[48:63], a[72:75], v[24:27], v[48:63]
    ds_read_b128 v[20:23], v10 offset:21504
    v_mfma_f32_32x32x16_bf16 v[64:79], a[200:203], v[24:27], v[64:79]
    s_waitcnt lgkmcnt(2)
    v_mfma_f32_32x32x16_bf16 v[48:63], a[76:79], v[28:31], v[48:63]
    ds_read_b128 v[24:27], v10 offset:22528
    v_mfma_f32_32x32x16_bf16 v[64:79], a[204:207], v[28:31], v[64:79]
    s_waitcnt lgkmcnt(2)
    v_mfma_f32_32x32x16_bf16 v[48:63], a[80:83], v[16:19], v[48:63]
    ds_read_b128 v[28:31], v10 offset:23552
    v_mfma_f32_32x32x16_bf16 v[64:79], a[208:211], v[16:19], v[64:79]
    s_waitcnt lgkmcnt(2)
    v_mfma_f32_32x32x16_bf16 v[48:63], a[84:87], v[20:23], v[48:63]
    ds_read_b128 v[16:19], v10 offset:24576
    v_mfma_f32_32x32x16_bf16 v[64:79], a[212:215], v[20:23], v[64:79]
    s_waitcnt lgkmcnt(2)
    v_mfma_f32_32x32x16_bf16 v[48:63], a[88:91], v[24:27], v[48:63]
    ds_read_b128 v[20:23], v10 offset:25600
    v_mfma_f32_32x32x16_bf16 v[64:79], a[216:219], v[24:27], v[64:79]
    s_waitcnt lgkmcnt(2)
    v_mfma_f32_32x32x16_bf16 v[48:63], a[92:95], v[28:31], v[48:63]
    ds_read_b128 v[24:27], v10 offset:26624
    v_mfma_f32_32x32x16_bf16 v[64:79], a[220:223], v[28:31], v[64:79]
    s_waitcnt vmcnt(13)
    s_barrier
    buffer_store_dword v117, v116, s[4:7], s72 offen sc1
Ltight_183_ret:
    v_add_u32 v117, 1, v117
    s_add_u32 s71, s71, 0x80000
    v_mov_b32 v6, v112
    v_mov_b32 v7, v113
    s_waitcnt lgkmcnt(2)
    v_mfma_f32_32x32x16_bf16 v[48:63], a[96:99], v[16:19], v[48:63]
    ds_read_b128 v[28:31], v10 offset:27648
    s_add_u32 m0, s70, 0x8000
    s_add_u32 s84, s73, s88
    buffer_load_dwordx4 v11, s[4:7], s84 offen lds
    v_mfma_f32_32x32x16_bf16 v[64:79], a[224:227], v[16:19], v[64:79]
    s_waitcnt lgkmcnt(2)
    v_mfma_f32_32x32x16_bf16 v[48:63], a[100:103], v[20:23], v[48:63]
    ds_read_b128 v[16:19], v10 offset:28672
    s_add_u32 m0, s70, 0x9000
    s_add_u32 s84, s73, s89
    buffer_load_dwordx4 v11, s[4:7], s84 offen lds
    v_mfma_f32_32x32x16_bf16 v[64:79], a[228:231], v[20:23], v[64:79]
    s_waitcnt lgkmcnt(2)
    v_mfma_f32_32x32x16_bf16 v[48:63], a[104:107], v[24:27], v[48:63]
    ds_read_b128 v[20:23], v10 offset:29696
    s_add_u32 m0, s70, 0xa000
    s_add_u32 s84, s73, s90
    buffer_load_dwordx4 v11, s[4:7], s84 offen lds
    v_mfma_f32_32x32x16_bf16 v[64:79], a[232:235], v[24:27], v[64:79]
    s_waitcnt lgkmcnt(2)
    v_mfma_f32_32x32x16_bf16 v[48:63], a[108:111], v[28:31], v[48:63]
    ds_read_b128 v[24:27], v10 offset:30720
    s_add_u32 m0, s70, 0xb000
    s_add_u32 s84, s73, s91
    buffer_load_dwordx4 v11, s[4:7], s84 offen lds
    v_mfma_f32_32x32x16_bf16 v[64:79], a[236:239], v[28:31], v[64:79]
    s_waitcnt lgkmcnt(2)
    v_mfma_f32_32x32x16_bf16 v[48:63], a[112:115], v[16:19], v[48:63]
    ds_read_b128 v[28:31], v10 offset:31744
    s_add_u32 m0, s70, 0xc000
    s_add_u32 s84, s73, s92
    buffer_load_dwordx4 v11, s[4:7], s84 offen lds
    v_mfma_f32_32x32x16_bf16 v[64:79], a[240:243], v[16:19], v[64:79]
    s_waitcnt lgkmcnt(2)
    v_mfma_f32_32x32x16_bf16 v[48:63], a[116:119], v[20:23], v[48:63]
    ds_read_b128 v[16:19], v10 offset:32768
    s_add_u32 m0, s70, 0xd000
    s_add_u32 s84, s73, s93
    buffer_load_dwordx4 v11, s[4:7], s84 offen lds
    v_mfma_f32_32x32x16_bf16 v[64:79], a[244:247], v[20:23], v[64:79]
    s_waitcnt lgkmcnt(2)
    v_mfma_f32_32x32x16_bf16 v[48:63], a[120:123], v[24:27], v[48:63]
    ds_read_b128 v[20:23], v10 offset:33792
    s_add_u32 m0, s70, 0xe000
    s_add_u32 s84, s73, s10
    buffer_load_dwordx4 v11, s[4:7], s84 offen lds
    v_mfma_f32_32x32x16_bf16 v[64:79], a[248:251], v[24:27], v[64:79]
    s_waitcnt lgkmcnt(2)
    v_mfma_f32_32x32x16_bf16 v[48:63], a[124:127], v[28:31], v[48:63]
    ds_read_b128 v[24:27], v10 offset:34816
    s_add_u32 m0, s70, 0xf000
    s_add_u32 s84, s73, s11
    buffer_load_dwordx4 v11, s[4:7], s84 offen lds
    v_mfma_f32_32x32x16_bf16 v[64:79], a[252:255], v[28:31], v[64:79]
    s_add_u32 s73, s73, 0x10000
    s_waitcnt lgkmcnt(2)
    v_mfma_f32_32x32x16_bf16 v[80:95], a[0:3], v[16:19], 0
    ds_read_b128 v[28:31], v10 offset:35840
    v_mfma_f32_32x32x16_bf16 v[96:111], a[128:131], v[16:19], 0
    s_waitcnt lgkmcnt(2)
    v_mfma_f32_32x32x16_bf16 v[80:95], a[4:7], v[20:23], v[80:95]
    ds_read_b128 v[16:19], v10 offset:36864
    v_cvt_pk_bf16_f32 v32, v48, v52
    v_cvt_pk_bf16_f32 v33, v49, v53
    v_mfma_f32_32x32x16_bf16 v[96:111], a[132:135], v[20:23], v[96:111]
    v_cvt_pk_bf16_f32 v34, v50, v54
    v_cvt_pk_bf16_f32 v35, v51, v55
    s_waitcnt lgkmcnt(2)
    v_mfma_f32_32x32x16_bf16 v[80:95], a[8:11], v[24:27], v[80:95]
    ds_read_b128 v[20:23], v10 offset:37888
    buffer_store_dwordx4 v[32:35], v6, s[4:7], s71 offen offset:0 sc1
    v_cvt_pk_bf16_f32 v36, v56, v60
    v_mfma_f32_32x32x16_bf16 v[96:111], a[136:139], v[24:27], v[96:111]
    v_cvt_pk_bf16_f32 v37, v57, v61
    v_cvt_pk_bf16_f32 v38, v58, v62
    s_waitcnt lgkmcnt(2)
    v_mfma_f32_32x32x16_bf16 v[80:95], a[12:15], v[28:31], v[80:95]
    ds_read_b128 v[24:27], v10 offset:38912
    v_cvt_pk_bf16_f32 v39, v59, v63
    buffer_store_dwordx4 v[36:39], v7, s[4:7], s71 offen offset:0 sc1
    v_mfma_f32_32x32x16_bf16 v[96:111], a[140:143], v[28:31], v[96:111]
    v_cvt_pk_bf16_f32 v40, v64, v68
    v_cvt_pk_bf16_f32 v41, v65, v69
    s_waitcnt lgkmcnt(2)
    v_mfma_f32_32x32x16_bf16 v[80:95], a[16:19], v[16:19], v[80:95]
    ds_read_b128 v[28:31], v10 offset:39936
    v_cvt_pk_bf16_f32 v42, v66, v70
    v_cvt_pk_bf16_f32 v43, v67, v71
    v_mfma_f32_32x32x16_bf16 v[96:111], a[144:147], v[16:19], v[96:111]
    buffer_store_dwordx4 v[40:43], v6, s[4:7], s71 offen offset:2048 sc1
    v_cvt_pk_bf16_f32 v44, v72, v76
    s_waitcnt lgkmcnt(2)
    v_mfma_f32_32x32x16_bf16 v[80:95], a[20:23], v[20:23], v[80:95]
    ds_read_b128 v[16:19], v10 offset:40960
    v_cvt_pk_bf16_f32 v45, v73, v77
    v_cvt_pk_bf16_f32 v46, v74, v78
    v_mfma_f32_32x32x16_bf16 v[96:111], a[148:151], v[20:23], v[96:111]
    v_cvt_pk_bf16_f32 v47, v75, v79
    buffer_store_dwordx4 v[44:47], v7, s[4:7], s71 offen offset:2048 sc1
    s_waitcnt lgkmcnt(2)
    v_mfma_f32_32x32x16_bf16 v[80:95], a[24:27], v[24:27], v[80:95]
    ds_read_b128 v[20:23], v10 offset:41984
    v_mfma_f32_32x32x16_bf16 v[96:111], a[152:155], v[24:27], v[96:111]
    s_waitcnt lgkmcnt(2)
    v_mfma_f32_32x32x16_bf16 v[80:95], a[28:31], v[28:31], v[80:95]
    ds_read_b128 v[24:27], v10 offset:43008
    v_mfma_f32_32x32x16_bf16 v[96:111], a[156:159], v[28:31], v[96:111]
    s_waitcnt lgkmcnt(2)
    v_mfma_f32_32x32x16_bf16 v[80:95], a[32:35], v[16:19], v[80:95]
    ds_read_b128 v[28:31], v10 offset:44032
    v_mfma_f32_32x32x16_bf16 v[96:111], a[160:163], v[16:19], v[96:111]
    s_waitcnt lgkmcnt(2)
    v_mfma_f32_32x32x16_bf16 v[80:95], a[36:39], v[20:23], v[80:95]
    ds_read_b128 v[16:19], v10 offset:45056
    v_mfma_f32_32x32x16_bf16 v[96:111], a[164:167], v[20:23], v[96:111]
    s_waitcnt lgkmcnt(2)
    v_mfma_f32_32x32x16_bf16 v[80:95], a[40:43], v[24:27], v[80:95]
    ds_read_b128 v[20:23], v10 offset:46080
    v_mfma_f32_32x32x16_bf16 v[96:111], a[168:171], v[24:27], v[96:111]
    s_waitcnt lgkmcnt(2)
    v_mfma_f32_32x32x16_bf16 v[80:95], a[44:47], v[28:31], v[80:95]
    ds_read_b128 v[24:27], v10 offset:47104
    v_mfma_f32_32x32x16_bf16 v[96:111], a[172:175], v[28:31], v[96:111]
    s_waitcnt lgkmcnt(2)
    v_mfma_f32_32x32x16_bf16 v[80:95], a[48:51], v[16:19], v[80:95]
    ds_read_b128 v[28:31], v10 offset:48128
    v_mfma_f32_32x32x16_bf16 v[96:111], a[176:179], v[16:19], v[96:111]
    s_waitcnt lgkmcnt(2)
    v_mfma_f32_32x32x16_bf16 v[80:95], a[52:55], v[20:23], v[80:95]
    ds_read_b128 v[16:19], v10 offset:49152
    v_mfma_f32_32x32x16_bf16 v[96:111], a[180:183], v[20:23], v[96:111]
    s_waitcnt lgkmcnt(2)
    v_mfma_f32_32x32x16_bf16 v[80:95], a[56:59], v[24:27], v[80:95]
    ds_read_b128 v[20:23], v10 offset:50176
    v_mfma_f32_32x32x16_bf16 v[96:111], a[184:187], v[24:27], v[96:111]
    s_waitcnt lgkmcnt(2)
    v_mfma_f32_32x32x16_bf16 v[80:95], a[60:63], v[28:31], v[80:95]
    ds_read_b128 v[24:27], v10 offset:51200
    v_mfma_f32_32x32x16_bf16 v[96:111], a[188:191], v[28:31], v[96:111]
    s_waitcnt lgkmcnt(2)
    v_mfma_f32_32x32x16_bf16 v[80:95], a[64:67], v[16:19], v[80:95]
    ds_read_b128 v[28:31], v10 offset:52224
    v_mfma_f32_32x32x16_bf16 v[96:111], a[192:195], v[16:19], v[96:111]
    s_waitcnt lgkmcnt(2)
    v_mfma_f32_32x32x16_bf16 v[80:95], a[68:71], v[20:23], v[80:95]
    ds_read_b128 v[16:19], v10 offset:53248
    v_mfma_f32_32x32x16_bf16 v[96:111], a[196:199], v[20:23], v[96:111]
    s_waitcnt lgkmcnt(2)
    v_mfma_f32_32x32x16_bf16 v[80:95], a[72:75], v[24:27], v[80:95]
    ds_read_b128 v[20:23], v10 offset:54272
    v_mfma_f32_32x32x16_bf16 v[96:111], a[200:203], v[24:27], v[96:111]
    s_waitcnt lgkmcnt(2)
    v_mfma_f32_32x32x16_bf16 v[80:95], a[76:79], v[28:31], v[80:95]
    ds_read_b128 v[24:27], v10 offset:55296
    v_mfma_f32_32x32x16_bf16 v[96:111], a[204:207], v[28:31], v[96:111]
    s_waitcnt lgkmcnt(2)
    v_mfma_f32_32x32x16_bf16 v[80:95], a[80:83], v[16:19], v[80:95]
    ds_read_b128 v[28:31], v10 offset:56320
    v_mfma_f32_32x32x16_bf16 v[96:111], a[208:211], v[16:19], v[96:111]
    s_waitcnt lgkmcnt(2)
    v_mfma_f32_32x32x16_bf16 v[80:95], a[84:87], v[20:23], v[80:95]
    ds_read_b128 v[16:19], v10 offset:57344
    v_mfma_f32_32x32x16_bf16 v[96:111], a[212:215], v[20:23], v[96:111]
    s_waitcnt lgkmcnt(2)
    v_mfma_f32_32x32x16_bf16 v[80:95], a[88:91], v[24:27], v[80:95]
    ds_read_b128 v[20:23], v10 offset:58368
    v_mfma_f32_32x32x16_bf16 v[96:111], a[216:219], v[24:27], v[96:111]
    s_waitcnt lgkmcnt(2)
    v_mfma_f32_32x32x16_bf16 v[80:95], a[92:95], v[28:31], v[80:95]
    ds_read_b128 v[24:27], v10 offset:59392
    v_mfma_f32_32x32x16_bf16 v[96:111], a[220:223], v[28:31], v[96:111]
    s_cmp_eq_u32 s74, 0
    s_cbranch_scc1 Ltight_184
    s_waitcnt vmcnt(13)
    s_barrier
    buffer_store_dword v117, v116, s[4:7], s72 offen sc1
Ltight_184_ret:
    v_add_u32 v117, 1, v117
    s_add_u32 s71, s71, 0x80000
    v_mov_b32 v6, v112
    v_mov_b32 v7, v113
    s_xor_b32 s70, s70, 0x10000
    s_waitcnt lgkmcnt(2)
    v_mfma_f32_32x32x16_bf16 v[80:95], a[96:99], v[16:19], v[80:95]
    ds_read_b128 v[28:31], v10 offset:60416
    s_add_u32 m0, s70, 0x0
    s_add_u32 s84, s73, s88
    buffer_load_dwordx4 v11, s[4:7], s84 offen lds
    v_mfma_f32_32x32x16_bf16 v[96:111], a[224:227], v[16:19], v[96:111]
    s_waitcnt lgkmcnt(2)
    v_mfma_f32_32x32x16_bf16 v[80:95], a[100:103], v[20:23], v[80:95]
    ds_read_b128 v[16:19], v10 offset:61440
    s_add_u32 m0, s70, 0x1000
    s_add_u32 s84, s73, s89
    buffer_load_dwordx4 v11, s[4:7], s84 offen lds
    v_mfma_f32_32x32x16_bf16 v[96:111], a[228:231], v[20:23], v[96:111]
    s_waitcnt lgkmcnt(2)
    v_mfma_f32_32x32x16_bf16 v[80:95], a[104:107], v[24:27], v[80:95]
    ds_read_b128 v[20:23], v10 offset:62464
    s_add_u32 m0, s70, 0x2000
    s_add_u32 s84, s73, s90
    buffer_load_dwordx4 v11, s[4:7], s84 offen lds
    v_mfma_f32_32x32x16_bf16 v[96:111], a[232:235], v[24:27], v[96:111]
    s_waitcnt lgkmcnt(2)
    v_mfma_f32_32x32x16_bf16 v[80:95], a[108:111], v[28:31], v[80:95]
    ds_read_b128 v[24:27], v10 offset:63488
    s_add_u32 m0, s70, 0x3000
    s_add_u32 s84, s73, s91
    buffer_load_dwordx4 v11, s[4:7], s84 offen lds
    v_mfma_f32_32x32x16_bf16 v[96:111], a[236:239], v[28:31], v[96:111]
    s_waitcnt lgkmcnt(2)
    v_mfma_f32_32x32x16_bf16 v[80:95], a[112:115], v[16:19], v[80:95]
    ds_read_b128 v[28:31], v10 offset:64512
    s_add_u32 m0, s70, 0x4000
    s_add_u32 s84, s73, s92
    buffer_load_dwordx4 v11, s[4:7], s84 offen lds
    v_mfma_f32_32x32x16_bf16 v[96:111], a[240:243], v[16:19], v[96:111]
    s_waitcnt lgkmcnt(2)
    v_mfma_f32_32x32x16_bf16 v[80:95], a[116:119], v[20:23], v[80:95]
    v_xor_b32 v10, 0x10000, v10
    ds_read_b128 v[16:19], v10 offset:0
    s_add_u32 m0, s70, 0x5000
    s_add_u32 s84, s73, s93
    buffer_load_dwordx4 v11, s[4:7], s84 offen lds
    v_mfma_f32_32x32x16_bf16 v[96:111], a[244:247], v[20:23], v[96:111]
    s_waitcnt lgkmcnt(2)
    v_mfma_f32_32x32x16_bf16 v[80:95], a[120:123], v[24:27], v[80:95]
    ds_read_b128 v[20:23], v10 offset:1024
    s_add_u32 m0, s70, 0x6000
    s_add_u32 s84, s73, s10
    buffer_load_dwordx4 v11, s[4:7], s84 offen lds
    v_mfma_f32_32x32x16_bf16 v[96:111], a[248:251], v[24:27], v[96:111]
    s_waitcnt lgkmcnt(2)
    v_mfma_f32_32x32x16_bf16 v[80:95], a[124:127], v[28:31], v[80:95]
    ds_read_b128 v[24:27], v10 offset:2048
    s_add_u32 m0, s70, 0x7000
    s_add_u32 s84, s73, s11
    buffer_load_dwordx4 v11, s[4:7], s84 offen lds
    v_mfma_f32_32x32x16_bf16 v[96:111], a[252:255], v[28:31], v[96:111]
    s_add_u32 s73, s73, 0x10000
    s_add_u32 s74, s74, 2
    s_cmp_lt_u32 s74, 32
    s_cbranch_scc1 L_p2k
    s_nop 11
    v_cvt_pk_bf16_f32 v32, v80, v84
    v_cvt_pk_bf16_f32 v33, v81, v85
    v_cvt_pk_bf16_f32 v34, v82, v86
    v_cvt_pk_bf16_f32 v35, v83, v87
    buffer_store_dwordx4 v[32:35], v6, s[4:7], s71 offen offset:0 sc1
    v_cvt_pk_bf16_f32 v36, v88, v92
    v_cvt_pk_bf16_f32 v37, v89, v93
    v_cvt_pk_bf16_f32 v38, v90, v94
    v_cvt_pk_bf16_f32 v39, v91, v95
    buffer_store_dwordx4 v[36:39], v7, s[4:7], s71 offen offset:0 sc1
    v_cvt_pk_bf16_f32 v40, v96, v100
    v_cvt_pk_bf16_f32 v41, v97, v101
    v_cvt_pk_bf16_f32 v42, v98, v102
    v_cvt_pk_bf16_f32 v43, v99, v103
    buffer_store_dwordx4 v[40:43], v6, s[4:7], s71 offen offset:2048 sc1
    v_cvt_pk_bf16_f32 v44, v104, v108
    v_cvt_pk_bf16_f32 v45, v105, v109
    v_cvt_pk_bf16_f32 v46, v106, v110
    v_cvt_pk_bf16_f32 v47, v107, v111
    buffer_store_dwordx4 v[44:47], v7, s[4:7], s71 offen offset:2048 sc1
    s_waitcnt vmcnt(0) lgkmcnt(0)
    s_barrier
    v_mov_b32 v117, 32
    buffer_store_dword v117, v116, s[4:7], s72 offen sc1
    s_branch L_p2_done
Ltight_184:
    s_waitcnt vmcnt(0)
    s_barrier
    v_mov_b32 v116, v118
    buffer_store_dword v9, v116, s[4:7], s72 offen sc1
    s_branch Ltight_184_ret
L_p2v:
    s_waitcnt lgkmcnt(2)
    v_mfma_f32_32x32x16_bf16 v[48:63], v[16:19], a[0:3], 0
    ds_read_b128 v[28:31], v10 offset:3072
    v_mfma_f32_32x32x16_bf16 v[64:79], v[16:19], a[128:131], 0
    s_waitcnt lgkmcnt(2)
    v_mfma_f32_32x32x16_bf16 v[48:63], v[20:23], a[4:7], v[48:63]
    ds_read_b128 v[16:19], v10 offset:4096
    v_cvt_pk_bf16_f32 v32, v80, v81
    v_cvt_pk_bf16_f32 v33, v82, v83
    v_mfma_f32_32x32x16_bf16 v[64:79], v[20:23], a[132:135], v[64:79]
    v_cvt_pk_bf16_f32 v34, v84, v85
    v_cvt_pk_bf16_f32 v35, v86, v87
    s_waitcnt lgkmcnt(2)
    v_mfma_f32_32x32x16_bf16 v[48:63], v[24:27], a[8:11], v[48:63]
    ds_read_b128 v[20:23], v10 offset:5120
    buffer_store_dwordx4 v[32:35], v6, s[4:7], s71 offen offset:0 sc1
    v_cvt_pk_bf16_f32 v36, v88, v89
    v_mfma_f32_32x32x16_bf16 v[64:79], v[24:27], a[136:139], v[64:79]
    v_cvt_pk_bf16_f32 v37, v90, v91
    v_cvt_pk_bf16_f32 v38, v92, v93
    s_waitcnt lgkmcnt(2)
    v_mfma_f32_32x32x16_bf16 v[48:63], v[28:31], a[12:15], v[48:63]
    ds_read_b128 v[24:27], v10 offset:6144
    v_cvt_pk_bf16_f32 v39, v94, v95
    buffer_store_dwordx4 v[36:39], v7, s[4:7], s71 offen offset:0 sc1
    v_mfma_f32_32x32x16_bf16 v[64:79], v[28:31], a[140:143], v[64:79]
    v_cvt_pk_bf16_f32 v40, v96, v97
    v_cvt_pk_bf16_f32 v41, v98, v99
    s_waitcnt lgkmcnt(2)
    v_mfma_f32_32x32x16_bf16 v[48:63], v[16:19], a[16:19], v[48:63]
    ds_read_b128 v[28:31], v10 offset:7168
    v_cvt_pk_bf16_f32 v42, v100, v101
    v_cvt_pk_bf16_f32 v43, v102, v103
    v_mfma_f32_32x32x16_bf16 v[64:79], v[16:19], a[144:147], v[64:79]
    buffer_store_dwordx4 v[40:43], v6, s[4:7], s71 offen offset:2048 sc1
    v_cvt_pk_bf16_f32 v44, v104, v105
    s_waitcnt lgkmcnt(2)
    v_mfma_f32_32x32x16_bf16 v[48:63], v[20:23], a[20:23], v[48:63]
    ds_read_b128 v[16:19], v10 offset:8192
    v_cvt_pk_bf16_f32 v45, v106, v107
    v_cvt_pk_bf16_f32 v46, v108, v109
    v_mfma_f32_32x32x16_bf16 v[64:79], v[20:23], a[148:151], v[64:79]
    v_cvt_pk_bf16_f32 v47, v110, v111
    buffer_store_dwordx4 v[44:47], v7, s[4:7], s71 offen offset:2048 sc1
    s_waitcnt lgkmcnt(2)
    v_mfma_f32_32x32x16_bf16 v[48:63], v[24:27], a[24:27], v[48:63]
    ds_read_b128 v[20:23], v10 offset:9216
    v_mfma_f32_32x32x16_bf16 v[64:79], v[24:27], a[152:155], v[64:79]
    s_waitcnt lgkmcnt(2)
    v_mfma_f32_32x32x16_bf16 v[48:63], v[28:31], a[28:31], v[48:63]
    ds_read_b128 v[24:27], v10 offset:10240
    v_mfma_f32_32x32x16_bf16 v[64:79], v[28:31], a[156:159], v[64:79]
    s_waitcnt lgkmcnt(2)
    v_mfma_f32_32x32x16_bf16 v[48:63], v[16:19], a[32:35], v[48:63]
    ds_read_b128 v[28:31], v10 offset:11264
    v_mfma_f32_32x32x16_bf16 v[64:79], v[16:19], a[160:163], v[64:79]
    s_waitcnt lgkmcnt(2)
    v_mfma_f32_32x32x16_bf16 v[48:63], v[20:23], a[36:39], v[48:63]
    ds_read_b128 v[16:19], v10 offset:12288
    v_mfma_f32_32x32x16_bf16 v[64:79], v[20:23], a[164:167], v[64:79]
    s_waitcnt lgkmcnt(2)
    v_mfma_f32_32x32x16_bf16 v[48:63], v[24:27], a[40:43], v[48:63]
    ds_read_b128 v[20:23], v10 offset:13312
    v_mfma_f32_32x32x16_bf16 v[64:79], v[24:27], a[168:171], v[64:79]
    s_waitcnt lgkmcnt(2)
    v_mfma_f32_32x32x16_bf16 v[48:63], v[28:31], a[44:47], v[48:63]
    ds_read_b128 v[24:27], v10 offset:14336
    v_mfma_f32_32x32x16_bf16 v[64:79], v[28:31], a[172:175], v[64:79]
    s_waitcnt lgkmcnt(2)
    v_mfma_f32_32x32x16_bf16 v[48:63], v[16:19], a[48:51], v[48:63]
    ds_read_b128 v[28:31], v10 offset:15360
    v_mfma_f32_32x32x16_bf16 v[64:79], v[16:19], a[176:179], v[64:79]
    s_waitcnt lgkmcnt(2)
    v_mfma_f32_32x32x16_bf16 v[48:63], v[20:23], a[52:55], v[48:63]
    ds_read_b128 v[16:19], v10 offset:16384
    v_mfma_f32_32x32x16_bf16 v[64:79], v[20:23], a[180:183], v[64:79]
    s_waitcnt lgkmcnt(2)
    v_mfma_f32_32x32x16_bf16 v[48:63], v[24:27], a[56:59], v[48:63]
    ds_read_b128 v[20:23], v10 offset:17408
    v_mfma_f32_32x32x16_bf16 v[64:79], v[24:27], a[184:187], v[64:79]
    s_waitcnt lgkmcnt(2)
    v_mfma_f32_32x32x16_bf16 v[48:63], v[28:31], a[60:63], v[48:63]
    ds_read_b128 v[24:27], v10 offset:18432
    v_mfma_f32_32x32x16_bf16 v[64:79], v[28:31], a[188:191], v[64:79]
    s_waitcnt lgkmcnt(2)
    v_mfma_f32_32x32x16_bf16 v[48:63], v[16:19], a[64:67], v[48:63]
    ds_read_b128 v[28:31], v10 offset:19456
    v_mfma_f32_32x32x16_bf16 v[64:79], v[16:19], a[192:195], v[64:79]
    s_waitcnt lgkmcnt(2)
    v_mfma_f32_32x32x16_bf16 v[48:63], v[20:23], a[68:71], v[48:63]
    ds_read_b128 v[16:19], v10 offset:20480
    v_mfma_f32_32x32x16_bf16 v[64:79], v[20:23], a[196:199], v[64:79]
    s_waitcnt lgkmcnt(2)
    v_mfma_f32_32x32x16_bf16 v[48:63], v[24:27], a[72:75], v[48:63]
    ds_read_b128 v[20:23], v10 offset:21504
    v_mfma_f32_32x32x16_bf16 v[64:79], v[24:27], a[200:203], v[64:79]
    s_waitcnt lgkmcnt(2)
    v_mfma_f32_32x32x16_bf16 v[48:63], v[28:31], a[76:79], v[48:63]
    ds_read_b128 v[24:27], v10 offset:22528
    v_mfma_f32_32x32x16_bf16 v[64:79], v[28:31], a[204:207], v[64:79]
    s_waitcnt lgkmcnt(2)
    v_mfma_f32_32x32x16_bf16 v[48:63], v[16:19], a[80:83], v[48:63]
    ds_read_b128 v[28:31], v10 offset:23552
    v_mfma_f32_32x32x16_bf16 v[64:79], v[16:19], a[208:211], v[64:79]
    s_waitcnt lgkmcnt(2)
    v_mfma_f32_32x32x16_bf16 v[48:63], v[20:23], a[84:87], v[48:63]
    ds_read_b128 v[16:19], v10 offset:24576
    v_mfma_f32_32x32x16_bf16 v[64:79], v[20:23], a[212:215], v[64:79]
    s_waitcnt lgkmcnt(2)
    v_mfma_f32_32x32x16_bf16 v[48:63], v[24:27], a[88:91], v[48:63]
    ds_read_b128 v[20:23], v10 offset:25600
    v_mfma_f32_32x32x16_bf16 v[64:79], v[24:27], a[216:219], v[64:79]
    s_waitcnt lgkmcnt(2)
    v_mfma_f32_32x32x16_bf16 v[48:63], v[28:31], a[92:95], v[48:63]
    ds_read_b128 v[24:27], v10 offset:26624
    v_mfma_f32_32x32x16_bf16 v[64:79], v[28:31], a[220:223], v[64:79]
    s_waitcnt vmcnt(13)
    s_barrier
    buffer_store_dword v117, v116, s[4:7], s72 offen sc1
Ltight_185_ret:
    v_add_u32 v117, 1, v117
    s_add_u32 s71, s71, 0x80000
    v_mov_b32 v6, v112
    v_mov_b32 v7, v113
    s_waitcnt lgkmcnt(2)
    v_mfma_f32_32x32x16_bf16 v[48:63], v[16:19], a[96:99], v[48:63]
    ds_read_b128 v[28:31], v10 offset:27648
    s_add_u32 m0, s70, 0x8000
    s_add_u32 s84, s73, s88
    buffer_load_dwordx4 v11, s[4:7], s84 offen lds
    v_mfma_f32_32x32x16_bf16 v[64:79], v[16:19], a[224:227], v[64:79]
    s_waitcnt lgkmcnt(2)
    v_mfma_f32_32x32x16_bf16 v[48:63], v[20:23], a[100:103], v[48:63]
    ds_read_b128 v[16:19], v10 offset:28672
    s_add_u32 m0, s70, 0x9000
    s_add_u32 s84, s73, s89
    buffer_load_dwordx4 v11, s[4:7], s84 offen lds
    v_mfma_f32_32x32x16_bf16 v[64:79], v[20:23], a[228:231], v[64:79]
    s_waitcnt lgkmcnt(2)
    v_mfma_f32_32x32x16_bf16 v[48:63], v[24:27], a[104:107], v[48:63]
    ds_read_b128 v[20:23], v10 offset:29696
    s_add_u32 m0, s70, 0xa000
    s_add_u32 s84, s73, s90
    buffer_load_dwordx4 v11, s[4:7], s84 offen lds
    v_mfma_f32_32x32x16_bf16 v[64:79], v[24:27], a[232:235], v[64:79]
    s_waitcnt lgkmcnt(2)
    v_mfma_f32_32x32x16_bf16 v[48:63], v[28:31], a[108:111], v[48:63]
    ds_read_b128 v[24:27], v10 offset:30720
    s_add_u32 m0, s70, 0xb000
    s_add_u32 s84, s73, s91
    buffer_load_dwordx4 v11, s[4:7], s84 offen lds
    v_mfma_f32_32x32x16_bf16 v[64:79], v[28:31], a[236:239], v[64:79]
    s_waitcnt lgkmcnt(2)
    v_mfma_f32_32x32x16_bf16 v[48:63], v[16:19], a[112:115], v[48:63]
    ds_read_b128 v[28:31], v10 offset:31744
    s_add_u32 m0, s70, 0xc000
    s_add_u32 s84, s73, s92
    buffer_load_dwordx4 v11, s[4:7], s84 offen lds
    v_mfma_f32_32x32x16_bf16 v[64:79], v[16:19], a[240:243], v[64:79]
    s_waitcnt lgkmcnt(2)
    v_mfma_f32_32x32x16_bf16 v[48:63], v[20:23], a[116:119], v[48:63]
    ds_read_b128 v[16:19], v10 offset:32768
    s_add_u32 m0, s70, 0xd000
    s_add_u32 s84, s73, s93
    buffer_load_dwordx4 v11, s[4:7], s84 offen lds
    v_mfma_f32_32x32x16_bf16 v[64:79], v[20:23], a[244:247], v[64:79]
    s_waitcnt lgkmcnt(2)
    v_mfma_f32_32x32x16_bf16 v[48:63], v[24:27], a[120:123], v[48:63]
    ds_read_b128 v[20:23], v10 offset:33792
    s_add_u32 m0, s70, 0xe000
    s_add_u32 s84, s73, s10
    buffer_load_dwordx4 v11, s[4:7], s84 offen lds
    v_mfma_f32_32x32x16_bf16 v[64:79], v[24:27], a[248:251], v[64:79]
    s_waitcnt lgkmcnt(2)
    v_mfma_f32_32x32x16_bf16 v[48:63], v[28:31], a[124:127], v[48:63]
    ds_read_b128 v[24:27], v10 offset:34816
    s_add_u32 m0, s70, 0xf000
    s_add_u32 s84, s73, s11
    buffer_load_dwordx4 v11, s[4:7], s84 offen lds
    v_mfma_f32_32x32x16_bf16 v[64:79], v[28:31], a[252:255], v[64:79]
    s_add_u32 s73, s73, 0x10000
    s_waitcnt lgkmcnt(2)
    v_mfma_f32_32x32x16_bf16 v[80:95], v[16:19], a[0:3], 0
    ds_read_b128 v[28:31], v10 offset:35840
    v_mfma_f32_32x32x16_bf16 v[96:111], v[16:19], a[128:131], 0
    s_waitcnt lgkmcnt(2)
    v_mfma_f32_32x32x16_bf16 v[80:95], v[20:23], a[4:7], v[80:95]
    ds_read_b128 v[16:19], v10 offset:36864
    v_cvt_pk_bf16_f32 v32, v48, v49
    v_cvt_pk_bf16_f32 v33, v50, v51
    v_mfma_f32_32x32x16_bf16 v[96:111], v[20:23], a[132:135], v[96:111]
    v_cvt_pk_bf16_f32 v34, v52, v53
    v_cvt_pk_bf16_f32 v35, v54, v55
    s_waitcnt lgkmcnt(2)
    v_mfma_f32_32x32x16_bf16 v[80:95], v[24:27], a[8:11], v[80:95]
    ds_read_b128 v[20:23], v10 offset:37888
    buffer_store_dwordx4 v[32:35], v6, s[4:7], s71 offen offset:0 sc1
    v_cvt_pk_bf16_f32 v36, v56, v57
    v_mfma_f32_32x32x16_bf16 v[96:111], v[24:27], a[136:139], v[96:111]
    v_cvt_pk_bf16_f32 v37, v58, v59
    v_cvt_pk_bf16_f32 v38, v60, v61
    s_waitcnt lgkmcnt(2)
    v_mfma_f32_32x32x16_bf16 v[80:95], v[28:31], a[12:15], v[80:95]
    ds_read_b128 v[24:27], v10 offset:38912
    v_cvt_pk_bf16_f32 v39, v62, v63
    buffer_store_dwordx4 v[36:39], v7, s[4:7], s71 offen offset:0 sc1
    v_mfma_f32_32x32x16_bf16 v[96:111], v[28:31], a[140:143], v[96:111]
    v_cvt_pk_bf16_f32 v40, v64, v65
    v_cvt_pk_bf16_f32 v41, v66, v67
    s_waitcnt lgkmcnt(2)
    v_mfma_f32_32x32x16_bf16 v[80:95], v[16:19], a[16:19], v[80:95]
    ds_read_b128 v[28:31], v10 offset:39936
    v_cvt_pk_bf16_f32 v42, v68, v69
    v_cvt_pk_bf16_f32 v43, v70, v71
    v_mfma_f32_32x32x16_bf16 v[96:111], v[16:19], a[144:147], v[96:111]
    buffer_store_dwordx4 v[40:43], v6, s[4:7], s71 offen offset:2048 sc1
    v_cvt_pk_bf16_f32 v44, v72, v73
    s_waitcnt lgkmcnt(2)
    v_mfma_f32_32x32x16_bf16 v[80:95], v[20:23], a[20:23], v[80:95]
    ds_read_b128 v[16:19], v10 offset:40960
    v_cvt_pk_bf16_f32 v45, v74, v75
    v_cvt_pk_bf16_f32 v46, v76, v77
    v_mfma_f32_32x32x16_bf16 v[96:111], v[20:23], a[148:151], v[96:111]
    v_cvt_pk_bf16_f32 v47, v78, v79
    buffer_store_dwordx4 v[44:47], v7, s[4:7], s71 offen offset:2048 sc1
    s_waitcnt lgkmcnt(2)
    v_mfma_f32_32x32x16_bf16 v[80:95], v[24:27], a[24:27], v[80:95]
    ds_read_b128 v[20:23], v10 offset:41984
    v_mfma_f32_32x32x16_bf16 v[96:111], v[24:27], a[152:155], v[96:111]
    s_waitcnt lgkmcnt(2)
    v_mfma_f32_32x32x16_bf16 v[80:95], v[28:31], a[28:31], v[80:95]
    ds_read_b128 v[24:27], v10 offset:43008
    v_mfma_f32_32x32x16_bf16 v[96:111], v[28:31], a[156:159], v[96:111]
    s_waitcnt lgkmcnt(2)
    v_mfma_f32_32x32x16_bf16 v[80:95], v[16:19], a[32:35], v[80:95]
    ds_read_b128 v[28:31], v10 offset:44032
    v_mfma_f32_32x32x16_bf16 v[96:111], v[16:19], a[160:163], v[96:111]
    s_waitcnt lgkmcnt(2)
    v_mfma_f32_32x32x16_bf16 v[80:95], v[20:23], a[36:39], v[80:95]
    ds_read_b128 v[16:19], v10 offset:45056
    v_mfma_f32_32x32x16_bf16 v[96:111], v[20:23], a[164:167], v[96:111]
    s_waitcnt lgkmcnt(2)
    v_mfma_f32_32x32x16_bf16 v[80:95], v[24:27], a[40:43], v[80:95]
    ds_read_b128 v[20:23], v10 offset:46080
    v_mfma_f32_32x32x16_bf16 v[96:111], v[24:27], a[168:171], v[96:111]
    s_waitcnt lgkmcnt(2)
    v_mfma_f32_32x32x16_bf16 v[80:95], v[28:31], a[44:47], v[80:95]
    ds_read_b128 v[24:27], v10 offset:47104
    v_mfma_f32_32x32x16_bf16 v[96:111], v[28:31], a[172:175], v[96:111]
    s_waitcnt lgkmcnt(2)
    v_mfma_f32_32x32x16_bf16 v[80:95], v[16:19], a[48:51], v[80:95]
    ds_read_b128 v[28:31], v10 offset:48128
    v_mfma_f32_32x32x16_bf16 v[96:111], v[16:19], a[176:179], v[96:111]
    s_waitcnt lgkmcnt(2)
    v_mfma_f32_32x32x16_bf16 v[80:95], v[20:23], a[52:55], v[80:95]
    ds_read_b128 v[16:19], v10 offset:49152
    v_mfma_f32_32x32x16_bf16 v[96:111], v[20:23], a[180:183], v[96:111]
    s_waitcnt lgkmcnt(2)
    v_mfma_f32_32x32x16_bf16 v[80:95], v[24:27], a[56:59], v[80:95]
    ds_read_b128 v[20:23], v10 offset:50176
    v_mfma_f32_32x32x16_bf16 v[96:111], v[24:27], a[184:187], v[96:111]
    s_waitcnt lgkmcnt(2)
    v_mfma_f32_32x32x16_bf16 v[80:95], v[28:31], a[60:63], v[80:95]
    ds_read_b128 v[24:27], v10 offset:51200
    v_mfma_f32_32x32x16_bf16 v[96:111], v[28:31], a[188:191], v[96:111]
    s_waitcnt lgkmcnt(2)
    v_mfma_f32_32x32x16_bf16 v[80:95], v[16:19], a[64:67], v[80:95]
    ds_read_b128 v[28:31], v10 offset:52224
    v_mfma_f32_32x32x16_bf16 v[96:111], v[16:19], a[192:195], v[96:111]
    s_waitcnt lgkmcnt(2)
    v_mfma_f32_32x32x16_bf16 v[80:95], v[20:23], a[68:71], v[80:95]
    ds_read_b128 v[16:19], v10 offset:53248
    v_mfma_f32_32x32x16_bf16 v[96:111], v[20:23], a[196:199], v[96:111]
    s_waitcnt lgkmcnt(2)
    v_mfma_f32_32x32x16_bf16 v[80:95], v[24:27], a[72:75], v[80:95]
    ds_read_b128 v[20:23], v10 offset:54272
    v_mfma_f32_32x32x16_bf16 v[96:111], v[24:27], a[200:203], v[96:111]
    s_waitcnt lgkmcnt(2)
    v_mfma_f32_32x32x16_bf16 v[80:95], v[28:31], a[76:79], v[80:95]
    ds_read_b128 v[24:27], v10 offset:55296
    v_mfma_f32_32x32x16_bf16 v[96:111], v[28:31], a[204:207], v[96:111]
    s_waitcnt lgkmcnt(2)
    v_mfma_f32_32x32x16_bf16 v[80:95], v[16:19], a[80:83], v[80:95]
    ds_read_b128 v[28:31], v10 offset:56320
    v_mfma_f32_32x32x16_bf16 v[96:111], v[16:19], a[208:211], v[96:111]
    s_waitcnt lgkmcnt(2)
    v_mfma_f32_32x32x16_bf16 v[80:95], v[20:23], a[84:87], v[80:95]
    ds_read_b128 v[16:19], v10 offset:57344
    v_mfma_f32_32x32x16_bf16 v[96:111], v[20:23], a[212:215], v[96:111]
    s_waitcnt lgkmcnt(2)
    v_mfma_f32_32x32x16_bf16 v[80:95], v[24:27], a[88:91], v[80:95]
    ds_read_b128 v[20:23], v10 offset:58368
    v_mfma_f32_32x32x16_bf16 v[96:111], v[24:27], a[216:219], v[96:111]
    s_waitcnt lgkmcnt(2)
    v_mfma_f32_32x32x16_bf16 v[80:95], v[28:31], a[92:95], v[80:95]
    ds_read_b128 v[24:27], v10 offset:59392
    v_mfma_f32_32x32x16_bf16 v[96:111], v[28:31], a[220:223], v[96:111]
    s_cmp_eq_u32 s74, 0
    s_cbranch_scc1 Ltight_186
    s_waitcnt vmcnt(13)
    s_barrier
    buffer_store_dword v117, v116, s[4:7], s72 offen sc1
Ltight_186_ret:
    v_add_u32 v117, 1, v117
    s_add_u32 s71, s71, 0x80000
    v_mov_b32 v6, v112
    v_mov_b32 v7, v113
    s_xor_b32 s70, s70, 0x10000
    s_waitcnt lgkmcnt(2)
    v_mfma_f32_32x32x16_bf16 v[80:95], v[16:19], a[96:99], v[80:95]
    ds_read_b128 v[28:31], v10 offset:60416
    s_add_u32 m0, s70, 0x0
    s_add_u32 s84, s73, s88
    buffer_load_dwordx4 v11, s[4:7], s84 offen lds
    v_mfma_f32_32x32x16_bf16 v[96:111], v[16:19], a[224:227], v[96:111]
    s_waitcnt lgkmcnt(2)
    v_mfma_f32_32x32x16_bf16 v[80:95], v[20:23], a[100:103], v[80:95]
    ds_read_b128 v[16:19], v10 offset:61440
    s_add_u32 m0, s70, 0x1000
    s_add_u32 s84, s73, s89
    buffer_load_dwordx4 v11, s[4:7], s84 offen lds
    v_mfma_f32_32x32x16_bf16 v[96:111], v[20:23], a[228:231], v[96:111]
    s_waitcnt lgkmcnt(2)
    v_mfma_f32_32x32x16_bf16 v[80:95], v[24:27], a[104:107], v[80:95]
    ds_read_b128 v[20:23], v10 offset:62464
    s_add_u32 m0, s70, 0x2000
    s_add_u32 s84, s73, s90
    buffer_load_dwordx4 v11, s[4:7], s84 offen lds
    v_mfma_f32_32x32x16_bf16 v[96:111], v[24:27], a[232:235], v[96:111]
    s_waitcnt lgkmcnt(2)
    v_mfma_f32_32x32x16_bf16 v[80:95], v[28:31], a[108:111], v[80:95]
    ds_read_b128 v[24:27], v10 offset:63488
    s_add_u32 m0, s70, 0x3000
    s_add_u32 s84, s73, s91
    buffer_load_dwordx4 v11, s[4:7], s84 offen lds
    v_mfma_f32_32x32x16_bf16 v[96:111], v[28:31], a[236:239], v[96:111]
    s_waitcnt lgkmcnt(2)
    v_mfma_f32_32x32x16_bf16 v[80:95], v[16:19], a[112:115], v[80:95]
    ds_read_b128 v[28:31], v10 offset:64512
    s_add_u32 m0, s70, 0x4000
    s_add_u32 s84, s73, s92
    buffer_load_dwordx4 v11, s[4:7], s84 offen lds
    v_mfma_f32_32x32x16_bf16 v[96:111], v[16:19], a[240:243], v[96:111]
    s_waitcnt lgkmcnt(2)
    v_mfma_f32_32x32x16_bf16 v[80:95], v[20:23], a[116:119], v[80:95]
    v_xor_b32 v10, 0x10000, v10
    ds_read_b128 v[16:19], v10 offset:0
    s_add_u32 m0, s70, 0x5000
    s_add_u32 s84, s73, s93
    buffer_load_dwordx4 v11, s[4:7], s84 offen lds
    v_mfma_f32_32x32x16_bf16 v[96:111], v[20:23], a[244:247], v[96:111]
    s_waitcnt lgkmcnt(2)
    v_mfma_f32_32x32x16_bf16 v[80:95], v[24:27], a[120:123], v[80:95]
    ds_read_b128 v[20:23], v10 offset:1024
    s_add_u32 m0, s70, 0x6000
    s_add_u32 s84, s73, s10
    buffer_load_dwordx4 v11, s[4:7], s84 offen lds
    v_mfma_f32_32x32x16_bf16 v[96:111], v[24:27], a[248:251], v[96:111]
    s_waitcnt lgkmcnt(2)
    v_mfma_f32_32x32x16_bf16 v[80:95], v[28:31], a[124:127], v[80:95]
    ds_read_b128 v[24:27], v10 offset:2048
    s_add_u32 m0, s70, 0x7000
    s_add_u32 s84, s73, s11
    buffer_load_dwordx4 v11, s[4:7], s84 offen lds
    v_mfma_f32_32x32x16_bf16 v[96:111], v[28:31], a[252:255], v[96:111]
    s_add_u32 s73, s73, 0x10000
    s_add_u32 s74, s74, 2
    s_cmp_lt_u32 s74, 32
    s_cbranch_scc1 L_p2v
    s_nop 11
    v_cvt_pk_bf16_f32 v32, v80, v81
    v_cvt_pk_bf16_f32 v33, v82, v83
    v_cvt_pk_bf16_f32 v34, v84, v85
    v_cvt_pk_bf16_f32 v35, v86, v87
    buffer_store_dwordx4 v[32:35], v6, s[4:7], s71 offen offset:0 sc1
    v_cvt_pk_bf16_f32 v36, v88, v89
    v_cvt_pk_bf16_f32 v37, v90, v91
    v_cvt_pk_bf16_f32 v38, v92, v93
    v_cvt_pk_bf16_f32 v39, v94, v95
    buffer_store_dwordx4 v[36:39], v7, s[4:7], s71 offen offset:0 sc1
    v_cvt_pk_bf16_f32 v40, v96, v97
    v_cvt_pk_bf16_f32 v41, v98, v99
    v_cvt_pk_bf16_f32 v42, v100, v101
    v_cvt_pk_bf16_f32 v43, v102, v103
    buffer_store_dwordx4 v[40:43], v6, s[4:7], s71 offen offset:2048 sc1
    v_cvt_pk_bf16_f32 v44, v104, v105
    v_cvt_pk_bf16_f32 v45, v106, v107
    v_cvt_pk_bf16_f32 v46, v108, v109
    v_cvt_pk_bf16_f32 v47, v110, v111
    buffer_store_dwordx4 v[44:47], v7, s[4:7], s71 offen offset:2048 sc1
    s_waitcnt vmcnt(0) lgkmcnt(0)
    s_barrier
    v_mov_b32 v117, 32
    buffer_store_dword v117, v116, s[4:7], s72 offen sc1
    s_branch L_p2_done
Ltight_186:
    s_waitcnt vmcnt(0)
    s_barrier
    v_mov_b32 v116, v118
    buffer_store_dword v9, v116, s[4:7], s72 offen sc1
    s_branch Ltight_186_ret
L_p2_skip:
Lwz_187:
    s_add_u32 s101, s101, 1
    s_cmp_gt_u32 s101, 0x400000
    s_cbranch_scc1 L_end
    v_mbcnt_lo_u32_b32 v117, -1, 0
    v_and_b32 v117, 7, v117
    v_lshlrev_b32 v117, 2, v117
    global_load_dword v116, v117, s[8:9] sc1
    s_waitcnt vmcnt(0)
    v_cmp_ne_u32 vcc, 1, v116
    s_cbranch_vccnz Lwz_187
    s_cmp_lg_u32 s56, 0
    s_cbranch_scc1 Lann_188
    s_lshr_b32 s3, s2, 3
    s_lshl_b32 s3, s3, 7
    s_and_b32 vcc_lo, s2, 7
    s_add_u32 s3, s3, vcc_lo
    s_add_u32 s3, s3, 0x2000
    v_mov_b32 v116, s3
    v_mov_b32 v117, s58
    s_mov_b64 exec, 1
    buffer_store_byte v117, v116, s[4:7], 0 offen sc1
    s_mov_b64 exec, -1
Lann_188:
    s_branch L_p2_done
L_p2_idle:
    v_lshrrev_b32 v12, 3, v1
    v_and_b32 v13, 7, v1
    s_lshl_b32 s78, s76, 16
    s_lshl_b32 s79, s56, 14
    s_add_u32 s78, s78, s79
    v_lshlrev_b32 v14, 10, v12
    v_lshl_add_u32 v14, v13, 4, v14
    v_add_u32 v14, s78, v14
    v_add_u32 v128, 0x2000, v14
    buffer_load_dwordx4 v[32:35], v14, s[28:31], 0 offen offset:0
    buffer_load_dwordx4 v[36:39], v14, s[28:31], 0 offen offset:128
    buffer_load_dwordx4 v[40:43], v14, s[28:31], 0 offen offset:256
    buffer_load_dwordx4 v[44:47], v14, s[28:31], 0 offen offset:384
    buffer_load_dwordx4 v[48:51], v14, s[28:31], 0 offen offset:512
    buffer_load_dwordx4 v[52:55], v14, s[28:31], 0 offen offset:640
    buffer_load_dwordx4 v[56:59], v14, s[28:31], 0 offen offset:768
    buffer_load_dwordx4 v[60:63], v14, s[28:31], 0 offen offset:896
    buffer_load_dwordx4 v[64:67], v128, s[28:31], 0 offen offset:0
    buffer_load_dwordx4 v[68:71], v128, s[28:31], 0 offen offset:128
    buffer_load_dwordx4 v[72:75], v128, s[28:31], 0 offen offset:256
    buffer_load_dwordx4 v[76:79], v128, s[28:31], 0 offen offset:384
    buffer_load_dwordx4 v[80:83], v128, s[28:31], 0 offen offset:512
    buffer_load_dwordx4 v[84:87], v128, s[28:31], 0 offen offset:640
    buffer_load_dwordx4 v[88:91], v128, s[28:31], 0 offen offset:768
    buffer_load_dwordx4 v[92:95], v128, s[28:31], 0 offen offset:896
    s_lshl_b32 s78, s76, 16
    s_lshr_b32 s79, s56, 1
    s_lshl_b32 s79, s79, 15
    s_add_u32 s78, s78, s79
    s_and_b32 s79, s56, 1
    s_lshl_b32 s79, s79, 8
    s_add_u32 s78, s78, s79
    s_add_u32 s78, s78, 0xc00000
    v_lshrrev_b32 v15, 1, v13
    v_lshlrev_b32 v15, 10, v15
    v_and_b32 v16, 1, v13
    v_lshl_add_u32 v15, v16, 9, v15
    v_lshl_add_u32 v15, v12, 4, v15
    v_mov_b32 v196, 0x7f817f81
    v_mov_b32 v197, 0x7f817f81
    v_mov_b32 v198, 0x7f817f81
    v_mov_b32 v199, 0x7f817f81
    v_mov_b32 v200, -1
    s_lshl_b32 s80, s76, 15
    s_lshl_b32 s81, s56, 13
    s_add_u32 s80, s80, s81
    s_add_u32 s80, s80, 0x200000
    s_add_u32 s81, s80, 0x1000
    s_lshl_b32 s82, s76, 10
    s_lshl_b32 s83, s56, 8
    s_add_u32 s82, s82, s83
    s_add_u32 s82, s82, 0x100000
    v_lshrrev_b32 v201, 2, v11
    s_waitcnt vmcnt(8)
    v_mov_b32 v16, 0x3f803f80
    v_mov_b32 v17, 0
    v_mov_b32 v18, 0
    v_mov_b32 v19, 0
    v_mov_b32 v20, 0
    v_dot2_f32_bf16 v18, v32, v16, v18
    v_dot2_f32_bf16 v20, v32, v32, v20
    v_dot2_f32_bf16 v17, v33, v16, v17
    v_dot2_f32_bf16 v19, v33, v33, v19
    v_dot2_f32_bf16 v18, v34, v16, v18
    v_dot2_f32_bf16 v20, v34, v34, v20
    v_dot2_f32_bf16 v17, v35, v16, v17
    v_dot2_f32_bf16 v19, v35, v35, v19
    v_dot2_f32_bf16 v18, v36, v16, v18
    v_dot2_f32_bf16 v20, v36, v36, v20
    v_dot2_f32_bf16 v17, v37, v16, v17
    v_dot2_f32_bf16 v19, v37, v37, v19
    v_dot2_f32_bf16 v18, v38, v16, v18
    v_dot2_f32_bf16 v20, v38, v38, v20
    v_dot2_f32_bf16 v17, v39, v16, v17
    v_dot2_f32_bf16 v19, v39, v39, v19
    v_dot2_f32_bf16 v18, v40, v16, v18
    v_dot2_f32_bf16 v20, v40, v40, v20
    v_dot2_f32_bf16 v17, v41, v16, v17
    v_dot2_f32_bf16 v19, v41, v41, v19
    v_dot2_f32_bf16 v18, v42, v16, v18
    v_dot2_f32_bf16 v20, v42, v42, v20
    v_dot2_f32_bf16 v17, v43, v16, v17
    v_dot2_f32_bf16 v19, v43, v43, v19
    v_dot2_f32_bf16 v18, v44, v16, v18
    v_dot2_f32_bf16 v20, v44, v44, v20
    v_dot2_f32_bf16 v17, v45, v16, v17
    v_dot2_f32_bf16 v19, v45, v45, v19
    v_dot2_f32_bf16 v18, v46, v16, v18
    v_dot2_f32_bf16 v20, v46, v46, v20
    v_dot2_f32_bf16 v17, v47, v16, v17
    v_dot2_f32_bf16 v19, v47, v47, v19
    v_dot2_f32_bf16 v18, v48, v16, v18
    v_dot2_f32_bf16 v20, v48, v48, v20
    v_dot2_f32_bf16 v17, v49, v16, v17
    v_dot2_f32_bf16 v19, v49, v49, v19
    v_dot2_f32_bf16 v18, v50, v16, v18
    v_dot2_f32_bf16 v20, v50, v50, v20
    v_dot2_f32_bf16 v17, v51, v16, v17
    v_dot2_f32_bf16 v19, v51, v51, v19
    v_dot2_f32_bf16 v18, v52, v16, v18
    v_dot2_f32_bf16 v20, v52, v52, v20
    v_dot2_f32_bf16 v17, v53, v16, v17
    v_dot2_f32_bf16 v19, v53, v53, v19
    v_dot2_f32_bf16 v18, v54, v16, v18
    v_dot2_f32_bf16 v20, v54, v54, v20
    v_dot2_f32_bf16 v17, v55, v16, v17
    v_dot2_f32_bf16 v19, v55, v55, v19
    v_dot2_f32_bf16 v18, v56, v16, v18
    v_dot2_f32_bf16 v20, v56, v56, v20
    v_dot2_f32_bf16 v17, v57, v16, v17
    v_dot2_f32_bf16 v19, v57, v57, v19
    v_dot2_f32_bf16 v18, v58, v16, v18
    v_dot2_f32_bf16 v20, v58, v58, v20
    v_dot2_f32_bf16 v17, v59, v16, v17
    v_dot2_f32_bf16 v19, v59, v59, v19
    v_dot2_f32_bf16 v18, v60, v16, v18
    v_dot2_f32_bf16 v20, v60, v60, v20
    v_dot2_f32_bf16 v17, v61, v16, v17
    v_dot2_f32_bf16 v19, v61, v61, v19
    v_dot2_f32_bf16 v18, v62, v16, v18
    v_dot2_f32_bf16 v20, v62, v62, v20
    v_dot2_f32_bf16 v17, v63, v16, v17
    v_dot2_f32_bf16 v19, v63, v63, v19
    s_nop 2
    v_add_f32 v17, v17, v18
    v_add_f32 v19, v19, v20
    s_nop 1
    v_add_f32_dpp v17, v17, v17 quad_perm:[1,0,3,2] row_mask:0xf bank_mask:0xf
    v_add_f32_dpp v19, v19, v19 quad_perm:[1,0,3,2] row_mask:0xf bank_mask:0xf
    s_nop 1
    v_add_f32_dpp v17, v17, v17 quad_perm:[2,3,0,1] row_mask:0xf bank_mask:0xf
    v_add_f32_dpp v19, v19, v19 quad_perm:[2,3,0,1] row_mask:0xf bank_mask:0xf
    s_nop 1
    v_add_f32_dpp v17, v17, v17 row_half_mirror row_mask:0xf bank_mask:0xf
    v_add_f32_dpp v19, v19, v19 row_half_mirror row_mask:0xf bank_mask:0xf
    v_mul_f32 v21, 0x3b000000, v17
    v_mul_f32 v22, 0x3b000000, v19
    v_fma_f32 v22, -v21, v21, v22
    v_max_f32 v22, 0, v22
    v_cvt_pk_bf16_f32 v22, v22, v21
    v_and_b32 v21, 0xffff0000, v22
    v_lshlrev_b32 v22, 16, v22
    v_add_f32 v22, 0x3727c5ac, v22
    v_cvt_pk_bf16_f32 v22, v22, v22
    v_lshlrev_b32 v22, 16, v22
    v_sqrt_f32 v22, v22
    s_nop 0
    v_cvt_pk_bf16_f32 v22, v22, v22
    v_lshlrev_b32 v22, 16, v22
    v_rcp_f32 v26, v22
    s_nop 0
    v_mov_b32 v27, v26
    v_lshlrev_b32 v28, 16, v32
    v_and_b32 v29, 0xffff0000, v32
    v_sub_f32 v28, v28, v21
    v_sub_f32 v29, v29, v21
    v_cvt_pk_bf16_f32 v29, v28, v29
    v_lshlrev_b32 v28, 16, v29
    v_and_b32 v29, 0xffff0000, v29
    v_pk_mul_f32 v[28:29], v[28:29], v[26:27]
    v_cvt_pk_bf16_f32 v132, v28, v29
    v_lshlrev_b32 v30, 16, v33
    v_and_b32 v31, 0xffff0000, v33
    v_sub_f32 v30, v30, v21
    v_sub_f32 v31, v31, v21
    v_cvt_pk_bf16_f32 v31, v30, v31
    v_lshlrev_b32 v30, 16, v31
    v_and_b32 v31, 0xffff0000, v31
    v_pk_mul_f32 v[30:31], v[30:31], v[26:27]
    v_cvt_pk_bf16_f32 v133, v30, v31
    v_lshlrev_b32 v28, 16, v34
    v_and_b32 v29, 0xffff0000, v34
    v_sub_f32 v28, v28, v21
    v_sub_f32 v29, v29, v21
    v_cvt_pk_bf16_f32 v29, v28, v29
    v_lshlrev_b32 v28, 16, v29
    v_and_b32 v29, 0xffff0000, v29
    v_pk_mul_f32 v[28:29], v[28:29], v[26:27]
    v_cvt_pk_bf16_f32 v134, v28, v29
    v_lshlrev_b32 v30, 16, v35
    v_and_b32 v31, 0xffff0000, v35
    v_sub_f32 v30, v30, v21
    v_sub_f32 v31, v31, v21
    v_cvt_pk_bf16_f32 v31, v30, v31
    v_lshlrev_b32 v30, 16, v31
    v_and_b32 v31, 0xffff0000, v31
    v_pk_mul_f32 v[30:31], v[30:31], v[26:27]
    v_cvt_pk_bf16_f32 v135, v30, v31
    v_lshlrev_b32 v28, 16, v36
    v_and_b32 v29, 0xffff0000, v36
    v_sub_f32 v28, v28, v21
    v_sub_f32 v29, v29, v21
    v_cvt_pk_bf16_f32 v29, v28, v29
    v_lshlrev_b32 v28, 16, v29
    v_and_b32 v29, 0xffff0000, v29
    v_pk_mul_f32 v[28:29], v[28:29], v[26:27]
    v_cvt_pk_bf16_f32 v136, v28, v29
    v_lshlrev_b32 v30, 16, v37
    v_and_b32 v31, 0xffff0000, v37
    v_sub_f32 v30, v30, v21
    v_sub_f32 v31, v31, v21
    v_cvt_pk_bf16_f32 v31, v30, v31
    v_lshlrev_b32 v30, 16, v31
    v_and_b32 v31, 0xffff0000, v31
    v_pk_mul_f32 v[30:31], v[30:31], v[26:27]
    v_cvt_pk_bf16_f32 v137, v30, v31
    v_lshlrev_b32 v28, 16, v38
    v_and_b32 v29, 0xffff0000, v38
    v_sub_f32 v28, v28, v21
    v_sub_f32 v29, v29, v21
    v_cvt_pk_bf16_f32 v29, v28, v29
    v_lshlrev_b32 v28, 16, v29
    v_and_b32 v29, 0xffff0000, v29
    v_pk_mul_f32 v[28:29], v[28:29], v[26:27]
    v_cvt_pk_bf16_f32 v138, v28, v29
    v_lshlrev_b32 v30, 16, v39
    v_and_b32 v31, 0xffff0000, v39
    v_sub_f32 v30, v30, v21
    v_sub_f32 v31, v31, v21
    v_cvt_pk_bf16_f32 v31, v30, v31
    v_lshlrev_b32 v30, 16, v31
    v_and_b32 v31, 0xffff0000, v31
    v_pk_mul_f32 v[30:31], v[30:31], v[26:27]
    v_cvt_pk_bf16_f32 v139, v30, v31
    v_lshlrev_b32 v28, 16, v40
    v_and_b32 v29, 0xffff0000, v40
    v_sub_f32 v28, v28, v21
    v_sub_f32 v29, v29, v21
    v_cvt_pk_bf16_f32 v29, v28, v29
    v_lshlrev_b32 v28, 16, v29
    v_and_b32 v29, 0xffff0000, v29
    v_pk_mul_f32 v[28:29], v[28:29], v[26:27]
    v_cvt_pk_bf16_f32 v140, v28, v29
    v_lshlrev_b32 v30, 16, v41
    v_and_b32 v31, 0xffff0000, v41
    v_sub_f32 v30, v30, v21
    v_sub_f32 v31, v31, v21
    v_cvt_pk_bf16_f32 v31, v30, v31
    v_lshlrev_b32 v30, 16, v31
    v_and_b32 v31, 0xffff0000, v31
    v_pk_mul_f32 v[30:31], v[30:31], v[26:27]
    v_cvt_pk_bf16_f32 v141, v30, v31
    v_lshlrev_b32 v28, 16, v42
    v_and_b32 v29, 0xffff0000, v42
    v_sub_f32 v28, v28, v21
    v_sub_f32 v29, v29, v21
    v_cvt_pk_bf16_f32 v29, v28, v29
    v_lshlrev_b32 v28, 16, v29
    v_and_b32 v29, 0xffff0000, v29
    v_pk_mul_f32 v[28:29], v[28:29], v[26:27]
    v_cvt_pk_bf16_f32 v142, v28, v29
    v_lshlrev_b32 v30, 16, v43
    v_and_b32 v31, 0xffff0000, v43
    v_sub_f32 v30, v30, v21
    v_sub_f32 v31, v31, v21
    v_cvt_pk_bf16_f32 v31, v30, v31
    v_lshlrev_b32 v30, 16, v31
    v_and_b32 v31, 0xffff0000, v31
    v_pk_mul_f32 v[30:31], v[30:31], v[26:27]
    v_cvt_pk_bf16_f32 v143, v30, v31
    v_lshlrev_b32 v28, 16, v44
    v_and_b32 v29, 0xffff0000, v44
    v_sub_f32 v28, v28, v21
    v_sub_f32 v29, v29, v21
    v_cvt_pk_bf16_f32 v29, v28, v29
    v_lshlrev_b32 v28, 16, v29
    v_and_b32 v29, 0xffff0000, v29
    v_pk_mul_f32 v[28:29], v[28:29], v[26:27]
    v_cvt_pk_bf16_f32 v144, v28, v29
    v_lshlrev_b32 v30, 16, v45
    v_and_b32 v31, 0xffff0000, v45
    v_sub_f32 v30, v30, v21
    v_sub_f32 v31, v31, v21
    v_cvt_pk_bf16_f32 v31, v30, v31
    v_lshlrev_b32 v30, 16, v31
    v_and_b32 v31, 0xffff0000, v31
    v_pk_mul_f32 v[30:31], v[30:31], v[26:27]
    v_cvt_pk_bf16_f32 v145, v30, v31
    v_lshlrev_b32 v28, 16, v46
    v_and_b32 v29, 0xffff0000, v46
    v_sub_f32 v28, v28, v21
    v_sub_f32 v29, v29, v21
    v_cvt_pk_bf16_f32 v29, v28, v29
    v_lshlrev_b32 v28, 16, v29
    v_and_b32 v29, 0xffff0000, v29
    v_pk_mul_f32 v[28:29], v[28:29], v[26:27]
    v_cvt_pk_bf16_f32 v146, v28, v29
    v_lshlrev_b32 v30, 16, v47
    v_and_b32 v31, 0xffff0000, v47
    v_sub_f32 v30, v30, v21
    v_sub_f32 v31, v31, v21
    v_cvt_pk_bf16_f32 v31, v30, v31
    v_lshlrev_b32 v30, 16, v31
    v_and_b32 v31, 0xffff0000, v31
    v_pk_mul_f32 v[30:31], v[30:31], v[26:27]
    v_cvt_pk_bf16_f32 v147, v30, v31
    v_lshlrev_b32 v28, 16, v48
    v_and_b32 v29, 0xffff0000, v48
    v_sub_f32 v28, v28, v21
    v_sub_f32 v29, v29, v21
    v_cvt_pk_bf16_f32 v29, v28, v29
    v_lshlrev_b32 v28, 16, v29
    v_and_b32 v29, 0xffff0000, v29
    v_pk_mul_f32 v[28:29], v[28:29], v[26:27]
    v_cvt_pk_bf16_f32 v148, v28, v29
    v_lshlrev_b32 v30, 16, v49
    v_and_b32 v31, 0xffff0000, v49
    v_sub_f32 v30, v30, v21
    v_sub_f32 v31, v31, v21
    v_cvt_pk_bf16_f32 v31, v30, v31
    v_lshlrev_b32 v30, 16, v31
    v_and_b32 v31, 0xffff0000, v31
    v_pk_mul_f32 v[30:31], v[30:31], v[26:27]
    v_cvt_pk_bf16_f32 v149, v30, v31
    v_lshlrev_b32 v28, 16, v50
    v_and_b32 v29, 0xffff0000, v50
    v_sub_f32 v28, v28, v21
    v_sub_f32 v29, v29, v21
    v_cvt_pk_bf16_f32 v29, v28, v29
    v_lshlrev_b32 v28, 16, v29
    v_and_b32 v29, 0xffff0000, v29
    v_pk_mul_f32 v[28:29], v[28:29], v[26:27]
    v_cvt_pk_bf16_f32 v150, v28, v29
    v_lshlrev_b32 v30, 16, v51
    v_and_b32 v31, 0xffff0000, v51
    v_sub_f32 v30, v30, v21
    v_sub_f32 v31, v31, v21
    v_cvt_pk_bf16_f32 v31, v30, v31
    v_lshlrev_b32 v30, 16, v31
    v_and_b32 v31, 0xffff0000, v31
    v_pk_mul_f32 v[30:31], v[30:31], v[26:27]
    v_cvt_pk_bf16_f32 v151, v30, v31
    v_lshlrev_b32 v28, 16, v52
    v_and_b32 v29, 0xffff0000, v52
    v_sub_f32 v28, v28, v21
    v_sub_f32 v29, v29, v21
    v_cvt_pk_bf16_f32 v29, v28, v29
    v_lshlrev_b32 v28, 16, v29
    v_and_b32 v29, 0xffff0000, v29
    v_pk_mul_f32 v[28:29], v[28:29], v[26:27]
    v_cvt_pk_bf16_f32 v152, v28, v29
    v_lshlrev_b32 v30, 16, v53
    v_and_b32 v31, 0xffff0000, v53
    v_sub_f32 v30, v30, v21
    v_sub_f32 v31, v31, v21
    v_cvt_pk_bf16_f32 v31, v30, v31
    v_lshlrev_b32 v30, 16, v31
    v_and_b32 v31, 0xffff0000, v31
    v_pk_mul_f32 v[30:31], v[30:31], v[26:27]
    v_cvt_pk_bf16_f32 v153, v30, v31
    v_lshlrev_b32 v28, 16, v54
    v_and_b32 v29, 0xffff0000, v54
    v_sub_f32 v28, v28, v21
    v_sub_f32 v29, v29, v21
    v_cvt_pk_bf16_f32 v29, v28, v29
    v_lshlrev_b32 v28, 16, v29
    v_and_b32 v29, 0xffff0000, v29
    v_pk_mul_f32 v[28:29], v[28:29], v[26:27]
    v_cvt_pk_bf16_f32 v154, v28, v29
    v_lshlrev_b32 v30, 16, v55
    v_and_b32 v31, 0xffff0000, v55
    v_sub_f32 v30, v30, v21
    v_sub_f32 v31, v31, v21
    v_cvt_pk_bf16_f32 v31, v30, v31
    v_lshlrev_b32 v30, 16, v31
    v_and_b32 v31, 0xffff0000, v31
    v_pk_mul_f32 v[30:31], v[30:31], v[26:27]
    v_cvt_pk_bf16_f32 v155, v30, v31
    v_lshlrev_b32 v28, 16, v56
    v_and_b32 v29, 0xffff0000, v56
    v_sub_f32 v28, v28, v21
    v_sub_f32 v29, v29, v21
    v_cvt_pk_bf16_f32 v29, v28, v29
    v_lshlrev_b32 v28, 16, v29
    v_and_b32 v29, 0xffff0000, v29
    v_pk_mul_f32 v[28:29], v[28:29], v[26:27]
    v_cvt_pk_bf16_f32 v156, v28, v29
    v_lshlrev_b32 v30, 16, v57
    v_and_b32 v31, 0xffff0000, v57
    v_sub_f32 v30, v30, v21
    v_sub_f32 v31, v31, v21
    v_cvt_pk_bf16_f32 v31, v30, v31
    v_lshlrev_b32 v30, 16, v31
    v_and_b32 v31, 0xffff0000, v31
    v_pk_mul_f32 v[30:31], v[30:31], v[26:27]
    v_cvt_pk_bf16_f32 v157, v30, v31
    v_lshlrev_b32 v28, 16, v58
    v_and_b32 v29, 0xffff0000, v58
    v_sub_f32 v28, v28, v21
    v_sub_f32 v29, v29, v21
    v_cvt_pk_bf16_f32 v29, v28, v29
    v_lshlrev_b32 v28, 16, v29
    v_and_b32 v29, 0xffff0000, v29
    v_pk_mul_f32 v[28:29], v[28:29], v[26:27]
    v_cvt_pk_bf16_f32 v158, v28, v29
    v_lshlrev_b32 v30, 16, v59
    v_and_b32 v31, 0xffff0000, v59
    v_sub_f32 v30, v30, v21
    v_sub_f32 v31, v31, v21
    v_cvt_pk_bf16_f32 v31, v30, v31
    v_lshlrev_b32 v30, 16, v31
    v_and_b32 v31, 0xffff0000, v31
    v_pk_mul_f32 v[30:31], v[30:31], v[26:27]
    v_cvt_pk_bf16_f32 v159, v30, v31
    v_lshlrev_b32 v28, 16, v60
    v_and_b32 v29, 0xffff0000, v60
    v_sub_f32 v28, v28, v21
    v_sub_f32 v29, v29, v21
    v_cvt_pk_bf16_f32 v29, v28, v29
    v_lshlrev_b32 v28, 16, v29
    v_and_b32 v29, 0xffff0000, v29
    v_pk_mul_f32 v[28:29], v[28:29], v[26:27]
    v_cvt_pk_bf16_f32 v160, v28, v29
    v_lshlrev_b32 v30, 16, v61
    v_and_b32 v31, 0xffff0000, v61
    v_sub_f32 v30, v30, v21
    v_sub_f32 v31, v31, v21
    v_cvt_pk_bf16_f32 v31, v30, v31
    v_lshlrev_b32 v30, 16, v31
    v_and_b32 v31, 0xffff0000, v31
    v_pk_mul_f32 v[30:31], v[30:31], v[26:27]
    v_cvt_pk_bf16_f32 v161, v30, v31
    v_lshlrev_b32 v28, 16, v62
    v_and_b32 v29, 0xffff0000, v62
    v_sub_f32 v28, v28, v21
    v_sub_f32 v29, v29, v21
    v_cvt_pk_bf16_f32 v29, v28, v29
    v_lshlrev_b32 v28, 16, v29
    v_and_b32 v29, 0xffff0000, v29
    v_pk_mul_f32 v[28:29], v[28:29], v[26:27]
    v_cvt_pk_bf16_f32 v162, v28, v29
    v_lshlrev_b32 v30, 16, v63
    v_and_b32 v31, 0xffff0000, v63
    v_sub_f32 v30, v30, v21
    v_sub_f32 v31, v31, v21
    v_cvt_pk_bf16_f32 v31, v30, v31
    v_lshlrev_b32 v30, 16, v31
    v_and_b32 v31, 0xffff0000, v31
    v_pk_mul_f32 v[30:31], v[30:31], v[26:27]
    v_cvt_pk_bf16_f32 v163, v30, v31
    s_add_u32 s79, s78, 0
    buffer_store_dwordx4 v[132:135], v15, s[4:7], s79 offen offset:0 sc1
    s_add_u32 s79, s78, 4096
    buffer_store_dwordx4 v[136:139], v15, s[4:7], s79 offen offset:0 sc1
    s_add_u32 s79, s78, 8192
    buffer_store_dwordx4 v[140:143], v15, s[4:7], s79 offen offset:0 sc1
    s_add_u32 s79, s78, 12288
    buffer_store_dwordx4 v[144:147], v15, s[4:7], s79 offen offset:0 sc1
    s_add_u32 s79, s78, 16384
    buffer_store_dwordx4 v[148:151], v15, s[4:7], s79 offen offset:0 sc1
    s_add_u32 s79, s78, 20480
    buffer_store_dwordx4 v[152:155], v15, s[4:7], s79 offen offset:0 sc1
    s_add_u32 s79, s78, 24576
    buffer_store_dwordx4 v[156:159], v15, s[4:7], s79 offen offset:0 sc1
    s_add_u32 s79, s78, 28672
    buffer_store_dwordx4 v[160:163], v15, s[4:7], s79 offen offset:0 sc1
    s_waitcnt vmcnt(8)
    v_mov_b32 v16, 0x3f803f80
    v_mov_b32 v17, 0
    v_mov_b32 v18, 0
    v_mov_b32 v19, 0
    v_mov_b32 v20, 0
    v_dot2_f32_bf16 v18, v64, v16, v18
    v_dot2_f32_bf16 v20, v64, v64, v20
    v_dot2_f32_bf16 v17, v65, v16, v17
    v_dot2_f32_bf16 v19, v65, v65, v19
    v_dot2_f32_bf16 v18, v66, v16, v18
    v_dot2_f32_bf16 v20, v66, v66, v20
    v_dot2_f32_bf16 v17, v67, v16, v17
    v_dot2_f32_bf16 v19, v67, v67, v19
    v_dot2_f32_bf16 v18, v68, v16, v18
    v_dot2_f32_bf16 v20, v68, v68, v20
    v_dot2_f32_bf16 v17, v69, v16, v17
    v_dot2_f32_bf16 v19, v69, v69, v19
    v_dot2_f32_bf16 v18, v70, v16, v18
    v_dot2_f32_bf16 v20, v70, v70, v20
    v_dot2_f32_bf16 v17, v71, v16, v17
    v_dot2_f32_bf16 v19, v71, v71, v19
    v_dot2_f32_bf16 v18, v72, v16, v18
    v_dot2_f32_bf16 v20, v72, v72, v20
    v_dot2_f32_bf16 v17, v73, v16, v17
    v_dot2_f32_bf16 v19, v73, v73, v19
    v_dot2_f32_bf16 v18, v74, v16, v18
    v_dot2_f32_bf16 v20, v74, v74, v20
    v_dot2_f32_bf16 v17, v75, v16, v17
    v_dot2_f32_bf16 v19, v75, v75, v19
    v_dot2_f32_bf16 v18, v76, v16, v18
    v_dot2_f32_bf16 v20, v76, v76, v20
    v_dot2_f32_bf16 v17, v77, v16, v17
    v_dot2_f32_bf16 v19, v77, v77, v19
    v_dot2_f32_bf16 v18, v78, v16, v18
    v_dot2_f32_bf16 v20, v78, v78, v20
    v_dot2_f32_bf16 v17, v79, v16, v17
    v_dot2_f32_bf16 v19, v79, v79, v19
    v_dot2_f32_bf16 v18, v80, v16, v18
    v_dot2_f32_bf16 v20, v80, v80, v20
    v_dot2_f32_bf16 v17, v81, v16, v17
    v_dot2_f32_bf16 v19, v81, v81, v19
    v_dot2_f32_bf16 v18, v82, v16, v18
    v_dot2_f32_bf16 v20, v82, v82, v20
    v_dot2_f32_bf16 v17, v83, v16, v17
    v_dot2_f32_bf16 v19, v83, v83, v19
    v_dot2_f32_bf16 v18, v84, v16, v18
    v_dot2_f32_bf16 v20, v84, v84, v20
    v_dot2_f32_bf16 v17, v85, v16, v17
    v_dot2_f32_bf16 v19, v85, v85, v19
    v_dot2_f32_bf16 v18, v86, v16, v18
    v_dot2_f32_bf16 v20, v86, v86, v20
    v_dot2_f32_bf16 v17, v87, v16, v17
    v_dot2_f32_bf16 v19, v87, v87, v19
    v_dot2_f32_bf16 v18, v88, v16, v18
    v_dot2_f32_bf16 v20, v88, v88, v20
    v_dot2_f32_bf16 v17, v89, v16, v17
    v_dot2_f32_bf16 v19, v89, v89, v19
    v_dot2_f32_bf16 v18, v90, v16, v18
    v_dot2_f32_bf16 v20, v90, v90, v20
    v_dot2_f32_bf16 v17, v91, v16, v17
    v_dot2_f32_bf16 v19, v91, v91, v19
    v_dot2_f32_bf16 v18, v92, v16, v18
    v_dot2_f32_bf16 v20, v92, v92, v20
    v_dot2_f32_bf16 v17, v93, v16, v17
    v_dot2_f32_bf16 v19, v93, v93, v19
    v_dot2_f32_bf16 v18, v94, v16, v18
    v_dot2_f32_bf16 v20, v94, v94, v20
    v_dot2_f32_bf16 v17, v95, v16, v17
    v_dot2_f32_bf16 v19, v95, v95, v19
    s_nop 2
    v_add_f32 v17, v17, v18
    v_add_f32 v19, v19, v20
    s_nop 1
    v_add_f32_dpp v17, v17, v17 quad_perm:[1,0,3,2] row_mask:0xf bank_mask:0xf
    v_add_f32_dpp v19, v19, v19 quad_perm:[1,0,3,2] row_mask:0xf bank_mask:0xf
    s_nop 1
    v_add_f32_dpp v17, v17, v17 quad_perm:[2,3,0,1] row_mask:0xf bank_mask:0xf
    v_add_f32_dpp v19, v19, v19 quad_perm:[2,3,0,1] row_mask:0xf bank_mask:0xf
    s_nop 1
    v_add_f32_dpp v17, v17, v17 row_half_mirror row_mask:0xf bank_mask:0xf
    v_add_f32_dpp v19, v19, v19 row_half_mirror row_mask:0xf bank_mask:0xf
    v_mul_f32 v21, 0x3b000000, v17
    v_mul_f32 v22, 0x3b000000, v19
    v_fma_f32 v22, -v21, v21, v22
    v_max_f32 v22, 0, v22
    v_cvt_pk_bf16_f32 v22, v22, v21
    v_and_b32 v21, 0xffff0000, v22
    v_lshlrev_b32 v22, 16, v22
    v_add_f32 v22, 0x3727c5ac, v22
    v_cvt_pk_bf16_f32 v22, v22, v22
    v_lshlrev_b32 v22, 16, v22
    v_sqrt_f32 v22, v22
    s_nop 0
    v_cvt_pk_bf16_f32 v22, v22, v22
    v_lshlrev_b32 v22, 16, v22
    v_rcp_f32 v26, v22
    s_nop 0
    v_mov_b32 v27, v26
    v_lshlrev_b32 v28, 16, v64
    v_and_b32 v29, 0xffff0000, v64
    v_sub_f32 v28, v28, v21
    v_sub_f32 v29, v29, v21
    v_cvt_pk_bf16_f32 v29, v28, v29
    v_lshlrev_b32 v28, 16, v29
    v_and_b32 v29, 0xffff0000, v29
    v_pk_mul_f32 v[28:29], v[28:29], v[26:27]
    v_cvt_pk_bf16_f32 v164, v28, v29
    v_lshlrev_b32 v30, 16, v65
    v_and_b32 v31, 0xffff0000, v65
    v_sub_f32 v30, v30, v21
    v_sub_f32 v31, v31, v21
    v_cvt_pk_bf16_f32 v31, v30, v31
    v_lshlrev_b32 v30, 16, v31
    v_and_b32 v31, 0xffff0000, v31
    v_pk_mul_f32 v[30:31], v[30:31], v[26:27]
    v_cvt_pk_bf16_f32 v165, v30, v31
    v_lshlrev_b32 v28, 16, v66
    v_and_b32 v29, 0xffff0000, v66
    v_sub_f32 v28, v28, v21
    v_sub_f32 v29, v29, v21
    v_cvt_pk_bf16_f32 v29, v28, v29
    v_lshlrev_b32 v28, 16, v29
    v_and_b32 v29, 0xffff0000, v29
    v_pk_mul_f32 v[28:29], v[28:29], v[26:27]
    v_cvt_pk_bf16_f32 v166, v28, v29
    v_lshlrev_b32 v30, 16, v67
    v_and_b32 v31, 0xffff0000, v67
    v_sub_f32 v30, v30, v21
    v_sub_f32 v31, v31, v21
    v_cvt_pk_bf16_f32 v31, v30, v31
    v_lshlrev_b32 v30, 16, v31
    v_and_b32 v31, 0xffff0000, v31
    v_pk_mul_f32 v[30:31], v[30:31], v[26:27]
    v_cvt_pk_bf16_f32 v167, v30, v31
    v_lshlrev_b32 v28, 16, v68
    v_and_b32 v29, 0xffff0000, v68
    v_sub_f32 v28, v28, v21
    v_sub_f32 v29, v29, v21
    v_cvt_pk_bf16_f32 v29, v28, v29
    v_lshlrev_b32 v28, 16, v29
    v_and_b32 v29, 0xffff0000, v29
    v_pk_mul_f32 v[28:29], v[28:29], v[26:27]
    v_cvt_pk_bf16_f32 v168, v28, v29
    v_lshlrev_b32 v30, 16, v69
    v_and_b32 v31, 0xffff0000, v69
    v_sub_f32 v30, v30, v21
    v_sub_f32 v31, v31, v21
    v_cvt_pk_bf16_f32 v31, v30, v31
    v_lshlrev_b32 v30, 16, v31
    v_and_b32 v31, 0xffff0000, v31
    v_pk_mul_f32 v[30:31], v[30:31], v[26:27]
    v_cvt_pk_bf16_f32 v169, v30, v31
    v_lshlrev_b32 v28, 16, v70
    v_and_b32 v29, 0xffff0000, v70
    v_sub_f32 v28, v28, v21
    v_sub_f32 v29, v29, v21
    v_cvt_pk_bf16_f32 v29, v28, v29
    v_lshlrev_b32 v28, 16, v29
    v_and_b32 v29, 0xffff0000, v29
    v_pk_mul_f32 v[28:29], v[28:29], v[26:27]
    v_cvt_pk_bf16_f32 v170, v28, v29
    v_lshlrev_b32 v30, 16, v71
    v_and_b32 v31, 0xffff0000, v71
    v_sub_f32 v30, v30, v21
    v_sub_f32 v31, v31, v21
    v_cvt_pk_bf16_f32 v31, v30, v31
    v_lshlrev_b32 v30, 16, v31
    v_and_b32 v31, 0xffff0000, v31
    v_pk_mul_f32 v[30:31], v[30:31], v[26:27]
    v_cvt_pk_bf16_f32 v171, v30, v31
    v_lshlrev_b32 v28, 16, v72
    v_and_b32 v29, 0xffff0000, v72
    v_sub_f32 v28, v28, v21
    v_sub_f32 v29, v29, v21
    v_cvt_pk_bf16_f32 v29, v28, v29
    v_lshlrev_b32 v28, 16, v29
    v_and_b32 v29, 0xffff0000, v29
    v_pk_mul_f32 v[28:29], v[28:29], v[26:27]
    v_cvt_pk_bf16_f32 v172, v28, v29
    v_lshlrev_b32 v30, 16, v73
    v_and_b32 v31, 0xffff0000, v73
    v_sub_f32 v30, v30, v21
    v_sub_f32 v31, v31, v21
    v_cvt_pk_bf16_f32 v31, v30, v31
    v_lshlrev_b32 v30, 16, v31
    v_and_b32 v31, 0xffff0000, v31
    v_pk_mul_f32 v[30:31], v[30:31], v[26:27]
    v_cvt_pk_bf16_f32 v173, v30, v31
    v_lshlrev_b32 v28, 16, v74
    v_and_b32 v29, 0xffff0000, v74
    v_sub_f32 v28, v28, v21
    v_sub_f32 v29, v29, v21
    v_cvt_pk_bf16_f32 v29, v28, v29
    v_lshlrev_b32 v28, 16, v29
    v_and_b32 v29, 0xffff0000, v29
    v_pk_mul_f32 v[28:29], v[28:29], v[26:27]
    v_cvt_pk_bf16_f32 v174, v28, v29
    v_lshlrev_b32 v30, 16, v75
    v_and_b32 v31, 0xffff0000, v75
    v_sub_f32 v30, v30, v21
    v_sub_f32 v31, v31, v21
    v_cvt_pk_bf16_f32 v31, v30, v31
    v_lshlrev_b32 v30, 16, v31
    v_and_b32 v31, 0xffff0000, v31
    v_pk_mul_f32 v[30:31], v[30:31], v[26:27]
    v_cvt_pk_bf16_f32 v175, v30, v31
    v_lshlrev_b32 v28, 16, v76
    v_and_b32 v29, 0xffff0000, v76
    v_sub_f32 v28, v28, v21
    v_sub_f32 v29, v29, v21
    v_cvt_pk_bf16_f32 v29, v28, v29
    v_lshlrev_b32 v28, 16, v29
    v_and_b32 v29, 0xffff0000, v29
    v_pk_mul_f32 v[28:29], v[28:29], v[26:27]
    v_cvt_pk_bf16_f32 v176, v28, v29
    v_lshlrev_b32 v30, 16, v77
    v_and_b32 v31, 0xffff0000, v77
    v_sub_f32 v30, v30, v21
    v_sub_f32 v31, v31, v21
    v_cvt_pk_bf16_f32 v31, v30, v31
    v_lshlrev_b32 v30, 16, v31
    v_and_b32 v31, 0xffff0000, v31
    v_pk_mul_f32 v[30:31], v[30:31], v[26:27]
    v_cvt_pk_bf16_f32 v177, v30, v31
    v_lshlrev_b32 v28, 16, v78
    v_and_b32 v29, 0xffff0000, v78
    v_sub_f32 v28, v28, v21
    v_sub_f32 v29, v29, v21
    v_cvt_pk_bf16_f32 v29, v28, v29
    v_lshlrev_b32 v28, 16, v29
    v_and_b32 v29, 0xffff0000, v29
    v_pk_mul_f32 v[28:29], v[28:29], v[26:27]
    v_cvt_pk_bf16_f32 v178, v28, v29
    v_lshlrev_b32 v30, 16, v79
    v_and_b32 v31, 0xffff0000, v79
    v_sub_f32 v30, v30, v21
    v_sub_f32 v31, v31, v21
    v_cvt_pk_bf16_f32 v31, v30, v31
    v_lshlrev_b32 v30, 16, v31
    v_and_b32 v31, 0xffff0000, v31
    v_pk_mul_f32 v[30:31], v[30:31], v[26:27]
    v_cvt_pk_bf16_f32 v179, v30, v31
    v_lshlrev_b32 v28, 16, v80
    v_and_b32 v29, 0xffff0000, v80
    v_sub_f32 v28, v28, v21
    v_sub_f32 v29, v29, v21
    v_cvt_pk_bf16_f32 v29, v28, v29
    v_lshlrev_b32 v28, 16, v29
    v_and_b32 v29, 0xffff0000, v29
    v_pk_mul_f32 v[28:29], v[28:29], v[26:27]
    v_cvt_pk_bf16_f32 v180, v28, v29
    v_lshlrev_b32 v30, 16, v81
    v_and_b32 v31, 0xffff0000, v81
    v_sub_f32 v30, v30, v21
    v_sub_f32 v31, v31, v21
    v_cvt_pk_bf16_f32 v31, v30, v31
    v_lshlrev_b32 v30, 16, v31
    v_and_b32 v31, 0xffff0000, v31
    v_pk_mul_f32 v[30:31], v[30:31], v[26:27]
    v_cvt_pk_bf16_f32 v181, v30, v31
    v_lshlrev_b32 v28, 16, v82
    v_and_b32 v29, 0xffff0000, v82
    v_sub_f32 v28, v28, v21
    v_sub_f32 v29, v29, v21
    v_cvt_pk_bf16_f32 v29, v28, v29
    v_lshlrev_b32 v28, 16, v29
    v_and_b32 v29, 0xffff0000, v29
    v_pk_mul_f32 v[28:29], v[28:29], v[26:27]
    v_cvt_pk_bf16_f32 v182, v28, v29
    v_lshlrev_b32 v30, 16, v83
    v_and_b32 v31, 0xffff0000, v83
    v_sub_f32 v30, v30, v21
    v_sub_f32 v31, v31, v21
    v_cvt_pk_bf16_f32 v31, v30, v31
    v_lshlrev_b32 v30, 16, v31
    v_and_b32 v31, 0xffff0000, v31
    v_pk_mul_f32 v[30:31], v[30:31], v[26:27]
    v_cvt_pk_bf16_f32 v183, v30, v31
    v_lshlrev_b32 v28, 16, v84
    v_and_b32 v29, 0xffff0000, v84
    v_sub_f32 v28, v28, v21
    v_sub_f32 v29, v29, v21
    v_cvt_pk_bf16_f32 v29, v28, v29
    v_lshlrev_b32 v28, 16, v29
    v_and_b32 v29, 0xffff0000, v29
    v_pk_mul_f32 v[28:29], v[28:29], v[26:27]
    v_cvt_pk_bf16_f32 v184, v28, v29
    v_lshlrev_b32 v30, 16, v85
    v_and_b32 v31, 0xffff0000, v85
    v_sub_f32 v30, v30, v21
    v_sub_f32 v31, v31, v21
    v_cvt_pk_bf16_f32 v31, v30, v31
    v_lshlrev_b32 v30, 16, v31
    v_and_b32 v31, 0xffff0000, v31
    v_pk_mul_f32 v[30:31], v[30:31], v[26:27]
    v_cvt_pk_bf16_f32 v185, v30, v31
    v_lshlrev_b32 v28, 16, v86
    v_and_b32 v29, 0xffff0000, v86
    v_sub_f32 v28, v28, v21
    v_sub_f32 v29, v29, v21
    v_cvt_pk_bf16_f32 v29, v28, v29
    v_lshlrev_b32 v28, 16, v29
    v_and_b32 v29, 0xffff0000, v29
    v_pk_mul_f32 v[28:29], v[28:29], v[26:27]
    v_cvt_pk_bf16_f32 v186, v28, v29
    v_lshlrev_b32 v30, 16, v87
    v_and_b32 v31, 0xffff0000, v87
    v_sub_f32 v30, v30, v21
    v_sub_f32 v31, v31, v21
    v_cvt_pk_bf16_f32 v31, v30, v31
    v_lshlrev_b32 v30, 16, v31
    v_and_b32 v31, 0xffff0000, v31
    v_pk_mul_f32 v[30:31], v[30:31], v[26:27]
    v_cvt_pk_bf16_f32 v187, v30, v31
    v_lshlrev_b32 v28, 16, v88
    v_and_b32 v29, 0xffff0000, v88
    v_sub_f32 v28, v28, v21
    v_sub_f32 v29, v29, v21
    v_cvt_pk_bf16_f32 v29, v28, v29
    v_lshlrev_b32 v28, 16, v29
    v_and_b32 v29, 0xffff0000, v29
    v_pk_mul_f32 v[28:29], v[28:29], v[26:27]
    v_cvt_pk_bf16_f32 v188, v28, v29
    v_lshlrev_b32 v30, 16, v89
    v_and_b32 v31, 0xffff0000, v89
    v_sub_f32 v30, v30, v21
    v_sub_f32 v31, v31, v21
    v_cvt_pk_bf16_f32 v31, v30, v31
    v_lshlrev_b32 v30, 16, v31
    v_and_b32 v31, 0xffff0000, v31
    v_pk_mul_f32 v[30:31], v[30:31], v[26:27]
    v_cvt_pk_bf16_f32 v189, v30, v31
    v_lshlrev_b32 v28, 16, v90
    v_and_b32 v29, 0xffff0000, v90
    v_sub_f32 v28, v28, v21
    v_sub_f32 v29, v29, v21
    v_cvt_pk_bf16_f32 v29, v28, v29
    v_lshlrev_b32 v28, 16, v29
    v_and_b32 v29, 0xffff0000, v29
    v_pk_mul_f32 v[28:29], v[28:29], v[26:27]
    v_cvt_pk_bf16_f32 v190, v28, v29
    v_lshlrev_b32 v30, 16, v91
    v_and_b32 v31, 0xffff0000, v91
    v_sub_f32 v30, v30, v21
    v_sub_f32 v31, v31, v21
    v_cvt_pk_bf16_f32 v31, v30, v31
    v_lshlrev_b32 v30, 16, v31
    v_and_b32 v31, 0xffff0000, v31
    v_pk_mul_f32 v[30:31], v[30:31], v[26:27]
    v_cvt_pk_bf16_f32 v191, v30, v31
    v_lshlrev_b32 v28, 16, v92
    v_and_b32 v29, 0xffff0000, v92
    v_sub_f32 v28, v28, v21
    v_sub_f32 v29, v29, v21
    v_cvt_pk_bf16_f32 v29, v28, v29
    v_lshlrev_b32 v28, 16, v29
    v_and_b32 v29, 0xffff0000, v29
    v_pk_mul_f32 v[28:29], v[28:29], v[26:27]
    v_cvt_pk_bf16_f32 v192, v28, v29
    v_lshlrev_b32 v30, 16, v93
    v_and_b32 v31, 0xffff0000, v93
    v_sub_f32 v30, v30, v21
    v_sub_f32 v31, v31, v21
    v_cvt_pk_bf16_f32 v31, v30, v31
    v_lshlrev_b32 v30, 16, v31
    v_and_b32 v31, 0xffff0000, v31
    v_pk_mul_f32 v[30:31], v[30:31], v[26:27]
    v_cvt_pk_bf16_f32 v193, v30, v31
    v_lshlrev_b32 v28, 16, v94
    v_and_b32 v29, 0xffff0000, v94
    v_sub_f32 v28, v28, v21
    v_sub_f32 v29, v29, v21
    v_cvt_pk_bf16_f32 v29, v28, v29
    v_lshlrev_b32 v28, 16, v29
    v_and_b32 v29, 0xffff0000, v29
    v_pk_mul_f32 v[28:29], v[28:29], v[26:27]
    v_cvt_pk_bf16_f32 v194, v28, v29
    v_lshlrev_b32 v30, 16, v95
    v_and_b32 v31, 0xffff0000, v95
    v_sub_f32 v30, v30, v21
    v_sub_f32 v31, v31, v21
    v_cvt_pk_bf16_f32 v31, v30, v31
    v_lshlrev_b32 v30, 16, v31
    v_and_b32 v31, 0xffff0000, v31
    v_pk_mul_f32 v[30:31], v[30:31], v[26:27]
    v_cvt_pk_bf16_f32 v195, v30, v31
    s_add_u32 s79, s78, 0
    buffer_store_dwordx4 v[164:167], v15, s[4:7], s79 offen offset:128 sc1
    s_add_u32 s79, s78, 4096
    buffer_store_dwordx4 v[168:171], v15, s[4:7], s79 offen offset:128 sc1
    s_add_u32 s79, s78, 8192
    buffer_store_dwordx4 v[172:175], v15, s[4:7], s79 offen offset:128 sc1
    s_add_u32 s79, s78, 12288
    buffer_store_dwordx4 v[176:179], v15, s[4:7], s79 offen offset:128 sc1
    s_add_u32 s79, s78, 16384
    buffer_store_dwordx4 v[180:183], v15, s[4:7], s79 offen offset:128 sc1
    s_add_u32 s79, s78, 20480
    buffer_store_dwordx4 v[184:187], v15, s[4:7], s79 offen offset:128 sc1
    s_add_u32 s79, s78, 24576
    buffer_store_dwordx4 v[188:191], v15, s[4:7], s79 offen offset:128 sc1
    s_add_u32 s79, s78, 28672
    buffer_store_dwordx4 v[192:195], v15, s[4:7], s79 offen offset:128 sc1
    buffer_store_dwordx4 v[196:199], v11, s[4:7], s80 offen offset:0 sc1
    buffer_store_dwordx4 v[196:199], v11, s[4:7], s80 offen offset:1024 sc1
    buffer_store_dwordx4 v[196:199], v11, s[4:7], s80 offen offset:2048 sc1
    buffer_store_dwordx4 v[196:199], v11, s[4:7], s80 offen offset:3072 sc1
    buffer_store_dwordx4 v[196:199], v11, s[4:7], s81 offen offset:0 sc1
    buffer_store_dwordx4 v[196:199], v11, s[4:7], s81 offen offset:1024 sc1
    buffer_store_dwordx4 v[196:199], v11, s[4:7], s81 offen offset:2048 sc1
    buffer_store_dwordx4 v[196:199], v11, s[4:7], s81 offen offset:3072 sc1
    buffer_store_dword v200, v201, s[4:7], s82 offen sc1
    s_mul_i32 s82, s76, 0x2000
    s_lshl_b32 s83, s56, 10
    s_add_u32 s82, s82, s83
    s_add_u32 s82, s82, 0x8f80000
    s_add_u32 s83, s82, 0x40000
    buffer_store_dwordx4 v[196:199], v11, s[4:7], s82 offen sc1
    buffer_store_dwordx4 v[196:199], v11, s[4:7], s83 offen sc1
Lwz_189:
    s_add_u32 s101, s101, 1
    s_cmp_gt_u32 s101, 0x400000
    s_cbranch_scc1 L_end
    v_mbcnt_lo_u32_b32 v117, -1, 0
    v_and_b32 v117, 7, v117
    v_lshlrev_b32 v117, 2, v117
    global_load_dword v116, v117, s[8:9] sc1
    s_waitcnt vmcnt(0)
    v_cmp_ne_u32 vcc, 1, v116
    s_cbranch_vccnz Lwz_189
    s_cmp_lg_u32 s56, 0
    s_cbranch_scc1 Lann_190
    s_lshr_b32 s3, s2, 3
    s_lshl_b32 s3, s3, 7
    s_and_b32 vcc_lo, s2, 7
    s_add_u32 s3, s3, vcc_lo
    s_add_u32 s3, s3, 0x2000
    v_mov_b32 v116, s3
    v_mov_b32 v117, s58
    s_mov_b64 exec, 1
    buffer_store_byte v117, v116, s[4:7], 0 offen sc1
    s_mov_b64 exec, -1
Lann_190:
    s_lshr_b32 s80, s59, 7
    s_and_b32 s80, s80, 32
    s_add_u32 s80, s80, 0x100
    s_barrier
    s_add_u32 s76, s76, s80
    buffer_store_byte v9, v3, s[4:7], s76 offen sc1
    s_mov_b32 s79, 0x400000
    v_mov_b32 v16, 0x3f803f80
    v_mov_b32 v17, 0
    v_mov_b32 v18, 0
    v_mov_b32 v19, 0
    v_mov_b32 v20, 0
    v_dot2_f32_bf16 v18, v132, v16, v18
    v_dot2_f32_bf16 v20, v132, v132, v20
    v_dot2_f32_bf16 v17, v133, v16, v17
    v_dot2_f32_bf16 v19, v133, v133, v19
    v_dot2_f32_bf16 v18, v134, v16, v18
    v_dot2_f32_bf16 v20, v134, v134, v20
    v_dot2_f32_bf16 v17, v135, v16, v17
    v_dot2_f32_bf16 v19, v135, v135, v19
    v_dot2_f32_bf16 v18, v136, v16, v18
    v_dot2_f32_bf16 v20, v136, v136, v20
    v_dot2_f32_bf16 v17, v137, v16, v17
    v_dot2_f32_bf16 v19, v137, v137, v19
    v_dot2_f32_bf16 v18, v138, v16, v18
    v_dot2_f32_bf16 v20, v138, v138, v20
    v_dot2_f32_bf16 v17, v139, v16, v17
    v_dot2_f32_bf16 v19, v139, v139, v19
    v_dot2_f32_bf16 v18, v140, v16, v18
    v_dot2_f32_bf16 v20, v140, v140, v20
    v_dot2_f32_bf16 v17, v141, v16, v17
    v_dot2_f32_bf16 v19, v141, v141, v19
    v_dot2_f32_bf16 v18, v142, v16, v18
    v_dot2_f32_bf16 v20, v142, v142, v20
    v_dot2_f32_bf16 v17, v143, v16, v17
    v_dot2_f32_bf16 v19, v143, v143, v19
    v_dot2_f32_bf16 v18, v144, v16, v18
    v_dot2_f32_bf16 v20, v144, v144, v20
    v_dot2_f32_bf16 v17, v145, v16, v17
    v_dot2_f32_bf16 v19, v145, v145, v19
    v_dot2_f32_bf16 v18, v146, v16, v18
    v_dot2_f32_bf16 v20, v146, v146, v20
    v_dot2_f32_bf16 v17, v147, v16, v17
    v_dot2_f32_bf16 v19, v147, v147, v19
    v_dot2_f32_bf16 v18, v148, v16, v18
    v_dot2_f32_bf16 v20, v148, v148, v20
    v_dot2_f32_bf16 v17, v149, v16, v17
    v_dot2_f32_bf16 v19, v149, v149, v19
    v_dot2_f32_bf16 v18, v150, v16, v18
    v_dot2_f32_bf16 v20, v150, v150, v20
    v_dot2_f32_bf16 v17, v151, v16, v17
    v_dot2_f32_bf16 v19, v151, v151, v19
    v_dot2_f32_bf16 v18, v152, v16, v18
    v_dot2_f32_bf16 v20, v152, v152, v20
    v_dot2_f32_bf16 v17, v153, v16, v17
    v_dot2_f32_bf16 v19, v153, v153, v19
    v_dot2_f32_bf16 v18, v154, v16, v18
    v_dot2_f32_bf16 v20, v154, v154, v20
    v_dot2_f32_bf16 v17, v155, v16, v17
    v_dot2_f32_bf16 v19, v155, v155, v19
    v_dot2_f32_bf16 v18, v156, v16, v18
    v_dot2_f32_bf16 v20, v156, v156, v20
    v_dot2_f32_bf16 v17, v157, v16, v17
    v_dot2_f32_bf16 v19, v157, v157, v19
    v_dot2_f32_bf16 v18, v158, v16, v18
    v_dot2_f32_bf16 v20, v158, v158, v20
    v_dot2_f32_bf16 v17, v159, v16, v17
    v_dot2_f32_bf16 v19, v159, v159, v19
    v_dot2_f32_bf16 v18, v160, v16, v18
    v_dot2_f32_bf16 v20, v160, v160, v20
    v_dot2_f32_bf16 v17, v161, v16, v17
    v_dot2_f32_bf16 v19, v161, v161, v19
    v_dot2_f32_bf16 v18, v162, v16, v18
    v_dot2_f32_bf16 v20, v162, v162, v20
    v_dot2_f32_bf16 v17, v163, v16, v17
    v_dot2_f32_bf16 v19, v163, v163, v19
    s_nop 2
    v_add_f32 v17, v17, v18
    v_add_f32 v19, v19, v20
    s_nop 1
    v_add_f32_dpp v17, v17, v17 quad_perm:[1,0,3,2] row_mask:0xf bank_mask:0xf
    v_add_f32_dpp v19, v19, v19 quad_perm:[1,0,3,2] row_mask:0xf bank_mask:0xf
    s_nop 1
    v_add_f32_dpp v17, v17, v17 quad_perm:[2,3,0,1] row_mask:0xf bank_mask:0xf
    v_add_f32_dpp v19, v19, v19 quad_perm:[2,3,0,1] row_mask:0xf bank_mask:0xf
    s_nop 1
    v_add_f32_dpp v17, v17, v17 row_half_mirror row_mask:0xf bank_mask:0xf
    v_add_f32_dpp v19, v19, v19 row_half_mirror row_mask:0xf bank_mask:0xf
    v_mul_f32 v21, 0x3b000000, v17
    v_mul_f32 v22, 0x3b000000, v19
    v_fma_f32 v22, -v21, v21, v22
    v_max_f32 v22, 0, v22
    v_cvt_pk_bf16_f32 v22, v22, v21
    v_and_b32 v21, 0xffff0000, v22
    v_lshlrev_b32 v22, 16, v22
    v_add_f32 v22, 0x3727c5ac, v22
    v_cvt_pk_bf16_f32 v22, v22, v22
    v_lshlrev_b32 v22, 16, v22
    v_sqrt_f32 v22, v22
    s_nop 0
    v_cvt_pk_bf16_f32 v22, v22, v22
    v_lshlrev_b32 v22, 16, v22
    v_rcp_f32 v26, v22
    s_nop 0
    v_mov_b32 v27, v26
    v_lshlrev_b32 v28, 16, v132
    v_and_b32 v29, 0xffff0000, v132
    v_sub_f32 v28, v28, v21
    v_sub_f32 v29, v29, v21
    v_cvt_pk_bf16_f32 v29, v28, v29
    v_lshlrev_b32 v28, 16, v29
    v_and_b32 v29, 0xffff0000, v29
    v_pk_mul_f32 v[28:29], v[28:29], v[26:27]
    v_cvt_pk_bf16_f32 v32, v28, v29
    v_lshlrev_b32 v30, 16, v133
    v_and_b32 v31, 0xffff0000, v133
    v_sub_f32 v30, v30, v21
    v_sub_f32 v31, v31, v21
    v_cvt_pk_bf16_f32 v31, v30, v31
    v_lshlrev_b32 v30, 16, v31
    v_and_b32 v31, 0xffff0000, v31
    v_pk_mul_f32 v[30:31], v[30:31], v[26:27]
    v_cvt_pk_bf16_f32 v33, v30, v31
    v_lshlrev_b32 v28, 16, v134
    v_and_b32 v29, 0xffff0000, v134
    v_sub_f32 v28, v28, v21
    v_sub_f32 v29, v29, v21
    v_cvt_pk_bf16_f32 v29, v28, v29
    v_lshlrev_b32 v28, 16, v29
    v_and_b32 v29, 0xffff0000, v29
    v_pk_mul_f32 v[28:29], v[28:29], v[26:27]
    v_cvt_pk_bf16_f32 v34, v28, v29
    v_lshlrev_b32 v30, 16, v135
    v_and_b32 v31, 0xffff0000, v135
    v_sub_f32 v30, v30, v21
    v_sub_f32 v31, v31, v21
    v_cvt_pk_bf16_f32 v31, v30, v31
    v_lshlrev_b32 v30, 16, v31
    v_and_b32 v31, 0xffff0000, v31
    v_pk_mul_f32 v[30:31], v[30:31], v[26:27]
    v_cvt_pk_bf16_f32 v35, v30, v31
    v_lshlrev_b32 v28, 16, v136
    v_and_b32 v29, 0xffff0000, v136
    v_sub_f32 v28, v28, v21
    v_sub_f32 v29, v29, v21
    v_cvt_pk_bf16_f32 v29, v28, v29
    v_lshlrev_b32 v28, 16, v29
    v_and_b32 v29, 0xffff0000, v29
    v_pk_mul_f32 v[28:29], v[28:29], v[26:27]
    v_cvt_pk_bf16_f32 v36, v28, v29
    v_lshlrev_b32 v30, 16, v137
    v_and_b32 v31, 0xffff0000, v137
    v_sub_f32 v30, v30, v21
    v_sub_f32 v31, v31, v21
    v_cvt_pk_bf16_f32 v31, v30, v31
    v_lshlrev_b32 v30, 16, v31
    v_and_b32 v31, 0xffff0000, v31
    v_pk_mul_f32 v[30:31], v[30:31], v[26:27]
    v_cvt_pk_bf16_f32 v37, v30, v31
    v_lshlrev_b32 v28, 16, v138
    v_and_b32 v29, 0xffff0000, v138
    v_sub_f32 v28, v28, v21
    v_sub_f32 v29, v29, v21
    v_cvt_pk_bf16_f32 v29, v28, v29
    v_lshlrev_b32 v28, 16, v29
    v_and_b32 v29, 0xffff0000, v29
    v_pk_mul_f32 v[28:29], v[28:29], v[26:27]
    v_cvt_pk_bf16_f32 v38, v28, v29
    v_lshlrev_b32 v30, 16, v139
    v_and_b32 v31, 0xffff0000, v139
    v_sub_f32 v30, v30, v21
    v_sub_f32 v31, v31, v21
    v_cvt_pk_bf16_f32 v31, v30, v31
    v_lshlrev_b32 v30, 16, v31
    v_and_b32 v31, 0xffff0000, v31
    v_pk_mul_f32 v[30:31], v[30:31], v[26:27]
    v_cvt_pk_bf16_f32 v39, v30, v31
    v_lshlrev_b32 v28, 16, v140
    v_and_b32 v29, 0xffff0000, v140
    v_sub_f32 v28, v28, v21
    v_sub_f32 v29, v29, v21
    v_cvt_pk_bf16_f32 v29, v28, v29
    v_lshlrev_b32 v28, 16, v29
    v_and_b32 v29, 0xffff0000, v29
    v_pk_mul_f32 v[28:29], v[28:29], v[26:27]
    v_cvt_pk_bf16_f32 v40, v28, v29
    v_lshlrev_b32 v30, 16, v141
    v_and_b32 v31, 0xffff0000, v141
    v_sub_f32 v30, v30, v21
    v_sub_f32 v31, v31, v21
    v_cvt_pk_bf16_f32 v31, v30, v31
    v_lshlrev_b32 v30, 16, v31
    v_and_b32 v31, 0xffff0000, v31
    v_pk_mul_f32 v[30:31], v[30:31], v[26:27]
    v_cvt_pk_bf16_f32 v41, v30, v31
    v_lshlrev_b32 v28, 16, v142
    v_and_b32 v29, 0xffff0000, v142
    v_sub_f32 v28, v28, v21
    v_sub_f32 v29, v29, v21
    v_cvt_pk_bf16_f32 v29, v28, v29
    v_lshlrev_b32 v28, 16, v29
    v_and_b32 v29, 0xffff0000, v29
    v_pk_mul_f32 v[28:29], v[28:29], v[26:27]
    v_cvt_pk_bf16_f32 v42, v28, v29
    v_lshlrev_b32 v30, 16, v143
    v_and_b32 v31, 0xffff0000, v143
    v_sub_f32 v30, v30, v21
    v_sub_f32 v31, v31, v21
    v_cvt_pk_bf16_f32 v31, v30, v31
    v_lshlrev_b32 v30, 16, v31
    v_and_b32 v31, 0xffff0000, v31
    v_pk_mul_f32 v[30:31], v[30:31], v[26:27]
    v_cvt_pk_bf16_f32 v43, v30, v31
    v_lshlrev_b32 v28, 16, v144
    v_and_b32 v29, 0xffff0000, v144
    v_sub_f32 v28, v28, v21
    v_sub_f32 v29, v29, v21
    v_cvt_pk_bf16_f32 v29, v28, v29
    v_lshlrev_b32 v28, 16, v29
    v_and_b32 v29, 0xffff0000, v29
    v_pk_mul_f32 v[28:29], v[28:29], v[26:27]
    v_cvt_pk_bf16_f32 v44, v28, v29
    v_lshlrev_b32 v30, 16, v145
    v_and_b32 v31, 0xffff0000, v145
    v_sub_f32 v30, v30, v21
    v_sub_f32 v31, v31, v21
    v_cvt_pk_bf16_f32 v31, v30, v31
    v_lshlrev_b32 v30, 16, v31
    v_and_b32 v31, 0xffff0000, v31
    v_pk_mul_f32 v[30:31], v[30:31], v[26:27]
    v_cvt_pk_bf16_f32 v45, v30, v31
    v_lshlrev_b32 v28, 16, v146
    v_and_b32 v29, 0xffff0000, v146
    v_sub_f32 v28, v28, v21
    v_sub_f32 v29, v29, v21
    v_cvt_pk_bf16_f32 v29, v28, v29
    v_lshlrev_b32 v28, 16, v29
    v_and_b32 v29, 0xffff0000, v29
    v_pk_mul_f32 v[28:29], v[28:29], v[26:27]
    v_cvt_pk_bf16_f32 v46, v28, v29
    v_lshlrev_b32 v30, 16, v147
    v_and_b32 v31, 0xffff0000, v147
    v_sub_f32 v30, v30, v21
    v_sub_f32 v31, v31, v21
    v_cvt_pk_bf16_f32 v31, v30, v31
    v_lshlrev_b32 v30, 16, v31
    v_and_b32 v31, 0xffff0000, v31
    v_pk_mul_f32 v[30:31], v[30:31], v[26:27]
    v_cvt_pk_bf16_f32 v47, v30, v31
    v_lshlrev_b32 v28, 16, v148
    v_and_b32 v29, 0xffff0000, v148
    v_sub_f32 v28, v28, v21
    v_sub_f32 v29, v29, v21
    v_cvt_pk_bf16_f32 v29, v28, v29
    v_lshlrev_b32 v28, 16, v29
    v_and_b32 v29, 0xffff0000, v29
    v_pk_mul_f32 v[28:29], v[28:29], v[26:27]
    v_cvt_pk_bf16_f32 v48, v28, v29
    v_lshlrev_b32 v30, 16, v149
    v_and_b32 v31, 0xffff0000, v149
    v_sub_f32 v30, v30, v21
    v_sub_f32 v31, v31, v21
    v_cvt_pk_bf16_f32 v31, v30, v31
    v_lshlrev_b32 v30, 16, v31
    v_and_b32 v31, 0xffff0000, v31
    v_pk_mul_f32 v[30:31], v[30:31], v[26:27]
    v_cvt_pk_bf16_f32 v49, v30, v31
    v_lshlrev_b32 v28, 16, v150
    v_and_b32 v29, 0xffff0000, v150
    v_sub_f32 v28, v28, v21
    v_sub_f32 v29, v29, v21
    v_cvt_pk_bf16_f32 v29, v28, v29
    v_lshlrev_b32 v28, 16, v29
    v_and_b32 v29, 0xffff0000, v29
    v_pk_mul_f32 v[28:29], v[28:29], v[26:27]
    v_cvt_pk_bf16_f32 v50, v28, v29
    v_lshlrev_b32 v30, 16, v151
    v_and_b32 v31, 0xffff0000, v151
    v_sub_f32 v30, v30, v21
    v_sub_f32 v31, v31, v21
    v_cvt_pk_bf16_f32 v31, v30, v31
    v_lshlrev_b32 v30, 16, v31
    v_and_b32 v31, 0xffff0000, v31
    v_pk_mul_f32 v[30:31], v[30:31], v[26:27]
    v_cvt_pk_bf16_f32 v51, v30, v31
    v_lshlrev_b32 v28, 16, v152
    v_and_b32 v29, 0xffff0000, v152
    v_sub_f32 v28, v28, v21
    v_sub_f32 v29, v29, v21
    v_cvt_pk_bf16_f32 v29, v28, v29
    v_lshlrev_b32 v28, 16, v29
    v_and_b32 v29, 0xffff0000, v29
    v_pk_mul_f32 v[28:29], v[28:29], v[26:27]
    v_cvt_pk_bf16_f32 v52, v28, v29
    v_lshlrev_b32 v30, 16, v153
    v_and_b32 v31, 0xffff0000, v153
    v_sub_f32 v30, v30, v21
    v_sub_f32 v31, v31, v21
    v_cvt_pk_bf16_f32 v31, v30, v31
    v_lshlrev_b32 v30, 16, v31
    v_and_b32 v31, 0xffff0000, v31
    v_pk_mul_f32 v[30:31], v[30:31], v[26:27]
    v_cvt_pk_bf16_f32 v53, v30, v31
    v_lshlrev_b32 v28, 16, v154
    v_and_b32 v29, 0xffff0000, v154
    v_sub_f32 v28, v28, v21
    v_sub_f32 v29, v29, v21
    v_cvt_pk_bf16_f32 v29, v28, v29
    v_lshlrev_b32 v28, 16, v29
    v_and_b32 v29, 0xffff0000, v29
    v_pk_mul_f32 v[28:29], v[28:29], v[26:27]
    v_cvt_pk_bf16_f32 v54, v28, v29
    v_lshlrev_b32 v30, 16, v155
    v_and_b32 v31, 0xffff0000, v155
    v_sub_f32 v30, v30, v21
    v_sub_f32 v31, v31, v21
    v_cvt_pk_bf16_f32 v31, v30, v31
    v_lshlrev_b32 v30, 16, v31
    v_and_b32 v31, 0xffff0000, v31
    v_pk_mul_f32 v[30:31], v[30:31], v[26:27]
    v_cvt_pk_bf16_f32 v55, v30, v31
    v_lshlrev_b32 v28, 16, v156
    v_and_b32 v29, 0xffff0000, v156
    v_sub_f32 v28, v28, v21
    v_sub_f32 v29, v29, v21
    v_cvt_pk_bf16_f32 v29, v28, v29
    v_lshlrev_b32 v28, 16, v29
    v_and_b32 v29, 0xffff0000, v29
    v_pk_mul_f32 v[28:29], v[28:29], v[26:27]
    v_cvt_pk_bf16_f32 v56, v28, v29
    v_lshlrev_b32 v30, 16, v157
    v_and_b32 v31, 0xffff0000, v157
    v_sub_f32 v30, v30, v21
    v_sub_f32 v31, v31, v21
    v_cvt_pk_bf16_f32 v31, v30, v31
    v_lshlrev_b32 v30, 16, v31
    v_and_b32 v31, 0xffff0000, v31
    v_pk_mul_f32 v[30:31], v[30:31], v[26:27]
    v_cvt_pk_bf16_f32 v57, v30, v31
    v_lshlrev_b32 v28, 16, v158
    v_and_b32 v29, 0xffff0000, v158
    v_sub_f32 v28, v28, v21
    v_sub_f32 v29, v29, v21
    v_cvt_pk_bf16_f32 v29, v28, v29
    v_lshlrev_b32 v28, 16, v29
    v_and_b32 v29, 0xffff0000, v29
    v_pk_mul_f32 v[28:29], v[28:29], v[26:27]
    v_cvt_pk_bf16_f32 v58, v28, v29
    v_lshlrev_b32 v30, 16, v159
    v_and_b32 v31, 0xffff0000, v159
    v_sub_f32 v30, v30, v21
    v_sub_f32 v31, v31, v21
    v_cvt_pk_bf16_f32 v31, v30, v31
    v_lshlrev_b32 v30, 16, v31
    v_and_b32 v31, 0xffff0000, v31
    v_pk_mul_f32 v[30:31], v[30:31], v[26:27]
    v_cvt_pk_bf16_f32 v59, v30, v31
    v_lshlrev_b32 v28, 16, v160
    v_and_b32 v29, 0xffff0000, v160
    v_sub_f32 v28, v28, v21
    v_sub_f32 v29, v29, v21
    v_cvt_pk_bf16_f32 v29, v28, v29
    v_lshlrev_b32 v28, 16, v29
    v_and_b32 v29, 0xffff0000, v29
    v_pk_mul_f32 v[28:29], v[28:29], v[26:27]
    v_cvt_pk_bf16_f32 v60, v28, v29
    v_lshlrev_b32 v30, 16, v161
    v_and_b32 v31, 0xffff0000, v161
    v_sub_f32 v30, v30, v21
    v_sub_f32 v31, v31, v21
    v_cvt_pk_bf16_f32 v31, v30, v31
    v_lshlrev_b32 v30, 16, v31
    v_and_b32 v31, 0xffff0000, v31
    v_pk_mul_f32 v[30:31], v[30:31], v[26:27]
    v_cvt_pk_bf16_f32 v61, v30, v31
    v_lshlrev_b32 v28, 16, v162
    v_and_b32 v29, 0xffff0000, v162
    v_sub_f32 v28, v28, v21
    v_sub_f32 v29, v29, v21
    v_cvt_pk_bf16_f32 v29, v28, v29
    v_lshlrev_b32 v28, 16, v29
    v_and_b32 v29, 0xffff0000, v29
    v_pk_mul_f32 v[28:29], v[28:29], v[26:27]
    v_cvt_pk_bf16_f32 v62, v28, v29
    v_lshlrev_b32 v30, 16, v163
    v_and_b32 v31, 0xffff0000, v163
    v_sub_f32 v30, v30, v21
    v_sub_f32 v31, v31, v21
    v_cvt_pk_bf16_f32 v31, v30, v31
    v_lshlrev_b32 v30, 16, v31
    v_and_b32 v31, 0xffff0000, v31
    v_pk_mul_f32 v[30:31], v[30:31], v[26:27]
    v_cvt_pk_bf16_f32 v63, v30, v31
    buffer_store_dwordx4 v[32:35], v14, s[4:7], s79 offen offset:0 sc1
    buffer_store_dwordx4 v[36:39], v14, s[4:7], s79 offen offset:128 sc1
    buffer_store_dwordx4 v[40:43], v14, s[4:7], s79 offen offset:256 sc1
    buffer_store_dwordx4 v[44:47], v14, s[4:7], s79 offen offset:384 sc1
    buffer_store_dwordx4 v[48:51], v14, s[4:7], s79 offen offset:512 sc1
    buffer_store_dwordx4 v[52:55], v14, s[4:7], s79 offen offset:640 sc1
    buffer_store_dwordx4 v[56:59], v14, s[4:7], s79 offen offset:768 sc1
    buffer_store_dwordx4 v[60:63], v14, s[4:7], s79 offen offset:896 sc1
    v_mov_b32 v16, 0x3f803f80
    v_mov_b32 v17, 0
    v_mov_b32 v18, 0
    v_mov_b32 v19, 0
    v_mov_b32 v20, 0
    v_dot2_f32_bf16 v18, v164, v16, v18
    v_dot2_f32_bf16 v20, v164, v164, v20
    v_dot2_f32_bf16 v17, v165, v16, v17
    v_dot2_f32_bf16 v19, v165, v165, v19
    v_dot2_f32_bf16 v18, v166, v16, v18
    v_dot2_f32_bf16 v20, v166, v166, v20
    v_dot2_f32_bf16 v17, v167, v16, v17
    v_dot2_f32_bf16 v19, v167, v167, v19
    v_dot2_f32_bf16 v18, v168, v16, v18
    v_dot2_f32_bf16 v20, v168, v168, v20
    v_dot2_f32_bf16 v17, v169, v16, v17
    v_dot2_f32_bf16 v19, v169, v169, v19
    v_dot2_f32_bf16 v18, v170, v16, v18
    v_dot2_f32_bf16 v20, v170, v170, v20
    v_dot2_f32_bf16 v17, v171, v16, v17
    v_dot2_f32_bf16 v19, v171, v171, v19
    v_dot2_f32_bf16 v18, v172, v16, v18
    v_dot2_f32_bf16 v20, v172, v172, v20
    v_dot2_f32_bf16 v17, v173, v16, v17
    v_dot2_f32_bf16 v19, v173, v173, v19
    v_dot2_f32_bf16 v18, v174, v16, v18
    v_dot2_f32_bf16 v20, v174, v174, v20
    v_dot2_f32_bf16 v17, v175, v16, v17
    v_dot2_f32_bf16 v19, v175, v175, v19
    v_dot2_f32_bf16 v18, v176, v16, v18
    v_dot2_f32_bf16 v20, v176, v176, v20
    v_dot2_f32_bf16 v17, v177, v16, v17
    v_dot2_f32_bf16 v19, v177, v177, v19
    v_dot2_f32_bf16 v18, v178, v16, v18
    v_dot2_f32_bf16 v20, v178, v178, v20
    v_dot2_f32_bf16 v17, v179, v16, v17
    v_dot2_f32_bf16 v19, v179, v179, v19
    v_dot2_f32_bf16 v18, v180, v16, v18
    v_dot2_f32_bf16 v20, v180, v180, v20
    v_dot2_f32_bf16 v17, v181, v16, v17
    v_dot2_f32_bf16 v19, v181, v181, v19
    v_dot2_f32_bf16 v18, v182, v16, v18
    v_dot2_f32_bf16 v20, v182, v182, v20
    v_dot2_f32_bf16 v17, v183, v16, v17
    v_dot2_f32_bf16 v19, v183, v183, v19
    v_dot2_f32_bf16 v18, v184, v16, v18
    v_dot2_f32_bf16 v20, v184, v184, v20
    v_dot2_f32_bf16 v17, v185, v16, v17
    v_dot2_f32_bf16 v19, v185, v185, v19
    v_dot2_f32_bf16 v18, v186, v16, v18
    v_dot2_f32_bf16 v20, v186, v186, v20
    v_dot2_f32_bf16 v17, v187, v16, v17
    v_dot2_f32_bf16 v19, v187, v187, v19
    v_dot2_f32_bf16 v18, v188, v16, v18
    v_dot2_f32_bf16 v20, v188, v188, v20
    v_dot2_f32_bf16 v17, v189, v16, v17
    v_dot2_f32_bf16 v19, v189, v189, v19
    v_dot2_f32_bf16 v18, v190, v16, v18
    v_dot2_f32_bf16 v20, v190, v190, v20
    v_dot2_f32_bf16 v17, v191, v16, v17
    v_dot2_f32_bf16 v19, v191, v191, v19
    v_dot2_f32_bf16 v18, v192, v16, v18
    v_dot2_f32_bf16 v20, v192, v192, v20
    v_dot2_f32_bf16 v17, v193, v16, v17
    v_dot2_f32_bf16 v19, v193, v193, v19
    v_dot2_f32_bf16 v18, v194, v16, v18
    v_dot2_f32_bf16 v20, v194, v194, v20
    v_dot2_f32_bf16 v17, v195, v16, v17
    v_dot2_f32_bf16 v19, v195, v195, v19
    s_nop 2
    v_add_f32 v17, v17, v18
    v_add_f32 v19, v19, v20
    s_nop 1
    v_add_f32_dpp v17, v17, v17 quad_perm:[1,0,3,2] row_mask:0xf bank_mask:0xf
    v_add_f32_dpp v19, v19, v19 quad_perm:[1,0,3,2] row_mask:0xf bank_mask:0xf
    s_nop 1
    v_add_f32_dpp v17, v17, v17 quad_perm:[2,3,0,1] row_mask:0xf bank_mask:0xf
    v_add_f32_dpp v19, v19, v19 quad_perm:[2,3,0,1] row_mask:0xf bank_mask:0xf
    s_nop 1
    v_add_f32_dpp v17, v17, v17 row_half_mirror row_mask:0xf bank_mask:0xf
    v_add_f32_dpp v19, v19, v19 row_half_mirror row_mask:0xf bank_mask:0xf
    v_mul_f32 v21, 0x3b000000, v17
    v_mul_f32 v22, 0x3b000000, v19
    v_fma_f32 v22, -v21, v21, v22
    v_max_f32 v22, 0, v22
    v_cvt_pk_bf16_f32 v22, v22, v21
    v_and_b32 v21, 0xffff0000, v22
    v_lshlrev_b32 v22, 16, v22
    v_add_f32 v22, 0x3727c5ac, v22
    v_cvt_pk_bf16_f32 v22, v22, v22
    v_lshlrev_b32 v22, 16, v22
    v_sqrt_f32 v22, v22
    s_nop 0
    v_cvt_pk_bf16_f32 v22, v22, v22
    v_lshlrev_b32 v22, 16, v22
    v_rcp_f32 v26, v22
    s_nop 0
    v_mov_b32 v27, v26
    v_lshlrev_b32 v28, 16, v164
    v_and_b32 v29, 0xffff0000, v164
    v_sub_f32 v28, v28, v21
    v_sub_f32 v29, v29, v21
    v_cvt_pk_bf16_f32 v29, v28, v29
    v_lshlrev_b32 v28, 16, v29
    v_and_b32 v29, 0xffff0000, v29
    v_pk_mul_f32 v[28:29], v[28:29], v[26:27]
    v_cvt_pk_bf16_f32 v64, v28, v29
    v_lshlrev_b32 v30, 16, v165
    v_and_b32 v31, 0xffff0000, v165
    v_sub_f32 v30, v30, v21
    v_sub_f32 v31, v31, v21
    v_cvt_pk_bf16_f32 v31, v30, v31
    v_lshlrev_b32 v30, 16, v31
    v_and_b32 v31, 0xffff0000, v31
    v_pk_mul_f32 v[30:31], v[30:31], v[26:27]
    v_cvt_pk_bf16_f32 v65, v30, v31
    v_lshlrev_b32 v28, 16, v166
    v_and_b32 v29, 0xffff0000, v166
    v_sub_f32 v28, v28, v21
    v_sub_f32 v29, v29, v21
    v_cvt_pk_bf16_f32 v29, v28, v29
    v_lshlrev_b32 v28, 16, v29
    v_and_b32 v29, 0xffff0000, v29
    v_pk_mul_f32 v[28:29], v[28:29], v[26:27]
    v_cvt_pk_bf16_f32 v66, v28, v29
    v_lshlrev_b32 v30, 16, v167
    v_and_b32 v31, 0xffff0000, v167
    v_sub_f32 v30, v30, v21
    v_sub_f32 v31, v31, v21
    v_cvt_pk_bf16_f32 v31, v30, v31
    v_lshlrev_b32 v30, 16, v31
    v_and_b32 v31, 0xffff0000, v31
    v_pk_mul_f32 v[30:31], v[30:31], v[26:27]
    v_cvt_pk_bf16_f32 v67, v30, v31
    v_lshlrev_b32 v28, 16, v168
    v_and_b32 v29, 0xffff0000, v168
    v_sub_f32 v28, v28, v21
    v_sub_f32 v29, v29, v21
    v_cvt_pk_bf16_f32 v29, v28, v29
    v_lshlrev_b32 v28, 16, v29
    v_and_b32 v29, 0xffff0000, v29
    v_pk_mul_f32 v[28:29], v[28:29], v[26:27]
    v_cvt_pk_bf16_f32 v68, v28, v29
    v_lshlrev_b32 v30, 16, v169
    v_and_b32 v31, 0xffff0000, v169
    v_sub_f32 v30, v30, v21
    v_sub_f32 v31, v31, v21
    v_cvt_pk_bf16_f32 v31, v30, v31
    v_lshlrev_b32 v30, 16, v31
    v_and_b32 v31, 0xffff0000, v31
    v_pk_mul_f32 v[30:31], v[30:31], v[26:27]
    v_cvt_pk_bf16_f32 v69, v30, v31
    v_lshlrev_b32 v28, 16, v170
    v_and_b32 v29, 0xffff0000, v170
    v_sub_f32 v28, v28, v21
    v_sub_f32 v29, v29, v21
    v_cvt_pk_bf16_f32 v29, v28, v29
    v_lshlrev_b32 v28, 16, v29
    v_and_b32 v29, 0xffff0000, v29
    v_pk_mul_f32 v[28:29], v[28:29], v[26:27]
    v_cvt_pk_bf16_f32 v70, v28, v29
    v_lshlrev_b32 v30, 16, v171
    v_and_b32 v31, 0xffff0000, v171
    v_sub_f32 v30, v30, v21
    v_sub_f32 v31, v31, v21
    v_cvt_pk_bf16_f32 v31, v30, v31
    v_lshlrev_b32 v30, 16, v31
    v_and_b32 v31, 0xffff0000, v31
    v_pk_mul_f32 v[30:31], v[30:31], v[26:27]
    v_cvt_pk_bf16_f32 v71, v30, v31
    v_lshlrev_b32 v28, 16, v172
    v_and_b32 v29, 0xffff0000, v172
    v_sub_f32 v28, v28, v21
    v_sub_f32 v29, v29, v21
    v_cvt_pk_bf16_f32 v29, v28, v29
    v_lshlrev_b32 v28, 16, v29
    v_and_b32 v29, 0xffff0000, v29
    v_pk_mul_f32 v[28:29], v[28:29], v[26:27]
    v_cvt_pk_bf16_f32 v72, v28, v29
    v_lshlrev_b32 v30, 16, v173
    v_and_b32 v31, 0xffff0000, v173
    v_sub_f32 v30, v30, v21
    v_sub_f32 v31, v31, v21
    v_cvt_pk_bf16_f32 v31, v30, v31
    v_lshlrev_b32 v30, 16, v31
    v_and_b32 v31, 0xffff0000, v31
    v_pk_mul_f32 v[30:31], v[30:31], v[26:27]
    v_cvt_pk_bf16_f32 v73, v30, v31
    v_lshlrev_b32 v28, 16, v174
    v_and_b32 v29, 0xffff0000, v174
    v_sub_f32 v28, v28, v21
    v_sub_f32 v29, v29, v21
    v_cvt_pk_bf16_f32 v29, v28, v29
    v_lshlrev_b32 v28, 16, v29
    v_and_b32 v29, 0xffff0000, v29
    v_pk_mul_f32 v[28:29], v[28:29], v[26:27]
    v_cvt_pk_bf16_f32 v74, v28, v29
    v_lshlrev_b32 v30, 16, v175
    v_and_b32 v31, 0xffff0000, v175
    v_sub_f32 v30, v30, v21
    v_sub_f32 v31, v31, v21
    v_cvt_pk_bf16_f32 v31, v30, v31
    v_lshlrev_b32 v30, 16, v31
    v_and_b32 v31, 0xffff0000, v31
    v_pk_mul_f32 v[30:31], v[30:31], v[26:27]
    v_cvt_pk_bf16_f32 v75, v30, v31
    v_lshlrev_b32 v28, 16, v176
    v_and_b32 v29, 0xffff0000, v176
    v_sub_f32 v28, v28, v21
    v_sub_f32 v29, v29, v21
    v_cvt_pk_bf16_f32 v29, v28, v29
    v_lshlrev_b32 v28, 16, v29
    v_and_b32 v29, 0xffff0000, v29
    v_pk_mul_f32 v[28:29], v[28:29], v[26:27]
    v_cvt_pk_bf16_f32 v76, v28, v29
    v_lshlrev_b32 v30, 16, v177
    v_and_b32 v31, 0xffff0000, v177
    v_sub_f32 v30, v30, v21
    v_sub_f32 v31, v31, v21
    v_cvt_pk_bf16_f32 v31, v30, v31
    v_lshlrev_b32 v30, 16, v31
    v_and_b32 v31, 0xffff0000, v31
    v_pk_mul_f32 v[30:31], v[30:31], v[26:27]
    v_cvt_pk_bf16_f32 v77, v30, v31
    v_lshlrev_b32 v28, 16, v178
    v_and_b32 v29, 0xffff0000, v178
    v_sub_f32 v28, v28, v21
    v_sub_f32 v29, v29, v21
    v_cvt_pk_bf16_f32 v29, v28, v29
    v_lshlrev_b32 v28, 16, v29
    v_and_b32 v29, 0xffff0000, v29
    v_pk_mul_f32 v[28:29], v[28:29], v[26:27]
    v_cvt_pk_bf16_f32 v78, v28, v29
    v_lshlrev_b32 v30, 16, v179
    v_and_b32 v31, 0xffff0000, v179
    v_sub_f32 v30, v30, v21
    v_sub_f32 v31, v31, v21
    v_cvt_pk_bf16_f32 v31, v30, v31
    v_lshlrev_b32 v30, 16, v31
    v_and_b32 v31, 0xffff0000, v31
    v_pk_mul_f32 v[30:31], v[30:31], v[26:27]
    v_cvt_pk_bf16_f32 v79, v30, v31
    v_lshlrev_b32 v28, 16, v180
    v_and_b32 v29, 0xffff0000, v180
    v_sub_f32 v28, v28, v21
    v_sub_f32 v29, v29, v21
    v_cvt_pk_bf16_f32 v29, v28, v29
    v_lshlrev_b32 v28, 16, v29
    v_and_b32 v29, 0xffff0000, v29
    v_pk_mul_f32 v[28:29], v[28:29], v[26:27]
    v_cvt_pk_bf16_f32 v80, v28, v29
    v_lshlrev_b32 v30, 16, v181
    v_and_b32 v31, 0xffff0000, v181
    v_sub_f32 v30, v30, v21
    v_sub_f32 v31, v31, v21
    v_cvt_pk_bf16_f32 v31, v30, v31
    v_lshlrev_b32 v30, 16, v31
    v_and_b32 v31, 0xffff0000, v31
    v_pk_mul_f32 v[30:31], v[30:31], v[26:27]
    v_cvt_pk_bf16_f32 v81, v30, v31
    v_lshlrev_b32 v28, 16, v182
    v_and_b32 v29, 0xffff0000, v182
    v_sub_f32 v28, v28, v21
    v_sub_f32 v29, v29, v21
    v_cvt_pk_bf16_f32 v29, v28, v29
    v_lshlrev_b32 v28, 16, v29
    v_and_b32 v29, 0xffff0000, v29
    v_pk_mul_f32 v[28:29], v[28:29], v[26:27]
    v_cvt_pk_bf16_f32 v82, v28, v29
    v_lshlrev_b32 v30, 16, v183
    v_and_b32 v31, 0xffff0000, v183
    v_sub_f32 v30, v30, v21
    v_sub_f32 v31, v31, v21
    v_cvt_pk_bf16_f32 v31, v30, v31
    v_lshlrev_b32 v30, 16, v31
    v_and_b32 v31, 0xffff0000, v31
    v_pk_mul_f32 v[30:31], v[30:31], v[26:27]
    v_cvt_pk_bf16_f32 v83, v30, v31
    v_lshlrev_b32 v28, 16, v184
    v_and_b32 v29, 0xffff0000, v184
    v_sub_f32 v28, v28, v21
    v_sub_f32 v29, v29, v21
    v_cvt_pk_bf16_f32 v29, v28, v29
    v_lshlrev_b32 v28, 16, v29
    v_and_b32 v29, 0xffff0000, v29
    v_pk_mul_f32 v[28:29], v[28:29], v[26:27]
    v_cvt_pk_bf16_f32 v84, v28, v29
    v_lshlrev_b32 v30, 16, v185
    v_and_b32 v31, 0xffff0000, v185
    v_sub_f32 v30, v30, v21
    v_sub_f32 v31, v31, v21
    v_cvt_pk_bf16_f32 v31, v30, v31
    v_lshlrev_b32 v30, 16, v31
    v_and_b32 v31, 0xffff0000, v31
    v_pk_mul_f32 v[30:31], v[30:31], v[26:27]
    v_cvt_pk_bf16_f32 v85, v30, v31
    v_lshlrev_b32 v28, 16, v186
    v_and_b32 v29, 0xffff0000, v186
    v_sub_f32 v28, v28, v21
    v_sub_f32 v29, v29, v21
    v_cvt_pk_bf16_f32 v29, v28, v29
    v_lshlrev_b32 v28, 16, v29
    v_and_b32 v29, 0xffff0000, v29
    v_pk_mul_f32 v[28:29], v[28:29], v[26:27]
    v_cvt_pk_bf16_f32 v86, v28, v29
    v_lshlrev_b32 v30, 16, v187
    v_and_b32 v31, 0xffff0000, v187
    v_sub_f32 v30, v30, v21
    v_sub_f32 v31, v31, v21
    v_cvt_pk_bf16_f32 v31, v30, v31
    v_lshlrev_b32 v30, 16, v31
    v_and_b32 v31, 0xffff0000, v31
    v_pk_mul_f32 v[30:31], v[30:31], v[26:27]
    v_cvt_pk_bf16_f32 v87, v30, v31
    v_lshlrev_b32 v28, 16, v188
    v_and_b32 v29, 0xffff0000, v188
    v_sub_f32 v28, v28, v21
    v_sub_f32 v29, v29, v21
    v_cvt_pk_bf16_f32 v29, v28, v29
    v_lshlrev_b32 v28, 16, v29
    v_and_b32 v29, 0xffff0000, v29
    v_pk_mul_f32 v[28:29], v[28:29], v[26:27]
    v_cvt_pk_bf16_f32 v88, v28, v29
    v_lshlrev_b32 v30, 16, v189
    v_and_b32 v31, 0xffff0000, v189
    v_sub_f32 v30, v30, v21
    v_sub_f32 v31, v31, v21
    v_cvt_pk_bf16_f32 v31, v30, v31
    v_lshlrev_b32 v30, 16, v31
    v_and_b32 v31, 0xffff0000, v31
    v_pk_mul_f32 v[30:31], v[30:31], v[26:27]
    v_cvt_pk_bf16_f32 v89, v30, v31
    v_lshlrev_b32 v28, 16, v190
    v_and_b32 v29, 0xffff0000, v190
    v_sub_f32 v28, v28, v21
    v_sub_f32 v29, v29, v21
    v_cvt_pk_bf16_f32 v29, v28, v29
    v_lshlrev_b32 v28, 16, v29
    v_and_b32 v29, 0xffff0000, v29
    v_pk_mul_f32 v[28:29], v[28:29], v[26:27]
    v_cvt_pk_bf16_f32 v90, v28, v29
    v_lshlrev_b32 v30, 16, v191
    v_and_b32 v31, 0xffff0000, v191
    v_sub_f32 v30, v30, v21
    v_sub_f32 v31, v31, v21
    v_cvt_pk_bf16_f32 v31, v30, v31
    v_lshlrev_b32 v30, 16, v31
    v_and_b32 v31, 0xffff0000, v31
    v_pk_mul_f32 v[30:31], v[30:31], v[26:27]
    v_cvt_pk_bf16_f32 v91, v30, v31
    v_lshlrev_b32 v28, 16, v192
    v_and_b32 v29, 0xffff0000, v192
    v_sub_f32 v28, v28, v21
    v_sub_f32 v29, v29, v21
    v_cvt_pk_bf16_f32 v29, v28, v29
    v_lshlrev_b32 v28, 16, v29
    v_and_b32 v29, 0xffff0000, v29
    v_pk_mul_f32 v[28:29], v[28:29], v[26:27]
    v_cvt_pk_bf16_f32 v92, v28, v29
    v_lshlrev_b32 v30, 16, v193
    v_and_b32 v31, 0xffff0000, v193
    v_sub_f32 v30, v30, v21
    v_sub_f32 v31, v31, v21
    v_cvt_pk_bf16_f32 v31, v30, v31
    v_lshlrev_b32 v30, 16, v31
    v_and_b32 v31, 0xffff0000, v31
    v_pk_mul_f32 v[30:31], v[30:31], v[26:27]
    v_cvt_pk_bf16_f32 v93, v30, v31
    v_lshlrev_b32 v28, 16, v194
    v_and_b32 v29, 0xffff0000, v194
    v_sub_f32 v28, v28, v21
    v_sub_f32 v29, v29, v21
    v_cvt_pk_bf16_f32 v29, v28, v29
    v_lshlrev_b32 v28, 16, v29
    v_and_b32 v29, 0xffff0000, v29
    v_pk_mul_f32 v[28:29], v[28:29], v[26:27]
    v_cvt_pk_bf16_f32 v94, v28, v29
    v_lshlrev_b32 v30, 16, v195
    v_and_b32 v31, 0xffff0000, v195
    v_sub_f32 v30, v30, v21
    v_sub_f32 v31, v31, v21
    v_cvt_pk_bf16_f32 v31, v30, v31
    v_lshlrev_b32 v30, 16, v31
    v_and_b32 v31, 0xffff0000, v31
    v_pk_mul_f32 v[30:31], v[30:31], v[26:27]
    v_cvt_pk_bf16_f32 v95, v30, v31
    buffer_store_dwordx4 v[64:67], v128, s[4:7], s79 offen offset:0 sc1
    buffer_store_dwordx4 v[68:71], v128, s[4:7], s79 offen offset:128 sc1
    buffer_store_dwordx4 v[72:75], v128, s[4:7], s79 offen offset:256 sc1
    buffer_store_dwordx4 v[76:79], v128, s[4:7], s79 offen offset:384 sc1
    buffer_store_dwordx4 v[80:83], v128, s[4:7], s79 offen offset:512 sc1
    buffer_store_dwordx4 v[84:87], v128, s[4:7], s79 offen offset:640 sc1
    buffer_store_dwordx4 v[88:91], v128, s[4:7], s79 offen offset:768 sc1
    buffer_store_dwordx4 v[92:95], v128, s[4:7], s79 offen offset:896 sc1
    s_waitcnt vmcnt(0)
    s_barrier
    buffer_store_byte v9, v3, s[4:7], s76 offen offset:128 sc1
L_p2_done:
Lval_191:
    s_add_u32 s101, s101, 1
    s_cmp_gt_u32 s101, 0x400000
    s_cbranch_scc1 L_end
    v_mbcnt_lo_u32_b32 v118, -1, 0
    v_lshlrev_b32 v118, 7, v118
    v_and_b32 v118, 0xf80, v118
    v_add_u32 v118, 0x2000, v118
    buffer_load_dwordx2 v[116:117], v118, s[4:7], 0 offen sc1
    s_waitcnt vmcnt(0)
Lval_191_chk:
    v_bfe_u32 v118, v116, 0, 5
    v_bfe_u32 v119, v116, 8, 5
    v_bfe_u32 v120, v116, 16, 5
    v_bfe_u32 v121, v116, 24, 5
    v_bfe_u32 v122, v117, 0, 5
    v_bfe_u32 v123, v117, 8, 5
    v_bfe_u32 v124, v117, 16, 5
    v_bfe_u32 v125, v117, 24, 5
    v_min3_u32 v126, v118, v119, v120
    v_min3_u32 v126, v126, v121, v122
    v_min3_u32 v126, v126, v123, v124
    v_min_u32 v126, v126, v125
    v_cmp_eq_u32 vcc, 0, v126
    s_cbranch_vccnz Lval_191
    s_mov_b32 s3, s59
    s_cmp_lg_u32 s59, 0
    s_cbranch_scc1 Lval_191_ok
    v_lshlrev_b32 v126, v118, 1
    v_lshlrev_b32 v127, v119, 1
    v_or_b32 v126, v126, v127
    v_lshlrev_b32 v127, v120, 1
    v_or_b32 v126, v126, v127
    v_lshlrev_b32 v127, v121, 1
    v_or_b32 v126, v126, v127
    v_lshlrev_b32 v127, v122, 1
    v_or_b32 v126, v126, v127
    v_lshlrev_b32 v127, v123, 1
    v_or_b32 v126, v126, v127
    v_lshlrev_b32 v127, v124, 1
    v_or_b32 v126, v126, v127
    v_lshlrev_b32 v127, v125, 1
    v_or_b32 v126, v126, v127
    v_cmp_ne_u32 vcc, 0x1fe, v126
    s_mov_b32 s3, 32
    s_cbranch_vccz Lval_191_ok
    s_lshr_b32 s60, s2, 3
    s_lshl_b32 s62, 1, s60
    s_sub_u32 s64, s62, 1
    s_or_b32 s66, s62, s64
    s_and_b32 s61, s2, 7
    s_mov_b32 s68, 0
    s_mov_b32 s69, 0
    s_mov_b32 s70, 0
    v_cmp_eq_u32 vcc, s58, v118
    s_cmp_gt_u32 s61, 0
    s_cselect_b32 s74, s66, s64
    s_and_b32 s74, s74, vcc_lo
    s_bcnt1_i32_b32 s71, s74
    s_add_u32 s68, s68, s71
    v_cmp_eq_u32 vcc, 1, v118
    s_bcnt1_i32_b32 s71, vcc_lo
    s_add_u32 s69, s69, s71
    v_cmp_gt_u32 vcc, s58, v118
    s_bcnt1_i32_b32 s71, vcc_lo
    s_add_u32 s70, s70, s71
    v_cmp_eq_u32 vcc, s58, v119
    s_cmp_gt_u32 s61, 1
    s_cselect_b32 s74, s66, s64
    s_and_b32 s74, s74, vcc_lo
    s_bcnt1_i32_b32 s71, s74
    s_add_u32 s68, s68, s71
    v_cmp_eq_u32 vcc, 1, v119
    s_bcnt1_i32_b32 s71, vcc_lo
    s_add_u32 s69, s69, s71
    v_cmp_gt_u32 vcc, s58, v119
    s_bcnt1_i32_b32 s71, vcc_lo
    s_add_u32 s70, s70, s71
    v_cmp_eq_u32 vcc, s58, v120
    s_cmp_gt_u32 s61, 2
    s_cselect_b32 s74, s66, s64
    s_and_b32 s74, s74, vcc_lo
    s_bcnt1_i32_b32 s71, s74
    s_add_u32 s68, s68, s71
    v_cmp_eq_u32 vcc, 1, v120
    s_bcnt1_i32_b32 s71, vcc_lo
    s_add_u32 s69, s69, s71
    v_cmp_gt_u32 vcc, s58, v120
    s_bcnt1_i32_b32 s71, vcc_lo
    s_add_u32 s70, s70, s71
    v_cmp_eq_u32 vcc, s58, v121
    s_cmp_gt_u32 s61, 3
    s_cselect_b32 s74, s66, s64
    s_and_b32 s74, s74, vcc_lo
    s_bcnt1_i32_b32 s71, s74
    s_add_u32 s68, s68, s71
    v_cmp_eq_u32 vcc, 1, v121
    s_bcnt1_i32_b32 s71, vcc_lo
    s_add_u32 s69, s69, s71
    v_cmp_gt_u32 vcc, s58, v121
    s_bcnt1_i32_b32 s71, vcc_lo
    s_add_u32 s70, s70, s71
    v_cmp_eq_u32 vcc, s58, v122
    s_cmp_gt_u32 s61, 4
    s_cselect_b32 s74, s66, s64
    s_and_b32 s74, s74, vcc_lo
    s_bcnt1_i32_b32 s71, s74
    s_add_u32 s68, s68, s71
    v_cmp_eq_u32 vcc, 1, v122
    s_bcnt1_i32_b32 s71, vcc_lo
    s_add_u32 s69, s69, s71
    v_cmp_gt_u32 vcc, s58, v122
    s_bcnt1_i32_b32 s71, vcc_lo
    s_add_u32 s70, s70, s71
    v_cmp_eq_u32 vcc, s58, v123
    s_cmp_gt_u32 s61, 5
    s_cselect_b32 s74, s66, s64
    s_and_b32 s74, s74, vcc_lo
    s_bcnt1_i32_b32 s71, s74
    s_add_u32 s68, s68, s71
    v_cmp_eq_u32 vcc, 1, v123
    s_bcnt1_i32_b32 s71, vcc_lo
    s_add_u32 s69, s69, s71
    v_cmp_gt_u32 vcc, s58, v123
    s_bcnt1_i32_b32 s71, vcc_lo
    s_add_u32 s70, s70, s71
    v_cmp_eq_u32 vcc, s58, v124
    s_cmp_gt_u32 s61, 6
    s_cselect_b32 s74, s66, s64
    s_and_b32 s74, s74, vcc_lo
    s_bcnt1_i32_b32 s71, s74
    s_add_u32 s68, s68, s71
    v_cmp_eq_u32 vcc, 1, v124
    s_bcnt1_i32_b32 s71, vcc_lo
    s_add_u32 s69, s69, s71
    v_cmp_gt_u32 vcc, s58, v124
    s_bcnt1_i32_b32 s71, vcc_lo
    s_add_u32 s70, s70, s71
    v_cmp_eq_u32 vcc, s58, v125
    s_cmp_gt_u32 s61, 7
    s_cselect_b32 s74, s66, s64
    s_and_b32 s74, s74, vcc_lo
    s_bcnt1_i32_b32 s71, s74
    s_add_u32 s68, s68, s71
    v_cmp_eq_u32 vcc, 1, v125
    s_bcnt1_i32_b32 s71, vcc_lo
    s_add_u32 s69, s69, s71
    v_cmp_gt_u32 vcc, s58, v125
    s_bcnt1_i32_b32 s71, vcc_lo
    s_add_u32 s70, s70, s71
    s_min_u32 s71, s69, 32
    s_sub_u32 s70, s70, s69
    s_add_u32 s70, s70, s71
    s_add_u32 s70, s70, s68
    s_sub_u32 s71, 256, s69
    s_add_u32 s71, s71, s68
    s_cmp_lt_u32 s68, 32
    s_cselect_b32 s71, s68, s71
    s_cmp_eq_u32 s58, 1
    s_cselect_b32 s57, s71, s70
    s_or_b32 s59, s69, 0x1000
    v_mbcnt_lo_u32_b32 v0, -1, 0
    v_mbcnt_hi_u32_b32 v0, -1, v0
    v_mov_b32 v116, s2
    v_mov_b32 v117, 1
    s_waitcnt vmcnt(0) lgkmcnt(0)
    s_barrier
    buffer_store_byte v117, v116, s[4:7], 0 offen sc1
    s_branch L_dispatch
Lval_191_ok:
    s_and_b32 s3, s3, 0xfff
    v_and_b32 v120, 15, v1
    v_lshrrev_b32 v121, 4, v1
    v_lshrrev_b32 v122, 2, v120
    v_and_b32 v123, 3, v120
    v_lshrrev_b32 v124, 5, v1
    v_and_b32 v125, 31, v1
    s_cmp_eq_u32 s99, -1
    s_cbranch_scc1 L_p4_done
    s_mov_b32 s63, s99
    s_cmp_eq_u32 s99, -1
    s_cbranch_scc1 L_wpf_done
    s_mov_b32 s76, 0x8000
    v_mov_b32 v114, 4
    s_cmp_lg_u32 s56, 0
    s_cbranch_scc1 L_wpf_gate_x
L_wpf_gate:
    s_add_u32 s101, s101, 1
    s_cmp_gt_u32 s101, 0x400000
    s_cbranch_scc1 L_end
    buffer_load_dword v112, v8, s[4:7], s76 offen sc1
    s_waitcnt vmcnt(0)
    v_cmp_gt_u32 vcc, v114, v112
    s_cbranch_vccz L_wpf_gate_x
    s_sleep 32
    s_branch L_wpf_gate
L_wpf_gate_x:
    s_barrier
    s_lshl2_add_u32 s76, s99, s56
    s_mul_i32 s76, s76, 14336
    s_mov_b32 s77, 0
L_wpf:
    buffer_load_dwordx4 v[16:19], v11, s[36:39], s76 offen
    buffer_load_dwordx4 v[20:23], v11, s[40:43], s76 offen
    s_add_u32 s76, s76, 1024
    s_add_u32 s77, s77, 1
    s_waitcnt vmcnt(2)
    s_cmp_lt_u32 s77, 14
    s_cbranch_scc1 L_wpf
    s_waitcnt vmcnt(0)
L_wpf_done:
    s_mov_b32 s76, 0x8000
    v_mov_b32 v114, 12
    s_cmp_lg_u32 s56, 0
    s_cbranch_scc1 L_p3_gate_x
L_p3_gate:
    s_add_u32 s101, s101, 1
    s_cmp_gt_u32 s101, 0x400000
    s_cbranch_scc1 L_end
    buffer_load_dword v112, v8, s[4:7], s76 offen sc1
    s_waitcnt vmcnt(0)
    v_cmp_gt_u32 vcc, v114, v112
    s_cbranch_vccz L_p3_gate_x
    s_sleep 32
    s_branch L_p3_gate
L_p3_gate_x:
    s_barrier
    v_and_b32 v113, 7, v0
    v_lshlrev_b32 v113, 2, v113
    s_lshr_b32 s76, s59, 7
    s_and_b32 s76, s76, 32
    s_add_u32 s76, s76, 0x180
    s_cmp_lg_u32 s56, 0
    s_cbranch_scc1 L_p3_h_x
L_p3_h:
    s_add_u32 s101, s101, 1
    s_cmp_gt_u32 s101, 0x400000
    s_cbranch_scc1 L_end
    buffer_load_dword v112, v113, s[4:7], s76 offen sc1
    s_waitcnt vmcnt(0)
    v_cmp_ne_u32 vcc, 0x01010101, v112
    s_cbranch_vccz L_p3_h_x
    s_sleep 8
    s_branch L_p3_h
L_p3_h_x:
    s_waitcnt vmcnt(0)
    s_barrier
L_p3_tile:
    v_lshrrev_b32 v112, 3, v1
    v_and_b32 v113, 7, v1
    v_and_b32 v114, 2, v112
    v_lshlrev_b32 v114, 1, v114
    v_xor_b32 v113, v113, v114
    v_lshlrev_b32 v113, 4, v113
    v_lshl_add_u32 v4, v112, 10, v113
    v_mul_u32_u24 v5, 3584, v112
    v_add_u32 v5, v5, v113
    v_lshl_add_u32 v112, v124, 3, v122
    v_lshlrev_b32 v112, 7, v112
    v_and_b32 v113, 2, v122
    v_lshl_add_u32 v112, v113, 5, v112
    v_and_b32 v113, 1, v121
    v_lshl_add_u32 v112, v113, 5, v112
    v_lshl_add_u32 v112, v123, 3, v112
    s_lshl_b32 s62, s56, 15
    v_add_u32 v6, s62, v112
    v_xor_b32 v7, 64, v6
    s_and_b32 s76, s63, 7
    s_lshr_b32 s77, s63, 3
    s_lshl_b32 s60, s56, 19
    s_lshl_b32 s78, s76, 7
    s_add_u32 s60, s60, s78
    s_add_u32 s60, s60, 0x400000
    s_mul_i32 s61, s56, 1835008
    s_lshl_b32 s78, s77, 7
    s_add_u32 s61, s61, s78
    s_add_u32 m0, s62, 0x0
    s_add_u32 s84, s60, 0x0
    buffer_load_dwordx4 v4, s[4:7], s84 offen lds
    s_add_u32 m0, s62, 0x400
    s_add_u32 s84, s60, 0x2000
    buffer_load_dwordx4 v4, s[4:7], s84 offen lds
    s_add_u32 m0, s62, 0x800
    s_add_u32 s84, s60, 0x4000
    buffer_load_dwordx4 v4, s[4:7], s84 offen lds
    s_add_u32 m0, s62, 0xc00
    s_add_u32 s84, s60, 0x6000
    buffer_load_dwordx4 v4, s[4:7], s84 offen lds
    s_add_u32 m0, s62, 0x1000
    s_add_u32 s84, s61, 0x0
    buffer_load_dwordx4 v5, s[36:39], s84 offen lds
    s_add_u32 m0, s62, 0x1400
    s_add_u32 s84, s61, 0x7000
    buffer_load_dwordx4 v5, s[36:39], s84 offen lds
    s_add_u32 m0, s62, 0x1800
    s_add_u32 s84, s61, 0xe000
    buffer_load_dwordx4 v5, s[36:39], s84 offen lds
    s_add_u32 m0, s62, 0x1c00
    s_add_u32 s84, s61, 0x15000
    buffer_load_dwordx4 v5, s[36:39], s84 offen lds
    s_add_u32 m0, s62, 0x2000
    s_add_u32 s84, s60, 0x8000
    buffer_load_dwordx4 v4, s[4:7], s84 offen lds
    s_add_u32 m0, s62, 0x2400
    s_add_u32 s84, s60, 0xa000
    buffer_load_dwordx4 v4, s[4:7], s84 offen lds
    s_add_u32 m0, s62, 0x2800
    s_add_u32 s84, s60, 0xc000
    buffer_load_dwordx4 v4, s[4:7], s84 offen lds
    s_add_u32 m0, s62, 0x2c00
    s_add_u32 s84, s60, 0xe000
    buffer_load_dwordx4 v4, s[4:7], s84 offen lds
    s_add_u32 m0, s62, 0x3000
    s_add_u32 s84, s61, 0x1c000
    buffer_load_dwordx4 v5, s[36:39], s84 offen lds
    s_add_u32 m0, s62, 0x3400
    s_add_u32 s84, s61, 0x23000
    buffer_load_dwordx4 v5, s[36:39], s84 offen lds
    s_add_u32 m0, s62, 0x3800
    s_add_u32 s84, s61, 0x2a000
    buffer_load_dwordx4 v5, s[36:39], s84 offen lds
    s_add_u32 m0, s62, 0x3c00
    s_add_u32 s84, s61, 0x31000
    buffer_load_dwordx4 v5, s[36:39], s84 offen lds
    s_add_u32 m0, s62, 0x4000
    s_add_u32 s84, s60, 0x10000
    buffer_load_dwordx4 v4, s[4:7], s84 offen lds
    s_add_u32 m0, s62, 0x4400
    s_add_u32 s84, s60, 0x12000
    buffer_load_dwordx4 v4, s[4:7], s84 offen lds
    s_add_u32 m0, s62, 0x4800
    s_add_u32 s84, s60, 0x14000
    buffer_load_dwordx4 v4, s[4:7], s84 offen lds
    s_add_u32 m0, s62, 0x4c00
    s_add_u32 s84, s60, 0x16000
    buffer_load_dwordx4 v4, s[4:7], s84 offen lds
    s_add_u32 m0, s62, 0x5000
    s_add_u32 s84, s61, 0x38000
    buffer_load_dwordx4 v5, s[36:39], s84 offen lds
    s_add_u32 m0, s62, 0x5400
    s_add_u32 s84, s61, 0x3f000
    buffer_load_dwordx4 v5, s[36:39], s84 offen lds
    s_add_u32 m0, s62, 0x5800
    s_add_u32 s84, s61, 0x46000
    buffer_load_dwordx4 v5, s[36:39], s84 offen lds
    s_add_u32 m0, s62, 0x5c00
    s_add_u32 s84, s61, 0x4d000
    buffer_load_dwordx4 v5, s[36:39], s84 offen lds
    s_add_u32 m0, s62, 0x6000
    s_add_u32 s84, s60, 0x18000
    buffer_load_dwordx4 v4, s[4:7], s84 offen lds
    s_add_u32 m0, s62, 0x6400
    s_add_u32 s84, s60, 0x1a000
    buffer_load_dwordx4 v4, s[4:7], s84 offen lds
    s_add_u32 m0, s62, 0x6800
    s_add_u32 s84, s60, 0x1c000
    buffer_load_dwordx4 v4, s[4:7], s84 offen lds
    s_add_u32 m0, s62, 0x6c00
    s_add_u32 s84, s60, 0x1e000
    buffer_load_dwordx4 v4, s[4:7], s84 offen lds
    s_add_u32 m0, s62, 0x7000
    s_add_u32 s84, s61, 0x54000
    buffer_load_dwordx4 v5, s[36:39], s84 offen lds
    s_add_u32 m0, s62, 0x7400
    s_add_u32 s84, s61, 0x5b000
    buffer_load_dwordx4 v5, s[36:39], s84 offen lds
    s_add_u32 m0, s62, 0x7800
    s_add_u32 s84, s61, 0x62000
    buffer_load_dwordx4 v5, s[36:39], s84 offen lds
    s_add_u32 m0, s62, 0x7c00
    s_add_u32 s84, s61, 0x69000
    buffer_load_dwordx4 v5, s[36:39], s84 offen lds
    s_lshr_b32 s79, s56, 1
    s_lshl_b32 s80, s77, 7
    s_lshl_b32 s81, s79, 6
    s_add_u32 s80, s80, s81
    v_lshlrev_b32 v112, 3, v124
    buffer_load_dwordx2 v[128:129], v112, s[48:51], s80 offen offset:0
    buffer_load_dwordx2 v[130:131], v112, s[48:51], s80 offen offset:16
    buffer_load_dwordx2 v[132:133], v112, s[48:51], s80 offen offset:32
    buffer_load_dwordx2 v[134:135], v112, s[48:51], s80 offen offset:48
    s_waitcnt vmcnt(28)
    ds_read_b64_tr_b16 v[24:25], v6 offset:4096
    ds_read_b64_tr_b16 v[26:27], v6 offset:4608
    ds_read_b64_tr_b16 v[28:29], v7 offset:4096
    ds_read_b64_tr_b16 v[30:31], v7 offset:4608
    ds_read_b64_tr_b16 v[16:17], v6 offset:0
    ds_read_b64_tr_b16 v[18:19], v6 offset:512
    ds_read_b64_tr_b16 v[20:21], v7 offset:0
    ds_read_b64_tr_b16 v[22:23], v7 offset:512
    s_waitcnt lgkmcnt(0)
    v_mfma_f32_32x32x16_bf16 v[48:63], v[24:27], v[16:19], 0
    ds_read_b64_tr_b16 v[40:41], v6 offset:6144
    ds_read_b64_tr_b16 v[42:43], v6 offset:6656
    v_mfma_f32_32x32x16_bf16 v[64:79], v[24:27], v[20:23], 0
    ds_read_b64_tr_b16 v[44:45], v7 offset:6144
    ds_read_b64_tr_b16 v[46:47], v7 offset:6656
    v_mfma_f32_32x32x16_bf16 v[80:95], v[28:31], v[16:19], 0
    ds_read_b64_tr_b16 v[32:33], v6 offset:2048
    ds_read_b64_tr_b16 v[34:35], v6 offset:2560
    v_mfma_f32_32x32x16_bf16 v[96:111], v[28:31], v[20:23], 0
    ds_read_b64_tr_b16 v[36:37], v7 offset:2048
    ds_read_b64_tr_b16 v[38:39], v7 offset:2560
    s_waitcnt vmcnt(20)
    s_waitcnt lgkmcnt(0)
    v_mfma_f32_32x32x16_bf16 v[48:63], v[40:43], v[32:35], v[48:63]
    ds_read_b64_tr_b16 v[24:25], v6 offset:12288
    ds_read_b64_tr_b16 v[26:27], v6 offset:12800
    v_mfma_f32_32x32x16_bf16 v[64:79], v[40:43], v[36:39], v[64:79]
    ds_read_b64_tr_b16 v[28:29], v7 offset:12288
    ds_read_b64_tr_b16 v[30:31], v7 offset:12800
    v_mfma_f32_32x32x16_bf16 v[80:95], v[44:47], v[32:35], v[80:95]
    ds_read_b64_tr_b16 v[16:17], v6 offset:8192
    ds_read_b64_tr_b16 v[18:19], v6 offset:8704
    v_mfma_f32_32x32x16_bf16 v[96:111], v[44:47], v[36:39], v[96:111]
    ds_read_b64_tr_b16 v[20:21], v7 offset:8192
    ds_read_b64_tr_b16 v[22:23], v7 offset:8704
    s_waitcnt lgkmcnt(0)
    v_mfma_f32_32x32x16_bf16 v[48:63], v[24:27], v[16:19], v[48:63]
    ds_read_b64_tr_b16 v[40:41], v6 offset:14336
    ds_read_b64_tr_b16 v[42:43], v6 offset:14848
    s_add_u32 m0, s62, 0x0
    s_add_u32 s84, s60, 0x20000
    buffer_load_dwordx4 v4, s[4:7], s84 offen lds
    s_add_u32 m0, s62, 0x400
    s_add_u32 s84, s60, 0x22000
    buffer_load_dwordx4 v4, s[4:7], s84 offen lds
    v_mfma_f32_32x32x16_bf16 v[64:79], v[24:27], v[20:23], v[64:79]
    ds_read_b64_tr_b16 v[44:45], v7 offset:14336
    ds_read_b64_tr_b16 v[46:47], v7 offset:14848
    s_add_u32 m0, s62, 0x800
    s_add_u32 s84, s60, 0x24000
    buffer_load_dwordx4 v4, s[4:7], s84 offen lds
    s_add_u32 m0, s62, 0xc00
    s_add_u32 s84, s60, 0x26000
    buffer_load_dwordx4 v4, s[4:7], s84 offen lds
    v_mfma_f32_32x32x16_bf16 v[80:95], v[28:31], v[16:19], v[80:95]
    ds_read_b64_tr_b16 v[32:33], v6 offset:10240
    ds_read_b64_tr_b16 v[34:35], v6 offset:10752
    s_add_u32 m0, s62, 0x1000
    s_add_u32 s84, s61, 0x70000
    buffer_load_dwordx4 v5, s[36:39], s84 offen lds
    s_add_u32 m0, s62, 0x1400
    s_add_u32 s84, s61, 0x77000
    buffer_load_dwordx4 v5, s[36:39], s84 offen lds
    v_mfma_f32_32x32x16_bf16 v[96:111], v[28:31], v[20:23], v[96:111]
    ds_read_b64_tr_b16 v[36:37], v7 offset:10240
    ds_read_b64_tr_b16 v[38:39], v7 offset:10752
    s_add_u32 m0, s62, 0x1800
    s_add_u32 s84, s61, 0x7e000
    buffer_load_dwordx4 v5, s[36:39], s84 offen lds
    s_add_u32 m0, s62, 0x1c00
    s_add_u32 s84, s61, 0x85000
    buffer_load_dwordx4 v5, s[36:39], s84 offen lds
    s_waitcnt vmcnt(20)
    s_waitcnt lgkmcnt(0)
    v_mfma_f32_32x32x16_bf16 v[48:63], v[40:43], v[32:35], v[48:63]
    ds_read_b64_tr_b16 v[24:25], v6 offset:20480
    ds_read_b64_tr_b16 v[26:27], v6 offset:20992
    v_mfma_f32_32x32x16_bf16 v[64:79], v[40:43], v[36:39], v[64:79]
    ds_read_b64_tr_b16 v[28:29], v7 offset:20480
    ds_read_b64_tr_b16 v[30:31], v7 offset:20992
    v_mfma_f32_32x32x16_bf16 v[80:95], v[44:47], v[32:35], v[80:95]
    ds_read_b64_tr_b16 v[16:17], v6 offset:16384
    ds_read_b64_tr_b16 v[18:19], v6 offset:16896
    v_mfma_f32_32x32x16_bf16 v[96:111], v[44:47], v[36:39], v[96:111]
    ds_read_b64_tr_b16 v[20:21], v7 offset:16384
    ds_read_b64_tr_b16 v[22:23], v7 offset:16896
    s_waitcnt lgkmcnt(0)
    v_mfma_f32_32x32x16_bf16 v[48:63], v[24:27], v[16:19], v[48:63]
    ds_read_b64_tr_b16 v[40:41], v6 offset:22528
    ds_read_b64_tr_b16 v[42:43], v6 offset:23040
    s_add_u32 m0, s62, 0x2000
    s_add_u32 s84, s60, 0x28000
    buffer_load_dwordx4 v4, s[4:7], s84 offen lds
    s_add_u32 m0, s62, 0x2400
    s_add_u32 s84, s60, 0x2a000
    buffer_load_dwordx4 v4, s[4:7], s84 offen lds
    v_mfma_f32_32x32x16_bf16 v[64:79], v[24:27], v[20:23], v[64:79]
    ds_read_b64_tr_b16 v[44:45], v7 offset:22528
    ds_read_b64_tr_b16 v[46:47], v7 offset:23040
    s_add_u32 m0, s62, 0x2800
    s_add_u32 s84, s60, 0x2c000
    buffer_load_dwordx4 v4, s[4:7], s84 offen lds
    s_add_u32 m0, s62, 0x2c00
    s_add_u32 s84, s60, 0x2e000
    buffer_load_dwordx4 v4, s[4:7], s84 offen lds
    v_mfma_f32_32x32x16_bf16 v[80:95], v[28:31], v[16:19], v[80:95]
    ds_read_b64_tr_b16 v[32:33], v6 offset:18432
    ds_read_b64_tr_b16 v[34:35], v6 offset:18944
    s_add_u32 m0, s62, 0x3000
    s_add_u32 s84, s61, 0x8c000
    buffer_load_dwordx4 v5, s[36:39], s84 offen lds
    s_add_u32 m0, s62, 0x3400
    s_add_u32 s84, s61, 0x93000
    buffer_load_dwordx4 v5, s[36:39], s84 offen lds
    v_mfma_f32_32x32x16_bf16 v[96:111], v[28:31], v[20:23], v[96:111]
    ds_read_b64_tr_b16 v[36:37], v7 offset:18432
    ds_read_b64_tr_b16 v[38:39], v7 offset:18944
    s_add_u32 m0, s62, 0x3800
    s_add_u32 s84, s61, 0x9a000
    buffer_load_dwordx4 v5, s[36:39], s84 offen lds
    s_add_u32 m0, s62, 0x3c00
    s_add_u32 s84, s61, 0xa1000
    buffer_load_dwordx4 v5, s[36:39], s84 offen lds
    s_waitcnt vmcnt(20)
    s_waitcnt lgkmcnt(0)
    v_mfma_f32_32x32x16_bf16 v[48:63], v[40:43], v[32:35], v[48:63]
    ds_read_b64_tr_b16 v[24:25], v6 offset:28672
    ds_read_b64_tr_b16 v[26:27], v6 offset:29184
    v_mfma_f32_32x32x16_bf16 v[64:79], v[40:43], v[36:39], v[64:79]
    ds_read_b64_tr_b16 v[28:29], v7 offset:28672
    ds_read_b64_tr_b16 v[30:31], v7 offset:29184
    v_mfma_f32_32x32x16_bf16 v[80:95], v[44:47], v[32:35], v[80:95]
    ds_read_b64_tr_b16 v[16:17], v6 offset:24576
    ds_read_b64_tr_b16 v[18:19], v6 offset:25088
    v_mfma_f32_32x32x16_bf16 v[96:111], v[44:47], v[36:39], v[96:111]
    ds_read_b64_tr_b16 v[20:21], v7 offset:24576
    ds_read_b64_tr_b16 v[22:23], v7 offset:25088
    s_waitcnt lgkmcnt(0)
    v_mfma_f32_32x32x16_bf16 v[48:63], v[24:27], v[16:19], v[48:63]
    ds_read_b64_tr_b16 v[40:41], v6 offset:30720
    ds_read_b64_tr_b16 v[42:43], v6 offset:31232
    s_add_u32 m0, s62, 0x4000
    s_add_u32 s84, s60, 0x30000
    buffer_load_dwordx4 v4, s[4:7], s84 offen lds
    s_add_u32 m0, s62, 0x4400
    s_add_u32 s84, s60, 0x32000
    buffer_load_dwordx4 v4, s[4:7], s84 offen lds
    v_mfma_f32_32x32x16_bf16 v[64:79], v[24:27], v[20:23], v[64:79]
    ds_read_b64_tr_b16 v[44:45], v7 offset:30720
    ds_read_b64_tr_b16 v[46:47], v7 offset:31232
    s_add_u32 m0, s62, 0x4800
    s_add_u32 s84, s60, 0x34000
    buffer_load_dwordx4 v4, s[4:7], s84 offen lds
    s_add_u32 m0, s62, 0x4c00
    s_add_u32 s84, s60, 0x36000
    buffer_load_dwordx4 v4, s[4:7], s84 offen lds
    v_mfma_f32_32x32x16_bf16 v[80:95], v[28:31], v[16:19], v[80:95]
    ds_read_b64_tr_b16 v[32:33], v6 offset:26624
    ds_read_b64_tr_b16 v[34:35], v6 offset:27136
    s_add_u32 m0, s62, 0x5000
    s_add_u32 s84, s61, 0xa8000
    buffer_load_dwordx4 v5, s[36:39], s84 offen lds
    s_add_u32 m0, s62, 0x5400
    s_add_u32 s84, s61, 0xaf000
    buffer_load_dwordx4 v5, s[36:39], s84 offen lds
    v_mfma_f32_32x32x16_bf16 v[96:111], v[28:31], v[20:23], v[96:111]
    ds_read_b64_tr_b16 v[36:37], v7 offset:26624
    ds_read_b64_tr_b16 v[38:39], v7 offset:27136
    s_add_u32 m0, s62, 0x5800
    s_add_u32 s84, s61, 0xb6000
    buffer_load_dwordx4 v5, s[36:39], s84 offen lds
    s_add_u32 m0, s62, 0x5c00
    s_add_u32 s84, s61, 0xbd000
    buffer_load_dwordx4 v5, s[36:39], s84 offen lds
    s_waitcnt vmcnt(16)
    s_waitcnt lgkmcnt(0)
    v_mfma_f32_32x32x16_bf16 v[48:63], v[40:43], v[32:35], v[48:63]
    ds_read_b64_tr_b16 v[24:25], v6 offset:4096
    ds_read_b64_tr_b16 v[26:27], v6 offset:4608
    v_mfma_f32_32x32x16_bf16 v[64:79], v[40:43], v[36:39], v[64:79]
    ds_read_b64_tr_b16 v[28:29], v7 offset:4096
    ds_read_b64_tr_b16 v[30:31], v7 offset:4608
    v_mfma_f32_32x32x16_bf16 v[80:95], v[44:47], v[32:35], v[80:95]
    ds_read_b64_tr_b16 v[16:17], v6 offset:0
    ds_read_b64_tr_b16 v[18:19], v6 offset:512
    v_mfma_f32_32x32x16_bf16 v[96:111], v[44:47], v[36:39], v[96:111]
    ds_read_b64_tr_b16 v[20:21], v7 offset:0
    ds_read_b64_tr_b16 v[22:23], v7 offset:512
    s_waitcnt lgkmcnt(0)
    v_mfma_f32_32x32x16_bf16 v[48:63], v[24:27], v[16:19], v[48:63]
    ds_read_b64_tr_b16 v[40:41], v6 offset:6144
    ds_read_b64_tr_b16 v[42:43], v6 offset:6656
    s_add_u32 m0, s62, 0x6000
    s_add_u32 s84, s60, 0x38000
    buffer_load_dwordx4 v4, s[4:7], s84 offen lds
    s_add_u32 m0, s62, 0x6400
    s_add_u32 s84, s60, 0x3a000
    buffer_load_dwordx4 v4, s[4:7], s84 offen lds
    v_mfma_f32_32x32x16_bf16 v[64:79], v[24:27], v[20:23], v[64:79]
    ds_read_b64_tr_b16 v[44:45], v7 offset:6144
    ds_read_b64_tr_b16 v[46:47], v7 offset:6656
    s_add_u32 m0, s62, 0x6800
    s_add_u32 s84, s60, 0x3c000
    buffer_load_dwordx4 v4, s[4:7], s84 offen lds
    s_add_u32 m0, s62, 0x6c00
    s_add_u32 s84, s60, 0x3e000
    buffer_load_dwordx4 v4, s[4:7], s84 offen lds
    v_mfma_f32_32x32x16_bf16 v[80:95], v[28:31], v[16:19], v[80:95]
    ds_read_b64_tr_b16 v[32:33], v6 offset:2048
    ds_read_b64_tr_b16 v[34:35], v6 offset:2560
    s_add_u32 m0, s62, 0x7000
    s_add_u32 s84, s61, 0xc4000
    buffer_load_dwordx4 v5, s[36:39], s84 offen lds
    s_add_u32 m0, s62, 0x7400
    s_add_u32 s84, s61, 0xcb000
    buffer_load_dwordx4 v5, s[36:39], s84 offen lds
    v_mfma_f32_32x32x16_bf16 v[96:111], v[28:31], v[20:23], v[96:111]
    ds_read_b64_tr_b16 v[36:37], v7 offset:2048
    ds_read_b64_tr_b16 v[38:39], v7 offset:2560
    s_add_u32 m0, s62, 0x7800
    s_add_u32 s84, s61, 0xd2000
    buffer_load_dwordx4 v5, s[36:39], s84 offen lds
    s_add_u32 m0, s62, 0x7c00
    s_add_u32 s84, s61, 0xd9000
    buffer_load_dwordx4 v5, s[36:39], s84 offen lds
    s_waitcnt vmcnt(16)
    s_waitcnt lgkmcnt(0)
    v_mfma_f32_32x32x16_bf16 v[48:63], v[40:43], v[32:35], v[48:63]
    ds_read_b64_tr_b16 v[24:25], v6 offset:12288
    ds_read_b64_tr_b16 v[26:27], v6 offset:12800
    v_mfma_f32_32x32x16_bf16 v[64:79], v[40:43], v[36:39], v[64:79]
    ds_read_b64_tr_b16 v[28:29], v7 offset:12288
    ds_read_b64_tr_b16 v[30:31], v7 offset:12800
    v_mfma_f32_32x32x16_bf16 v[80:95], v[44:47], v[32:35], v[80:95]
    ds_read_b64_tr_b16 v[16:17], v6 offset:8192
    ds_read_b64_tr_b16 v[18:19], v6 offset:8704
    v_mfma_f32_32x32x16_bf16 v[96:111], v[44:47], v[36:39], v[96:111]
    ds_read_b64_tr_b16 v[20:21], v7 offset:8192
    ds_read_b64_tr_b16 v[22:23], v7 offset:8704
    s_waitcnt lgkmcnt(0)
    v_mfma_f32_32x32x16_bf16 v[48:63], v[24:27], v[16:19], v[48:63]
    ds_read_b64_tr_b16 v[40:41], v6 offset:14336
    ds_read_b64_tr_b16 v[42:43], v6 offset:14848
    s_add_u32 m0, s62, 0x0
    s_add_u32 s84, s60, 0x40000
    buffer_load_dwordx4 v4, s[4:7], s84 offen lds
    s_add_u32 m0, s62, 0x400
    s_add_u32 s84, s60, 0x42000
    buffer_load_dwordx4 v4, s[4:7], s84 offen lds
    v_mfma_f32_32x32x16_bf16 v[64:79], v[24:27], v[20:23], v[64:79]
    ds_read_b64_tr_b16 v[44:45], v7 offset:14336
    ds_read_b64_tr_b16 v[46:47], v7 offset:14848
    s_add_u32 m0, s62, 0x800
    s_add_u32 s84, s60, 0x44000
    buffer_load_dwordx4 v4, s[4:7], s84 offen lds
    s_add_u32 m0, s62, 0xc00
    s_add_u32 s84, s60, 0x46000
    buffer_load_dwordx4 v4, s[4:7], s84 offen lds
    v_mfma_f32_32x32x16_bf16 v[80:95], v[28:31], v[16:19], v[80:95]
    ds_read_b64_tr_b16 v[32:33], v6 offset:10240
    ds_read_b64_tr_b16 v[34:35], v6 offset:10752
    s_add_u32 m0, s62, 0x1000
    s_add_u32 s84, s61, 0xe0000
    buffer_load_dwordx4 v5, s[36:39], s84 offen lds
    s_add_u32 m0, s62, 0x1400
    s_add_u32 s84, s61, 0xe7000
    buffer_load_dwordx4 v5, s[36:39], s84 offen lds
    v_mfma_f32_32x32x16_bf16 v[96:111], v[28:31], v[20:23], v[96:111]
    ds_read_b64_tr_b16 v[36:37], v7 offset:10240
    ds_read_b64_tr_b16 v[38:39], v7 offset:10752
    s_add_u32 m0, s62, 0x1800
    s_add_u32 s84, s61, 0xee000
    buffer_load_dwordx4 v5, s[36:39], s84 offen lds
    s_add_u32 m0, s62, 0x1c00
    s_add_u32 s84, s61, 0xf5000
    buffer_load_dwordx4 v5, s[36:39], s84 offen lds
    s_waitcnt vmcnt(16)
    s_waitcnt lgkmcnt(0)
    v_mfma_f32_32x32x16_bf16 v[48:63], v[40:43], v[32:35], v[48:63]
    ds_read_b64_tr_b16 v[24:25], v6 offset:20480
    ds_read_b64_tr_b16 v[26:27], v6 offset:20992
    v_mfma_f32_32x32x16_bf16 v[64:79], v[40:43], v[36:39], v[64:79]
    ds_read_b64_tr_b16 v[28:29], v7 offset:20480
    ds_read_b64_tr_b16 v[30:31], v7 offset:20992
    v_mfma_f32_32x32x16_bf16 v[80:95], v[44:47], v[32:35], v[80:95]
    ds_read_b64_tr_b16 v[16:17], v6 offset:16384
    ds_read_b64_tr_b16 v[18:19], v6 offset:16896
    v_mfma_f32_32x32x16_bf16 v[96:111], v[44:47], v[36:39], v[96:111]
    ds_read_b64_tr_b16 v[20:21], v7 offset:16384
    ds_read_b64_tr_b16 v[22:23], v7 offset:16896
    s_waitcnt lgkmcnt(0)
    v_mfma_f32_32x32x16_bf16 v[48:63], v[24:27], v[16:19], v[48:63]
    ds_read_b64_tr_b16 v[40:41], v6 offset:22528
    ds_read_b64_tr_b16 v[42:43], v6 offset:23040
    s_add_u32 m0, s62, 0x2000
    s_add_u32 s84, s60, 0x48000
    buffer_load_dwordx4 v4, s[4:7], s84 offen lds
    s_add_u32 m0, s62, 0x2400
    s_add_u32 s84, s60, 0x4a000
    buffer_load_dwordx4 v4, s[4:7], s84 offen lds
    v_mfma_f32_32x32x16_bf16 v[64:79], v[24:27], v[20:23], v[64:79]
    ds_read_b64_tr_b16 v[44:45], v7 offset:22528
    ds_read_b64_tr_b16 v[46:47], v7 offset:23040
    s_add_u32 m0, s62, 0x2800
    s_add_u32 s84, s60, 0x4c000
    buffer_load_dwordx4 v4, s[4:7], s84 offen lds
    s_add_u32 m0, s62, 0x2c00
    s_add_u32 s84, s60, 0x4e000
    buffer_load_dwordx4 v4, s[4:7], s84 offen lds
    v_mfma_f32_32x32x16_bf16 v[80:95], v[28:31], v[16:19], v[80:95]
    ds_read_b64_tr_b16 v[32:33], v6 offset:18432
    ds_read_b64_tr_b16 v[34:35], v6 offset:18944
    s_add_u32 m0, s62, 0x3000
    s_add_u32 s84, s61, 0xfc000
    buffer_load_dwordx4 v5, s[36:39], s84 offen lds
    s_add_u32 m0, s62, 0x3400
    s_add_u32 s84, s61, 0x103000
    buffer_load_dwordx4 v5, s[36:39], s84 offen lds
    v_mfma_f32_32x32x16_bf16 v[96:111], v[28:31], v[20:23], v[96:111]
    ds_read_b64_tr_b16 v[36:37], v7 offset:18432
    ds_read_b64_tr_b16 v[38:39], v7 offset:18944
    s_add_u32 m0, s62, 0x3800
    s_add_u32 s84, s61, 0x10a000
    buffer_load_dwordx4 v5, s[36:39], s84 offen lds
    s_add_u32 m0, s62, 0x3c00
    s_add_u32 s84, s61, 0x111000
    buffer_load_dwordx4 v5, s[36:39], s84 offen lds
    s_waitcnt vmcnt(16)
    s_waitcnt lgkmcnt(0)
    v_mfma_f32_32x32x16_bf16 v[48:63], v[40:43], v[32:35], v[48:63]
    ds_read_b64_tr_b16 v[24:25], v6 offset:28672
    ds_read_b64_tr_b16 v[26:27], v6 offset:29184
    v_mfma_f32_32x32x16_bf16 v[64:79], v[40:43], v[36:39], v[64:79]
    ds_read_b64_tr_b16 v[28:29], v7 offset:28672
    ds_read_b64_tr_b16 v[30:31], v7 offset:29184
    v_mfma_f32_32x32x16_bf16 v[80:95], v[44:47], v[32:35], v[80:95]
    ds_read_b64_tr_b16 v[16:17], v6 offset:24576
    ds_read_b64_tr_b16 v[18:19], v6 offset:25088
    v_mfma_f32_32x32x16_bf16 v[96:111], v[44:47], v[36:39], v[96:111]
    ds_read_b64_tr_b16 v[20:21], v7 offset:24576
    ds_read_b64_tr_b16 v[22:23], v7 offset:25088
    s_waitcnt lgkmcnt(0)
    v_mfma_f32_32x32x16_bf16 v[48:63], v[24:27], v[16:19], v[48:63]
    ds_read_b64_tr_b16 v[40:41], v6 offset:30720
    ds_read_b64_tr_b16 v[42:43], v6 offset:31232
    s_add_u32 m0, s62, 0x4000
    s_add_u32 s84, s60, 0x50000
    buffer_load_dwordx4 v4, s[4:7], s84 offen lds
    s_add_u32 m0, s62, 0x4400
    s_add_u32 s84, s60, 0x52000
    buffer_load_dwordx4 v4, s[4:7], s84 offen lds
    v_mfma_f32_32x32x16_bf16 v[64:79], v[24:27], v[20:23], v[64:79]
    ds_read_b64_tr_b16 v[44:45], v7 offset:30720
    ds_read_b64_tr_b16 v[46:47], v7 offset:31232
    s_add_u32 m0, s62, 0x4800
    s_add_u32 s84, s60, 0x54000
    buffer_load_dwordx4 v4, s[4:7], s84 offen lds
    s_add_u32 m0, s62, 0x4c00
    s_add_u32 s84, s60, 0x56000
    buffer_load_dwordx4 v4, s[4:7], s84 offen lds
    v_mfma_f32_32x32x16_bf16 v[80:95], v[28:31], v[16:19], v[80:95]
    ds_read_b64_tr_b16 v[32:33], v6 offset:26624
    ds_read_b64_tr_b16 v[34:35], v6 offset:27136
    s_add_u32 m0, s62, 0x5000
    s_add_u32 s84, s61, 0x118000
    buffer_load_dwordx4 v5, s[36:39], s84 offen lds
    s_add_u32 m0, s62, 0x5400
    s_add_u32 s84, s61, 0x11f000
    buffer_load_dwordx4 v5, s[36:39], s84 offen lds
    v_mfma_f32_32x32x16_bf16 v[96:111], v[28:31], v[20:23], v[96:111]
    ds_read_b64_tr_b16 v[36:37], v7 offset:26624
    ds_read_b64_tr_b16 v[38:39], v7 offset:27136
    s_add_u32 m0, s62, 0x5800
    s_add_u32 s84, s61, 0x126000
    buffer_load_dwordx4 v5, s[36:39], s84 offen lds
    s_add_u32 m0, s62, 0x5c00
    s_add_u32 s84, s61, 0x12d000
    buffer_load_dwordx4 v5, s[36:39], s84 offen lds
    s_waitcnt vmcnt(16)
    s_waitcnt lgkmcnt(0)
    v_mfma_f32_32x32x16_bf16 v[48:63], v[40:43], v[32:35], v[48:63]
    ds_read_b64_tr_b16 v[24:25], v6 offset:4096
    ds_read_b64_tr_b16 v[26:27], v6 offset:4608
    v_mfma_f32_32x32x16_bf16 v[64:79], v[40:43], v[36:39], v[64:79]
    ds_read_b64_tr_b16 v[28:29], v7 offset:4096
    ds_read_b64_tr_b16 v[30:31], v7 offset:4608
    v_mfma_f32_32x32x16_bf16 v[80:95], v[44:47], v[32:35], v[80:95]
    ds_read_b64_tr_b16 v[16:17], v6 offset:0
    ds_read_b64_tr_b16 v[18:19], v6 offset:512
    v_mfma_f32_32x32x16_bf16 v[96:111], v[44:47], v[36:39], v[96:111]
    ds_read_b64_tr_b16 v[20:21], v7 offset:0
    ds_read_b64_tr_b16 v[22:23], v7 offset:512
    s_waitcnt lgkmcnt(0)
    v_mfma_f32_32x32x16_bf16 v[48:63], v[24:27], v[16:19], v[48:63]
    ds_read_b64_tr_b16 v[40:41], v6 offset:6144
    ds_read_b64_tr_b16 v[42:43], v6 offset:6656
    s_add_u32 m0, s62, 0x6000
    s_add_u32 s84, s60, 0x58000
    buffer_load_dwordx4 v4, s[4:7], s84 offen lds
    s_add_u32 m0, s62, 0x6400
    s_add_u32 s84, s60, 0x5a000
    buffer_load_dwordx4 v4, s[4:7], s84 offen lds
    v_mfma_f32_32x32x16_bf16 v[64:79], v[24:27], v[20:23], v[64:79]
    ds_read_b64_tr_b16 v[44:45], v7 offset:6144
    ds_read_b64_tr_b16 v[46:47], v7 offset:6656
    s_add_u32 m0, s62, 0x6800
    s_add_u32 s84, s60, 0x5c000
    buffer_load_dwordx4 v4, s[4:7], s84 offen lds
    s_add_u32 m0, s62, 0x6c00
    s_add_u32 s84, s60, 0x5e000
    buffer_load_dwordx4 v4, s[4:7], s84 offen lds
    v_mfma_f32_32x32x16_bf16 v[80:95], v[28:31], v[16:19], v[80:95]
    ds_read_b64_tr_b16 v[32:33], v6 offset:2048
    ds_read_b64_tr_b16 v[34:35], v6 offset:2560
    s_add_u32 m0, s62, 0x7000
    s_add_u32 s84, s61, 0x134000
    buffer_load_dwordx4 v5, s[36:39], s84 offen lds
    s_add_u32 m0, s62, 0x7400
    s_add_u32 s84, s61, 0x13b000
    buffer_load_dwordx4 v5, s[36:39], s84 offen lds
    v_mfma_f32_32x32x16_bf16 v[96:111], v[28:31], v[20:23], v[96:111]
    ds_read_b64_tr_b16 v[36:37], v7 offset:2048
    ds_read_b64_tr_b16 v[38:39], v7 offset:2560
    s_add_u32 m0, s62, 0x7800
    s_add_u32 s84, s61, 0x142000
    buffer_load_dwordx4 v5, s[36:39], s84 offen lds
    s_add_u32 m0, s62, 0x7c00
    s_add_u32 s84, s61, 0x149000
    buffer_load_dwordx4 v5, s[36:39], s84 offen lds
    s_waitcnt vmcnt(16)
    s_waitcnt lgkmcnt(0)
    v_mfma_f32_32x32x16_bf16 v[48:63], v[40:43], v[32:35], v[48:63]
    ds_read_b64_tr_b16 v[24:25], v6 offset:12288
    ds_read_b64_tr_b16 v[26:27], v6 offset:12800
    v_mfma_f32_32x32x16_bf16 v[64:79], v[40:43], v[36:39], v[64:79]
    ds_read_b64_tr_b16 v[28:29], v7 offset:12288
    ds_read_b64_tr_b16 v[30:31], v7 offset:12800
    v_mfma_f32_32x32x16_bf16 v[80:95], v[44:47], v[32:35], v[80:95]
    ds_read_b64_tr_b16 v[16:17], v6 offset:8192
    ds_read_b64_tr_b16 v[18:19], v6 offset:8704
    v_mfma_f32_32x32x16_bf16 v[96:111], v[44:47], v[36:39], v[96:111]
    ds_read_b64_tr_b16 v[20:21], v7 offset:8192
    ds_read_b64_tr_b16 v[22:23], v7 offset:8704
    s_waitcnt lgkmcnt(0)
    v_mfma_f32_32x32x16_bf16 v[48:63], v[24:27], v[16:19], v[48:63]
    ds_read_b64_tr_b16 v[40:41], v6 offset:14336
    ds_read_b64_tr_b16 v[42:43], v6 offset:14848
    s_add_u32 m0, s62, 0x0
    s_add_u32 s84, s60, 0x60000
    buffer_load_dwordx4 v4, s[4:7], s84 offen lds
    s_add_u32 m0, s62, 0x400
    s_add_u32 s84, s60, 0x62000
    buffer_load_dwordx4 v4, s[4:7], s84 offen lds
    v_mfma_f32_32x32x16_bf16 v[64:79], v[24:27], v[20:23], v[64:79]
    ds_read_b64_tr_b16 v[44:45], v7 offset:14336
    ds_read_b64_tr_b16 v[46:47], v7 offset:14848
    s_add_u32 m0, s62, 0x800
    s_add_u32 s84, s60, 0x64000
    buffer_load_dwordx4 v4, s[4:7], s84 offen lds
    s_add_u32 m0, s62, 0xc00
    s_add_u32 s84, s60, 0x66000
    buffer_load_dwordx4 v4, s[4:7], s84 offen lds
    v_mfma_f32_32x32x16_bf16 v[80:95], v[28:31], v[16:19], v[80:95]
    ds_read_b64_tr_b16 v[32:33], v6 offset:10240
    ds_read_b64_tr_b16 v[34:35], v6 offset:10752
    s_add_u32 m0, s62, 0x1000
    s_add_u32 s84, s61, 0x150000
    buffer_load_dwordx4 v5, s[36:39], s84 offen lds
    s_add_u32 m0, s62, 0x1400
    s_add_u32 s84, s61, 0x157000
    buffer_load_dwordx4 v5, s[36:39], s84 offen lds
    v_mfma_f32_32x32x16_bf16 v[96:111], v[28:31], v[20:23], v[96:111]
    ds_read_b64_tr_b16 v[36:37], v7 offset:10240
    ds_read_b64_tr_b16 v[38:39], v7 offset:10752
    s_add_u32 m0, s62, 0x1800
    s_add_u32 s84, s61, 0x15e000
    buffer_load_dwordx4 v5, s[36:39], s84 offen lds
    s_add_u32 m0, s62, 0x1c00
    s_add_u32 s84, s61, 0x165000
    buffer_load_dwordx4 v5, s[36:39], s84 offen lds
    s_waitcnt vmcnt(16)
    s_waitcnt lgkmcnt(0)
    v_mfma_f32_32x32x16_bf16 v[48:63], v[40:43], v[32:35], v[48:63]
    ds_read_b64_tr_b16 v[24:25], v6 offset:20480
    ds_read_b64_tr_b16 v[26:27], v6 offset:20992
    v_mfma_f32_32x32x16_bf16 v[64:79], v[40:43], v[36:39], v[64:79]
    ds_read_b64_tr_b16 v[28:29], v7 offset:20480
    ds_read_b64_tr_b16 v[30:31], v7 offset:20992
    v_mfma_f32_32x32x16_bf16 v[80:95], v[44:47], v[32:35], v[80:95]
    ds_read_b64_tr_b16 v[16:17], v6 offset:16384
    ds_read_b64_tr_b16 v[18:19], v6 offset:16896
    v_mfma_f32_32x32x16_bf16 v[96:111], v[44:47], v[36:39], v[96:111]
    ds_read_b64_tr_b16 v[20:21], v7 offset:16384
    ds_read_b64_tr_b16 v[22:23], v7 offset:16896
    s_waitcnt lgkmcnt(0)
    v_mfma_f32_32x32x16_bf16 v[48:63], v[24:27], v[16:19], v[48:63]
    ds_read_b64_tr_b16 v[40:41], v6 offset:22528
    ds_read_b64_tr_b16 v[42:43], v6 offset:23040
    s_add_u32 m0, s62, 0x2000
    s_add_u32 s84, s60, 0x68000
    buffer_load_dwordx4 v4, s[4:7], s84 offen lds
    s_add_u32 m0, s62, 0x2400
    s_add_u32 s84, s60, 0x6a000
    buffer_load_dwordx4 v4, s[4:7], s84 offen lds
    v_mfma_f32_32x32x16_bf16 v[64:79], v[24:27], v[20:23], v[64:79]
    ds_read_b64_tr_b16 v[44:45], v7 offset:22528
    ds_read_b64_tr_b16 v[46:47], v7 offset:23040
    s_add_u32 m0, s62, 0x2800
    s_add_u32 s84, s60, 0x6c000
    buffer_load_dwordx4 v4, s[4:7], s84 offen lds
    s_add_u32 m0, s62, 0x2c00
    s_add_u32 s84, s60, 0x6e000
    buffer_load_dwordx4 v4, s[4:7], s84 offen lds
    v_mfma_f32_32x32x16_bf16 v[80:95], v[28:31], v[16:19], v[80:95]
    ds_read_b64_tr_b16 v[32:33], v6 offset:18432
    ds_read_b64_tr_b16 v[34:35], v6 offset:18944
    s_add_u32 m0, s62, 0x3000
    s_add_u32 s84, s61, 0x16c000
    buffer_load_dwordx4 v5, s[36:39], s84 offen lds
    s_add_u32 m0, s62, 0x3400
    s_add_u32 s84, s61, 0x173000
    buffer_load_dwordx4 v5, s[36:39], s84 offen lds
    v_mfma_f32_32x32x16_bf16 v[96:111], v[28:31], v[20:23], v[96:111]
    ds_read_b64_tr_b16 v[36:37], v7 offset:18432
    ds_read_b64_tr_b16 v[38:39], v7 offset:18944
    s_add_u32 m0, s62, 0x3800
    s_add_u32 s84, s61, 0x17a000
    buffer_load_dwordx4 v5, s[36:39], s84 offen lds
    s_add_u32 m0, s62, 0x3c00
    s_add_u32 s84, s61, 0x181000
    buffer_load_dwordx4 v5, s[36:39], s84 offen lds
    s_waitcnt vmcnt(16)
    s_waitcnt lgkmcnt(0)
    v_mfma_f32_32x32x16_bf16 v[48:63], v[40:43], v[32:35], v[48:63]
    ds_read_b64_tr_b16 v[24:25], v6 offset:28672
    ds_read_b64_tr_b16 v[26:27], v6 offset:29184
    v_mfma_f32_32x32x16_bf16 v[64:79], v[40:43], v[36:39], v[64:79]
    ds_read_b64_tr_b16 v[28:29], v7 offset:28672
    ds_read_b64_tr_b16 v[30:31], v7 offset:29184
    v_mfma_f32_32x32x16_bf16 v[80:95], v[44:47], v[32:35], v[80:95]
    ds_read_b64_tr_b16 v[16:17], v6 offset:24576
    ds_read_b64_tr_b16 v[18:19], v6 offset:25088
    v_mfma_f32_32x32x16_bf16 v[96:111], v[44:47], v[36:39], v[96:111]
    ds_read_b64_tr_b16 v[20:21], v7 offset:24576
    ds_read_b64_tr_b16 v[22:23], v7 offset:25088
    s_waitcnt lgkmcnt(0)
    v_mfma_f32_32x32x16_bf16 v[48:63], v[24:27], v[16:19], v[48:63]
    ds_read_b64_tr_b16 v[40:41], v6 offset:30720
    ds_read_b64_tr_b16 v[42:43], v6 offset:31232
    s_add_u32 m0, s62, 0x4000
    s_add_u32 s84, s60, 0x70000
    buffer_load_dwordx4 v4, s[4:7], s84 offen lds
    s_add_u32 m0, s62, 0x4400
    s_add_u32 s84, s60, 0x72000
    buffer_load_dwordx4 v4, s[4:7], s84 offen lds
    v_mfma_f32_32x32x16_bf16 v[64:79], v[24:27], v[20:23], v[64:79]
    ds_read_b64_tr_b16 v[44:45], v7 offset:30720
    ds_read_b64_tr_b16 v[46:47], v7 offset:31232
    s_add_u32 m0, s62, 0x4800
    s_add_u32 s84, s60, 0x74000
    buffer_load_dwordx4 v4, s[4:7], s84 offen lds
    s_add_u32 m0, s62, 0x4c00
    s_add_u32 s84, s60, 0x76000
    buffer_load_dwordx4 v4, s[4:7], s84 offen lds
    v_mfma_f32_32x32x16_bf16 v[80:95], v[28:31], v[16:19], v[80:95]
    ds_read_b64_tr_b16 v[32:33], v6 offset:26624
    ds_read_b64_tr_b16 v[34:35], v6 offset:27136
    s_add_u32 m0, s62, 0x5000
    s_add_u32 s84, s61, 0x188000
    buffer_load_dwordx4 v5, s[36:39], s84 offen lds
    s_add_u32 m0, s62, 0x5400
    s_add_u32 s84, s61, 0x18f000
    buffer_load_dwordx4 v5, s[36:39], s84 offen lds
    v_mfma_f32_32x32x16_bf16 v[96:111], v[28:31], v[20:23], v[96:111]
    ds_read_b64_tr_b16 v[36:37], v7 offset:26624
    ds_read_b64_tr_b16 v[38:39], v7 offset:27136
    s_add_u32 m0, s62, 0x5800
    s_add_u32 s84, s61, 0x196000
    buffer_load_dwordx4 v5, s[36:39], s84 offen lds
    s_add_u32 m0, s62, 0x5c00
    s_add_u32 s84, s61, 0x19d000
    buffer_load_dwordx4 v5, s[36:39], s84 offen lds
    s_waitcnt vmcnt(16)
    s_waitcnt lgkmcnt(0)
    v_mfma_f32_32x32x16_bf16 v[48:63], v[40:43], v[32:35], v[48:63]
    ds_read_b64_tr_b16 v[24:25], v6 offset:4096
    ds_read_b64_tr_b16 v[26:27], v6 offset:4608
    v_mfma_f32_32x32x16_bf16 v[64:79], v[40:43], v[36:39], v[64:79]
    ds_read_b64_tr_b16 v[28:29], v7 offset:4096
    ds_read_b64_tr_b16 v[30:31], v7 offset:4608
    v_mfma_f32_32x32x16_bf16 v[80:95], v[44:47], v[32:35], v[80:95]
    ds_read_b64_tr_b16 v[16:17], v6 offset:0
    ds_read_b64_tr_b16 v[18:19], v6 offset:512
    v_mfma_f32_32x32x16_bf16 v[96:111], v[44:47], v[36:39], v[96:111]
    ds_read_b64_tr_b16 v[20:21], v7 offset:0
    ds_read_b64_tr_b16 v[22:23], v7 offset:512
    s_waitcnt lgkmcnt(0)
    v_mfma_f32_32x32x16_bf16 v[48:63], v[24:27], v[16:19], v[48:63]
    ds_read_b64_tr_b16 v[40:41], v6 offset:6144
    ds_read_b64_tr_b16 v[42:43], v6 offset:6656
    s_add_u32 m0, s62, 0x6000
    s_add_u32 s84, s60, 0x78000
    buffer_load_dwordx4 v4, s[4:7], s84 offen lds
    s_add_u32 m0, s62, 0x6400
    s_add_u32 s84, s60, 0x7a000
    buffer_load_dwordx4 v4, s[4:7], s84 offen lds
    v_mfma_f32_32x32x16_bf16 v[64:79], v[24:27], v[20:23], v[64:79]
    ds_read_b64_tr_b16 v[44:45], v7 offset:6144
    ds_read_b64_tr_b16 v[46:47], v7 offset:6656
    s_add_u32 m0, s62, 0x6800
    s_add_u32 s84, s60, 0x7c000
    buffer_load_dwordx4 v4, s[4:7], s84 offen lds
    s_add_u32 m0, s62, 0x6c00
    s_add_u32 s84, s60, 0x7e000
    buffer_load_dwordx4 v4, s[4:7], s84 offen lds
    v_mfma_f32_32x32x16_bf16 v[80:95], v[28:31], v[16:19], v[80:95]
    ds_read_b64_tr_b16 v[32:33], v6 offset:2048
    ds_read_b64_tr_b16 v[34:35], v6 offset:2560
    s_add_u32 m0, s62, 0x7000
    s_add_u32 s84, s61, 0x1a4000
    buffer_load_dwordx4 v5, s[36:39], s84 offen lds
    s_add_u32 m0, s62, 0x7400
    s_add_u32 s84, s61, 0x1ab000
    buffer_load_dwordx4 v5, s[36:39], s84 offen lds
    v_mfma_f32_32x32x16_bf16 v[96:111], v[28:31], v[20:23], v[96:111]
    ds_read_b64_tr_b16 v[36:37], v7 offset:2048
    ds_read_b64_tr_b16 v[38:39], v7 offset:2560
    s_add_u32 m0, s62, 0x7800
    s_add_u32 s84, s61, 0x1b2000
    buffer_load_dwordx4 v5, s[36:39], s84 offen lds
    s_add_u32 m0, s62, 0x7c00
    s_add_u32 s84, s61, 0x1b9000
    buffer_load_dwordx4 v5, s[36:39], s84 offen lds
    s_waitcnt vmcnt(16)
    s_waitcnt lgkmcnt(0)
    v_mfma_f32_32x32x16_bf16 v[48:63], v[40:43], v[32:35], v[48:63]
    ds_read_b64_tr_b16 v[24:25], v6 offset:12288
    ds_read_b64_tr_b16 v[26:27], v6 offset:12800
    v_mfma_f32_32x32x16_bf16 v[64:79], v[40:43], v[36:39], v[64:79]
    ds_read_b64_tr_b16 v[28:29], v7 offset:12288
    ds_read_b64_tr_b16 v[30:31], v7 offset:12800
    v_mfma_f32_32x32x16_bf16 v[80:95], v[44:47], v[32:35], v[80:95]
    ds_read_b64_tr_b16 v[16:17], v6 offset:8192
    ds_read_b64_tr_b16 v[18:19], v6 offset:8704
    v_mfma_f32_32x32x16_bf16 v[96:111], v[44:47], v[36:39], v[96:111]
    ds_read_b64_tr_b16 v[20:21], v7 offset:8192
    ds_read_b64_tr_b16 v[22:23], v7 offset:8704
    s_waitcnt lgkmcnt(0)
    v_mfma_f32_32x32x16_bf16 v[48:63], v[24:27], v[16:19], v[48:63]
    ds_read_b64_tr_b16 v[40:41], v6 offset:14336
    ds_read_b64_tr_b16 v[42:43], v6 offset:14848
    v_mfma_f32_32x32x16_bf16 v[64:79], v[24:27], v[20:23], v[64:79]
    ds_read_b64_tr_b16 v[44:45], v7 offset:14336
    ds_read_b64_tr_b16 v[46:47], v7 offset:14848
    v_mfma_f32_32x32x16_bf16 v[80:95], v[28:31], v[16:19], v[80:95]
    ds_read_b64_tr_b16 v[32:33], v6 offset:10240
    ds_read_b64_tr_b16 v[34:35], v6 offset:10752
    v_mfma_f32_32x32x16_bf16 v[96:111], v[28:31], v[20:23], v[96:111]
    ds_read_b64_tr_b16 v[36:37], v7 offset:10240
    ds_read_b64_tr_b16 v[38:39], v7 offset:10752
    s_waitcnt vmcnt(8)
    s_waitcnt lgkmcnt(0)
    v_mfma_f32_32x32x16_bf16 v[48:63], v[40:43], v[32:35], v[48:63]
    ds_read_b64_tr_b16 v[24:25], v6 offset:20480
    ds_read_b64_tr_b16 v[26:27], v6 offset:20992
    v_mfma_f32_32x32x16_bf16 v[64:79], v[40:43], v[36:39], v[64:79]
    ds_read_b64_tr_b16 v[28:29], v7 offset:20480
    ds_read_b64_tr_b16 v[30:31], v7 offset:20992
    v_mfma_f32_32x32x16_bf16 v[80:95], v[44:47], v[32:35], v[80:95]
    ds_read_b64_tr_b16 v[16:17], v6 offset:16384
    ds_read_b64_tr_b16 v[18:19], v6 offset:16896
    v_mfma_f32_32x32x16_bf16 v[96:111], v[44:47], v[36:39], v[96:111]
    ds_read_b64_tr_b16 v[20:21], v7 offset:16384
    ds_read_b64_tr_b16 v[22:23], v7 offset:16896
    s_waitcnt lgkmcnt(0)
    v_mfma_f32_32x32x16_bf16 v[48:63], v[24:27], v[16:19], v[48:63]
    ds_read_b64_tr_b16 v[40:41], v6 offset:22528
    ds_read_b64_tr_b16 v[42:43], v6 offset:23040
    v_mfma_f32_32x32x16_bf16 v[64:79], v[24:27], v[20:23], v[64:79]
    ds_read_b64_tr_b16 v[44:45], v7 offset:22528
    ds_read_b64_tr_b16 v[46:47], v7 offset:23040
    v_mfma_f32_32x32x16_bf16 v[80:95], v[28:31], v[16:19], v[80:95]
    ds_read_b64_tr_b16 v[32:33], v6 offset:18432
    ds_read_b64_tr_b16 v[34:35], v6 offset:18944
    v_mfma_f32_32x32x16_bf16 v[96:111], v[28:31], v[20:23], v[96:111]
    ds_read_b64_tr_b16 v[36:37], v7 offset:18432
    ds_read_b64_tr_b16 v[38:39], v7 offset:18944
    s_waitcnt vmcnt(0)
    s_waitcnt lgkmcnt(0)
    v_mfma_f32_32x32x16_bf16 v[48:63], v[40:43], v[32:35], v[48:63]
    ds_read_b64_tr_b16 v[24:25], v6 offset:28672
    ds_read_b64_tr_b16 v[26:27], v6 offset:29184
    v_mfma_f32_32x32x16_bf16 v[64:79], v[40:43], v[36:39], v[64:79]
    ds_read_b64_tr_b16 v[28:29], v7 offset:28672
    ds_read_b64_tr_b16 v[30:31], v7 offset:29184
    v_mfma_f32_32x32x16_bf16 v[80:95], v[44:47], v[32:35], v[80:95]
    ds_read_b64_tr_b16 v[16:17], v6 offset:24576
    ds_read_b64_tr_b16 v[18:19], v6 offset:25088
    v_mfma_f32_32x32x16_bf16 v[96:111], v[44:47], v[36:39], v[96:111]
    ds_read_b64_tr_b16 v[20:21], v7 offset:24576
    ds_read_b64_tr_b16 v[22:23], v7 offset:25088
    s_waitcnt lgkmcnt(0)
    v_mfma_f32_32x32x16_bf16 v[48:63], v[24:27], v[16:19], v[48:63]
    ds_read_b64_tr_b16 v[40:41], v6 offset:30720
    ds_read_b64_tr_b16 v[42:43], v6 offset:31232
    v_mfma_f32_32x32x16_bf16 v[64:79], v[24:27], v[20:23], v[64:79]
    ds_read_b64_tr_b16 v[44:45], v7 offset:30720
    ds_read_b64_tr_b16 v[46:47], v7 offset:31232
    v_mfma_f32_32x32x16_bf16 v[80:95], v[28:31], v[16:19], v[80:95]
    ds_read_b64_tr_b16 v[32:33], v6 offset:26624
    ds_read_b64_tr_b16 v[34:35], v6 offset:27136
    v_mfma_f32_32x32x16_bf16 v[96:111], v[28:31], v[20:23], v[96:111]
    ds_read_b64_tr_b16 v[36:37], v7 offset:26624
    ds_read_b64_tr_b16 v[38:39], v7 offset:27136
    s_waitcnt lgkmcnt(0)
    v_mfma_f32_32x32x16_bf16 v[48:63], v[40:43], v[32:35], v[48:63]
    v_mfma_f32_32x32x16_bf16 v[64:79], v[40:43], v[36:39], v[64:79]
    v_mfma_f32_32x32x16_bf16 v[80:95], v[44:47], v[32:35], v[80:95]
    v_mfma_f32_32x32x16_bf16 v[96:111], v[44:47], v[36:39], v[96:111]
    s_nop 11
    v_add_u32 v112, s62, v11
    ds_write_b128 v112, v[48:51] offset:0
    ds_write_b128 v112, v[52:55] offset:1024
    ds_write_b128 v112, v[56:59] offset:2048
    ds_write_b128 v112, v[60:63] offset:3072
    ds_write_b128 v112, v[64:67] offset:4096
    ds_write_b128 v112, v[68:71] offset:5120
    ds_write_b128 v112, v[72:75] offset:6144
    ds_write_b128 v112, v[76:79] offset:7168
    ds_write_b128 v112, v[80:83] offset:8192
    ds_write_b128 v112, v[84:87] offset:9216
    ds_write_b128 v112, v[88:91] offset:10240
    ds_write_b128 v112, v[92:95] offset:11264
    ds_write_b128 v112, v[96:99] offset:12288
    ds_write_b128 v112, v[100:103] offset:13312
    ds_write_b128 v112, v[104:107] offset:14336
    ds_write_b128 v112, v[108:111] offset:15360
    s_lshl_b32 s81, s56, 12
    v_add_u32 v112, s81, v11
    v_add_u32 v113, 0x10000, v112
    s_waitcnt lgkmcnt(0)
    s_barrier
    ds_read_b128 v[48:51], v112 offset:0
    ds_read_b128 v[52:55], v112 offset:1024
    ds_read_b128 v[56:59], v112 offset:2048
    ds_read_b128 v[60:63], v112 offset:3072
    ds_read_b128 v[64:67], v112 offset:32768
    ds_read_b128 v[68:71], v112 offset:33792
    ds_read_b128 v[72:75], v112 offset:34816
    ds_read_b128 v[76:79], v112 offset:35840
    ds_read_b128 v[80:83], v113 offset:0
    ds_read_b128 v[84:87], v113 offset:1024
    ds_read_b128 v[88:91], v113 offset:2048
    ds_read_b128 v[92:95], v113 offset:3072
    ds_read_b128 v[96:99], v113 offset:32768
    ds_read_b128 v[100:103], v113 offset:33792
    ds_read_b128 v[104:107], v113 offset:34816
    ds_read_b128 v[108:111], v113 offset:35840
    s_waitcnt vmcnt(0) lgkmcnt(0)
    v_add_f32 v48, v48, v64
    v_add_f32 v80, v80, v96
    v_add_f32 v49, v49, v65
    v_add_f32 v81, v81, v97
    v_add_f32 v50, v50, v66
    v_add_f32 v82, v82, v98
    v_add_f32 v51, v51, v67
    v_add_f32 v83, v83, v99
    v_add_f32 v52, v52, v68
    v_add_f32 v84, v84, v100
    v_add_f32 v53, v53, v69
    v_add_f32 v85, v85, v101
    v_add_f32 v54, v54, v70
    v_add_f32 v86, v86, v102
    v_add_f32 v55, v55, v71
    v_add_f32 v87, v87, v103
    v_add_f32 v56, v56, v72
    v_add_f32 v88, v88, v104
    v_add_f32 v57, v57, v73
    v_add_f32 v89, v89, v105
    v_add_f32 v58, v58, v74
    v_add_f32 v90, v90, v106
    v_add_f32 v59, v59, v75
    v_add_f32 v91, v91, v107
    v_add_f32 v60, v60, v76
    v_add_f32 v92, v92, v108
    v_add_f32 v61, v61, v77
    v_add_f32 v93, v93, v109
    v_add_f32 v62, v62, v78
    v_add_f32 v94, v94, v110
    v_add_f32 v63, v63, v79
    v_add_f32 v95, v95, v111
    v_add_f32 v48, v48, v80
    v_add_f32 v49, v49, v81
    v_add_f32 v50, v50, v82
    v_add_f32 v51, v51, v83
    v_add_f32 v52, v52, v84
    v_add_f32 v53, v53, v85
    v_add_f32 v54, v54, v86
    v_add_f32 v55, v55, v87
    v_add_f32 v56, v56, v88
    v_add_f32 v57, v57, v89
    v_add_f32 v58, v58, v90
    v_add_f32 v59, v59, v91
    v_add_f32 v60, v60, v92
    v_add_f32 v61, v61, v93
    v_add_f32 v62, v62, v94
    v_add_f32 v63, v63, v95
    v_cvt_pk_bf16_f32 v112, v48, v49
    v_lshlrev_b32 v48, 16, v112
    v_and_b32 v49, 0xffff0000, v112
    v_cvt_pk_bf16_f32 v112, v50, v51
    v_lshlrev_b32 v50, 16, v112
    v_and_b32 v51, 0xffff0000, v112
    v_cvt_pk_bf16_f32 v112, v52, v53
    v_lshlrev_b32 v52, 16, v112
    v_and_b32 v53, 0xffff0000, v112
    v_cvt_pk_bf16_f32 v112, v54, v55
    v_lshlrev_b32 v54, 16, v112
    v_and_b32 v55, 0xffff0000, v112
    v_cvt_pk_bf16_f32 v112, v56, v57
    v_lshlrev_b32 v56, 16, v112
    v_and_b32 v57, 0xffff0000, v112
    v_cvt_pk_bf16_f32 v112, v58, v59
    v_lshlrev_b32 v58, 16, v112
    v_and_b32 v59, 0xffff0000, v112
    v_cvt_pk_bf16_f32 v112, v60, v61
    v_lshlrev_b32 v60, 16, v112
    v_and_b32 v61, 0xffff0000, v112
    v_cvt_pk_bf16_f32 v112, v62, v63
    v_lshlrev_b32 v62, 16, v112
    v_and_b32 v63, 0xffff0000, v112
    v_lshlrev_b32 v112, 16, v128
    v_add_f32 v48, v48, v112
    v_and_b32 v112, 0xffff0000, v128
    v_add_f32 v49, v49, v112
    v_lshlrev_b32 v112, 16, v129
    v_add_f32 v50, v50, v112
    v_and_b32 v112, 0xffff0000, v129
    v_add_f32 v51, v51, v112
    v_lshlrev_b32 v112, 16, v130
    v_add_f32 v52, v52, v112
    v_and_b32 v112, 0xffff0000, v130
    v_add_f32 v53, v53, v112
    v_lshlrev_b32 v112, 16, v131
    v_add_f32 v54, v54, v112
    v_and_b32 v112, 0xffff0000, v131
    v_add_f32 v55, v55, v112
    v_lshlrev_b32 v112, 16, v132
    v_add_f32 v56, v56, v112
    v_and_b32 v112, 0xffff0000, v132
    v_add_f32 v57, v57, v112
    v_lshlrev_b32 v112, 16, v133
    v_add_f32 v58, v58, v112
    v_and_b32 v112, 0xffff0000, v133
    v_add_f32 v59, v59, v112
    v_lshlrev_b32 v112, 16, v134
    v_add_f32 v60, v60, v112
    v_and_b32 v112, 0xffff0000, v134
    v_add_f32 v61, v61, v112
    v_lshlrev_b32 v112, 16, v135
    v_add_f32 v62, v62, v112
    v_and_b32 v112, 0xffff0000, v135
    v_add_f32 v63, v63, v112
    v_cvt_pk_bf16_f32 v112, v48, v49
    v_lshlrev_b32 v48, 16, v112
    v_and_b32 v49, 0xffff0000, v112
    v_cvt_pk_bf16_f32 v112, v50, v51
    v_lshlrev_b32 v50, 16, v112
    v_and_b32 v51, 0xffff0000, v112
    v_cvt_pk_bf16_f32 v112, v52, v53
    v_lshlrev_b32 v52, 16, v112
    v_and_b32 v53, 0xffff0000, v112
    v_cvt_pk_bf16_f32 v112, v54, v55
    v_lshlrev_b32 v54, 16, v112
    v_and_b32 v55, 0xffff0000, v112
    v_cvt_pk_bf16_f32 v112, v56, v57
    v_lshlrev_b32 v56, 16, v112
    v_and_b32 v57, 0xffff0000, v112
    v_cvt_pk_bf16_f32 v112, v58, v59
    v_lshlrev_b32 v58, 16, v112
    v_and_b32 v59, 0xffff0000, v112
    v_cvt_pk_bf16_f32 v112, v60, v61
    v_lshlrev_b32 v60, 16, v112
    v_and_b32 v61, 0xffff0000, v112
    v_cvt_pk_bf16_f32 v112, v62, v63
    v_lshlrev_b32 v62, 16, v112
    v_and_b32 v63, 0xffff0000, v112
    s_mov_b32 s82, 0xc0135761
    s_mov_b32 s83, 0xbdd2d3e8
    v_mov_b32 v113, s82
    v_mul_f32 v64, v48, v48
    v_fma_f32 v64, v64, s83, v113
    v_mul_f32 v64, v64, v48
    v_mul_f32 v65, v49, v49
    v_fma_f32 v65, v65, s83, v113
    v_mul_f32 v65, v65, v49
    v_mul_f32 v66, v50, v50
    v_fma_f32 v66, v66, s83, v113
    v_mul_f32 v66, v66, v50
    v_mul_f32 v67, v51, v51
    v_fma_f32 v67, v67, s83, v113
    v_mul_f32 v67, v67, v51
    v_mul_f32 v68, v52, v52
    v_fma_f32 v68, v68, s83, v113
    v_mul_f32 v68, v68, v52
    v_mul_f32 v69, v53, v53
    v_fma_f32 v69, v69, s83, v113
    v_mul_f32 v69, v69, v53
    v_mul_f32 v70, v54, v54
    v_fma_f32 v70, v70, s83, v113
    v_mul_f32 v70, v70, v54
    v_mul_f32 v71, v55, v55
    v_fma_f32 v71, v71, s83, v113
    v_mul_f32 v71, v71, v55
    v_mul_f32 v72, v56, v56
    v_fma_f32 v72, v72, s83, v113
    v_mul_f32 v72, v72, v56
    v_mul_f32 v73, v57, v57
    v_fma_f32 v73, v73, s83, v113
    v_mul_f32 v73, v73, v57
    v_mul_f32 v74, v58, v58
    v_fma_f32 v74, v74, s83, v113
    v_mul_f32 v74, v74, v58
    v_mul_f32 v75, v59, v59
    v_fma_f32 v75, v75, s83, v113
    v_mul_f32 v75, v75, v59
    v_mul_f32 v76, v60, v60
    v_fma_f32 v76, v76, s83, v113
    v_mul_f32 v76, v76, v60
    v_mul_f32 v77, v61, v61
    v_fma_f32 v77, v77, s83, v113
    v_mul_f32 v77, v77, v61
    v_mul_f32 v78, v62, v62
    v_fma_f32 v78, v78, s83, v113
    v_mul_f32 v78, v78, v62
    v_mul_f32 v79, v63, v63
    v_fma_f32 v79, v79, s83, v113
    v_mul_f32 v79, v79, v63
    v_exp_f32 v64, v64
    v_exp_f32 v65, v65
    v_exp_f32 v66, v66
    v_exp_f32 v67, v67
    v_exp_f32 v68, v68
    v_exp_f32 v69, v69
    v_exp_f32 v70, v70
    v_exp_f32 v71, v71
    v_exp_f32 v72, v72
    v_exp_f32 v73, v73
    v_exp_f32 v74, v74
    v_exp_f32 v75, v75
    v_exp_f32 v76, v76
    v_exp_f32 v77, v77
    v_exp_f32 v78, v78
    v_exp_f32 v79, v79
    v_add_f32 v64, 1.0, v64
    v_add_f32 v65, 1.0, v65
    v_add_f32 v66, 1.0, v66
    v_add_f32 v67, 1.0, v67
    v_add_f32 v68, 1.0, v68
    v_add_f32 v69, 1.0, v69
    v_add_f32 v70, 1.0, v70
    v_add_f32 v71, 1.0, v71
    v_add_f32 v72, 1.0, v72
    v_add_f32 v73, 1.0, v73
    v_add_f32 v74, 1.0, v74
    v_add_f32 v75, 1.0, v75
    v_add_f32 v76, 1.0, v76
    v_add_f32 v77, 1.0, v77
    v_add_f32 v78, 1.0, v78
    v_add_f32 v79, 1.0, v79
    v_rcp_f32 v64, v64
    v_rcp_f32 v65, v65
    v_rcp_f32 v66, v66
    v_rcp_f32 v67, v67
    v_rcp_f32 v68, v68
    v_rcp_f32 v69, v69
    v_rcp_f32 v70, v70
    v_rcp_f32 v71, v71
    v_rcp_f32 v72, v72
    v_rcp_f32 v73, v73
    v_rcp_f32 v74, v74
    v_rcp_f32 v75, v75
    v_rcp_f32 v76, v76
    v_rcp_f32 v77, v77
    v_rcp_f32 v78, v78
    v_rcp_f32 v79, v79
    v_mul_f32 v48, v48, v64
    v_mul_f32 v49, v49, v65
    v_mul_f32 v50, v50, v66
    v_mul_f32 v51, v51, v67
    v_mul_f32 v52, v52, v68
    v_mul_f32 v53, v53, v69
    v_mul_f32 v54, v54, v70
    v_mul_f32 v55, v55, v71
    v_mul_f32 v56, v56, v72
    v_mul_f32 v57, v57, v73
    v_mul_f32 v58, v58, v74
    v_mul_f32 v59, v59, v75
    v_mul_f32 v60, v60, v76
    v_mul_f32 v61, v61, v77
    v_mul_f32 v62, v62, v78
    v_mul_f32 v63, v63, v79
    v_cvt_pk_bf16_f32 v80, v48, v49
    v_cvt_pk_bf16_f32 v81, v50, v51
    v_cvt_pk_bf16_f32 v82, v52, v53
    v_cvt_pk_bf16_f32 v83, v54, v55
    v_cvt_pk_bf16_f32 v84, v56, v57
    v_cvt_pk_bf16_f32 v85, v58, v59
    v_cvt_pk_bf16_f32 v86, v60, v61
    v_cvt_pk_bf16_f32 v87, v62, v63
    s_lshl1_add_u32 s80, s77, s79
    s_lshl_b32 s80, s80, 15
    s_and_b32 s81, s56, 1
    s_lshl1_add_u32 s81, s76, s81
    s_lshl_b32 s81, s81, 10
    s_add_u32 s80, s80, s81
    s_add_u32 s80, s80, 0x600000
    s_add_u32 s81, s80, 0x4000
    buffer_store_dwordx4 v[80:83], v11, s[4:7], s80 offen sc1
    buffer_store_dwordx4 v[84:87], v11, s[4:7], s81 offen sc1
    s_lshl_b32 s80, s63, 2
    s_add_u32 s80, s80, 0x400
    s_waitcnt vmcnt(0)
    s_barrier
    buffer_store_dword v9, v3, s[4:7], s80 offen sc1
    s_add_u32 s63, s63, 128
    s_cmp_lt_u32 s63, 224
    s_cbranch_scc1 L_p3_tile
    s_mov_b32 s60, s99
    s_lshr_b32 s86, s60, 5
    s_and_b32 s87, s60, 3
    s_lshl2_add_u32 s86, s86, s87
    s_bfe_u32 s87, s60, 0x30002
    s_lshl3_add_u32 s60, s86, s87
    s_lshl_b32 s63, s56, 15
    s_mul_i32 s61, s56, 1835008
    s_lshl_b32 s76, s86, 8
    s_add_u32 s61, s61, s76
    s_mul_i32 s62, s56, 458752
    s_lshl_b32 s76, s87, 11
    s_add_u32 s62, s62, s76
    s_add_u32 s62, s62, 0x600000
    v_lshlrev_b32 v112, 2, v121
    v_xor_b32 v112, v120, v112
    v_lshlrev_b32 v112, 4, v112
    v_lshl_add_u32 v4, v121, 12, v112
    v_lshl_add_u32 v112, v124, 2, v122
    v_lshlrev_b32 v112, 8, v112
    v_lshl_add_u32 v112, v122, 6, v112
    v_and_b32 v113, 1, v121
    v_lshl_add_u32 v112, v113, 5, v112
    v_lshl_add_u32 v112, v123, 3, v112
    v_add_u32 v12, s63, v112
    v_xor_b32 v13, 64, v12
    v_xor_b32 v14, 128, v12
    v_xor_b32 v15, 192, v12
    s_add_u32 m0, s63, 0x0
    s_add_u32 s84, s61, 0x0
    buffer_load_dwordx4 v4, s[40:43], s84 offen lds
    s_add_u32 m0, s63, 0x400
    s_add_u32 s84, s61, 0x4000
    buffer_load_dwordx4 v4, s[40:43], s84 offen lds
    s_add_u32 m0, s63, 0x800
    s_add_u32 s84, s61, 0x8000
    buffer_load_dwordx4 v4, s[40:43], s84 offen lds
    s_add_u32 m0, s63, 0xc00
    s_add_u32 s84, s61, 0xc000
    buffer_load_dwordx4 v4, s[40:43], s84 offen lds
    s_add_u32 m0, s63, 0x1000
    s_add_u32 s84, s61, 0x10000
    buffer_load_dwordx4 v4, s[40:43], s84 offen lds
    s_add_u32 m0, s63, 0x1400
    s_add_u32 s84, s61, 0x14000
    buffer_load_dwordx4 v4, s[40:43], s84 offen lds
    s_add_u32 m0, s63, 0x1800
    s_add_u32 s84, s61, 0x18000
    buffer_load_dwordx4 v4, s[40:43], s84 offen lds
    s_add_u32 m0, s63, 0x1c00
    s_add_u32 s84, s61, 0x1c000
    buffer_load_dwordx4 v4, s[40:43], s84 offen lds
    s_add_u32 m0, s63, 0x2000
    s_add_u32 s84, s61, 0x20000
    buffer_load_dwordx4 v4, s[40:43], s84 offen lds
    s_add_u32 m0, s63, 0x2400
    s_add_u32 s84, s61, 0x24000
    buffer_load_dwordx4 v4, s[40:43], s84 offen lds
    s_add_u32 m0, s63, 0x2800
    s_add_u32 s84, s61, 0x28000
    buffer_load_dwordx4 v4, s[40:43], s84 offen lds
    s_add_u32 m0, s63, 0x2c00
    s_add_u32 s84, s61, 0x2c000
    buffer_load_dwordx4 v4, s[40:43], s84 offen lds
    s_add_u32 m0, s63, 0x3000
    s_add_u32 s84, s61, 0x30000
    buffer_load_dwordx4 v4, s[40:43], s84 offen lds
    s_add_u32 m0, s63, 0x3400
    s_add_u32 s84, s61, 0x34000
    buffer_load_dwordx4 v4, s[40:43], s84 offen lds
    s_add_u32 m0, s63, 0x3800
    s_add_u32 s84, s61, 0x38000
    buffer_load_dwordx4 v4, s[40:43], s84 offen lds
    s_add_u32 m0, s63, 0x3c00
    s_add_u32 s84, s61, 0x3c000
    buffer_load_dwordx4 v4, s[40:43], s84 offen lds
    s_add_u32 m0, s63, 0x4000
    s_add_u32 s84, s61, 0x40000
    buffer_load_dwordx4 v4, s[40:43], s84 offen lds
    s_add_u32 m0, s63, 0x4400
    s_add_u32 s84, s61, 0x44000
    buffer_load_dwordx4 v4, s[40:43], s84 offen lds
    s_add_u32 m0, s63, 0x4800
    s_add_u32 s84, s61, 0x48000
    buffer_load_dwordx4 v4, s[40:43], s84 offen lds
    s_add_u32 m0, s63, 0x4c00
    s_add_u32 s84, s61, 0x4c000
    buffer_load_dwordx4 v4, s[40:43], s84 offen lds
    s_add_u32 m0, s63, 0x5000
    s_add_u32 s84, s61, 0x50000
    buffer_load_dwordx4 v4, s[40:43], s84 offen lds
    s_add_u32 m0, s63, 0x5400
    s_add_u32 s84, s61, 0x54000
    buffer_load_dwordx4 v4, s[40:43], s84 offen lds
    s_add_u32 m0, s63, 0x5800
    s_add_u32 s84, s61, 0x58000
    buffer_load_dwordx4 v4, s[40:43], s84 offen lds
    s_add_u32 m0, s63, 0x5c00
    s_add_u32 s84, s61, 0x5c000
    buffer_load_dwordx4 v4, s[40:43], s84 offen lds
    s_add_u32 m0, s63, 0x6000
    s_add_u32 s84, s61, 0x60000
    buffer_load_dwordx4 v4, s[40:43], s84 offen lds
    s_add_u32 m0, s63, 0x6400
    s_add_u32 s84, s61, 0x64000
    buffer_load_dwordx4 v4, s[40:43], s84 offen lds
    s_add_u32 m0, s63, 0x6800
    s_add_u32 s84, s61, 0x68000
    buffer_load_dwordx4 v4, s[40:43], s84 offen lds
    s_add_u32 m0, s63, 0x6c00
    s_add_u32 s84, s61, 0x6c000
    buffer_load_dwordx4 v4, s[40:43], s84 offen lds
    s_add_u32 m0, s63, 0x7000
    s_add_u32 s84, s61, 0x70000
    buffer_load_dwordx4 v4, s[40:43], s84 offen lds
    s_add_u32 m0, s63, 0x7400
    s_add_u32 s84, s61, 0x74000
    buffer_load_dwordx4 v4, s[40:43], s84 offen lds
    s_add_u32 m0, s63, 0x7800
    s_add_u32 s84, s61, 0x78000
    buffer_load_dwordx4 v4, s[40:43], s84 offen lds
    s_add_u32 m0, s63, 0x7c00
    s_add_u32 s84, s61, 0x7c000
    buffer_load_dwordx4 v4, s[40:43], s84 offen lds
    v_min_u32 v113, 27, v1
    v_lshlrev_b32 v113, 5, v113
    s_lshl_b32 s76, s87, 2
    s_add_u32 s76, s76, 0x400
    s_cmp_lg_u32 s56, 0
    s_cbranch_scc1 L_p4_u_x
L_p4_u:
    s_add_u32 s101, s101, 1
    s_cmp_gt_u32 s101, 0x400000
    s_cbranch_scc1 L_end
    buffer_load_dword v112, v113, s[4:7], s76 offen sc1
    s_waitcnt vmcnt(0)
    v_cmp_ne_u32 vcc, 1, v112
    s_cbranch_vccz L_p4_u_x
    s_sleep 8
    s_branch L_p4_u
L_p4_u_x:
    s_barrier
    s_add_u32 s84, s62, 0x0
    buffer_load_dwordx4 v[48:51], v11, s[4:7], s84 offen offset:0
    buffer_load_dwordx4 v[52:55], v11, s[4:7], s84 offen offset:1024
    s_add_u32 s84, s62, 0x4000
    buffer_load_dwordx4 v[56:59], v11, s[4:7], s84 offen offset:0
    buffer_load_dwordx4 v[60:63], v11, s[4:7], s84 offen offset:1024
    s_add_u32 s84, s62, 0x8000
    buffer_load_dwordx4 v[64:67], v11, s[4:7], s84 offen offset:0
    buffer_load_dwordx4 v[68:71], v11, s[4:7], s84 offen offset:1024
    s_add_u32 s84, s62, 0xc000
    buffer_load_dwordx4 v[72:75], v11, s[4:7], s84 offen offset:0
    buffer_load_dwordx4 v[76:79], v11, s[4:7], s84 offen offset:1024
    s_add_u32 s84, s62, 0x10000
    buffer_load_dwordx4 v[80:83], v11, s[4:7], s84 offen offset:0
    buffer_load_dwordx4 v[84:87], v11, s[4:7], s84 offen offset:1024
    s_add_u32 s84, s62, 0x14000
    buffer_load_dwordx4 v[88:91], v11, s[4:7], s84 offen offset:0
    buffer_load_dwordx4 v[92:95], v11, s[4:7], s84 offen offset:1024
    s_add_u32 s84, s62, 0x18000
    buffer_load_dwordx4 v[96:99], v11, s[4:7], s84 offen offset:0
    buffer_load_dwordx4 v[100:103], v11, s[4:7], s84 offen offset:1024
    s_add_u32 s84, s62, 0x1c000
    buffer_load_dwordx4 v[104:107], v11, s[4:7], s84 offen offset:0
    buffer_load_dwordx4 v[108:111], v11, s[4:7], s84 offen offset:1024
    s_lshl_b32 s76, s86, 2
    s_add_u32 s85, s76, s56
    s_lshl_b32 s76, s85, 15
    s_lshl_b32 s77, s87, 7
    s_add_u32 s76, s76, s77
    v_lshlrev_b32 v112, 10, v125
    v_lshl_add_u32 v112, v124, 3, v112
    s_lshl_b32 s77, s85, 6
    v_lshlrev_b32 v113, 1, v125
    buffer_load_dwordx2 a[0:1], v112, s[28:31], s76 offen offset:0
    buffer_load_dwordx2 a[2:3], v112, s[28:31], s76 offen offset:16
    buffer_load_dwordx2 a[4:5], v112, s[28:31], s76 offen offset:32
    buffer_load_dwordx2 a[6:7], v112, s[28:31], s76 offen offset:48
    buffer_load_dwordx2 a[8:9], v112, s[28:31], s76 offen offset:64
    buffer_load_dwordx2 a[10:11], v112, s[28:31], s76 offen offset:80
    buffer_load_dwordx2 a[12:13], v112, s[28:31], s76 offen offset:96
    buffer_load_dwordx2 a[14:15], v112, s[28:31], s76 offen offset:112
    buffer_load_ushort v5, v113, s[52:55], s77 offen
    s_waitcnt vmcnt(21)
    ds_read_b64_tr_b16 v[16:17], v12 offset:0
    ds_read_b64_tr_b16 v[18:19], v12 offset:2048
    ds_read_b64_tr_b16 v[20:21], v13 offset:0
    ds_read_b64_tr_b16 v[22:23], v13 offset:2048
    ds_read_b64_tr_b16 v[24:25], v14 offset:0
    ds_read_b64_tr_b16 v[26:27], v14 offset:2048
    ds_read_b64_tr_b16 v[28:29], v15 offset:0
    ds_read_b64_tr_b16 v[30:31], v15 offset:2048
    s_waitcnt lgkmcnt(0)
    v_mfma_f32_32x32x16_bf16 v[128:143], v[48:51], v[16:19], 0
    ds_read_b64_tr_b16 v[32:33], v12 offset:4096
    v_mfma_f32_32x32x16_bf16 v[144:159], v[52:55], v[16:19], 0
    ds_read_b64_tr_b16 v[34:35], v12 offset:6144
    v_mfma_f32_32x32x16_bf16 v[160:175], v[48:51], v[20:23], 0
    ds_read_b64_tr_b16 v[36:37], v13 offset:4096
    v_mfma_f32_32x32x16_bf16 v[176:191], v[52:55], v[20:23], 0
    ds_read_b64_tr_b16 v[38:39], v13 offset:6144
    v_mfma_f32_32x32x16_bf16 v[192:207], v[48:51], v[24:27], 0
    ds_read_b64_tr_b16 v[40:41], v14 offset:4096
    v_mfma_f32_32x32x16_bf16 v[208:223], v[52:55], v[24:27], 0
    ds_read_b64_tr_b16 v[42:43], v14 offset:6144
    v_mfma_f32_32x32x16_bf16 v[224:239], v[48:51], v[28:31], 0
    ds_read_b64_tr_b16 v[44:45], v15 offset:4096
    v_mfma_f32_32x32x16_bf16 v[240:255], v[52:55], v[28:31], 0
    ds_read_b64_tr_b16 v[46:47], v15 offset:6144
    s_waitcnt vmcnt(17)
    s_waitcnt lgkmcnt(0)
    v_mfma_f32_32x32x16_bf16 v[128:143], v[56:59], v[32:35], v[128:143]
    ds_read_b64_tr_b16 v[16:17], v12 offset:8192
    v_mfma_f32_32x32x16_bf16 v[144:159], v[60:63], v[32:35], v[144:159]
    ds_read_b64_tr_b16 v[18:19], v12 offset:10240
    v_mfma_f32_32x32x16_bf16 v[160:175], v[56:59], v[36:39], v[160:175]
    ds_read_b64_tr_b16 v[20:21], v13 offset:8192
    v_mfma_f32_32x32x16_bf16 v[176:191], v[60:63], v[36:39], v[176:191]
    ds_read_b64_tr_b16 v[22:23], v13 offset:10240
    v_mfma_f32_32x32x16_bf16 v[192:207], v[56:59], v[40:43], v[192:207]
    ds_read_b64_tr_b16 v[24:25], v14 offset:8192
    v_mfma_f32_32x32x16_bf16 v[208:223], v[60:63], v[40:43], v[208:223]
    ds_read_b64_tr_b16 v[26:27], v14 offset:10240
    v_mfma_f32_32x32x16_bf16 v[224:239], v[56:59], v[44:47], v[224:239]
    ds_read_b64_tr_b16 v[28:29], v15 offset:8192
    v_mfma_f32_32x32x16_bf16 v[240:255], v[60:63], v[44:47], v[240:255]
    ds_read_b64_tr_b16 v[30:31], v15 offset:10240
    s_waitcnt lgkmcnt(0)
    v_mfma_f32_32x32x16_bf16 v[128:143], v[64:67], v[16:19], v[128:143]
    ds_read_b64_tr_b16 v[32:33], v12 offset:12288
    v_mfma_f32_32x32x16_bf16 v[144:159], v[68:71], v[16:19], v[144:159]
    ds_read_b64_tr_b16 v[34:35], v12 offset:14336
    s_add_u32 m0, s63, 0x0
    s_add_u32 s84, s61, 0x80000
    buffer_load_dwordx4 v4, s[40:43], s84 offen lds
    s_add_u32 m0, s63, 0x400
    s_add_u32 s84, s61, 0x84000
    buffer_load_dwordx4 v4, s[40:43], s84 offen lds
    v_mfma_f32_32x32x16_bf16 v[160:175], v[64:67], v[20:23], v[160:175]
    ds_read_b64_tr_b16 v[36:37], v13 offset:12288
    s_add_u32 m0, s63, 0x800
    s_add_u32 s84, s61, 0x88000
    buffer_load_dwordx4 v4, s[40:43], s84 offen lds
    s_add_u32 m0, s63, 0xc00
    s_add_u32 s84, s61, 0x8c000
    buffer_load_dwordx4 v4, s[40:43], s84 offen lds
    v_mfma_f32_32x32x16_bf16 v[176:191], v[68:71], v[20:23], v[176:191]
    ds_read_b64_tr_b16 v[38:39], v13 offset:14336
    s_add_u32 m0, s63, 0x1000
    s_add_u32 s84, s61, 0x90000
    buffer_load_dwordx4 v4, s[40:43], s84 offen lds
    s_add_u32 m0, s63, 0x1400
    s_add_u32 s84, s61, 0x94000
    buffer_load_dwordx4 v4, s[40:43], s84 offen lds
    v_mfma_f32_32x32x16_bf16 v[192:207], v[64:67], v[24:27], v[192:207]
    ds_read_b64_tr_b16 v[40:41], v14 offset:12288
    s_add_u32 m0, s63, 0x1800
    s_add_u32 s84, s61, 0x98000
    buffer_load_dwordx4 v4, s[40:43], s84 offen lds
    s_add_u32 m0, s63, 0x1c00
    s_add_u32 s84, s61, 0x9c000
    buffer_load_dwordx4 v4, s[40:43], s84 offen lds
    v_mfma_f32_32x32x16_bf16 v[208:223], v[68:71], v[24:27], v[208:223]
    ds_read_b64_tr_b16 v[42:43], v14 offset:14336
    s_add_u32 s84, s62, 0x20000
    buffer_load_dwordx4 v[48:51], v11, s[4:7], s84 offen offset:0
    buffer_load_dwordx4 v[52:55], v11, s[4:7], s84 offen offset:1024
    v_mfma_f32_32x32x16_bf16 v[224:239], v[64:67], v[28:31], v[224:239]
    ds_read_b64_tr_b16 v[44:45], v15 offset:12288
    s_add_u32 s84, s62, 0x24000
    buffer_load_dwordx4 v[56:59], v11, s[4:7], s84 offen offset:0
    buffer_load_dwordx4 v[60:63], v11, s[4:7], s84 offen offset:1024
    v_mfma_f32_32x32x16_bf16 v[240:255], v[68:71], v[28:31], v[240:255]
    ds_read_b64_tr_b16 v[46:47], v15 offset:14336
    s_waitcnt vmcnt(25)
    s_waitcnt lgkmcnt(0)
    v_mfma_f32_32x32x16_bf16 v[128:143], v[72:75], v[32:35], v[128:143]
    ds_read_b64_tr_b16 v[16:17], v12 offset:16384
    v_mfma_f32_32x32x16_bf16 v[144:159], v[76:79], v[32:35], v[144:159]
    ds_read_b64_tr_b16 v[18:19], v12 offset:18432
    v_mfma_f32_32x32x16_bf16 v[160:175], v[72:75], v[36:39], v[160:175]
    ds_read_b64_tr_b16 v[20:21], v13 offset:16384
    v_mfma_f32_32x32x16_bf16 v[176:191], v[76:79], v[36:39], v[176:191]
    ds_read_b64_tr_b16 v[22:23], v13 offset:18432
    v_mfma_f32_32x32x16_bf16 v[192:207], v[72:75], v[40:43], v[192:207]
    ds_read_b64_tr_b16 v[24:25], v14 offset:16384
    v_mfma_f32_32x32x16_bf16 v[208:223], v[76:79], v[40:43], v[208:223]
    ds_read_b64_tr_b16 v[26:27], v14 offset:18432
    v_mfma_f32_32x32x16_bf16 v[224:239], v[72:75], v[44:47], v[224:239]
    ds_read_b64_tr_b16 v[28:29], v15 offset:16384
    v_mfma_f32_32x32x16_bf16 v[240:255], v[76:79], v[44:47], v[240:255]
    ds_read_b64_tr_b16 v[30:31], v15 offset:18432
    s_waitcnt lgkmcnt(0)
    v_mfma_f32_32x32x16_bf16 v[128:143], v[80:83], v[16:19], v[128:143]
    ds_read_b64_tr_b16 v[32:33], v12 offset:20480
    v_mfma_f32_32x32x16_bf16 v[144:159], v[84:87], v[16:19], v[144:159]
    ds_read_b64_tr_b16 v[34:35], v12 offset:22528
    s_add_u32 m0, s63, 0x2000
    s_add_u32 s84, s61, 0xa0000
    buffer_load_dwordx4 v4, s[40:43], s84 offen lds
    s_add_u32 m0, s63, 0x2400
    s_add_u32 s84, s61, 0xa4000
    buffer_load_dwordx4 v4, s[40:43], s84 offen lds
    v_mfma_f32_32x32x16_bf16 v[160:175], v[80:83], v[20:23], v[160:175]
    ds_read_b64_tr_b16 v[36:37], v13 offset:20480
    s_add_u32 m0, s63, 0x2800
    s_add_u32 s84, s61, 0xa8000
    buffer_load_dwordx4 v4, s[40:43], s84 offen lds
    s_add_u32 m0, s63, 0x2c00
    s_add_u32 s84, s61, 0xac000
    buffer_load_dwordx4 v4, s[40:43], s84 offen lds
    v_mfma_f32_32x32x16_bf16 v[176:191], v[84:87], v[20:23], v[176:191]
    ds_read_b64_tr_b16 v[38:39], v13 offset:22528
    s_add_u32 m0, s63, 0x3000
    s_add_u32 s84, s61, 0xb0000
    buffer_load_dwordx4 v4, s[40:43], s84 offen lds
    s_add_u32 m0, s63, 0x3400
    s_add_u32 s84, s61, 0xb4000
    buffer_load_dwordx4 v4, s[40:43], s84 offen lds
    v_mfma_f32_32x32x16_bf16 v[192:207], v[80:83], v[24:27], v[192:207]
    ds_read_b64_tr_b16 v[40:41], v14 offset:20480
    s_add_u32 m0, s63, 0x3800
    s_add_u32 s84, s61, 0xb8000
    buffer_load_dwordx4 v4, s[40:43], s84 offen lds
    s_add_u32 m0, s63, 0x3c00
    s_add_u32 s84, s61, 0xbc000
    buffer_load_dwordx4 v4, s[40:43], s84 offen lds
    v_mfma_f32_32x32x16_bf16 v[208:223], v[84:87], v[24:27], v[208:223]
    ds_read_b64_tr_b16 v[42:43], v14 offset:22528
    s_add_u32 s84, s62, 0x28000
    buffer_load_dwordx4 v[64:67], v11, s[4:7], s84 offen offset:0
    buffer_load_dwordx4 v[68:71], v11, s[4:7], s84 offen offset:1024
    v_mfma_f32_32x32x16_bf16 v[224:239], v[80:83], v[28:31], v[224:239]
    ds_read_b64_tr_b16 v[44:45], v15 offset:20480
    s_add_u32 s84, s62, 0x2c000
    buffer_load_dwordx4 v[72:75], v11, s[4:7], s84 offen offset:0
    buffer_load_dwordx4 v[76:79], v11, s[4:7], s84 offen offset:1024
    v_mfma_f32_32x32x16_bf16 v[240:255], v[84:87], v[28:31], v[240:255]
    ds_read_b64_tr_b16 v[46:47], v15 offset:22528
    s_waitcnt vmcnt(33)
    s_waitcnt lgkmcnt(0)
    v_mfma_f32_32x32x16_bf16 v[128:143], v[88:91], v[32:35], v[128:143]
    ds_read_b64_tr_b16 v[16:17], v12 offset:24576
    v_mfma_f32_32x32x16_bf16 v[144:159], v[92:95], v[32:35], v[144:159]
    ds_read_b64_tr_b16 v[18:19], v12 offset:26624
    v_mfma_f32_32x32x16_bf16 v[160:175], v[88:91], v[36:39], v[160:175]
    ds_read_b64_tr_b16 v[20:21], v13 offset:24576
    v_mfma_f32_32x32x16_bf16 v[176:191], v[92:95], v[36:39], v[176:191]
    ds_read_b64_tr_b16 v[22:23], v13 offset:26624
    v_mfma_f32_32x32x16_bf16 v[192:207], v[88:91], v[40:43], v[192:207]
    ds_read_b64_tr_b16 v[24:25], v14 offset:24576
    v_mfma_f32_32x32x16_bf16 v[208:223], v[92:95], v[40:43], v[208:223]
    ds_read_b64_tr_b16 v[26:27], v14 offset:26624
    v_mfma_f32_32x32x16_bf16 v[224:239], v[88:91], v[44:47], v[224:239]
    ds_read_b64_tr_b16 v[28:29], v15 offset:24576
    v_mfma_f32_32x32x16_bf16 v[240:255], v[92:95], v[44:47], v[240:255]
    ds_read_b64_tr_b16 v[30:31], v15 offset:26624
    s_waitcnt lgkmcnt(0)
    v_mfma_f32_32x32x16_bf16 v[128:143], v[96:99], v[16:19], v[128:143]
    ds_read_b64_tr_b16 v[32:33], v12 offset:28672
    v_mfma_f32_32x32x16_bf16 v[144:159], v[100:103], v[16:19], v[144:159]
    ds_read_b64_tr_b16 v[34:35], v12 offset:30720
    s_add_u32 m0, s63, 0x4000
    s_add_u32 s84, s61, 0xc0000
    buffer_load_dwordx4 v4, s[40:43], s84 offen lds
    s_add_u32 m0, s63, 0x4400
    s_add_u32 s84, s61, 0xc4000
    buffer_load_dwordx4 v4, s[40:43], s84 offen lds
    v_mfma_f32_32x32x16_bf16 v[160:175], v[96:99], v[20:23], v[160:175]
    ds_read_b64_tr_b16 v[36:37], v13 offset:28672
    s_add_u32 m0, s63, 0x4800
    s_add_u32 s84, s61, 0xc8000
    buffer_load_dwordx4 v4, s[40:43], s84 offen lds
    s_add_u32 m0, s63, 0x4c00
    s_add_u32 s84, s61, 0xcc000
    buffer_load_dwordx4 v4, s[40:43], s84 offen lds
    v_mfma_f32_32x32x16_bf16 v[176:191], v[100:103], v[20:23], v[176:191]
    ds_read_b64_tr_b16 v[38:39], v13 offset:30720
    s_add_u32 m0, s63, 0x5000
    s_add_u32 s84, s61, 0xd0000
    buffer_load_dwordx4 v4, s[40:43], s84 offen lds
    s_add_u32 m0, s63, 0x5400
    s_add_u32 s84, s61, 0xd4000
    buffer_load_dwordx4 v4, s[40:43], s84 offen lds
    v_mfma_f32_32x32x16_bf16 v[192:207], v[96:99], v[24:27], v[192:207]
    ds_read_b64_tr_b16 v[40:41], v14 offset:28672
    s_add_u32 m0, s63, 0x5800
    s_add_u32 s84, s61, 0xd8000
    buffer_load_dwordx4 v4, s[40:43], s84 offen lds
    s_add_u32 m0, s63, 0x5c00
    s_add_u32 s84, s61, 0xdc000
    buffer_load_dwordx4 v4, s[40:43], s84 offen lds
    v_mfma_f32_32x32x16_bf16 v[208:223], v[100:103], v[24:27], v[208:223]
    ds_read_b64_tr_b16 v[42:43], v14 offset:30720
    s_add_u32 s84, s62, 0x30000
    buffer_load_dwordx4 v[80:83], v11, s[4:7], s84 offen offset:0
    buffer_load_dwordx4 v[84:87], v11, s[4:7], s84 offen offset:1024
    v_mfma_f32_32x32x16_bf16 v[224:239], v[96:99], v[28:31], v[224:239]
    ds_read_b64_tr_b16 v[44:45], v15 offset:28672
    s_add_u32 s84, s62, 0x34000
    buffer_load_dwordx4 v[88:91], v11, s[4:7], s84 offen offset:0
    buffer_load_dwordx4 v[92:95], v11, s[4:7], s84 offen offset:1024
    v_mfma_f32_32x32x16_bf16 v[240:255], v[100:103], v[28:31], v[240:255]
    ds_read_b64_tr_b16 v[46:47], v15 offset:30720
    s_waitcnt vmcnt(24)
    s_waitcnt lgkmcnt(0)
    v_mfma_f32_32x32x16_bf16 v[128:143], v[104:107], v[32:35], v[128:143]
    ds_read_b64_tr_b16 v[16:17], v12 offset:0
    v_mfma_f32_32x32x16_bf16 v[144:159], v[108:111], v[32:35], v[144:159]
    ds_read_b64_tr_b16 v[18:19], v12 offset:2048
    v_mfma_f32_32x32x16_bf16 v[160:175], v[104:107], v[36:39], v[160:175]
    ds_read_b64_tr_b16 v[20:21], v13 offset:0
    v_mfma_f32_32x32x16_bf16 v[176:191], v[108:111], v[36:39], v[176:191]
    ds_read_b64_tr_b16 v[22:23], v13 offset:2048
    v_mfma_f32_32x32x16_bf16 v[192:207], v[104:107], v[40:43], v[192:207]
    ds_read_b64_tr_b16 v[24:25], v14 offset:0
    v_mfma_f32_32x32x16_bf16 v[208:223], v[108:111], v[40:43], v[208:223]
    ds_read_b64_tr_b16 v[26:27], v14 offset:2048
    v_mfma_f32_32x32x16_bf16 v[224:239], v[104:107], v[44:47], v[224:239]
    ds_read_b64_tr_b16 v[28:29], v15 offset:0
    v_mfma_f32_32x32x16_bf16 v[240:255], v[108:111], v[44:47], v[240:255]
    ds_read_b64_tr_b16 v[30:31], v15 offset:2048
    s_waitcnt lgkmcnt(0)
    v_mfma_f32_32x32x16_bf16 v[128:143], v[48:51], v[16:19], v[128:143]
    ds_read_b64_tr_b16 v[32:33], v12 offset:4096
    v_mfma_f32_32x32x16_bf16 v[144:159], v[52:55], v[16:19], v[144:159]
    ds_read_b64_tr_b16 v[34:35], v12 offset:6144
    s_add_u32 m0, s63, 0x6000
    s_add_u32 s84, s61, 0xe0000
    buffer_load_dwordx4 v4, s[40:43], s84 offen lds
    s_add_u32 m0, s63, 0x6400
    s_add_u32 s84, s61, 0xe4000
    buffer_load_dwordx4 v4, s[40:43], s84 offen lds
    v_mfma_f32_32x32x16_bf16 v[160:175], v[48:51], v[20:23], v[160:175]
    ds_read_b64_tr_b16 v[36:37], v13 offset:4096
    s_add_u32 m0, s63, 0x6800
    s_add_u32 s84, s61, 0xe8000
    buffer_load_dwordx4 v4, s[40:43], s84 offen lds
    s_add_u32 m0, s63, 0x6c00
    s_add_u32 s84, s61, 0xec000
    buffer_load_dwordx4 v4, s[40:43], s84 offen lds
    v_mfma_f32_32x32x16_bf16 v[176:191], v[52:55], v[20:23], v[176:191]
    ds_read_b64_tr_b16 v[38:39], v13 offset:6144
    s_add_u32 m0, s63, 0x7000
    s_add_u32 s84, s61, 0xf0000
    buffer_load_dwordx4 v4, s[40:43], s84 offen lds
    s_add_u32 m0, s63, 0x7400
    s_add_u32 s84, s61, 0xf4000
    buffer_load_dwordx4 v4, s[40:43], s84 offen lds
    v_mfma_f32_32x32x16_bf16 v[192:207], v[48:51], v[24:27], v[192:207]
    ds_read_b64_tr_b16 v[40:41], v14 offset:4096
    s_add_u32 m0, s63, 0x7800
    s_add_u32 s84, s61, 0xf8000
    buffer_load_dwordx4 v4, s[40:43], s84 offen lds
    s_add_u32 m0, s63, 0x7c00
    s_add_u32 s84, s61, 0xfc000
    buffer_load_dwordx4 v4, s[40:43], s84 offen lds
    v_mfma_f32_32x32x16_bf16 v[208:223], v[52:55], v[24:27], v[208:223]
    ds_read_b64_tr_b16 v[42:43], v14 offset:6144
    s_add_u32 s84, s62, 0x38000
    buffer_load_dwordx4 v[96:99], v11, s[4:7], s84 offen offset:0
    buffer_load_dwordx4 v[100:103], v11, s[4:7], s84 offen offset:1024
    v_mfma_f32_32x32x16_bf16 v[224:239], v[48:51], v[28:31], v[224:239]
    ds_read_b64_tr_b16 v[44:45], v15 offset:4096
    s_add_u32 s84, s62, 0x3c000
    buffer_load_dwordx4 v[104:107], v11, s[4:7], s84 offen offset:0
    buffer_load_dwordx4 v[108:111], v11, s[4:7], s84 offen offset:1024
    v_mfma_f32_32x32x16_bf16 v[240:255], v[52:55], v[28:31], v[240:255]
    ds_read_b64_tr_b16 v[46:47], v15 offset:6144
    s_waitcnt vmcnt(24)
    s_waitcnt lgkmcnt(0)
    v_mfma_f32_32x32x16_bf16 v[128:143], v[56:59], v[32:35], v[128:143]
    ds_read_b64_tr_b16 v[16:17], v12 offset:8192
    v_mfma_f32_32x32x16_bf16 v[144:159], v[60:63], v[32:35], v[144:159]
    ds_read_b64_tr_b16 v[18:19], v12 offset:10240
    v_mfma_f32_32x32x16_bf16 v[160:175], v[56:59], v[36:39], v[160:175]
    ds_read_b64_tr_b16 v[20:21], v13 offset:8192
    v_mfma_f32_32x32x16_bf16 v[176:191], v[60:63], v[36:39], v[176:191]
    ds_read_b64_tr_b16 v[22:23], v13 offset:10240
    v_mfma_f32_32x32x16_bf16 v[192:207], v[56:59], v[40:43], v[192:207]
    ds_read_b64_tr_b16 v[24:25], v14 offset:8192
    v_mfma_f32_32x32x16_bf16 v[208:223], v[60:63], v[40:43], v[208:223]
    ds_read_b64_tr_b16 v[26:27], v14 offset:10240
    v_mfma_f32_32x32x16_bf16 v[224:239], v[56:59], v[44:47], v[224:239]
    ds_read_b64_tr_b16 v[28:29], v15 offset:8192
    v_mfma_f32_32x32x16_bf16 v[240:255], v[60:63], v[44:47], v[240:255]
    ds_read_b64_tr_b16 v[30:31], v15 offset:10240
    s_waitcnt lgkmcnt(0)
    v_mfma_f32_32x32x16_bf16 v[128:143], v[64:67], v[16:19], v[128:143]
    ds_read_b64_tr_b16 v[32:33], v12 offset:12288
    v_mfma_f32_32x32x16_bf16 v[144:159], v[68:71], v[16:19], v[144:159]
    ds_read_b64_tr_b16 v[34:35], v12 offset:14336
    s_add_u32 m0, s63, 0x0
    s_add_u32 s84, s61, 0x100000
    buffer_load_dwordx4 v4, s[40:43], s84 offen lds
    s_add_u32 m0, s63, 0x400
    s_add_u32 s84, s61, 0x104000
    buffer_load_dwordx4 v4, s[40:43], s84 offen lds
    v_mfma_f32_32x32x16_bf16 v[160:175], v[64:67], v[20:23], v[160:175]
    ds_read_b64_tr_b16 v[36:37], v13 offset:12288
    s_add_u32 m0, s63, 0x800
    s_add_u32 s84, s61, 0x108000
    buffer_load_dwordx4 v4, s[40:43], s84 offen lds
    s_add_u32 m0, s63, 0xc00
    s_add_u32 s84, s61, 0x10c000
    buffer_load_dwordx4 v4, s[40:43], s84 offen lds
    v_mfma_f32_32x32x16_bf16 v[176:191], v[68:71], v[20:23], v[176:191]
    ds_read_b64_tr_b16 v[38:39], v13 offset:14336
    s_add_u32 m0, s63, 0x1000
    s_add_u32 s84, s61, 0x110000
    buffer_load_dwordx4 v4, s[40:43], s84 offen lds
    s_add_u32 m0, s63, 0x1400
    s_add_u32 s84, s61, 0x114000
    buffer_load_dwordx4 v4, s[40:43], s84 offen lds
    v_mfma_f32_32x32x16_bf16 v[192:207], v[64:67], v[24:27], v[192:207]
    ds_read_b64_tr_b16 v[40:41], v14 offset:12288
    s_add_u32 m0, s63, 0x1800
    s_add_u32 s84, s61, 0x118000
    buffer_load_dwordx4 v4, s[40:43], s84 offen lds
    s_add_u32 m0, s63, 0x1c00
    s_add_u32 s84, s61, 0x11c000
    buffer_load_dwordx4 v4, s[40:43], s84 offen lds
    v_mfma_f32_32x32x16_bf16 v[208:223], v[68:71], v[24:27], v[208:223]
    ds_read_b64_tr_b16 v[42:43], v14 offset:14336
    s_add_u32 s84, s62, 0x40000
    buffer_load_dwordx4 v[48:51], v11, s[4:7], s84 offen offset:0
    buffer_load_dwordx4 v[52:55], v11, s[4:7], s84 offen offset:1024
    v_mfma_f32_32x32x16_bf16 v[224:239], v[64:67], v[28:31], v[224:239]
    ds_read_b64_tr_b16 v[44:45], v15 offset:12288
    s_add_u32 s84, s62, 0x44000
    buffer_load_dwordx4 v[56:59], v11, s[4:7], s84 offen offset:0
    buffer_load_dwordx4 v[60:63], v11, s[4:7], s84 offen offset:1024
    v_mfma_f32_32x32x16_bf16 v[240:255], v[68:71], v[28:31], v[240:255]
    ds_read_b64_tr_b16 v[46:47], v15 offset:14336
    s_waitcnt vmcnt(24)
    s_waitcnt lgkmcnt(0)
    v_mfma_f32_32x32x16_bf16 v[128:143], v[72:75], v[32:35], v[128:143]
    ds_read_b64_tr_b16 v[16:17], v12 offset:16384
    v_mfma_f32_32x32x16_bf16 v[144:159], v[76:79], v[32:35], v[144:159]
    ds_read_b64_tr_b16 v[18:19], v12 offset:18432
    v_mfma_f32_32x32x16_bf16 v[160:175], v[72:75], v[36:39], v[160:175]
    ds_read_b64_tr_b16 v[20:21], v13 offset:16384
    v_mfma_f32_32x32x16_bf16 v[176:191], v[76:79], v[36:39], v[176:191]
    ds_read_b64_tr_b16 v[22:23], v13 offset:18432
    v_mfma_f32_32x32x16_bf16 v[192:207], v[72:75], v[40:43], v[192:207]
    ds_read_b64_tr_b16 v[24:25], v14 offset:16384
    v_mfma_f32_32x32x16_bf16 v[208:223], v[76:79], v[40:43], v[208:223]
    ds_read_b64_tr_b16 v[26:27], v14 offset:18432
    v_mfma_f32_32x32x16_bf16 v[224:239], v[72:75], v[44:47], v[224:239]
    ds_read_b64_tr_b16 v[28:29], v15 offset:16384
    v_mfma_f32_32x32x16_bf16 v[240:255], v[76:79], v[44:47], v[240:255]
    ds_read_b64_tr_b16 v[30:31], v15 offset:18432
    s_waitcnt lgkmcnt(0)
    v_mfma_f32_32x32x16_bf16 v[128:143], v[80:83], v[16:19], v[128:143]
    ds_read_b64_tr_b16 v[32:33], v12 offset:20480
    v_mfma_f32_32x32x16_bf16 v[144:159], v[84:87], v[16:19], v[144:159]
    ds_read_b64_tr_b16 v[34:35], v12 offset:22528
    s_add_u32 m0, s63, 0x2000
    s_add_u32 s84, s61, 0x120000
    buffer_load_dwordx4 v4, s[40:43], s84 offen lds
    s_add_u32 m0, s63, 0x2400
    s_add_u32 s84, s61, 0x124000
    buffer_load_dwordx4 v4, s[40:43], s84 offen lds
    v_mfma_f32_32x32x16_bf16 v[160:175], v[80:83], v[20:23], v[160:175]
    ds_read_b64_tr_b16 v[36:37], v13 offset:20480
    s_add_u32 m0, s63, 0x2800
    s_add_u32 s84, s61, 0x128000
    buffer_load_dwordx4 v4, s[40:43], s84 offen lds
    s_add_u32 m0, s63, 0x2c00
    s_add_u32 s84, s61, 0x12c000
    buffer_load_dwordx4 v4, s[40:43], s84 offen lds
    v_mfma_f32_32x32x16_bf16 v[176:191], v[84:87], v[20:23], v[176:191]
    ds_read_b64_tr_b16 v[38:39], v13 offset:22528
    s_add_u32 m0, s63, 0x3000
    s_add_u32 s84, s61, 0x130000
    buffer_load_dwordx4 v4, s[40:43], s84 offen lds
    s_add_u32 m0, s63, 0x3400
    s_add_u32 s84, s61, 0x134000
    buffer_load_dwordx4 v4, s[40:43], s84 offen lds
    v_mfma_f32_32x32x16_bf16 v[192:207], v[80:83], v[24:27], v[192:207]
    ds_read_b64_tr_b16 v[40:41], v14 offset:20480
    s_add_u32 m0, s63, 0x3800
    s_add_u32 s84, s61, 0x138000
    buffer_load_dwordx4 v4, s[40:43], s84 offen lds
    s_add_u32 m0, s63, 0x3c00
    s_add_u32 s84, s61, 0x13c000
    buffer_load_dwordx4 v4, s[40:43], s84 offen lds
    v_mfma_f32_32x32x16_bf16 v[208:223], v[84:87], v[24:27], v[208:223]
    ds_read_b64_tr_b16 v[42:43], v14 offset:22528
    s_add_u32 s84, s62, 0x48000
    buffer_load_dwordx4 v[64:67], v11, s[4:7], s84 offen offset:0
    buffer_load_dwordx4 v[68:71], v11, s[4:7], s84 offen offset:1024
    v_mfma_f32_32x32x16_bf16 v[224:239], v[80:83], v[28:31], v[224:239]
    ds_read_b64_tr_b16 v[44:45], v15 offset:20480
    s_add_u32 s84, s62, 0x4c000
    buffer_load_dwordx4 v[72:75], v11, s[4:7], s84 offen offset:0
    buffer_load_dwordx4 v[76:79], v11, s[4:7], s84 offen offset:1024
    v_mfma_f32_32x32x16_bf16 v[240:255], v[84:87], v[28:31], v[240:255]
    ds_read_b64_tr_b16 v[46:47], v15 offset:22528
    s_waitcnt vmcnt(24)
    s_waitcnt lgkmcnt(0)
    v_mfma_f32_32x32x16_bf16 v[128:143], v[88:91], v[32:35], v[128:143]
    ds_read_b64_tr_b16 v[16:17], v12 offset:24576
    v_mfma_f32_32x32x16_bf16 v[144:159], v[92:95], v[32:35], v[144:159]
    ds_read_b64_tr_b16 v[18:19], v12 offset:26624
    v_mfma_f32_32x32x16_bf16 v[160:175], v[88:91], v[36:39], v[160:175]
    ds_read_b64_tr_b16 v[20:21], v13 offset:24576
    v_mfma_f32_32x32x16_bf16 v[176:191], v[92:95], v[36:39], v[176:191]
    ds_read_b64_tr_b16 v[22:23], v13 offset:26624
    v_mfma_f32_32x32x16_bf16 v[192:207], v[88:91], v[40:43], v[192:207]
    ds_read_b64_tr_b16 v[24:25], v14 offset:24576
    v_mfma_f32_32x32x16_bf16 v[208:223], v[92:95], v[40:43], v[208:223]
    ds_read_b64_tr_b16 v[26:27], v14 offset:26624
    v_mfma_f32_32x32x16_bf16 v[224:239], v[88:91], v[44:47], v[224:239]
    ds_read_b64_tr_b16 v[28:29], v15 offset:24576
    v_mfma_f32_32x32x16_bf16 v[240:255], v[92:95], v[44:47], v[240:255]
    ds_read_b64_tr_b16 v[30:31], v15 offset:26624
    s_waitcnt lgkmcnt(0)
    v_mfma_f32_32x32x16_bf16 v[128:143], v[96:99], v[16:19], v[128:143]
    ds_read_b64_tr_b16 v[32:33], v12 offset:28672
    v_mfma_f32_32x32x16_bf16 v[144:159], v[100:103], v[16:19], v[144:159]
    ds_read_b64_tr_b16 v[34:35], v12 offset:30720
    s_add_u32 m0, s63, 0x4000
    s_add_u32 s84, s61, 0x140000
    buffer_load_dwordx4 v4, s[40:43], s84 offen lds
    s_add_u32 m0, s63, 0x4400
    s_add_u32 s84, s61, 0x144000
    buffer_load_dwordx4 v4, s[40:43], s84 offen lds
    v_mfma_f32_32x32x16_bf16 v[160:175], v[96:99], v[20:23], v[160:175]
    ds_read_b64_tr_b16 v[36:37], v13 offset:28672
    s_add_u32 m0, s63, 0x4800
    s_add_u32 s84, s61, 0x148000
    buffer_load_dwordx4 v4, s[40:43], s84 offen lds
    s_add_u32 m0, s63, 0x4c00
    s_add_u32 s84, s61, 0x14c000
    buffer_load_dwordx4 v4, s[40:43], s84 offen lds
    v_mfma_f32_32x32x16_bf16 v[176:191], v[100:103], v[20:23], v[176:191]
    ds_read_b64_tr_b16 v[38:39], v13 offset:30720
    s_add_u32 m0, s63, 0x5000
    s_add_u32 s84, s61, 0x150000
    buffer_load_dwordx4 v4, s[40:43], s84 offen lds
    s_add_u32 m0, s63, 0x5400
    s_add_u32 s84, s61, 0x154000
    buffer_load_dwordx4 v4, s[40:43], s84 offen lds
    v_mfma_f32_32x32x16_bf16 v[192:207], v[96:99], v[24:27], v[192:207]
    ds_read_b64_tr_b16 v[40:41], v14 offset:28672
    s_add_u32 m0, s63, 0x5800
    s_add_u32 s84, s61, 0x158000
    buffer_load_dwordx4 v4, s[40:43], s84 offen lds
    s_add_u32 m0, s63, 0x5c00
    s_add_u32 s84, s61, 0x15c000
    buffer_load_dwordx4 v4, s[40:43], s84 offen lds
    v_mfma_f32_32x32x16_bf16 v[208:223], v[100:103], v[24:27], v[208:223]
    ds_read_b64_tr_b16 v[42:43], v14 offset:30720
    s_add_u32 s84, s62, 0x50000
    buffer_load_dwordx4 v[80:83], v11, s[4:7], s84 offen offset:0
    buffer_load_dwordx4 v[84:87], v11, s[4:7], s84 offen offset:1024
    v_mfma_f32_32x32x16_bf16 v[224:239], v[96:99], v[28:31], v[224:239]
    ds_read_b64_tr_b16 v[44:45], v15 offset:28672
    s_add_u32 s84, s62, 0x54000
    buffer_load_dwordx4 v[88:91], v11, s[4:7], s84 offen offset:0
    buffer_load_dwordx4 v[92:95], v11, s[4:7], s84 offen offset:1024
    v_mfma_f32_32x32x16_bf16 v[240:255], v[100:103], v[28:31], v[240:255]
    ds_read_b64_tr_b16 v[46:47], v15 offset:30720
    s_waitcnt vmcnt(24)
    s_waitcnt lgkmcnt(0)
    v_mfma_f32_32x32x16_bf16 v[128:143], v[104:107], v[32:35], v[128:143]
    ds_read_b64_tr_b16 v[16:17], v12 offset:0
    v_mfma_f32_32x32x16_bf16 v[144:159], v[108:111], v[32:35], v[144:159]
    ds_read_b64_tr_b16 v[18:19], v12 offset:2048
    v_mfma_f32_32x32x16_bf16 v[160:175], v[104:107], v[36:39], v[160:175]
    ds_read_b64_tr_b16 v[20:21], v13 offset:0
    v_mfma_f32_32x32x16_bf16 v[176:191], v[108:111], v[36:39], v[176:191]
    ds_read_b64_tr_b16 v[22:23], v13 offset:2048
    v_mfma_f32_32x32x16_bf16 v[192:207], v[104:107], v[40:43], v[192:207]
    ds_read_b64_tr_b16 v[24:25], v14 offset:0
    v_mfma_f32_32x32x16_bf16 v[208:223], v[108:111], v[40:43], v[208:223]
    ds_read_b64_tr_b16 v[26:27], v14 offset:2048
    v_mfma_f32_32x32x16_bf16 v[224:239], v[104:107], v[44:47], v[224:239]
    ds_read_b64_tr_b16 v[28:29], v15 offset:0
    v_mfma_f32_32x32x16_bf16 v[240:255], v[108:111], v[44:47], v[240:255]
    ds_read_b64_tr_b16 v[30:31], v15 offset:2048
    s_waitcnt lgkmcnt(0)
    v_mfma_f32_32x32x16_bf16 v[128:143], v[48:51], v[16:19], v[128:143]
    ds_read_b64_tr_b16 v[32:33], v12 offset:4096
    v_mfma_f32_32x32x16_bf16 v[144:159], v[52:55], v[16:19], v[144:159]
    ds_read_b64_tr_b16 v[34:35], v12 offset:6144
    s_add_u32 m0, s63, 0x6000
    s_add_u32 s84, s61, 0x160000
    buffer_load_dwordx4 v4, s[40:43], s84 offen lds
    s_add_u32 m0, s63, 0x6400
    s_add_u32 s84, s61, 0x164000
    buffer_load_dwordx4 v4, s[40:43], s84 offen lds
    v_mfma_f32_32x32x16_bf16 v[160:175], v[48:51], v[20:23], v[160:175]
    ds_read_b64_tr_b16 v[36:37], v13 offset:4096
    s_add_u32 m0, s63, 0x6800
    s_add_u32 s84, s61, 0x168000
    buffer_load_dwordx4 v4, s[40:43], s84 offen lds
    s_add_u32 m0, s63, 0x6c00
    s_add_u32 s84, s61, 0x16c000
    buffer_load_dwordx4 v4, s[40:43], s84 offen lds
    v_mfma_f32_32x32x16_bf16 v[176:191], v[52:55], v[20:23], v[176:191]
    ds_read_b64_tr_b16 v[38:39], v13 offset:6144
    s_add_u32 m0, s63, 0x7000
    s_add_u32 s84, s61, 0x170000
    buffer_load_dwordx4 v4, s[40:43], s84 offen lds
    s_add_u32 m0, s63, 0x7400
    s_add_u32 s84, s61, 0x174000
    buffer_load_dwordx4 v4, s[40:43], s84 offen lds
    v_mfma_f32_32x32x16_bf16 v[192:207], v[48:51], v[24:27], v[192:207]
    ds_read_b64_tr_b16 v[40:41], v14 offset:4096
    s_add_u32 m0, s63, 0x7800
    s_add_u32 s84, s61, 0x178000
    buffer_load_dwordx4 v4, s[40:43], s84 offen lds
    s_add_u32 m0, s63, 0x7c00
    s_add_u32 s84, s61, 0x17c000
    buffer_load_dwordx4 v4, s[40:43], s84 offen lds
    v_mfma_f32_32x32x16_bf16 v[208:223], v[52:55], v[24:27], v[208:223]
    ds_read_b64_tr_b16 v[42:43], v14 offset:6144
    s_add_u32 s84, s62, 0x58000
    buffer_load_dwordx4 v[96:99], v11, s[4:7], s84 offen offset:0
    buffer_load_dwordx4 v[100:103], v11, s[4:7], s84 offen offset:1024
    v_mfma_f32_32x32x16_bf16 v[224:239], v[48:51], v[28:31], v[224:239]
    ds_read_b64_tr_b16 v[44:45], v15 offset:4096
    s_add_u32 s84, s62, 0x5c000
    buffer_load_dwordx4 v[104:107], v11, s[4:7], s84 offen offset:0
    buffer_load_dwordx4 v[108:111], v11, s[4:7], s84 offen offset:1024
    v_mfma_f32_32x32x16_bf16 v[240:255], v[52:55], v[28:31], v[240:255]
    ds_read_b64_tr_b16 v[46:47], v15 offset:6144
    s_waitcnt vmcnt(24)
    s_waitcnt lgkmcnt(0)
    v_mfma_f32_32x32x16_bf16 v[128:143], v[56:59], v[32:35], v[128:143]
    ds_read_b64_tr_b16 v[16:17], v12 offset:8192
    v_mfma_f32_32x32x16_bf16 v[144:159], v[60:63], v[32:35], v[144:159]
    ds_read_b64_tr_b16 v[18:19], v12 offset:10240
    v_mfma_f32_32x32x16_bf16 v[160:175], v[56:59], v[36:39], v[160:175]
    ds_read_b64_tr_b16 v[20:21], v13 offset:8192
    v_mfma_f32_32x32x16_bf16 v[176:191], v[60:63], v[36:39], v[176:191]
    ds_read_b64_tr_b16 v[22:23], v13 offset:10240
    v_mfma_f32_32x32x16_bf16 v[192:207], v[56:59], v[40:43], v[192:207]
    ds_read_b64_tr_b16 v[24:25], v14 offset:8192
    v_mfma_f32_32x32x16_bf16 v[208:223], v[60:63], v[40:43], v[208:223]
    ds_read_b64_tr_b16 v[26:27], v14 offset:10240
    v_mfma_f32_32x32x16_bf16 v[224:239], v[56:59], v[44:47], v[224:239]
    ds_read_b64_tr_b16 v[28:29], v15 offset:8192
    v_mfma_f32_32x32x16_bf16 v[240:255], v[60:63], v[44:47], v[240:255]
    ds_read_b64_tr_b16 v[30:31], v15 offset:10240
    s_waitcnt lgkmcnt(0)
    v_mfma_f32_32x32x16_bf16 v[128:143], v[64:67], v[16:19], v[128:143]
    ds_read_b64_tr_b16 v[32:33], v12 offset:12288
    v_mfma_f32_32x32x16_bf16 v[144:159], v[68:71], v[16:19], v[144:159]
    ds_read_b64_tr_b16 v[34:35], v12 offset:14336
    s_add_u32 m0, s63, 0x0
    s_add_u32 s84, s61, 0x180000
    buffer_load_dwordx4 v4, s[40:43], s84 offen lds
    s_add_u32 m0, s63, 0x400
    s_add_u32 s84, s61, 0x184000
    buffer_load_dwordx4 v4, s[40:43], s84 offen lds
    v_mfma_f32_32x32x16_bf16 v[160:175], v[64:67], v[20:23], v[160:175]
    ds_read_b64_tr_b16 v[36:37], v13 offset:12288
    s_add_u32 m0, s63, 0x800
    s_add_u32 s84, s61, 0x188000
    buffer_load_dwordx4 v4, s[40:43], s84 offen lds
    s_add_u32 m0, s63, 0xc00
    s_add_u32 s84, s61, 0x18c000
    buffer_load_dwordx4 v4, s[40:43], s84 offen lds
    v_mfma_f32_32x32x16_bf16 v[176:191], v[68:71], v[20:23], v[176:191]
    ds_read_b64_tr_b16 v[38:39], v13 offset:14336
    s_add_u32 m0, s63, 0x1000
    s_add_u32 s84, s61, 0x190000
    buffer_load_dwordx4 v4, s[40:43], s84 offen lds
    s_add_u32 m0, s63, 0x1400
    s_add_u32 s84, s61, 0x194000
    buffer_load_dwordx4 v4, s[40:43], s84 offen lds
    v_mfma_f32_32x32x16_bf16 v[192:207], v[64:67], v[24:27], v[192:207]
    ds_read_b64_tr_b16 v[40:41], v14 offset:12288
    s_add_u32 m0, s63, 0x1800
    s_add_u32 s84, s61, 0x198000
    buffer_load_dwordx4 v4, s[40:43], s84 offen lds
    s_add_u32 m0, s63, 0x1c00
    s_add_u32 s84, s61, 0x19c000
    buffer_load_dwordx4 v4, s[40:43], s84 offen lds
    v_mfma_f32_32x32x16_bf16 v[208:223], v[68:71], v[24:27], v[208:223]
    ds_read_b64_tr_b16 v[42:43], v14 offset:14336
    s_add_u32 s84, s62, 0x60000
    buffer_load_dwordx4 v[48:51], v11, s[4:7], s84 offen offset:0
    buffer_load_dwordx4 v[52:55], v11, s[4:7], s84 offen offset:1024
    v_mfma_f32_32x32x16_bf16 v[224:239], v[64:67], v[28:31], v[224:239]
    ds_read_b64_tr_b16 v[44:45], v15 offset:12288
    s_add_u32 s84, s62, 0x64000
    buffer_load_dwordx4 v[56:59], v11, s[4:7], s84 offen offset:0
    buffer_load_dwordx4 v[60:63], v11, s[4:7], s84 offen offset:1024
    v_mfma_f32_32x32x16_bf16 v[240:255], v[68:71], v[28:31], v[240:255]
    ds_read_b64_tr_b16 v[46:47], v15 offset:14336
    s_waitcnt vmcnt(24)
    s_waitcnt lgkmcnt(0)
    v_mfma_f32_32x32x16_bf16 v[128:143], v[72:75], v[32:35], v[128:143]
    ds_read_b64_tr_b16 v[16:17], v12 offset:16384
    v_mfma_f32_32x32x16_bf16 v[144:159], v[76:79], v[32:35], v[144:159]
    ds_read_b64_tr_b16 v[18:19], v12 offset:18432
    v_mfma_f32_32x32x16_bf16 v[160:175], v[72:75], v[36:39], v[160:175]
    ds_read_b64_tr_b16 v[20:21], v13 offset:16384
    v_mfma_f32_32x32x16_bf16 v[176:191], v[76:79], v[36:39], v[176:191]
    ds_read_b64_tr_b16 v[22:23], v13 offset:18432
    v_mfma_f32_32x32x16_bf16 v[192:207], v[72:75], v[40:43], v[192:207]
    ds_read_b64_tr_b16 v[24:25], v14 offset:16384
    v_mfma_f32_32x32x16_bf16 v[208:223], v[76:79], v[40:43], v[208:223]
    ds_read_b64_tr_b16 v[26:27], v14 offset:18432
    v_mfma_f32_32x32x16_bf16 v[224:239], v[72:75], v[44:47], v[224:239]
    ds_read_b64_tr_b16 v[28:29], v15 offset:16384
    v_mfma_f32_32x32x16_bf16 v[240:255], v[76:79], v[44:47], v[240:255]
    ds_read_b64_tr_b16 v[30:31], v15 offset:18432
    s_waitcnt lgkmcnt(0)
    v_mfma_f32_32x32x16_bf16 v[128:143], v[80:83], v[16:19], v[128:143]
    ds_read_b64_tr_b16 v[32:33], v12 offset:20480
    v_mfma_f32_32x32x16_bf16 v[144:159], v[84:87], v[16:19], v[144:159]
    ds_read_b64_tr_b16 v[34:35], v12 offset:22528
    s_add_u32 m0, s63, 0x2000
    s_add_u32 s84, s61, 0x1a0000
    buffer_load_dwordx4 v4, s[40:43], s84 offen lds
    s_add_u32 m0, s63, 0x2400
    s_add_u32 s84, s61, 0x1a4000
    buffer_load_dwordx4 v4, s[40:43], s84 offen lds
    v_mfma_f32_32x32x16_bf16 v[160:175], v[80:83], v[20:23], v[160:175]
    ds_read_b64_tr_b16 v[36:37], v13 offset:20480
    s_add_u32 m0, s63, 0x2800
    s_add_u32 s84, s61, 0x1a8000
    buffer_load_dwordx4 v4, s[40:43], s84 offen lds
    s_add_u32 m0, s63, 0x2c00
    s_add_u32 s84, s61, 0x1ac000
    buffer_load_dwordx4 v4, s[40:43], s84 offen lds
    v_mfma_f32_32x32x16_bf16 v[176:191], v[84:87], v[20:23], v[176:191]
    ds_read_b64_tr_b16 v[38:39], v13 offset:22528
    s_add_u32 m0, s63, 0x3000
    s_add_u32 s84, s61, 0x1b0000
    buffer_load_dwordx4 v4, s[40:43], s84 offen lds
    s_add_u32 m0, s63, 0x3400
    s_add_u32 s84, s61, 0x1b4000
    buffer_load_dwordx4 v4, s[40:43], s84 offen lds
    v_mfma_f32_32x32x16_bf16 v[192:207], v[80:83], v[24:27], v[192:207]
    ds_read_b64_tr_b16 v[40:41], v14 offset:20480
    s_add_u32 m0, s63, 0x3800
    s_add_u32 s84, s61, 0x1b8000
    buffer_load_dwordx4 v4, s[40:43], s84 offen lds
    s_add_u32 m0, s63, 0x3c00
    s_add_u32 s84, s61, 0x1bc000
    buffer_load_dwordx4 v4, s[40:43], s84 offen lds
    v_mfma_f32_32x32x16_bf16 v[208:223], v[84:87], v[24:27], v[208:223]
    ds_read_b64_tr_b16 v[42:43], v14 offset:22528
    s_add_u32 s84, s62, 0x68000
    buffer_load_dwordx4 v[64:67], v11, s[4:7], s84 offen offset:0
    buffer_load_dwordx4 v[68:71], v11, s[4:7], s84 offen offset:1024
    v_mfma_f32_32x32x16_bf16 v[224:239], v[80:83], v[28:31], v[224:239]
    ds_read_b64_tr_b16 v[44:45], v15 offset:20480
    s_add_u32 s84, s62, 0x6c000
    buffer_load_dwordx4 v[72:75], v11, s[4:7], s84 offen offset:0
    buffer_load_dwordx4 v[76:79], v11, s[4:7], s84 offen offset:1024
    v_mfma_f32_32x32x16_bf16 v[240:255], v[84:87], v[28:31], v[240:255]
    ds_read_b64_tr_b16 v[46:47], v15 offset:22528
    s_waitcnt vmcnt(24)
    s_waitcnt lgkmcnt(0)
    v_mfma_f32_32x32x16_bf16 v[128:143], v[88:91], v[32:35], v[128:143]
    ds_read_b64_tr_b16 v[16:17], v12 offset:24576
    v_mfma_f32_32x32x16_bf16 v[144:159], v[92:95], v[32:35], v[144:159]
    ds_read_b64_tr_b16 v[18:19], v12 offset:26624
    v_mfma_f32_32x32x16_bf16 v[160:175], v[88:91], v[36:39], v[160:175]
    ds_read_b64_tr_b16 v[20:21], v13 offset:24576
    v_mfma_f32_32x32x16_bf16 v[176:191], v[92:95], v[36:39], v[176:191]
    ds_read_b64_tr_b16 v[22:23], v13 offset:26624
    v_mfma_f32_32x32x16_bf16 v[192:207], v[88:91], v[40:43], v[192:207]
    ds_read_b64_tr_b16 v[24:25], v14 offset:24576
    v_mfma_f32_32x32x16_bf16 v[208:223], v[92:95], v[40:43], v[208:223]
    ds_read_b64_tr_b16 v[26:27], v14 offset:26624
    v_mfma_f32_32x32x16_bf16 v[224:239], v[88:91], v[44:47], v[224:239]
    ds_read_b64_tr_b16 v[28:29], v15 offset:24576
    v_mfma_f32_32x32x16_bf16 v[240:255], v[92:95], v[44:47], v[240:255]
    ds_read_b64_tr_b16 v[30:31], v15 offset:26624
    s_waitcnt lgkmcnt(0)
    v_mfma_f32_32x32x16_bf16 v[128:143], v[96:99], v[16:19], v[128:143]
    ds_read_b64_tr_b16 v[32:33], v12 offset:28672
    v_mfma_f32_32x32x16_bf16 v[144:159], v[100:103], v[16:19], v[144:159]
    ds_read_b64_tr_b16 v[34:35], v12 offset:30720
    v_mfma_f32_32x32x16_bf16 v[160:175], v[96:99], v[20:23], v[160:175]
    ds_read_b64_tr_b16 v[36:37], v13 offset:28672
    v_mfma_f32_32x32x16_bf16 v[176:191], v[100:103], v[20:23], v[176:191]
    ds_read_b64_tr_b16 v[38:39], v13 offset:30720
    v_mfma_f32_32x32x16_bf16 v[192:207], v[96:99], v[24:27], v[192:207]
    ds_read_b64_tr_b16 v[40:41], v14 offset:28672
    v_mfma_f32_32x32x16_bf16 v[208:223], v[100:103], v[24:27], v[208:223]
    ds_read_b64_tr_b16 v[42:43], v14 offset:30720
    v_mfma_f32_32x32x16_bf16 v[224:239], v[96:99], v[28:31], v[224:239]
    ds_read_b64_tr_b16 v[44:45], v15 offset:28672
    v_mfma_f32_32x32x16_bf16 v[240:255], v[100:103], v[28:31], v[240:255]
    ds_read_b64_tr_b16 v[46:47], v15 offset:30720
    s_waitcnt vmcnt(12)
    s_waitcnt lgkmcnt(0)
    v_mfma_f32_32x32x16_bf16 v[128:143], v[104:107], v[32:35], v[128:143]
    ds_read_b64_tr_b16 v[16:17], v12 offset:0
    v_mfma_f32_32x32x16_bf16 v[144:159], v[108:111], v[32:35], v[144:159]
    ds_read_b64_tr_b16 v[18:19], v12 offset:2048
    v_mfma_f32_32x32x16_bf16 v[160:175], v[104:107], v[36:39], v[160:175]
    ds_read_b64_tr_b16 v[20:21], v13 offset:0
    v_mfma_f32_32x32x16_bf16 v[176:191], v[108:111], v[36:39], v[176:191]
    ds_read_b64_tr_b16 v[22:23], v13 offset:2048
    v_mfma_f32_32x32x16_bf16 v[192:207], v[104:107], v[40:43], v[192:207]
    ds_read_b64_tr_b16 v[24:25], v14 offset:0
    v_mfma_f32_32x32x16_bf16 v[208:223], v[108:111], v[40:43], v[208:223]
    ds_read_b64_tr_b16 v[26:27], v14 offset:2048
    v_mfma_f32_32x32x16_bf16 v[224:239], v[104:107], v[44:47], v[224:239]
    ds_read_b64_tr_b16 v[28:29], v15 offset:0
    v_mfma_f32_32x32x16_bf16 v[240:255], v[108:111], v[44:47], v[240:255]
    ds_read_b64_tr_b16 v[30:31], v15 offset:2048
    s_waitcnt lgkmcnt(0)
    v_mfma_f32_32x32x16_bf16 v[128:143], v[48:51], v[16:19], v[128:143]
    ds_read_b64_tr_b16 v[32:33], v12 offset:4096
    v_mfma_f32_32x32x16_bf16 v[144:159], v[52:55], v[16:19], v[144:159]
    ds_read_b64_tr_b16 v[34:35], v12 offset:6144
    v_mfma_f32_32x32x16_bf16 v[160:175], v[48:51], v[20:23], v[160:175]
    ds_read_b64_tr_b16 v[36:37], v13 offset:4096
    v_mfma_f32_32x32x16_bf16 v[176:191], v[52:55], v[20:23], v[176:191]
    ds_read_b64_tr_b16 v[38:39], v13 offset:6144
    v_mfma_f32_32x32x16_bf16 v[192:207], v[48:51], v[24:27], v[192:207]
    ds_read_b64_tr_b16 v[40:41], v14 offset:4096
    v_mfma_f32_32x32x16_bf16 v[208:223], v[52:55], v[24:27], v[208:223]
    ds_read_b64_tr_b16 v[42:43], v14 offset:6144
    v_mfma_f32_32x32x16_bf16 v[224:239], v[48:51], v[28:31], v[224:239]
    ds_read_b64_tr_b16 v[44:45], v15 offset:4096
    v_mfma_f32_32x32x16_bf16 v[240:255], v[52:55], v[28:31], v[240:255]
    ds_read_b64_tr_b16 v[46:47], v15 offset:6144
    s_waitcnt vmcnt(0)
    s_waitcnt lgkmcnt(0)
    v_mfma_f32_32x32x16_bf16 v[128:143], v[56:59], v[32:35], v[128:143]
    ds_read_b64_tr_b16 v[16:17], v12 offset:8192
    v_mfma_f32_32x32x16_bf16 v[144:159], v[60:63], v[32:35], v[144:159]
    ds_read_b64_tr_b16 v[18:19], v12 offset:10240
    v_mfma_f32_32x32x16_bf16 v[160:175], v[56:59], v[36:39], v[160:175]
    ds_read_b64_tr_b16 v[20:21], v13 offset:8192
    v_mfma_f32_32x32x16_bf16 v[176:191], v[60:63], v[36:39], v[176:191]
    ds_read_b64_tr_b16 v[22:23], v13 offset:10240
    v_mfma_f32_32x32x16_bf16 v[192:207], v[56:59], v[40:43], v[192:207]
    ds_read_b64_tr_b16 v[24:25], v14 offset:8192
    v_mfma_f32_32x32x16_bf16 v[208:223], v[60:63], v[40:43], v[208:223]
    ds_read_b64_tr_b16 v[26:27], v14 offset:10240
    v_mfma_f32_32x32x16_bf16 v[224:239], v[56:59], v[44:47], v[224:239]
    ds_read_b64_tr_b16 v[28:29], v15 offset:8192
    v_mfma_f32_32x32x16_bf16 v[240:255], v[60:63], v[44:47], v[240:255]
    ds_read_b64_tr_b16 v[30:31], v15 offset:10240
    s_waitcnt lgkmcnt(0)
    v_mfma_f32_32x32x16_bf16 v[128:143], v[64:67], v[16:19], v[128:143]
    ds_read_b64_tr_b16 v[32:33], v12 offset:12288
    v_mfma_f32_32x32x16_bf16 v[144:159], v[68:71], v[16:19], v[144:159]
    ds_read_b64_tr_b16 v[34:35], v12 offset:14336
    v_mfma_f32_32x32x16_bf16 v[160:175], v[64:67], v[20:23], v[160:175]
    ds_read_b64_tr_b16 v[36:37], v13 offset:12288
    v_mfma_f32_32x32x16_bf16 v[176:191], v[68:71], v[20:23], v[176:191]
    ds_read_b64_tr_b16 v[38:39], v13 offset:14336
    v_mfma_f32_32x32x16_bf16 v[192:207], v[64:67], v[24:27], v[192:207]
    ds_read_b64_tr_b16 v[40:41], v14 offset:12288
    v_mfma_f32_32x32x16_bf16 v[208:223], v[68:71], v[24:27], v[208:223]
    ds_read_b64_tr_b16 v[42:43], v14 offset:14336
    v_mfma_f32_32x32x16_bf16 v[224:239], v[64:67], v[28:31], v[224:239]
    ds_read_b64_tr_b16 v[44:45], v15 offset:12288
    v_mfma_f32_32x32x16_bf16 v[240:255], v[68:71], v[28:31], v[240:255]
    ds_read_b64_tr_b16 v[46:47], v15 offset:14336
    s_waitcnt lgkmcnt(0)
    v_mfma_f32_32x32x16_bf16 v[128:143], v[72:75], v[32:35], v[128:143]
    v_mfma_f32_32x32x16_bf16 v[144:159], v[76:79], v[32:35], v[144:159]
    v_mfma_f32_32x32x16_bf16 v[160:175], v[72:75], v[36:39], v[160:175]
    v_mfma_f32_32x32x16_bf16 v[176:191], v[76:79], v[36:39], v[176:191]
    v_mfma_f32_32x32x16_bf16 v[192:207], v[72:75], v[40:43], v[192:207]
    v_mfma_f32_32x32x16_bf16 v[208:223], v[76:79], v[40:43], v[208:223]
    v_mfma_f32_32x32x16_bf16 v[224:239], v[72:75], v[44:47], v[224:239]
    v_mfma_f32_32x32x16_bf16 v[240:255], v[76:79], v[44:47], v[240:255]
    s_nop 11
    v_add_u32 v112, s63, v11
    ds_write_b128 v112, v[128:131] offset:0
    ds_write_b128 v112, v[132:135] offset:1024
    ds_write_b128 v112, v[136:139] offset:2048
    ds_write_b128 v112, v[140:143] offset:3072
    ds_write_b128 v112, v[144:147] offset:4096
    ds_write_b128 v112, v[148:151] offset:5120
    ds_write_b128 v112, v[152:155] offset:6144
    ds_write_b128 v112, v[156:159] offset:7168
    ds_write_b128 v112, v[160:163] offset:8192
    ds_write_b128 v112, v[164:167] offset:9216
    ds_write_b128 v112, v[168:171] offset:10240
    ds_write_b128 v112, v[172:175] offset:11264
    ds_write_b128 v112, v[176:179] offset:12288
    ds_write_b128 v112, v[180:183] offset:13312
    ds_write_b128 v112, v[184:187] offset:14336
    ds_write_b128 v112, v[188:191] offset:15360
    ds_write_b128 v112, v[192:195] offset:16384
    ds_write_b128 v112, v[196:199] offset:17408
    ds_write_b128 v112, v[200:203] offset:18432
    ds_write_b128 v112, v[204:207] offset:19456
    ds_write_b128 v112, v[208:211] offset:20480
    ds_write_b128 v112, v[212:215] offset:21504
    ds_write_b128 v112, v[216:219] offset:22528
    ds_write_b128 v112, v[220:223] offset:23552
    ds_write_b128 v112, v[224:227] offset:24576
    ds_write_b128 v112, v[228:231] offset:25600
    ds_write_b128 v112, v[232:235] offset:26624
    ds_write_b128 v112, v[236:239] offset:27648
    ds_write_b128 v112, v[240:243] offset:28672
    ds_write_b128 v112, v[244:247] offset:29696
    ds_write_b128 v112, v[248:251] offset:30720
    ds_write_b128 v112, v[252:255] offset:31744
    s_lshl_b32 s81, s56, 13
    v_add_u32 v112, s81, v11
    v_add_u32 v113, 0x10000, v112
    s_waitcnt lgkmcnt(0)
    s_barrier
    ds_read_b128 v[128:131], v112 offset:0
    ds_read_b128 v[132:135], v112 offset:1024
    ds_read_b128 v[136:139], v112 offset:2048
    ds_read_b128 v[140:143], v112 offset:3072
    ds_read_b128 v[144:147], v112 offset:4096
    ds_read_b128 v[148:151], v112 offset:5120
    ds_read_b128 v[152:155], v112 offset:6144
    ds_read_b128 v[156:159], v112 offset:7168
    ds_read_b128 v[160:163], v112 offset:32768
    ds_read_b128 v[164:167], v112 offset:33792
    ds_read_b128 v[168:171], v112 offset:34816
    ds_read_b128 v[172:175], v112 offset:35840
    ds_read_b128 v[176:179], v112 offset:36864
    ds_read_b128 v[180:183], v112 offset:37888
    ds_read_b128 v[184:187], v112 offset:38912
    ds_read_b128 v[188:191], v112 offset:39936
    ds_read_b128 v[192:195], v113 offset:0
    ds_read_b128 v[196:199], v113 offset:1024
    ds_read_b128 v[200:203], v113 offset:2048
    ds_read_b128 v[204:207], v113 offset:3072
    ds_read_b128 v[208:211], v113 offset:4096
    ds_read_b128 v[212:215], v113 offset:5120
    ds_read_b128 v[216:219], v113 offset:6144
    ds_read_b128 v[220:223], v113 offset:7168
    ds_read_b128 v[224:227], v113 offset:32768
    ds_read_b128 v[228:231], v113 offset:33792
    ds_read_b128 v[232:235], v113 offset:34816
    ds_read_b128 v[236:239], v113 offset:35840
    ds_read_b128 v[240:243], v113 offset:36864
    ds_read_b128 v[244:247], v113 offset:37888
    ds_read_b128 v[248:251], v113 offset:38912
    ds_read_b128 v[252:255], v113 offset:39936
    s_waitcnt vmcnt(0) lgkmcnt(0)
    v_add_f32 v128, v128, v160
    v_add_f32 v192, v192, v224
    v_add_f32 v129, v129, v161
    v_add_f32 v193, v193, v225
    v_add_f32 v130, v130, v162
    v_add_f32 v194, v194, v226
    v_add_f32 v131, v131, v163
    v_add_f32 v195, v195, v227
    v_add_f32 v132, v132, v164
    v_add_f32 v196, v196, v228
    v_add_f32 v133, v133, v165
    v_add_f32 v197, v197, v229
    v_add_f32 v134, v134, v166
    v_add_f32 v198, v198, v230
    v_add_f32 v135, v135, v167
    v_add_f32 v199, v199, v231
    v_add_f32 v136, v136, v168
    v_add_f32 v200, v200, v232
    v_add_f32 v137, v137, v169
    v_add_f32 v201, v201, v233
    v_add_f32 v138, v138, v170
    v_add_f32 v202, v202, v234
    v_add_f32 v139, v139, v171
    v_add_f32 v203, v203, v235
    v_add_f32 v140, v140, v172
    v_add_f32 v204, v204, v236
    v_add_f32 v141, v141, v173
    v_add_f32 v205, v205, v237
    v_add_f32 v142, v142, v174
    v_add_f32 v206, v206, v238
    v_add_f32 v143, v143, v175
    v_add_f32 v207, v207, v239
    v_add_f32 v144, v144, v176
    v_add_f32 v208, v208, v240
    v_add_f32 v145, v145, v177
    v_add_f32 v209, v209, v241
    v_add_f32 v146, v146, v178
    v_add_f32 v210, v210, v242
    v_add_f32 v147, v147, v179
    v_add_f32 v211, v211, v243
    v_add_f32 v148, v148, v180
    v_add_f32 v212, v212, v244
    v_add_f32 v149, v149, v181
    v_add_f32 v213, v213, v245
    v_add_f32 v150, v150, v182
    v_add_f32 v214, v214, v246
    v_add_f32 v151, v151, v183
    v_add_f32 v215, v215, v247
    v_add_f32 v152, v152, v184
    v_add_f32 v216, v216, v248
    v_add_f32 v153, v153, v185
    v_add_f32 v217, v217, v249
    v_add_f32 v154, v154, v186
    v_add_f32 v218, v218, v250
    v_add_f32 v155, v155, v187
    v_add_f32 v219, v219, v251
    v_add_f32 v156, v156, v188
    v_add_f32 v220, v220, v252
    v_add_f32 v157, v157, v189
    v_add_f32 v221, v221, v253
    v_add_f32 v158, v158, v190
    v_add_f32 v222, v222, v254
    v_add_f32 v159, v159, v191
    v_add_f32 v223, v223, v255
    v_add_f32 v128, v128, v192
    v_add_f32 v129, v129, v193
    v_add_f32 v130, v130, v194
    v_add_f32 v131, v131, v195
    v_add_f32 v132, v132, v196
    v_add_f32 v133, v133, v197
    v_add_f32 v134, v134, v198
    v_add_f32 v135, v135, v199
    v_add_f32 v136, v136, v200
    v_add_f32 v137, v137, v201
    v_add_f32 v138, v138, v202
    v_add_f32 v139, v139, v203
    v_add_f32 v140, v140, v204
    v_add_f32 v141, v141, v205
    v_add_f32 v142, v142, v206
    v_add_f32 v143, v143, v207
    v_add_f32 v144, v144, v208
    v_add_f32 v145, v145, v209
    v_add_f32 v146, v146, v210
    v_add_f32 v147, v147, v211
    v_add_f32 v148, v148, v212
    v_add_f32 v149, v149, v213
    v_add_f32 v150, v150, v214
    v_add_f32 v151, v151, v215
    v_add_f32 v152, v152, v216
    v_add_f32 v153, v153, v217
    v_add_f32 v154, v154, v218
    v_add_f32 v155, v155, v219
    v_add_f32 v156, v156, v220
    v_add_f32 v157, v157, v221
    v_add_f32 v158, v158, v222
    v_add_f32 v159, v159, v223
    v_cvt_pk_bf16_f32 v112, v128, v129
    v_lshlrev_b32 v128, 16, v112
    v_and_b32 v129, 0xffff0000, v112
    v_cvt_pk_bf16_f32 v112, v130, v131
    v_lshlrev_b32 v130, 16, v112
    v_and_b32 v131, 0xffff0000, v112
    v_cvt_pk_bf16_f32 v112, v132, v133
    v_lshlrev_b32 v132, 16, v112
    v_and_b32 v133, 0xffff0000, v112
    v_cvt_pk_bf16_f32 v112, v134, v135
    v_lshlrev_b32 v134, 16, v112
    v_and_b32 v135, 0xffff0000, v112
    v_cvt_pk_bf16_f32 v112, v136, v137
    v_lshlrev_b32 v136, 16, v112
    v_and_b32 v137, 0xffff0000, v112
    v_cvt_pk_bf16_f32 v112, v138, v139
    v_lshlrev_b32 v138, 16, v112
    v_and_b32 v139, 0xffff0000, v112
    v_cvt_pk_bf16_f32 v112, v140, v141
    v_lshlrev_b32 v140, 16, v112
    v_and_b32 v141, 0xffff0000, v112
    v_cvt_pk_bf16_f32 v112, v142, v143
    v_lshlrev_b32 v142, 16, v112
    v_and_b32 v143, 0xffff0000, v112
    v_cvt_pk_bf16_f32 v112, v144, v145
    v_lshlrev_b32 v144, 16, v112
    v_and_b32 v145, 0xffff0000, v112
    v_cvt_pk_bf16_f32 v112, v146, v147
    v_lshlrev_b32 v146, 16, v112
    v_and_b32 v147, 0xffff0000, v112
    v_cvt_pk_bf16_f32 v112, v148, v149
    v_lshlrev_b32 v148, 16, v112
    v_and_b32 v149, 0xffff0000, v112
    v_cvt_pk_bf16_f32 v112, v150, v151
    v_lshlrev_b32 v150, 16, v112
    v_and_b32 v151, 0xffff0000, v112
    v_cvt_pk_bf16_f32 v112, v152, v153
    v_lshlrev_b32 v152, 16, v112
    v_and_b32 v153, 0xffff0000, v112
    v_cvt_pk_bf16_f32 v112, v154, v155
    v_lshlrev_b32 v154, 16, v112
    v_and_b32 v155, 0xffff0000, v112
    v_cvt_pk_bf16_f32 v112, v156, v157
    v_lshlrev_b32 v156, 16, v112
    v_and_b32 v157, 0xffff0000, v112
    v_cvt_pk_bf16_f32 v112, v158, v159
    v_lshlrev_b32 v158, 16, v112
    v_and_b32 v159, 0xffff0000, v112
    v_lshlrev_b32 v5, 16, v5
    v_add_f32 v128, v128, v5
    v_add_f32 v129, v129, v5
    v_add_f32 v130, v130, v5
    v_add_f32 v131, v131, v5
    v_add_f32 v132, v132, v5
    v_add_f32 v133, v133, v5
    v_add_f32 v134, v134, v5
    v_add_f32 v135, v135, v5
    v_add_f32 v136, v136, v5
    v_add_f32 v137, v137, v5
    v_add_f32 v138, v138, v5
    v_add_f32 v139, v139, v5
    v_add_f32 v140, v140, v5
    v_add_f32 v141, v141, v5
    v_add_f32 v142, v142, v5
    v_add_f32 v143, v143, v5
    v_add_f32 v144, v144, v5
    v_add_f32 v145, v145, v5
    v_add_f32 v146, v146, v5
    v_add_f32 v147, v147, v5
    v_add_f32 v148, v148, v5
    v_add_f32 v149, v149, v5
    v_add_f32 v150, v150, v5
    v_add_f32 v151, v151, v5
    v_add_f32 v152, v152, v5
    v_add_f32 v153, v153, v5
    v_add_f32 v154, v154, v5
    v_add_f32 v155, v155, v5
    v_add_f32 v156, v156, v5
    v_add_f32 v157, v157, v5
    v_add_f32 v158, v158, v5
    v_add_f32 v159, v159, v5
    v_cvt_pk_bf16_f32 v112, v128, v129
    v_lshlrev_b32 v128, 16, v112
    v_and_b32 v129, 0xffff0000, v112
    v_cvt_pk_bf16_f32 v112, v130, v131
    v_lshlrev_b32 v130, 16, v112
    v_and_b32 v131, 0xffff0000, v112
    v_cvt_pk_bf16_f32 v112, v132, v133
    v_lshlrev_b32 v132, 16, v112
    v_and_b32 v133, 0xffff0000, v112
    v_cvt_pk_bf16_f32 v112, v134, v135
    v_lshlrev_b32 v134, 16, v112
    v_and_b32 v135, 0xffff0000, v112
    v_cvt_pk_bf16_f32 v112, v136, v137
    v_lshlrev_b32 v136, 16, v112
    v_and_b32 v137, 0xffff0000, v112
    v_cvt_pk_bf16_f32 v112, v138, v139
    v_lshlrev_b32 v138, 16, v112
    v_and_b32 v139, 0xffff0000, v112
    v_cvt_pk_bf16_f32 v112, v140, v141
    v_lshlrev_b32 v140, 16, v112
    v_and_b32 v141, 0xffff0000, v112
    v_cvt_pk_bf16_f32 v112, v142, v143
    v_lshlrev_b32 v142, 16, v112
    v_and_b32 v143, 0xffff0000, v112
    v_cvt_pk_bf16_f32 v112, v144, v145
    v_lshlrev_b32 v144, 16, v112
    v_and_b32 v145, 0xffff0000, v112
    v_cvt_pk_bf16_f32 v112, v146, v147
    v_lshlrev_b32 v146, 16, v112
    v_and_b32 v147, 0xffff0000, v112
    v_cvt_pk_bf16_f32 v112, v148, v149
    v_lshlrev_b32 v148, 16, v112
    v_and_b32 v149, 0xffff0000, v112
    v_cvt_pk_bf16_f32 v112, v150, v151
    v_lshlrev_b32 v150, 16, v112
    v_and_b32 v151, 0xffff0000, v112
    v_cvt_pk_bf16_f32 v112, v152, v153
    v_lshlrev_b32 v152, 16, v112
    v_and_b32 v153, 0xffff0000, v112
    v_cvt_pk_bf16_f32 v112, v154, v155
    v_lshlrev_b32 v154, 16, v112
    v_and_b32 v155, 0xffff0000, v112
    v_cvt_pk_bf16_f32 v112, v156, v157
    v_lshlrev_b32 v156, 16, v112
    v_and_b32 v157, 0xffff0000, v112
    v_cvt_pk_bf16_f32 v112, v158, v159
    v_lshlrev_b32 v158, 16, v112
    v_and_b32 v159, 0xffff0000, v112
    v_accvgpr_read_b32 v112, a0
    v_lshlrev_b32 v113, 16, v112
    v_and_b32 v112, 0xffff0000, v112
    v_add_f32 v128, v128, v113
    v_add_f32 v129, v129, v112
    v_accvgpr_read_b32 v112, a1
    v_lshlrev_b32 v113, 16, v112
    v_and_b32 v112, 0xffff0000, v112
    v_add_f32 v130, v130, v113
    v_add_f32 v131, v131, v112
    v_accvgpr_read_b32 v112, a2
    v_lshlrev_b32 v113, 16, v112
    v_and_b32 v112, 0xffff0000, v112
    v_add_f32 v132, v132, v113
    v_add_f32 v133, v133, v112
    v_accvgpr_read_b32 v112, a3
    v_lshlrev_b32 v113, 16, v112
    v_and_b32 v112, 0xffff0000, v112
    v_add_f32 v134, v134, v113
    v_add_f32 v135, v135, v112
    v_accvgpr_read_b32 v112, a4
    v_lshlrev_b32 v113, 16, v112
    v_and_b32 v112, 0xffff0000, v112
    v_add_f32 v136, v136, v113
    v_add_f32 v137, v137, v112
    v_accvgpr_read_b32 v112, a5
    v_lshlrev_b32 v113, 16, v112
    v_and_b32 v112, 0xffff0000, v112
    v_add_f32 v138, v138, v113
    v_add_f32 v139, v139, v112
    v_accvgpr_read_b32 v112, a6
    v_lshlrev_b32 v113, 16, v112
    v_and_b32 v112, 0xffff0000, v112
    v_add_f32 v140, v140, v113
    v_add_f32 v141, v141, v112
    v_accvgpr_read_b32 v112, a7
    v_lshlrev_b32 v113, 16, v112
    v_and_b32 v112, 0xffff0000, v112
    v_add_f32 v142, v142, v113
    v_add_f32 v143, v143, v112
    v_accvgpr_read_b32 v112, a8
    v_lshlrev_b32 v113, 16, v112
    v_and_b32 v112, 0xffff0000, v112
    v_add_f32 v144, v144, v113
    v_add_f32 v145, v145, v112
    v_accvgpr_read_b32 v112, a9
    v_lshlrev_b32 v113, 16, v112
    v_and_b32 v112, 0xffff0000, v112
    v_add_f32 v146, v146, v113
    v_add_f32 v147, v147, v112
    v_accvgpr_read_b32 v112, a10
    v_lshlrev_b32 v113, 16, v112
    v_and_b32 v112, 0xffff0000, v112
    v_add_f32 v148, v148, v113
    v_add_f32 v149, v149, v112
    v_accvgpr_read_b32 v112, a11
    v_lshlrev_b32 v113, 16, v112
    v_and_b32 v112, 0xffff0000, v112
    v_add_f32 v150, v150, v113
    v_add_f32 v151, v151, v112
    v_accvgpr_read_b32 v112, a12
    v_lshlrev_b32 v113, 16, v112
    v_and_b32 v112, 0xffff0000, v112
    v_add_f32 v152, v152, v113
    v_add_f32 v153, v153, v112
    v_accvgpr_read_b32 v112, a13
    v_lshlrev_b32 v113, 16, v112
    v_and_b32 v112, 0xffff0000, v112
    v_add_f32 v154, v154, v113
    v_add_f32 v155, v155, v112
    v_accvgpr_read_b32 v112, a14
    v_lshlrev_b32 v113, 16, v112
    v_and_b32 v112, 0xffff0000, v112
    v_add_f32 v156, v156, v113
    v_add_f32 v157, v157, v112
    v_accvgpr_read_b32 v112, a15
    v_lshlrev_b32 v113, 16, v112
    v_and_b32 v112, 0xffff0000, v112
    v_add_f32 v158, v158, v113
    v_add_f32 v159, v159, v112
    s_lshl_b32 s76, s85, 16
    s_lshl_b32 s77, s87, 13
    s_add_u32 s76, s76, s77
    s_add_u32 s76, s76, 0x800000
    s_add_u32 s77, s76, 0x1000
    buffer_store_dwordx4 v[128:131], v11, s[4:7], s76 offen offset:0 sc1
    buffer_store_dwordx4 v[132:135], v11, s[4:7], s76 offen offset:1024 sc1
    buffer_store_dwordx4 v[136:139], v11, s[4:7], s76 offen offset:2048 sc1
    buffer_store_dwordx4 v[140:143], v11, s[4:7], s76 offen offset:3072 sc1
    buffer_store_dwordx4 v[144:147], v11, s[4:7], s77 offen offset:0 sc1
    buffer_store_dwordx4 v[148:151], v11, s[4:7], s77 offen offset:1024 sc1
    buffer_store_dwordx4 v[152:155], v11, s[4:7], s77 offen offset:2048 sc1
    buffer_store_dwordx4 v[156:159], v11, s[4:7], s77 offen offset:3072 sc1
    s_lshl_b32 s80, s60, 2
    s_add_u32 s80, s80, 0x800
    s_waitcnt vmcnt(0)
    s_barrier
    buffer_store_dword v9, v3, s[4:7], s80 offen sc1
L_p4_done:
    s_and_b32 s60, s57, 31
    s_lshr_b32 s61, s57, 5
    s_lshl_b32 s62, s56, 15
    s_lshl_b32 s69, s56, 10
    s_lshl_b32 s68, s60, 7
    s_add_u32 s68, s68, 0x1000
    s_barrier
    v_lshlrev_b32 v112, 2, v121
    v_xor_b32 v112, v120, v112
    v_lshlrev_b32 v112, 4, v112
    v_lshl_add_u32 v4, v121, 10, v112
    v_lshl_add_u32 v112, v124, 2, v122
    v_lshlrev_b32 v112, 8, v112
    v_lshl_add_u32 v112, v122, 6, v112
    v_and_b32 v113, 1, v121
    v_lshl_add_u32 v112, v113, 5, v112
    v_lshl_add_u32 v112, v123, 3, v112
    v_add_u32 v12, s62, v112
    v_xor_b32 v13, 64, v12
    v_xor_b32 v14, 128, v12
    v_xor_b32 v15, 192, v12
    s_lshl_b32 s76, s60, 17
    s_lshl_b32 s77, s56, 8
    s_add_u32 s76, s76, s77
    s_add_u32 m0, s62, 0x0
    s_add_u32 s84, s76, 0x0
    buffer_load_dwordx4 v4, s[24:27], s84 offen lds
    s_add_u32 m0, s62, 0x400
    s_add_u32 s84, s76, 0x1000
    buffer_load_dwordx4 v4, s[24:27], s84 offen lds
    s_add_u32 m0, s62, 0x800
    s_add_u32 s84, s76, 0x2000
    buffer_load_dwordx4 v4, s[24:27], s84 offen lds
    s_add_u32 m0, s62, 0xc00
    s_add_u32 s84, s76, 0x3000
    buffer_load_dwordx4 v4, s[24:27], s84 offen lds
    s_add_u32 m0, s62, 0x1000
    s_add_u32 s84, s76, 0x4000
    buffer_load_dwordx4 v4, s[24:27], s84 offen lds
    s_add_u32 m0, s62, 0x1400
    s_add_u32 s84, s76, 0x5000
    buffer_load_dwordx4 v4, s[24:27], s84 offen lds
    s_add_u32 m0, s62, 0x1800
    s_add_u32 s84, s76, 0x6000
    buffer_load_dwordx4 v4, s[24:27], s84 offen lds
    s_add_u32 m0, s62, 0x1c00
    s_add_u32 s84, s76, 0x7000
    buffer_load_dwordx4 v4, s[24:27], s84 offen lds
    s_add_u32 m0, s62, 0x2000
    s_add_u32 s84, s76, 0x8000
    buffer_load_dwordx4 v4, s[24:27], s84 offen lds
    s_add_u32 m0, s62, 0x2400
    s_add_u32 s84, s76, 0x9000
    buffer_load_dwordx4 v4, s[24:27], s84 offen lds
    s_add_u32 m0, s62, 0x2800
    s_add_u32 s84, s76, 0xa000
    buffer_load_dwordx4 v4, s[24:27], s84 offen lds
    s_add_u32 m0, s62, 0x2c00
    s_add_u32 s84, s76, 0xb000
    buffer_load_dwordx4 v4, s[24:27], s84 offen lds
    s_add_u32 m0, s62, 0x3000
    s_add_u32 s84, s76, 0xc000
    buffer_load_dwordx4 v4, s[24:27], s84 offen lds
    s_add_u32 m0, s62, 0x3400
    s_add_u32 s84, s76, 0xd000
    buffer_load_dwordx4 v4, s[24:27], s84 offen lds
    s_add_u32 m0, s62, 0x3800
    s_add_u32 s84, s76, 0xe000
    buffer_load_dwordx4 v4, s[24:27], s84 offen lds
    s_add_u32 m0, s62, 0x3c00
    s_add_u32 s84, s76, 0xf000
    buffer_load_dwordx4 v4, s[24:27], s84 offen lds
    s_add_u32 m0, s62, 0x4000
    s_add_u32 s84, s76, 0x10000
    buffer_load_dwordx4 v4, s[24:27], s84 offen lds
    s_add_u32 m0, s62, 0x4400
    s_add_u32 s84, s76, 0x11000
    buffer_load_dwordx4 v4, s[24:27], s84 offen lds
    s_add_u32 m0, s62, 0x4800
    s_add_u32 s84, s76, 0x12000
    buffer_load_dwordx4 v4, s[24:27], s84 offen lds
    s_add_u32 m0, s62, 0x4c00
    s_add_u32 s84, s76, 0x13000
    buffer_load_dwordx4 v4, s[24:27], s84 offen lds
    s_add_u32 m0, s62, 0x5000
    s_add_u32 s84, s76, 0x14000
    buffer_load_dwordx4 v4, s[24:27], s84 offen lds
    s_add_u32 m0, s62, 0x5400
    s_add_u32 s84, s76, 0x15000
    buffer_load_dwordx4 v4, s[24:27], s84 offen lds
    s_add_u32 m0, s62, 0x5800
    s_add_u32 s84, s76, 0x16000
    buffer_load_dwordx4 v4, s[24:27], s84 offen lds
    s_add_u32 m0, s62, 0x5c00
    s_add_u32 s84, s76, 0x17000
    buffer_load_dwordx4 v4, s[24:27], s84 offen lds
    s_add_u32 m0, s62, 0x6000
    s_add_u32 s84, s76, 0x18000
    buffer_load_dwordx4 v4, s[24:27], s84 offen lds
    s_add_u32 m0, s62, 0x6400
    s_add_u32 s84, s76, 0x19000
    buffer_load_dwordx4 v4, s[24:27], s84 offen lds
    s_add_u32 m0, s62, 0x6800
    s_add_u32 s84, s76, 0x1a000
    buffer_load_dwordx4 v4, s[24:27], s84 offen lds
    s_add_u32 m0, s62, 0x6c00
    s_add_u32 s84, s76, 0x1b000
    buffer_load_dwordx4 v4, s[24:27], s84 offen lds
    s_add_u32 m0, s62, 0x7000
    s_add_u32 s84, s76, 0x1c000
    buffer_load_dwordx4 v4, s[24:27], s84 offen lds
    s_add_u32 m0, s62, 0x7400
    s_add_u32 s84, s76, 0x1d000
    buffer_load_dwordx4 v4, s[24:27], s84 offen lds
    s_add_u32 m0, s62, 0x7800
    s_add_u32 s84, s76, 0x1e000
    buffer_load_dwordx4 v4, s[24:27], s84 offen lds
    s_add_u32 m0, s62, 0x7c00
    s_add_u32 s84, s76, 0x1f000
    buffer_load_dwordx4 v4, s[24:27], s84 offen lds
    v_and_b32 v113, 1, v1
    v_lshlrev_b32 v113, 7, v113
    s_lshr_b32 s77, s60, 1
    s_add_u32 s77, s77, 32
    s_sub_u32 s77, s77, s60
    s_lshl_b32 s77, s77, 9
    v_and_b32 v114, 4, v1
    v_cmp_ne_u32 vcc, 0, v114
    v_mov_b32 v114, s77
    s_nop 0
    v_cndmask_b32 v114, 0, v114, vcc
    v_add_u32 v113, v113, v114
    s_lshl_b32 s77, s60, 9
    s_add_u32 s77, s77, 0x8000
    s_cmp_lg_u32 s56, 0
    s_cbranch_scc1 L_p5_p2_x
L_p5_p2:
    s_add_u32 s101, s101, 1
    s_cmp_gt_u32 s101, 0x400000
    s_cbranch_scc1 L_end
    buffer_load_dword v112, v113, s[4:7], s77 offen sc1
    s_waitcnt vmcnt(0)
    v_cmp_ne_u32 vcc, 32, v112
    s_cbranch_vccz L_p5_p2_x
    s_sleep 8
    s_branch L_p5_p2
L_p5_p2_x:
    s_barrier
    s_waitcnt vmcnt(0)
    ds_read_b64_tr_b16 a[0:1], v12 offset:0
    ds_read_b64_tr_b16 a[2:3], v12 offset:2048
    ds_read_b64_tr_b16 a[4:5], v12 offset:4096
    ds_read_b64_tr_b16 a[6:7], v12 offset:6144
    ds_read_b64_tr_b16 a[8:9], v12 offset:8192
    ds_read_b64_tr_b16 a[10:11], v12 offset:10240
    ds_read_b64_tr_b16 a[12:13], v12 offset:12288
    ds_read_b64_tr_b16 a[14:15], v12 offset:14336
    ds_read_b64_tr_b16 a[16:17], v12 offset:16384
    ds_read_b64_tr_b16 a[18:19], v12 offset:18432
    ds_read_b64_tr_b16 a[20:21], v12 offset:20480
    ds_read_b64_tr_b16 a[22:23], v12 offset:22528
    ds_read_b64_tr_b16 a[24:25], v12 offset:24576
    ds_read_b64_tr_b16 a[26:27], v12 offset:26624
    ds_read_b64_tr_b16 a[28:29], v12 offset:28672
    ds_read_b64_tr_b16 a[30:31], v12 offset:30720
    s_waitcnt lgkmcnt(0)
    ds_read_b64_tr_b16 a[32:33], v13 offset:0
    ds_read_b64_tr_b16 a[34:35], v13 offset:2048
    ds_read_b64_tr_b16 a[36:37], v13 offset:4096
    ds_read_b64_tr_b16 a[38:39], v13 offset:6144
    ds_read_b64_tr_b16 a[40:41], v13 offset:8192
    ds_read_b64_tr_b16 a[42:43], v13 offset:10240
    ds_read_b64_tr_b16 a[44:45], v13 offset:12288
    ds_read_b64_tr_b16 a[46:47], v13 offset:14336
    ds_read_b64_tr_b16 a[48:49], v13 offset:16384
    ds_read_b64_tr_b16 a[50:51], v13 offset:18432
    ds_read_b64_tr_b16 a[52:53], v13 offset:20480
    ds_read_b64_tr_b16 a[54:55], v13 offset:22528
    ds_read_b64_tr_b16 a[56:57], v13 offset:24576
    ds_read_b64_tr_b16 a[58:59], v13 offset:26624
    ds_read_b64_tr_b16 a[60:61], v13 offset:28672
    ds_read_b64_tr_b16 a[62:63], v13 offset:30720
    s_waitcnt lgkmcnt(0)
    ds_read_b64_tr_b16 a[64:65], v14 offset:0
    ds_read_b64_tr_b16 a[66:67], v14 offset:2048
    ds_read_b64_tr_b16 a[68:69], v14 offset:4096
    ds_read_b64_tr_b16 a[70:71], v14 offset:6144
    ds_read_b64_tr_b16 a[72:73], v14 offset:8192
    ds_read_b64_tr_b16 a[74:75], v14 offset:10240
    ds_read_b64_tr_b16 a[76:77], v14 offset:12288
    ds_read_b64_tr_b16 a[78:79], v14 offset:14336
    ds_read_b64_tr_b16 a[80:81], v14 offset:16384
    ds_read_b64_tr_b16 a[82:83], v14 offset:18432
    ds_read_b64_tr_b16 a[84:85], v14 offset:20480
    ds_read_b64_tr_b16 a[86:87], v14 offset:22528
    ds_read_b64_tr_b16 a[88:89], v14 offset:24576
    ds_read_b64_tr_b16 a[90:91], v14 offset:26624
    ds_read_b64_tr_b16 a[92:93], v14 offset:28672
    ds_read_b64_tr_b16 a[94:95], v14 offset:30720
    s_waitcnt lgkmcnt(0)
    ds_read_b64_tr_b16 a[96:97], v15 offset:0
    ds_read_b64_tr_b16 a[98:99], v15 offset:2048
    ds_read_b64_tr_b16 a[100:101], v15 offset:4096
    ds_read_b64_tr_b16 a[102:103], v15 offset:6144
    ds_read_b64_tr_b16 a[104:105], v15 offset:8192
    ds_read_b64_tr_b16 a[106:107], v15 offset:10240
    ds_read_b64_tr_b16 a[108:109], v15 offset:12288
    ds_read_b64_tr_b16 a[110:111], v15 offset:14336
    ds_read_b64_tr_b16 a[112:113], v15 offset:16384
    ds_read_b64_tr_b16 a[114:115], v15 offset:18432
    ds_read_b64_tr_b16 a[116:117], v15 offset:20480
    ds_read_b64_tr_b16 a[118:119], v15 offset:22528
    ds_read_b64_tr_b16 a[120:121], v15 offset:24576
    ds_read_b64_tr_b16 a[122:123], v15 offset:26624
    ds_read_b64_tr_b16 a[124:125], v15 offset:28672
    ds_read_b64_tr_b16 a[126:127], v15 offset:30720
    s_waitcnt lgkmcnt(0)
    s_barrier
    v_mov_b32 v4, v11
    v_and_b32 v112, 1, v1
    v_lshlrev_b32 v112, 8, v112
    v_bfe_u32 v113, v1, 1, 2
    v_lshl_add_u32 v112, v113, 6, v112
    v_lshl_add_u32 v112, v124, 4, v112
    v_add_u32 v5, 24576, v112
    v_lshlrev_b32 v112, 10, v124
    v_lshl_add_u32 v112, v125, 4, v112
    v_add_u32 v6, 16384, v112
    v_and_b32 v112, 1, v121
    v_lshlrev_b32 v112, 8, v112
    v_lshl_add_u32 v112, v124, 7, v112
    v_lshl_add_u32 v112, v120, 2, v112
    v_add_u32 v7, 26624, v112
    v_lshlrev_b32 v112, 18, v124
    v_lshl_add_u32 v10, v125, 4, v112
    v_lshlrev_b32 v112, 10, v121
    v_lshl_add_u32 v112, v120, 4, v112
    s_lshl_b32 s76, s56, 8
    v_add_u32 v12, s76, v112
    s_lshr_b32 s76, s60, 4
    s_lshl_b32 s76, s76, 4
    s_lshr_b32 s77, s60, 1
    s_and_b32 s77, s77, 4
    s_add_u32 s76, s76, s77
    v_and_b32 v112, 1, v122
    v_lshl_add_u32 v112, v112, 3, v123
    v_add_u32 v112, s76, v112
    s_and_b32 s78, s60, 7
    s_lshr_b32 s76, s56, 1
    s_lshl1_add_u32 s76, s78, s76
    s_lshl_b32 s76, s76, 12
    s_and_b32 s77, s56, 1
    s_lshl_b32 s77, s77, 11
    s_add_u32 s76, s76, s77
    v_lshlrev_b32 v113, 9, v121
    v_lshl_add_u32 v113, v112, 4, v113
    v_add_u32 v13, s76, v113
    s_lshl_b32 s76, s78, 7
    s_lshl_b32 s77, s56, 5
    s_add_u32 s76, s76, s77
    v_lshlrev_b32 v113, 10, v112
    v_lshl_add_u32 v113, v121, 3, v113
    v_add_u32 v113, s76, v113
    v_bfrev_b32 v114, 1
    v_cmp_lt_u32 vcc, 7, v120
    s_nop 1
    v_cndmask_b32 v14, v113, v114, vcc
    v_and_b32 v112, 7, v120
    v_lshrrev_b32 v113, 1, v112
    v_and_b32 v112, 1, v112
    v_mov_b32 v114, 0x3f80
    v_mov_b32 v115, 0x3f800000
    v_cmp_eq_u32 vcc, 1, v112
    s_nop 1
    v_cndmask_b32 v114, v114, v115, vcc
    v_cmp_eq_u32 vcc, 0, v113
    s_nop 1
    v_cndmask_b32 v16, 0, v114, vcc
    v_cmp_eq_u32 vcc, 1, v113
    s_nop 1
    v_cndmask_b32 v17, 0, v114, vcc
    v_cmp_eq_u32 vcc, 2, v113
    s_nop 1
    v_cndmask_b32 v18, 0, v114, vcc
    v_cmp_eq_u32 vcc, 3, v113
    s_nop 1
    v_cndmask_b32 v19, 0, v114, vcc
    v_lshlrev_b32 v112, 2, v124
    v_sub_u32 v112, v125, v112
    v_cmp_le_i32 s[12:13], 0, v112
    v_cmp_le_i32 s[14:15], 1, v112
    v_cmp_le_i32 s[16:17], 2, v112
    v_cmp_le_i32 s[18:19], 3, v112
    v_cmp_le_i32 s[20:21], 8, v112
    v_cmp_le_i32 s[22:23], 9, v112
    v_cmp_le_i32 s[24:25], 10, v112
    v_cmp_le_i32 s[26:27], 11, v112
    v_cmp_le_i32 s[28:29], 16, v112
    v_cmp_le_i32 s[30:31], 17, v112
    v_cmp_le_i32 s[32:33], 18, v112
    v_cmp_le_i32 s[34:35], 19, v112
    v_cmp_le_i32 s[36:37], 24, v112
    v_cmp_le_i32 s[38:39], 25, v112
    v_cmp_le_i32 s[40:41], 26, v112
    v_cmp_le_i32 s[42:43], 27, v112
    v_lshlrev_b32 v15, 6, v1
    s_lshl_b32 s76, s61, 11
    s_add_u32 s76, s76, 0x4000
    v_add_u32 v15, s76, v15
    v_mov_b32 v2, 0
    v_mov_b32 v126, 0
    v_mov_b32 v127, 0
    s_mov_b32 s63, -1
    s_lshl_b32 s65, s61, 20
    s_mov_b32 s67, 0
    s_lshl_b32 s76, s61, 18
    s_mul_i32 s77, s60, 0x2000
    s_add_u32 s64, s76, s77
    s_add_u32 s64, s64, s69
    s_add_u32 m0, s69, 0x0
    s_add_u32 s84, s64, 0x6000000
    buffer_load_dwordx4 v11, s[4:7], s84 offen lds
    s_add_u32 m0, s69, 0x1000
    s_add_u32 s84, s64, 0x6001000
    buffer_load_dwordx4 v11, s[4:7], s84 offen lds
    s_add_u32 m0, s69, 0x2000
    s_add_u32 s84, s64, 0x2000000
    buffer_load_dwordx4 v11, s[4:7], s84 offen lds
    s_add_u32 m0, s69, 0x3000
    s_add_u32 s84, s64, 0x2001000
    buffer_load_dwordx4 v11, s[4:7], s84 offen lds
    s_add_u32 m0, s69, 0x4000
    s_add_u32 s84, s64, 0x4000000
    buffer_load_dwordx4 v11, s[4:7], s84 offen lds
    s_add_u32 m0, s69, 0x5000
    s_add_u32 s84, s64, 0x4001000
    buffer_load_dwordx4 v11, s[4:7], s84 offen lds
L_p5_loop:
    s_cmp_eq_u32 s63, -1
    s_cbranch_scc1 L_p5_nored
    s_lshr_b32 s77, s63, 2
    s_lshl_b32 s77, s77, 3
    s_and_b32 s78, s60, 7
    s_add_u32 s77, s77, s78
    s_lshl_b32 s77, s77, 2
    s_add_u32 s77, s77, 0x800
    v_mov_b32 v114, s77
    v_cmp_lt_u32 vcc, 31*16, v11
    s_mov_b32 s78, 0
    s_nop 0
    v_cndmask_b32 v113, v15, v114, vcc
    v_cndmask_b32 v114, v2, v9, vcc
    s_cmp_lg_u32 s56, 0
    s_cbranch_scc1 L_p5_r1_x
L_p5_r1:
    s_add_u32 s101, s101, 1
    s_cmp_gt_u32 s101, 0x400000
    s_cbranch_scc1 L_end
    buffer_load_dword v112, v113, s[4:7], s78 offen sc1
    s_waitcnt vmcnt(0)
    v_cmp_gt_u32 vcc, v114, v112
    s_cbranch_vccz L_p5_r1_x
    s_sleep 2
    s_branch L_p5_r1
L_p5_r1_x:
    s_barrier
    s_lshl_b32 s77, s60, 15
    s_add_u32 s76, s70, s77
    s_add_u32 s76, s76, 0xa000000
    buffer_load_dwordx4 v[20:23], v12, s[4:7], s76 offen sc1
    s_add_u32 s76, s76, 0x1000
    buffer_load_dwordx4 v[24:27], v12, s[4:7], s76 offen sc1
    s_add_u32 s76, s76, 0x1000
    buffer_load_dwordx4 v[28:31], v12, s[4:7], s76 offen sc1
    s_add_u32 s76, s76, 0x1000
    buffer_load_dwordx4 v[32:35], v12, s[4:7], s76 offen sc1
    s_add_u32 s76, s76, 0x1000
    buffer_load_dwordx4 v[36:39], v12, s[4:7], s76 offen sc1
    s_add_u32 s76, s76, 0x1000
    buffer_load_dwordx4 v[40:43], v12, s[4:7], s76 offen sc1
    s_add_u32 s76, s76, 0x1000
    buffer_load_dwordx4 v[44:47], v12, s[4:7], s76 offen sc1
    s_add_u32 s76, s76, 0x1000
    buffer_load_dwordx4 v[48:51], v12, s[4:7], s76 offen sc1
    s_add_u32 s76, s76, 0x1000
    s_lshl_b32 s76, s63, 16
    s_add_u32 s76, s76, 0x800000
    buffer_load_dwordx4 v[52:55], v13, s[4:7], s76 offen sc1
    s_waitcnt vmcnt(8)
    v_mfma_f32_16x16x32_bf16 v[56:59], v[20:23], v[16:19], 0
    s_waitcnt vmcnt(7)
    v_mfma_f32_16x16x32_bf16 v[56:59], v[24:27], v[16:19], v[56:59]
    s_waitcnt vmcnt(6)
    v_mfma_f32_16x16x32_bf16 v[56:59], v[28:31], v[16:19], v[56:59]
    s_waitcnt vmcnt(5)
    v_mfma_f32_16x16x32_bf16 v[56:59], v[32:35], v[16:19], v[56:59]
    s_waitcnt vmcnt(4)
    v_mfma_f32_16x16x32_bf16 v[56:59], v[36:39], v[16:19], v[56:59]
    s_waitcnt vmcnt(3)
    v_mfma_f32_16x16x32_bf16 v[56:59], v[40:43], v[16:19], v[56:59]
    s_waitcnt vmcnt(2)
    v_mfma_f32_16x16x32_bf16 v[56:59], v[44:47], v[16:19], v[56:59]
    s_waitcnt vmcnt(1)
    v_mfma_f32_16x16x32_bf16 v[56:59], v[48:51], v[16:19], v[56:59]
    s_waitcnt vmcnt(0)
    s_nop 7
    v_add_f32 v52, v52, v56
    v_add_f32 v53, v53, v57
    v_add_f32 v54, v54, v58
    v_add_f32 v55, v55, v59
    s_lshl_b32 s76, s63, 15
    v_cvt_pk_bf16_f32 v52, v52, v53
    v_cvt_pk_bf16_f32 v53, v54, v55
    buffer_store_dwordx2 v[52:53], v14, s[44:47], s76 offen
    s_cmp_lt_u32 s61, 50
    s_cbranch_scc1 L_p5_nored
    s_cmp_gt_u32 s61, 56
    s_cbranch_scc1 L_p5_nored
    s_cmp_lg_u32 s59, 0
    s_cbranch_scc1 L_p5_nored
    v_mov_b32 v20, 0x7f817f81
    v_mov_b32 v21, 0x7f817f81
    v_mov_b32 v22, 0x7f817f81
    v_mov_b32 v23, 0x7f817f81
    s_lshl_b32 s77, s60, 15
    s_add_u32 s76, s70, s77
    s_add_u32 s76, s76, 0xa000000
    buffer_store_dwordx4 v[20:23], v12, s[4:7], s76 offen
    s_add_u32 s76, s76, 0x1000
    buffer_store_dwordx4 v[20:23], v12, s[4:7], s76 offen
    s_add_u32 s76, s76, 0x1000
    buffer_store_dwordx4 v[20:23], v12, s[4:7], s76 offen
    s_add_u32 s76, s76, 0x1000
    buffer_store_dwordx4 v[20:23], v12, s[4:7], s76 offen
    s_add_u32 s76, s76, 0x1000
    buffer_store_dwordx4 v[20:23], v12, s[4:7], s76 offen
    s_add_u32 s76, s76, 0x1000
    buffer_store_dwordx4 v[20:23], v12, s[4:7], s76 offen
    s_add_u32 s76, s76, 0x1000
    buffer_store_dwordx4 v[20:23], v12, s[4:7], s76 offen
    s_add_u32 s76, s76, 0x1000
    buffer_store_dwordx4 v[20:23], v12, s[4:7], s76 offen
    s_add_u32 s76, s76, 0x1000
L_p5_nored:
    s_waitcnt vmcnt(0)
    s_barrier
    s_cmp_ge_u32 s61, 57
    s_cbranch_scc1 L_p5_nonext
    s_xor_b32 s76, s67, 0x8000
    s_add_u32 s76, s76, s69
    s_add_u32 s77, s64, 0x1c0000
    s_add_u32 m0, s76, 0x0
    s_add_u32 s84, s77, 0x6000000
    buffer_load_dwordx4 v11, s[4:7], s84 offen lds
    s_add_u32 m0, s76, 0x1000
    s_add_u32 s84, s77, 0x6001000
    buffer_load_dwordx4 v11, s[4:7], s84 offen lds
    s_add_u32 m0, s76, 0x2000
    s_add_u32 s84, s77, 0x2000000
    buffer_load_dwordx4 v11, s[4:7], s84 offen lds
    s_add_u32 m0, s76, 0x3000
    s_add_u32 s84, s77, 0x2001000
    buffer_load_dwordx4 v11, s[4:7], s84 offen lds
    s_add_u32 m0, s76, 0x4000
    s_add_u32 s84, s77, 0x4000000
    buffer_load_dwordx4 v11, s[4:7], s84 offen lds
    s_add_u32 m0, s76, 0x5000
    s_add_u32 s84, s77, 0x4001000
    buffer_load_dwordx4 v11, s[4:7], s84 offen lds
L_p5_nonext:
    ds_read_b128 v[20:23], v4 offset:0
    ds_read_b128 v[52:55], v4 offset:8192
    ds_read_b128 v[24:27], v4 offset:1024
    ds_read_b128 v[56:59], v4 offset:9216
    ds_read_b128 v[28:31], v4 offset:2048
    ds_read_b128 v[60:63], v4 offset:10240
    ds_read_b128 v[32:35], v4 offset:3072
    ds_read_b128 v[64:67], v4 offset:11264
    ds_read_b128 v[36:39], v4 offset:4096
    ds_read_b128 v[68:71], v4 offset:12288
    ds_read_b128 v[40:43], v4 offset:5120
    ds_read_b128 v[72:75], v4 offset:13312
    ds_read_b128 v[44:47], v4 offset:6144
    ds_read_b128 v[76:79], v4 offset:14336
    ds_read_b128 v[48:51], v4 offset:7168
    ds_read_b128 v[80:83], v4 offset:15360
    s_waitcnt lgkmcnt(14)
    v_mfma_f32_32x32x16_bf16 v[84:99], v[52:55], v[20:23], 0
    s_waitcnt lgkmcnt(12)
    v_mfma_f32_32x32x16_bf16 v[84:99], v[56:59], v[24:27], v[84:99]
    s_waitcnt lgkmcnt(10)
    v_mfma_f32_32x32x16_bf16 v[84:99], v[60:63], v[28:31], v[84:99]
    s_waitcnt lgkmcnt(8)
    v_mfma_f32_32x32x16_bf16 v[84:99], v[64:67], v[32:35], v[84:99]
    s_waitcnt lgkmcnt(6)
    v_mfma_f32_32x32x16_bf16 v[84:99], v[68:71], v[36:39], v[84:99]
    s_waitcnt lgkmcnt(4)
    v_mfma_f32_32x32x16_bf16 v[84:99], v[72:75], v[40:43], v[84:99]
    s_waitcnt lgkmcnt(2)
    v_mfma_f32_32x32x16_bf16 v[84:99], v[76:79], v[44:47], v[84:99]
    s_waitcnt lgkmcnt(0)
    v_mfma_f32_32x32x16_bf16 v[84:99], v[80:83], v[48:51], v[84:99]
    ds_read_b128 v[52:55], v6 offset:0
    ds_read_b128 v[56:59], v6 offset:512
    ds_read_b128 v[60:63], v6 offset:2048
    ds_read_b128 v[64:67], v6 offset:2560
    ds_read_b128 v[68:71], v6 offset:4096
    ds_read_b128 v[72:75], v6 offset:4608
    ds_read_b128 v[76:79], v6 offset:6144
    ds_read_b128 v[80:83], v6 offset:6656
    v_mov_b32 v241, 0xd028965f
    s_mov_b32 s71, 0x3e0293ee
    s_nop 2
    v_cndmask_b32 v84, v241, v84, s[12:13]
    v_cndmask_b32 v85, v241, v85, s[14:15]
    v_cndmask_b32 v86, v241, v86, s[16:17]
    v_cndmask_b32 v87, v241, v87, s[18:19]
    v_cndmask_b32 v88, v241, v88, s[20:21]
    v_cndmask_b32 v89, v241, v89, s[22:23]
    v_cndmask_b32 v90, v241, v90, s[24:25]
    v_cndmask_b32 v91, v241, v91, s[26:27]
    v_cndmask_b32 v92, v241, v92, s[28:29]
    v_cndmask_b32 v93, v241, v93, s[30:31]
    v_cndmask_b32 v94, v241, v94, s[32:33]
    v_cndmask_b32 v95, v241, v95, s[34:35]
    v_cndmask_b32 v96, v241, v96, s[36:37]
    v_cndmask_b32 v97, v241, v97, s[38:39]
    v_cndmask_b32 v98, v241, v98, s[40:41]
    v_cndmask_b32 v99, v241, v99, s[42:43]
    v_max3_f32 v240, v84, v85, v86
    v_max3_f32 v240, v240, v87, v88
    v_max3_f32 v240, v240, v89, v90
    v_max3_f32 v240, v240, v91, v92
    v_max3_f32 v240, v240, v93, v94
    v_max3_f32 v240, v240, v95, v96
    v_max3_f32 v240, v240, v97, v98
    v_max_f32 v240, v240, v99
    v_mov_b32 v241, v240
    s_nop 1
    v_permlane32_swap_b32 v240, v241
    v_max_f32 v240, v240, v241
    v_mul_f32 v240, s71, v240
    v_fma_f32 v84, v84, s71, -v240
    v_fma_f32 v85, v85, s71, -v240
    v_fma_f32 v86, v86, s71, -v240
    v_fma_f32 v87, v87, s71, -v240
    v_fma_f32 v88, v88, s71, -v240
    v_fma_f32 v89, v89, s71, -v240
    v_fma_f32 v90, v90, s71, -v240
    v_fma_f32 v91, v91, s71, -v240
    v_fma_f32 v92, v92, s71, -v240
    v_fma_f32 v93, v93, s71, -v240
    v_fma_f32 v94, v94, s71, -v240
    v_fma_f32 v95, v95, s71, -v240
    v_fma_f32 v96, v96, s71, -v240
    v_fma_f32 v97, v97, s71, -v240
    v_fma_f32 v98, v98, s71, -v240
    v_fma_f32 v99, v99, s71, -v240
    v_exp_f32 v84, v84
    v_exp_f32 v85, v85
    v_exp_f32 v86, v86
    v_exp_f32 v87, v87
    v_exp_f32 v88, v88
    v_exp_f32 v89, v89
    v_exp_f32 v90, v90
    v_exp_f32 v91, v91
    v_exp_f32 v92, v92
    v_exp_f32 v93, v93
    v_exp_f32 v94, v94
    v_exp_f32 v95, v95
    v_exp_f32 v96, v96
    v_exp_f32 v97, v97
    v_exp_f32 v98, v98
    v_exp_f32 v99, v99
    v_add_f32 v242, v84, v85
    v_add_f32 v241, v86, v87
    v_add_f32 v242, v242, v88
    v_add_f32 v241, v241, v89
    v_add_f32 v242, v242, v90
    v_add_f32 v241, v241, v91
    v_add_f32 v242, v242, v92
    v_add_f32 v241, v241, v93
    v_add_f32 v242, v242, v94
    v_add_f32 v241, v241, v95
    v_add_f32 v242, v242, v96
    v_add_f32 v241, v241, v97
    v_add_f32 v242, v242, v98
    v_add_f32 v241, v241, v99
    v_add_f32 v242, v242, v241
    v_cvt_pk_bf16_f32 v116, v84, v85
    v_cvt_pk_bf16_f32 v117, v86, v87
    v_cvt_pk_bf16_f32 v118, v88, v89
    v_cvt_pk_bf16_f32 v119, v90, v91
    v_cvt_pk_bf16_f32 v120, v92, v93
    v_cvt_pk_bf16_f32 v121, v94, v95
    v_cvt_pk_bf16_f32 v122, v96, v97
    v_cvt_pk_bf16_f32 v123, v98, v99
    s_waitcnt lgkmcnt(0)
    s_nop 0
    v_mfma_f32_32x32x16_bf16 v[144:159], v[52:55], v[116:119], 0
    v_mfma_f32_32x32x16_bf16 v[144:159], v[56:59], v[120:123], v[144:159]
    v_mfma_f32_32x32x16_bf16 v[160:175], v[60:63], v[116:119], 0
    v_mfma_f32_32x32x16_bf16 v[160:175], v[64:67], v[120:123], v[160:175]
    v_mfma_f32_32x32x16_bf16 v[176:191], v[68:71], v[116:119], 0
    v_mfma_f32_32x32x16_bf16 v[176:191], v[72:75], v[120:123], v[176:191]
    v_mfma_f32_32x32x16_bf16 v[192:207], v[76:79], v[116:119], 0
    v_mfma_f32_32x32x16_bf16 v[192:207], v[80:83], v[120:123], v[192:207]
    v_mov_b32 v86, 0
    v_mov_b32 v87, 0
    v_mov_b32 v90, 0
    v_mov_b32 v91, 0
    v_mov_b32 v94, 0
    v_mov_b32 v95, 0
    v_mov_b32 v98, 0
    v_mov_b32 v99, 0
    s_cmp_lt_u32 s61, 57
    s_cbranch_scc1 L_p5_nobase
    s_lshr_b32 s77, s61, 2
    s_lshl_b32 s77, s77, 3
    s_and_b32 s78, s60, 7
    s_add_u32 s77, s77, s78
    s_lshl_b32 s77, s77, 2
    s_add_u32 s77, s77, 0x800
    v_mov_b32 v114, s77
    v_cmp_lt_u32 vcc, 31*16, v11
    s_mov_b32 s78, 0
    s_nop 0
    v_cndmask_b32 v113, v15, v114, vcc
    v_cndmask_b32 v114, v2, v9, vcc
    v_readlane_b32 s79, v113, 32
L_p5_bf:
    s_add_u32 s101, s101, 1
    s_cmp_gt_u32 s101, 0x400000
    s_cbranch_scc1 L_end
    buffer_load_dword v112, v8, s[4:7], s79 offen sc1
    s_waitcnt vmcnt(0)
    v_cmp_ne_u32 vcc, 1, v112
    s_cbranch_vccnz L_p5_bf
    s_lshl_b32 s76, s61, 16
    s_add_u32 s76, s76, 0x800000
    buffer_load_dwordx4 v[248:251], v13, s[4:7], s76 offen sc1
L_p5_nobase:
    s_cmp_gt_u32 s61, 61
    s_cselect_b32 s80, 60, s61
    s_cmp_lg_u32 s56, 0
    s_cbranch_scc1 L_p5_pgx
L_p5_pg:
    s_add_u32 s101, s101, 1
    s_cmp_gt_u32 s101, 0x400000
    s_cbranch_scc1 L_end
    v_mov_b32 v112, 0
    buffer_atomic_or v112, v3, s[4:7], s68 offen sc0
    s_waitcnt vmcnt(0)
    v_readfirstlane_b32 s76, v112
    s_cmp_gt_u32 s76, s80
    s_cbranch_scc1 L_p5_pgx
    s_sub_u32 s76, s80, s76
    s_cmp_eq_u32 s76, 0
    s_cbranch_scc1 L_p5_near
L_p5_far:
    s_sleep 40
    s_sub_u32 s76, s76, 1
    s_cmp_lg_u32 s76, 0
    s_cbranch_scc1 L_p5_far
L_p5_near:
    s_sleep 4
    s_branch L_p5_pg
L_p5_pgx:
    s_barrier
    s_add_u32 s76, s67, s69
    s_add_u32 s84, s64, 0x8000000
    s_cmp_gt_u32 s61, 61
    s_cbranch_scc1 L_p5_watch
    s_add_u32 m0, s76, 24576
    s_nop 0
    buffer_load_dwordx4 v11, s[4:7], s84 offen sc1 lds
    s_waitcnt vmcnt(0)
L_p5_kvm:
    s_barrier
    ds_read_b128 v[52:55], v5 offset:0
    ds_read_b128 v[56:59], v5 offset:32
    ds_read_b128 v[60:63], v5 offset:512
    ds_read_b128 v[64:67], v5 offset:544
    ds_read_b128 v[68:71], v5 offset:1024
    ds_read_b128 v[72:75], v5 offset:1056
    ds_read_b128 v[76:79], v5 offset:1536
    ds_read_b128 v[80:83], v5 offset:1568
    v_add_u32 v241, 1024, v7
    ds_read2_b32 v[84:85], v7 offset0:0 offset1:16
    ds_read2_b32 v[88:89], v7 offset0:128 offset1:144
    ds_read2_b32 v[92:93], v241 offset0:0 offset1:16
    ds_read2_b32 v[96:97], v241 offset0:128 offset1:144
    s_waitcnt lgkmcnt(11)
    v_mfma_f32_32x32x16_bf16 v[100:115], v[52:55], v[20:23], 0
    s_waitcnt lgkmcnt(10)
    v_mfma_f32_32x32x16_bf16 v[100:115], v[56:59], v[24:27], v[100:115]
    s_waitcnt lgkmcnt(9)
    v_mfma_f32_32x32x16_bf16 v[100:115], v[60:63], v[28:31], v[100:115]
    s_waitcnt lgkmcnt(8)
    v_mfma_f32_32x32x16_bf16 v[100:115], v[64:67], v[32:35], v[100:115]
    s_waitcnt lgkmcnt(7)
    v_mfma_f32_32x32x16_bf16 v[100:115], v[68:71], v[36:39], v[100:115]
    s_waitcnt lgkmcnt(6)
    v_mfma_f32_32x32x16_bf16 v[100:115], v[72:75], v[40:43], v[100:115]
    s_waitcnt lgkmcnt(5)
    v_mfma_f32_32x32x16_bf16 v[100:115], v[76:79], v[44:47], v[100:115]
    s_waitcnt lgkmcnt(4)
    v_mfma_f32_32x32x16_bf16 v[100:115], v[80:83], v[48:51], v[100:115]
    s_nop 11
    v_max3_f32 v243, v100, v101, v102
    v_max_f32 v243, v243, v103
    v_mov_b32 v241, v243
    s_nop 1
    v_permlane32_swap_b32 v243, v241
    v_max_f32 v243, v243, v241
    v_mul_f32 v243, s71, v243
    v_max_f32 v243, v243, v240
    v_sub_f32 v244, v240, v243
    v_fma_f32 v100, v100, s71, -v243
    v_fma_f32 v101, v101, s71, -v243
    v_fma_f32 v102, v102, s71, -v243
    v_fma_f32 v103, v103, s71, -v243
    v_exp_f32 v244, v244
    v_exp_f32 v100, v100
    v_exp_f32 v101, v101
    v_exp_f32 v102, v102
    v_exp_f32 v103, v103
    v_mul_f32 v242, v242, v244
    v_add_f32 v241, v100, v101
    v_add_f32 v242, v242, v102
    v_add_f32 v241, v241, v103
    v_add_f32 v242, v242, v241
    v_mov_b32 v241, v242
    s_nop 1
    v_permlane32_swap_b32 v242, v241
    v_add_f32 v242, v242, v241
    v_rcp_f32 v246, v242
    s_nop 0
    v_mul_f32 v244, v244, v246
    v_mul_f32 v100, v100, v246
    v_mul_f32 v101, v101, v246
    v_mul_f32 v102, v102, v246
    v_mul_f32 v103, v103, v246
    v_mov_b32 v245, v244
    v_cvt_pk_bf16_f32 v124, v100, v101
    v_cvt_pk_bf16_f32 v125, v102, v103
    v_pk_mul_f32 v[144:145], v[144:145], v[244:245]
    v_pk_mul_f32 v[146:147], v[146:147], v[244:245]
    v_pk_mul_f32 v[148:149], v[148:149], v[244:245]
    v_pk_mul_f32 v[150:151], v[150:151], v[244:245]
    v_pk_mul_f32 v[152:153], v[152:153], v[244:245]
    v_pk_mul_f32 v[154:155], v[154:155], v[244:245]
    v_pk_mul_f32 v[156:157], v[156:157], v[244:245]
    v_pk_mul_f32 v[158:159], v[158:159], v[244:245]
    v_pk_mul_f32 v[160:161], v[160:161], v[244:245]
    v_pk_mul_f32 v[162:163], v[162:163], v[244:245]
    v_pk_mul_f32 v[164:165], v[164:165], v[244:245]
    v_pk_mul_f32 v[166:167], v[166:167], v[244:245]
    v_pk_mul_f32 v[168:169], v[168:169], v[244:245]
    v_pk_mul_f32 v[170:171], v[170:171], v[244:245]
    v_pk_mul_f32 v[172:173], v[172:173], v[244:245]
    v_pk_mul_f32 v[174:175], v[174:175], v[244:245]
    v_pk_mul_f32 v[176:177], v[176:177], v[244:245]
    v_pk_mul_f32 v[178:179], v[178:179], v[244:245]
    v_pk_mul_f32 v[180:181], v[180:181], v[244:245]
    v_pk_mul_f32 v[182:183], v[182:183], v[244:245]
    v_pk_mul_f32 v[184:185], v[184:185], v[244:245]
    v_pk_mul_f32 v[186:187], v[186:187], v[244:245]
    v_pk_mul_f32 v[188:189], v[188:189], v[244:245]
    v_pk_mul_f32 v[190:191], v[190:191], v[244:245]
    v_pk_mul_f32 v[192:193], v[192:193], v[244:245]
    v_pk_mul_f32 v[194:195], v[194:195], v[244:245]
    v_pk_mul_f32 v[196:197], v[196:197], v[244:245]
    v_pk_mul_f32 v[198:199], v[198:199], v[244:245]
    v_pk_mul_f32 v[200:201], v[200:201], v[244:245]
    v_pk_mul_f32 v[202:203], v[202:203], v[244:245]
    v_pk_mul_f32 v[204:205], v[204:205], v[244:245]
    v_pk_mul_f32 v[206:207], v[206:207], v[244:245]
    s_waitcnt lgkmcnt(0)
    s_nop 0
    v_mfma_f32_32x32x16_bf16 v[144:159], v[84:87], v[124:127], v[144:159]
    v_mfma_f32_32x32x16_bf16 v[160:175], v[88:91], v[124:127], v[160:175]
    v_mfma_f32_32x32x16_bf16 v[176:191], v[92:95], v[124:127], v[176:191]
    v_mfma_f32_32x32x16_bf16 v[192:207], v[96:99], v[124:127], v[192:207]
    s_lshl_b32 s76, s60, 10
    s_add_u32 s66, s65, s76
    s_lshl_b32 s76, s56, 16
    s_add_u32 s66, s66, s76
    s_add_u32 s66, s66, 0xa000000
    v_cvt_pk_bf16_f32 v208, v144, v145
    v_cvt_pk_bf16_f32 v209, v146, v147
    v_cvt_pk_bf16_f32 v210, v148, v149
    v_cvt_pk_bf16_f32 v211, v150, v151
    v_cvt_pk_bf16_f32 v212, v152, v153
    v_cvt_pk_bf16_f32 v213, v154, v155
    v_cvt_pk_bf16_f32 v214, v156, v157
    v_cvt_pk_bf16_f32 v215, v158, v159
    v_cvt_pk_bf16_f32 v216, v160, v161
    v_cvt_pk_bf16_f32 v217, v162, v163
    v_cvt_pk_bf16_f32 v218, v164, v165
    v_cvt_pk_bf16_f32 v219, v166, v167
    v_cvt_pk_bf16_f32 v220, v168, v169
    v_cvt_pk_bf16_f32 v221, v170, v171
    v_cvt_pk_bf16_f32 v222, v172, v173
    v_cvt_pk_bf16_f32 v223, v174, v175
    v_cvt_pk_bf16_f32 v224, v176, v177
    v_cvt_pk_bf16_f32 v225, v178, v179
    v_cvt_pk_bf16_f32 v226, v180, v181
    v_cvt_pk_bf16_f32 v227, v182, v183
    v_cvt_pk_bf16_f32 v228, v184, v185
    v_cvt_pk_bf16_f32 v229, v186, v187
    v_cvt_pk_bf16_f32 v230, v188, v189
    v_cvt_pk_bf16_f32 v231, v190, v191
    v_cvt_pk_bf16_f32 v232, v192, v193
    v_cvt_pk_bf16_f32 v233, v194, v195
    v_cvt_pk_bf16_f32 v234, v196, v197
    v_cvt_pk_bf16_f32 v235, v198, v199
    v_cvt_pk_bf16_f32 v236, v200, v201
    v_cvt_pk_bf16_f32 v237, v202, v203
    v_cvt_pk_bf16_f32 v238, v204, v205
    v_cvt_pk_bf16_f32 v239, v206, v207
    s_nop 0
    v_mfma_f32_32x32x16_bf16 v[144:159], v[208:211], a[0:3], 0
    v_mfma_f32_32x32x16_bf16 v[144:159], v[212:215], a[4:7], v[144:159]
    v_mfma_f32_32x32x16_bf16 v[144:159], v[216:219], a[8:11], v[144:159]
    v_mfma_f32_32x32x16_bf16 v[144:159], v[220:223], a[12:15], v[144:159]
    v_mfma_f32_32x32x16_bf16 v[144:159], v[224:227], a[16:19], v[144:159]
    v_mfma_f32_32x32x16_bf16 v[144:159], v[228:231], a[20:23], v[144:159]
    v_mfma_f32_32x32x16_bf16 v[144:159], v[232:235], a[24:27], v[144:159]
    v_mfma_f32_32x32x16_bf16 v[144:159], v[236:239], a[28:31], v[144:159]
    v_mfma_f32_32x32x16_bf16 v[160:175], v[208:211], a[32:35], 0
    v_mfma_f32_32x32x16_bf16 v[160:175], v[212:215], a[36:39], v[160:175]
    v_mfma_f32_32x32x16_bf16 v[160:175], v[216:219], a[40:43], v[160:175]
    v_cvt_pk_bf16_f32 v84, v144, v145
    v_cvt_pk_bf16_f32 v85, v146, v147
    v_mfma_f32_32x32x16_bf16 v[160:175], v[220:223], a[44:47], v[160:175]
    v_cvt_pk_bf16_f32 v86, v148, v149
    v_cvt_pk_bf16_f32 v87, v150, v151
    v_mfma_f32_32x32x16_bf16 v[160:175], v[224:227], a[48:51], v[160:175]
    s_add_u32 s84, s66, 0x0
    buffer_store_dwordx4 v[84:87], v10, s[4:7], s84 offen offset:0
    v_cvt_pk_bf16_f32 v88, v152, v153
    v_mfma_f32_32x32x16_bf16 v[160:175], v[228:231], a[52:55], v[160:175]
    v_cvt_pk_bf16_f32 v89, v154, v155
    v_cvt_pk_bf16_f32 v90, v156, v157
    v_mfma_f32_32x32x16_bf16 v[160:175], v[232:235], a[56:59], v[160:175]
    v_cvt_pk_bf16_f32 v91, v158, v159
    s_add_u32 s84, s66, 0x80000
    buffer_store_dwordx4 v[88:91], v10, s[4:7], s84 offen offset:0
    v_mfma_f32_32x32x16_bf16 v[160:175], v[236:239], a[60:63], v[160:175]
    v_mfma_f32_32x32x16_bf16 v[176:191], v[208:211], a[64:67], 0
    v_mfma_f32_32x32x16_bf16 v[176:191], v[212:215], a[68:71], v[176:191]
    v_mfma_f32_32x32x16_bf16 v[176:191], v[216:219], a[72:75], v[176:191]
    v_cvt_pk_bf16_f32 v92, v160, v161
    v_cvt_pk_bf16_f32 v93, v162, v163
    v_mfma_f32_32x32x16_bf16 v[176:191], v[220:223], a[76:79], v[176:191]
    v_cvt_pk_bf16_f32 v94, v164, v165
    v_cvt_pk_bf16_f32 v95, v166, v167
    v_mfma_f32_32x32x16_bf16 v[176:191], v[224:227], a[80:83], v[176:191]
    s_add_u32 s84, s66, 0x0
    buffer_store_dwordx4 v[92:95], v10, s[4:7], s84 offen offset:512
    v_cvt_pk_bf16_f32 v96, v168, v169
    v_mfma_f32_32x32x16_bf16 v[176:191], v[228:231], a[84:87], v[176:191]
    v_cvt_pk_bf16_f32 v97, v170, v171
    v_cvt_pk_bf16_f32 v98, v172, v173
    v_mfma_f32_32x32x16_bf16 v[176:191], v[232:235], a[88:91], v[176:191]
    v_cvt_pk_bf16_f32 v99, v174, v175
    s_add_u32 s84, s66, 0x80000
    buffer_store_dwordx4 v[96:99], v10, s[4:7], s84 offen offset:512
    v_mfma_f32_32x32x16_bf16 v[176:191], v[236:239], a[92:95], v[176:191]
    v_mfma_f32_32x32x16_bf16 v[192:207], v[208:211], a[96:99], 0
    v_mfma_f32_32x32x16_bf16 v[192:207], v[212:215], a[100:103], v[192:207]
    v_mfma_f32_32x32x16_bf16 v[192:207], v[216:219], a[104:107], v[192:207]
    v_cvt_pk_bf16_f32 v84, v176, v177
    v_cvt_pk_bf16_f32 v85, v178, v179
    v_mfma_f32_32x32x16_bf16 v[192:207], v[220:223], a[108:111], v[192:207]
    v_cvt_pk_bf16_f32 v86, v180, v181
    v_cvt_pk_bf16_f32 v87, v182, v183
    v_mfma_f32_32x32x16_bf16 v[192:207], v[224:227], a[112:115], v[192:207]
    s_add_u32 s84, s66, 0x8000
    buffer_store_dwordx4 v[84:87], v10, s[4:7], s84 offen offset:0
    v_cvt_pk_bf16_f32 v88, v184, v185
    v_mfma_f32_32x32x16_bf16 v[192:207], v[228:231], a[116:119], v[192:207]
    v_cvt_pk_bf16_f32 v89, v186, v187
    v_cvt_pk_bf16_f32 v90, v188, v189
    v_mfma_f32_32x32x16_bf16 v[192:207], v[232:235], a[120:123], v[192:207]
    v_cvt_pk_bf16_f32 v91, v190, v191
    s_add_u32 s84, s66, 0x88000
    buffer_store_dwordx4 v[88:91], v10, s[4:7], s84 offen offset:0
    v_mfma_f32_32x32x16_bf16 v[192:207], v[236:239], a[124:127], v[192:207]
    s_nop 11
    v_cvt_pk_bf16_f32 v92, v192, v193
    v_cvt_pk_bf16_f32 v93, v194, v195
    v_cvt_pk_bf16_f32 v94, v196, v197
    v_cvt_pk_bf16_f32 v95, v198, v199
    s_add_u32 s84, s66, 0x8000
    buffer_store_dwordx4 v[92:95], v10, s[4:7], s84 offen offset:512
    v_cvt_pk_bf16_f32 v96, v200, v201
    v_cvt_pk_bf16_f32 v97, v202, v203
    v_cvt_pk_bf16_f32 v98, v204, v205
    v_cvt_pk_bf16_f32 v99, v206, v207
    s_add_u32 s84, s66, 0x88000
    buffer_store_dwordx4 v[96:99], v10, s[4:7], s84 offen offset:512
    v_add_u32 v2, 1, v2
    s_cmp_lt_u32 s61, 57
    s_cbranch_scc1 L_p5_pub
    s_cmp_eq_u32 s59, 0
    s_cbranch_scc1 L_p5_final
L_p5_pub:
    s_lshl_b32 s76, s57, 6
    s_add_u32 s76, s76, 0x4000
    s_xor_b32 s67, s67, 0x8000
    v_xor_b32 v4, 0x8000, v4
    v_xor_b32 v5, 0x8000, v5
    v_xor_b32 v6, 0x8000, v6
    v_xor_b32 v7, 0x8000, v7
    s_waitcnt vmcnt(0)
    s_barrier
    s_mov_b32 s70, s65
    s_cmp_lg_u32 s59, 0
    s_cbranch_scc1 L_p5_slowpub
    buffer_store_dword v2, v3, s[4:7], s76 offen
    s_xor_b32 s65, s65, 0x800000
L_p5_pubd:
    s_mov_b32 s63, s61
    s_add_u32 s61, s61, 7
    s_add_u32 s64, s64, 0x1c0000
    s_cmp_lt_u32 s61, 64
    s_cbranch_scc1 L_p5_loop
    s_lshr_b32 s77, s63, 2
    s_lshl_b32 s77, s77, 3
    s_and_b32 s78, s60, 7
    s_add_u32 s77, s77, s78
    s_lshl_b32 s77, s77, 2
    s_add_u32 s77, s77, 0x800
    v_mov_b32 v114, s77
    v_cmp_lt_u32 vcc, 31*16, v11
    s_mov_b32 s78, 0
    s_nop 0
    v_cndmask_b32 v113, v15, v114, vcc
    v_cndmask_b32 v114, v2, v9, vcc
    s_cmp_lg_u32 s56, 0
    s_cbranch_scc1 L_p5_r2_x
L_p5_r2:
    s_add_u32 s101, s101, 1
    s_cmp_gt_u32 s101, 0x400000
    s_cbranch_scc1 L_end
    buffer_load_dword v112, v113, s[4:7], s78 offen sc1
    s_waitcnt vmcnt(0)
    v_cmp_gt_u32 vcc, v114, v112
    s_cbranch_vccz L_p5_r2_x
    s_sleep 2
    s_branch L_p5_r2
L_p5_r2_x:
    s_barrier
    s_lshl_b32 s77, s60, 15
    s_add_u32 s76, s70, s77
    s_add_u32 s76, s76, 0xa000000
    buffer_load_dwordx4 v[20:23], v12, s[4:7], s76 offen sc1
    s_add_u32 s76, s76, 0x1000
    buffer_load_dwordx4 v[24:27], v12, s[4:7], s76 offen sc1
    s_add_u32 s76, s76, 0x1000
    buffer_load_dwordx4 v[28:31], v12, s[4:7], s76 offen sc1
    s_add_u32 s76, s76, 0x1000
    buffer_load_dwordx4 v[32:35], v12, s[4:7], s76 offen sc1
    s_add_u32 s76, s76, 0x1000
    buffer_load_dwordx4 v[36:39], v12, s[4:7], s76 offen sc1
    s_add_u32 s76, s76, 0x1000
    buffer_load_dwordx4 v[40:43], v12, s[4:7], s76 offen sc1
    s_add_u32 s76, s76, 0x1000
    buffer_load_dwordx4 v[44:47], v12, s[4:7], s76 offen sc1
    s_add_u32 s76, s76, 0x1000
    buffer_load_dwordx4 v[48:51], v12, s[4:7], s76 offen sc1
    s_add_u32 s76, s76, 0x1000
    s_lshl_b32 s76, s63, 16
    s_add_u32 s76, s76, 0x800000
    buffer_load_dwordx4 v[52:55], v13, s[4:7], s76 offen sc1
    s_waitcnt vmcnt(8)
    v_mfma_f32_16x16x32_bf16 v[56:59], v[20:23], v[16:19], 0
    s_waitcnt vmcnt(7)
    v_mfma_f32_16x16x32_bf16 v[56:59], v[24:27], v[16:19], v[56:59]
    s_waitcnt vmcnt(6)
    v_mfma_f32_16x16x32_bf16 v[56:59], v[28:31], v[16:19], v[56:59]
    s_waitcnt vmcnt(5)
    v_mfma_f32_16x16x32_bf16 v[56:59], v[32:35], v[16:19], v[56:59]
    s_waitcnt vmcnt(4)
    v_mfma_f32_16x16x32_bf16 v[56:59], v[36:39], v[16:19], v[56:59]
    s_waitcnt vmcnt(3)
    v_mfma_f32_16x16x32_bf16 v[56:59], v[40:43], v[16:19], v[56:59]
    s_waitcnt vmcnt(2)
    v_mfma_f32_16x16x32_bf16 v[56:59], v[44:47], v[16:19], v[56:59]
    s_waitcnt vmcnt(1)
    v_mfma_f32_16x16x32_bf16 v[56:59], v[48:51], v[16:19], v[56:59]
    s_waitcnt vmcnt(0)
    s_nop 7
    v_add_f32 v52, v52, v56
    v_add_f32 v53, v53, v57
    v_add_f32 v54, v54, v58
    v_add_f32 v55, v55, v59
    s_lshl_b32 s76, s63, 15
    v_cvt_pk_bf16_f32 v52, v52, v53
    v_cvt_pk_bf16_f32 v53, v54, v55
    buffer_store_dwordx2 v[52:53], v14, s[44:47], s76 offen
    s_waitcnt vmcnt(0)
    s_branch L_p5_done
L_p5_slowpub:
    buffer_wbl2 sc1
    s_waitcnt vmcnt(0)
    s_barrier
    buffer_store_dword v2, v3, s[4:7], s76 offen sc1
    s_add_u32 s65, s65, 0x700000
    s_branch L_p5_pubd
L_p5_watch:
    v_add_u32 v241, s76, v11
    s_mov_b32 s77, 0x7f817f81
L_p5_watch_l:
    s_add_u32 s101, s101, 1
    s_cmp_gt_u32 s101, 0x400000
    s_cbranch_scc1 L_end
    buffer_load_dwordx4 v[100:103], v11, s[4:7], s84 offen sc1
    s_waitcnt vmcnt(0)
    v_cmp_eq_u32 vcc, s77, v100
    v_cmp_eq_u32 s[78:79], s77, v101
    v_cmp_eq_u32 s[80:81], s77, v102
    v_cmp_eq_u32 s[82:83], s77, v103
    s_or_b64 vcc, vcc, s[78:79]
    s_or_b64 vcc, vcc, s[80:81]
    s_or_b64 vcc, vcc, s[82:83]
    s_cbranch_scc1 L_p5_watch_l
    ds_write_b128 v241, v[100:103] offset:24576
    s_waitcnt lgkmcnt(0)
    s_branch L_p5_kvm
L_p5_final:
    s_add_u32 s101, s101, 1
    s_cmp_gt_u32 s101, 0x400000
    s_cbranch_scc1 L_end
    s_lshl_b32 s77, s60, 15
    s_add_u32 s76, s65, s77
    s_add_u32 s76, s76, 0xa000000
    buffer_load_dwordx4 v[20:23], v12, s[4:7], s76 offen sc1
    s_add_u32 s76, s76, 0x1000
    buffer_load_dwordx4 v[24:27], v12, s[4:7], s76 offen sc1
    s_add_u32 s76, s76, 0x1000
    buffer_load_dwordx4 v[28:31], v12, s[4:7], s76 offen sc1
    s_add_u32 s76, s76, 0x1000
    buffer_load_dwordx4 v[32:35], v12, s[4:7], s76 offen sc1
    s_add_u32 s76, s76, 0x1000
    buffer_load_dwordx4 v[36:39], v12, s[4:7], s76 offen sc1
    s_add_u32 s76, s76, 0x1000
    buffer_load_dwordx4 v[40:43], v12, s[4:7], s76 offen sc1
    s_add_u32 s76, s76, 0x1000
    buffer_load_dwordx4 v[44:47], v12, s[4:7], s76 offen sc1
    s_add_u32 s76, s76, 0x1000
    buffer_load_dwordx4 v[48:51], v12, s[4:7], s76 offen sc1
    s_add_u32 s76, s76, 0x1000
    s_waitcnt vmcnt(7)
    v_mfma_f32_16x16x32_bf16 v[56:59], v[20:23], v[16:19], 0
    s_waitcnt vmcnt(6)
    v_mfma_f32_16x16x32_bf16 v[56:59], v[24:27], v[16:19], v[56:59]
    s_waitcnt vmcnt(5)
    v_mfma_f32_16x16x32_bf16 v[56:59], v[28:31], v[16:19], v[56:59]
    s_waitcnt vmcnt(4)
    v_mfma_f32_16x16x32_bf16 v[56:59], v[32:35], v[16:19], v[56:59]
    s_waitcnt vmcnt(3)
    v_mfma_f32_16x16x32_bf16 v[56:59], v[36:39], v[16:19], v[56:59]
    s_waitcnt vmcnt(2)
    v_mfma_f32_16x16x32_bf16 v[56:59], v[40:43], v[16:19], v[56:59]
    s_waitcnt vmcnt(1)
    v_mfma_f32_16x16x32_bf16 v[56:59], v[44:47], v[16:19], v[56:59]
    s_waitcnt vmcnt(0)
    v_mfma_f32_16x16x32_bf16 v[56:59], v[48:51], v[16:19], v[56:59]
    s_nop 7
    v_cmp_u_f32 vcc, v56, v57
    v_cmp_u_f32 s[78:79], v58, v59
    s_or_b64 vcc, vcc, s[78:79]
    s_cbranch_scc0 L_p5_final_ok
    s_add_u32 s63, s63, 1
    s_cmp_lt_u32 s63, 128
    s_cbranch_scc1 L_p5_final
    s_mov_b32 s77, 0x7f817f81
    s_mov_b64 s[78:79], 0
    v_cmp_eq_u32 vcc, s77, v20
    s_or_b64 s[78:79], s[78:79], vcc
    v_cmp_eq_u32 vcc, s77, v21
    s_or_b64 s[78:79], s[78:79], vcc
    v_cmp_eq_u32 vcc, s77, v22
    s_or_b64 s[78:79], s[78:79], vcc
    v_cmp_eq_u32 vcc, s77, v23
    s_or_b64 s[78:79], s[78:79], vcc
    v_cmp_eq_u32 vcc, s77, v24
    s_or_b64 s[78:79], s[78:79], vcc
    v_cmp_eq_u32 vcc, s77, v25
    s_or_b64 s[78:79], s[78:79], vcc
    v_cmp_eq_u32 vcc, s77, v26
    s_or_b64 s[78:79], s[78:79], vcc
    v_cmp_eq_u32 vcc, s77, v27
    s_or_b64 s[78:79], s[78:79], vcc
    v_cmp_eq_u32 vcc, s77, v28
    s_or_b64 s[78:79], s[78:79], vcc
    v_cmp_eq_u32 vcc, s77, v29
    s_or_b64 s[78:79], s[78:79], vcc
    v_cmp_eq_u32 vcc, s77, v30
    s_or_b64 s[78:79], s[78:79], vcc
    v_cmp_eq_u32 vcc, s77, v31
    s_or_b64 s[78:79], s[78:79], vcc
    v_cmp_eq_u32 vcc, s77, v32
    s_or_b64 s[78:79], s[78:79], vcc
    v_cmp_eq_u32 vcc, s77, v33
    s_or_b64 s[78:79], s[78:79], vcc
    v_cmp_eq_u32 vcc, s77, v34
    s_or_b64 s[78:79], s[78:79], vcc
    v_cmp_eq_u32 vcc, s77, v35
    s_or_b64 s[78:79], s[78:79], vcc
    v_cmp_eq_u32 vcc, s77, v36
    s_or_b64 s[78:79], s[78:79], vcc
    v_cmp_eq_u32 vcc, s77, v37
    s_or_b64 s[78:79], s[78:79], vcc
    v_cmp_eq_u32 vcc, s77, v38
    s_or_b64 s[78:79], s[78:79], vcc
    v_cmp_eq_u32 vcc, s77, v39
    s_or_b64 s[78:79], s[78:79], vcc
    v_cmp_eq_u32 vcc, s77, v40
    s_or_b64 s[78:79], s[78:79], vcc
    v_cmp_eq_u32 vcc, s77, v41
    s_or_b64 s[78:79], s[78:79], vcc
    v_cmp_eq_u32 vcc, s77, v42
    s_or_b64 s[78:79], s[78:79], vcc
    v_cmp_eq_u32 vcc, s77, v43
    s_or_b64 s[78:79], s[78:79], vcc
    v_cmp_eq_u32 vcc, s77, v44
    s_or_b64 s[78:79], s[78:79], vcc
    v_cmp_eq_u32 vcc, s77, v45
    s_or_b64 s[78:79], s[78:79], vcc
    v_cmp_eq_u32 vcc, s77, v46
    s_or_b64 s[78:79], s[78:79], vcc
    v_cmp_eq_u32 vcc, s77, v47
    s_or_b64 s[78:79], s[78:79], vcc
    v_cmp_eq_u32 vcc, s77, v48
    s_or_b64 s[78:79], s[78:79], vcc
    v_cmp_eq_u32 vcc, s77, v49
    s_or_b64 s[78:79], s[78:79], vcc
    v_cmp_eq_u32 vcc, s77, v50
    s_or_b64 s[78:79], s[78:79], vcc
    v_cmp_eq_u32 vcc, s77, v51
    s_or_b64 s[78:79], s[78:79], vcc
    s_cbranch_scc1 L_p5_final
L_p5_final_ok:
    v_add_f32 v52, v248, v56
    v_add_f32 v53, v249, v57
    v_add_f32 v54, v250, v58
    v_add_f32 v55, v251, v59
    s_lshl_b32 s76, s61, 15
    v_cvt_pk_bf16_f32 v52, v52, v53
    v_cvt_pk_bf16_f32 v53, v54, v55
    buffer_store_dwordx2 v[52:53], v14, s[44:47], s76 offen
    s_waitcnt vmcnt(0)
L_p5_done:
L_end:
    s_endpgm
.section .rodata,"a"
.p2align 6
.amdhsa_kernel parallel_sum__memory_aug_recurrent_mem_tr__mixer_token_mlp__prompt_kernel
  .amdhsa_next_free_vgpr 512
  .amdhsa_next_free_sgpr 102
  .amdhsa_accum_offset 256
  .amdhsa_group_segment_fixed_size 0
  .amdhsa_kernarg_size 120
  .amdhsa_user_sgpr_count 2
  .amdhsa_user_sgpr_kernarg_segment_ptr 1
  .amdhsa_system_sgpr_workgroup_id_x 1
.end_amdhsa_kernel
```
